```python
import torch

def _softmax(x, axis=-1):
    return torch.softmax(x, dim=axis)
def _gelu(x):
    return torch.nn.functional.gelu(x, approximate="tanh")
def _silu(x):
    return torch.nn.functional.silu(x)
def _sigmoid(x):
    return torch.sigmoid(x)
def _layernorm(x, axis=-1, eps=1e-5):
    m = x.mean(dim=axis, keepdim=True)
    v = x.var(dim=axis, keepdim=True, unbiased=False)
    return (x - m) / torch.sqrt(v + eps)
def _scatter_add(tgt, idx, src, axis=0):
    return tgt.clone().index_add_(axis, idx, src)
def _segment_sum(src, seg, n):
    out = torch.zeros((n,) + src.shape[1:], dtype=src.dtype)
    return out.index_add_(0, seg, src)
def _pad(x, pw):
    flat = tuple(v for pair in reversed(pw) for v in pair)
    return torch.nn.functional.pad(x, flat)

kernel_name = 'gated_mix__ssm_conv_s4d__swiglu_ffn__prompt'

def setup_inputs():

    _w = (lambda a: (lambda t: t.to(torch.bfloat16) if t.is_floating_point() else t)(torch.as_tensor(a)))
    def _A_setup():
        Bsz, L, D, N = 1, 2048, 576, 128
        return {
            "u": _w((lambda *s: torch.randn(*s, dtype=torch.bfloat16) * 0.05)(Bsz, L, D)),
            "log_A_real": _w((lambda *s: torch.randn(*s, dtype=torch.bfloat16) * 6.4)(D, N) * 0.5),
            "A_imag": _w((lambda *s: torch.randn(*s, dtype=torch.bfloat16) * 0.05)(D, N) * 3.14),
            "C_real": _w((lambda *s: torch.randn(*s, dtype=torch.bfloat16) * 0.05)(D, N) / N ** 0.5),
            "C_imag": _w((lambda *s: torch.randn(*s, dtype=torch.bfloat16) * 0.05)(D, N) / N ** 0.5),
            "log_dt": _w((lambda *s: torch.randn(*s, dtype=torch.bfloat16) * 0.05)(D) * 0.5 - 4.0),
            "D_skip": _w((lambda *s: torch.randn(*s, dtype=torch.bfloat16) * 0.05)(D)),
        }
    _A_in = _A_setup()

    def _B_setup():
        B, S, D, F = 1, 2048, 576, 4608
        return {
            "x": _w((lambda *s: torch.randn(*s, dtype=torch.bfloat16) * 0.05)(B, S, D)),
            "w_gate": _w((lambda *s: torch.randn(*s, dtype=torch.bfloat16) * 0.05)(D, F)),
            "w_up": _w((lambda *s: torch.randn(*s, dtype=torch.bfloat16) * 0.05)(D, F)),
            "w_down": _w((lambda *s: torch.randn(*s, dtype=torch.bfloat16) * 0.05)(F, D)),
        }
    _B_in = _B_setup()

    return {
        "A_u": _A_in["u"],
        "A_log_A_real": _A_in["log_A_real"],
        "A_A_imag": _A_in["A_imag"],
        "A_C_real": _A_in["C_real"],
        "A_C_imag": _A_in["C_imag"],
        "A_log_dt": _A_in["log_dt"],
        "A_D_skip": _A_in["D_skip"],
        "B_x": _B_in["x"],
        "B_w_gate": _B_in["w_gate"],
        "B_w_up": _B_in["w_up"],
        "B_w_down": _B_in["w_down"],
        "gate_w": _w((lambda *s: torch.randn(*s, dtype=torch.bfloat16) * 0.05)(576) * 16.0),
    }

def reference(A_u, A_log_A_real, A_A_imag, A_C_real, A_C_imag, A_log_dt, A_D_skip, B_x, B_w_gate, B_w_up, B_w_down, gate_w):
    def _A_ref(u, log_A_real, A_imag, C_real, C_imag, log_dt, D_skip):
        L = u.shape[1]
        dt = torch.exp(log_dt)
        A = -torch.exp(log_A_real) + 1j * A_imag
        C = (C_real + 1j * C_imag) * dt[:, None]
        pos = (lambda x, dt: x.to(dt))(torch.arange(L), log_dt.dtype)
        P = torch.exp((A * dt[:, None])[:, :, None] * pos[None, None, :])
        K = 2.0 * torch.einsum("dn,dnl->dl", C, P).real
        L2 = 2 * L
        u_t = (lambda x, *d: x.permute(*d))(u, 0, 2, 1)
        Kf = (lambda x, *a, **k: torch.fft.rfft(x.float(), *a, **k))(K, L2)
        Uf = (lambda x, *a, **k: torch.fft.rfft(x.float(), *a, **k))(u_t, L2)
        y = (lambda x, *a, **k: torch.fft.irfft(x, *a, **k).to(torch.bfloat16))(Uf * Kf[None, :, :], L2)[:, :, :L]
        y = (lambda x, *d: x.permute(*d))(y, 0, 2, 1)
        return y + u * D_skip[None, None, :]

    def _B_ref(x, w_gate, w_up, w_down):
        g = _silu(x @ w_gate)
        u = x @ w_up
        return (g * u) @ w_down

    x = A_u
    g = _sigmoid((x * gate_w).sum(-1, keepdims=True))
    a = _A_ref(x, A_log_A_real, A_A_imag, A_C_real, A_C_imag, A_log_dt, A_D_skip)
    b = _B_ref(x, B_w_gate, B_w_up, B_w_down)
    return g * a + (1 - g) * b
```

```asm
; @launch grid=(256,1,1) block=(256,1,1) lds=163840
.amdgcn_target "amdgcn-amd-amdhsa--gfx950"
.text
.globl gated_mix__ssm_conv_s4d__swiglu_ffn__prompt_kernel
.p2align 8
.type gated_mix__ssm_conv_s4d__swiglu_ffn__prompt_kernel,@function
gated_mix__ssm_conv_s4d__swiglu_ffn__prompt_kernel:
 s_cmp_ge_u32 s2, 256
 s_cbranch_scc1 L1_end
 s_load_dwordx16 s[64:79], s[0:1], 0
 s_load_dwordx8 s[80:87], s[0:1], 64
 s_load_dwordx4 s[4:7], s[0:1], 96
 s_load_dwordx2 s[88:89], s[0:1], 112
 v_lshrrev_b32 v1, 6, v0
 v_and_b32 v0, 63, v0
 v_readfirstlane_b32 s24, v1
 s_and_b32 s12, s2, 7
 s_lshr_b32 s13, s2, 3
 s_getpc_b64 s[42:43]
L_pce:
 s_lshl_b32 s3, s13, 2
 s_add_u32 s3, s3, s24
 s_lshl_b32 s3, s3, 7
 v_and_b32 v93, 7, v0
 v_lshl_add_u32 v93, v93, 14, s3
 v_min_u32 v93, L_text_end-L_pce-4, v93
 global_load_dword v93, v93, s[42:43]
 s_cmp_ge_u32 s13, 27
 s_cbranch_scc1 L1_helper
 s_mul_i32 s14, s12, 27
 s_add_u32 s14, s14, s13
 s_mul_i32 s25, s14, 10923
 s_lshr_b32 s25, s25, 16
 s_mul_i32 s15, s25, 6
 s_sub_u32 s26, s14, s15
 s_mul_i32 s14, s26, 11
 s_mul_i32 s15, s26, 10
 s_add_u32 s15, s15, 4
 s_min_u32 s57, s14, s15
 s_mul_i32 s58, s25, 21846
 s_lshr_b32 s58, s58, 16
 s_mul_i32 s14, s58, 21846
 s_lshr_b32 s14, s14, 16
 s_mul_i32 s14, s14, 3
 s_sub_u32 s14, s58, s14
 s_lshl_b32 s27, s14, 2
 s_cmp_lt_u32 s26, 4
 s_cselect_b32 s59, 11, 10
 s_cselect_b32 s14, 8, 6
 s_min_u32 s27, s27, s14
 s_and_b32 s14, s25, 3
 s_mov_b32 s15, 2162688
 s_cmp_eq_u32 s14, 1
 s_cselect_b32 s14, 2162688, s15
 s_lshl_b32 s15, s26, 2
 s_lshr_b32 s14, s14, s15
 s_and_b32 s14, s14, 15
 s_mul_i32 s15, s12, 0
 s_add_u32 s14, s14, s15
 s_mul_i32 s15, s14, 7282
 s_lshr_b32 s15, s15, 16
 s_mul_i32 s15, s15, 9
 s_sub_u32 s14, s14, s15
 s_and_b32 s15, s24, 1
 s_mul_i32 s15, s15, 294912
 s_lshr_b32 s16, s25, 0
 s_lshl_b32 s16, s16, 0
 s_add_u32 s17, s16, s25
 s_lshl_b32 s16, s17, 7
 s_add_u32 s15, s15, s16
 s_lshl_b32 s30, s14, 7
 s_mul_i32 s16, s14, 589824
 s_add_u32 s40, s16, s15
 s_mov_b32 s52, s14
 s_mov_b32 s53, s15
 s_lshl_b32 s50, s24, 13
 s_lshl_b32 s51, s24, 12
 s_add_u32 s51, s51, 32768
 s_add_u32 s14, s27, s24
 s_sub_u32 s15, s14, s59
 s_min_u32 s14, s14, s15
 s_add_u32 s14, s14, s57
 s_mul_i32 s14, s14, 36864
 v_lshrrev_b32 v1, 4, v0
 v_and_b32 v2, 15, v0
 v_lshrrev_b32 v3, 3, v0
 v_and_b32 v4, 7, v0
 v_mul_u32_u24 v6, 1152, v3
 v_xor_b32 v7, v4, v1
 v_lshl_add_u32 v8, v7, 4, v6
 v_xor_b32 v9, 64, v8
 v_add_u32 v14, s14, v8
 v_add_u32 v15, s14, v9
 v_add_u32 v16, 16384, v14
 v_add_u32 v17, 24576, v15
 v_add_u32 v15, 8192, v15
 v_lshrrev_b32 v5, 1, v2
 v_xor_b32 v5, v5, v1
 v_lshlrev_b32 v5, 5, v5
 v_and_b32 v6, 1, v0
 v_lshl_add_u32 v5, v6, 4, v5
 v_and_b32 v6, 128, v5
 v_and_b32 v5, 127, v5
 v_lshl_or_b32 v5, v6, 0, v5
 v_mul_u32_u24 v6, 9216, v1
 v_add_u32 v10, v5, v6
 v_add_u32 v11, 35840, v10
 v_xor_b32 v5, 128, v5
 v_add_u32 v5, v5, v6
 v_add_u32 v12, 71680, v5
 v_add_u32 v13, 107520, v5
 s_waitcnt lgkmcnt(0)
 s_cmp_lt_u32 s24, 2
 s_cselect_b32 s12, s80, s82
 s_cselect_b32 s13, s81, s83
 s_mov_b32 s14, 5308416
 s_mov_b32 s15, 0x20000
 s_mov_b32 s8, s64
 s_mov_b32 s9, s65
 s_mov_b32 s10, 2359296
 s_mov_b32 s11, 0x20000
 s_add_u32 m0, s51, 0
 s_nop 0
 buffer_load_dwordx4 v14, s[8:11], s30 offen  lds
 buffer_load_dwordx4 v15, s[8:11], s30 offen offset:1024  lds
 buffer_load_dwordx4 v16, s[8:11], s30 offen offset:2048  lds
 buffer_load_dwordx4 v17, s[8:11], s30 offen offset:3072  lds
 s_add_u32 m0, s50, 0
 s_nop 0
 buffer_load_dwordx4 v10, s[12:15], s40 offen  lds
 buffer_load_dwordx4 v11, s[12:15], s40 offen offset:1024  lds
 buffer_load_dwordx4 v12, s[12:15], s40 offen offset:2048  lds
 buffer_load_dwordx4 v13, s[12:15], s40 offen offset:3072  lds
 s_add_u32 m0, s50, 4096
 s_add_u32 s40, s40, 147456
 buffer_load_dwordx4 v10, s[12:15], s40 offen  lds
 buffer_load_dwordx4 v11, s[12:15], s40 offen offset:1024  lds
 buffer_load_dwordx4 v12, s[12:15], s40 offen offset:2048  lds
 buffer_load_dwordx4 v13, s[12:15], s40 offen offset:3072  lds
 s_cmp_lt_u32 s26, 4
 s_cselect_b32 s54, 1, 2
 s_add_u32 s52, s52, s54
 s_sub_u32 s3, s52, 9
 s_min_u32 s52, s52, s3
 s_lshl_b32 s31, s52, 7
 s_mul_i32 s3, s52, 589824
 s_add_u32 s41, s3, s53
 s_add_u32 s52, s52, s54
 s_sub_u32 s3, s52, 9
 s_min_u32 s52, s52, s3
 s_lshl_b32 s32, s52, 7
 s_mul_i32 s3, s52, 589824
 s_add_u32 s42, s3, s53
 s_add_u32 s52, s52, s54
 s_sub_u32 s3, s52, 9
 s_min_u32 s52, s52, s3
 s_lshl_b32 s33, s52, 7
 s_mul_i32 s3, s52, 589824
 s_add_u32 s43, s3, s53
 s_add_u32 s52, s52, s54
 s_sub_u32 s3, s52, 9
 s_min_u32 s52, s52, s3
 s_lshl_b32 s34, s52, 7
 s_mul_i32 s3, s52, 589824
 s_add_u32 s44, s3, s53
 s_add_u32 s52, s52, s54
 s_sub_u32 s3, s52, 9
 s_min_u32 s52, s52, s3
 s_lshl_b32 s35, s52, 7
 s_mul_i32 s3, s52, 589824
 s_add_u32 s45, s3, s53
 s_add_u32 s52, s52, s54
 s_sub_u32 s3, s52, 9
 s_min_u32 s52, s52, s3
 s_lshl_b32 s36, s52, 7
 s_mul_i32 s3, s52, 589824
 s_add_u32 s46, s3, s53
 s_add_u32 s52, s52, s54
 s_sub_u32 s3, s52, 9
 s_min_u32 s52, s52, s3
 s_lshl_b32 s37, s52, 7
 s_mul_i32 s3, s52, 589824
 s_add_u32 s47, s3, s53
 s_add_u32 s52, s52, s54
 s_sub_u32 s3, s52, 9
 s_min_u32 s52, s52, s3
 s_lshl_b32 s38, s52, 7
 s_mul_i32 s3, s52, 589824
 s_add_u32 s48, s3, s53
 s_mov_b32 s55, s17
 s_mov_b32 s16, s88
 s_mov_b32 s17, s89
 s_mov_b32 s18, 268435456
 s_mov_b32 s19, 0x20000
 s_mov_b32 s20, s84
 s_mov_b32 s21, s85
 s_mov_b32 s22, 5308416
 s_mov_b32 s23, 0x20000
 s_and_b32 s80, s24, 1
 s_mov_b32 s52, 147456
 s_add_u32 s53, s57, s27
 s_mul_i32 s53, s53, 294912
 s_lshl_b32 s3, s25, 2
 s_add_u32 s3, s3, s24
 s_lshl_b32 s3, s3, 10
 s_add_u32 s53, s53, s3
 s_add_u32 s53, s53, 1048576
 s_mov_b32 s54, 0xbfb8aa3b
 s_add_u32 s3, s27, 4
 s_sub_u32 s81, s3, s59
 s_min_u32 s3, s3, s81
 s_add_u32 s3, s3, s57
 s_mul_i32 s3, s3, 36864
 s_mul_i32 s81, s24, 9216
 s_add_u32 s3, s3, s81
 s_lshl_b32 s80, s80, 6
 v_xor_b32 v18, s80, v8
 v_add_u32 v18, s3, v18
 v_lshlrev_b32 v19, 4, v0
 v_lshrrev_b32 v5, 1, v2
 v_xor_b32 v5, v5, v1
 v_lshlrev_b32 v5, 4, v5
 v_lshl_add_u32 v20, v2, 7, v5
 v_xor_b32 v21, 64, v20
 v_add_u32 v22, 49152, v20
 v_add_u32 v23, 49152, v21
 v_add_u32 v24, 98304, v20
 v_add_u32 v25, 98304, v21
 v_lshrrev_b32 v5, 2, v2
 v_and_b32 v6, 1, v1
 v_lshl_or_b32 v6, v6, 2, v5
 v_lshrrev_b32 v7, 1, v6
 v_xor_b32 v7, s24, v7
 v_lshlrev_b32 v7, 5, v7
 v_lshl_add_u32 v7, v6, 7, v7
 v_and_b32 v27, 3, v0
 v_lshl_add_u32 v7, v27, 3, v7
 v_lshrrev_b32 v28, 1, v1
 v_lshl_add_u32 v8, v28, 10, v7
 v_add_u32 v9, 147456, v8
 v_add_u32 v8, 36864, v8
 v_lshlrev_b32 v28, 1, v1
 v_xor_b32 v28, v28, v4
 v_mul_u32_u24 v7, 1152, v3
 v_lshl_add_u32 v7, v28, 4, v7
 s_lshl_b32 s3, s24, 1
 v_xor_b32 v6, s3, v6
 v_lshlrev_b32 v6, 5, v6
 v_lshl_add_u32 v5, v1, 3, v5
 v_lshl_add_u32 v6, v5, 8, v6
 v_lshl_add_u32 v26, v27, 3, v6
 v_xor_b32 v27, 32, v26
 v_add_u32 v28, 49152, v26
 v_add_u32 v29, 49152, v27
 v_add_u32 v30, 98304, v26
 v_add_u32 v31, 98304, v27
 v_and_b32 v5, 8, v2
 v_lshlrev_b32 v5, 10, v5
 s_cmp_eq_u32 s24, 0
 s_cselect_b32 s3, 2, 0
 v_lshlrev_b32 v1, 7, v0
 v_mov_b32 v2, 1073741824
 v_cmp_gt_u32 vcc, s3, v0
 s_nop 1
 v_cndmask_b32 v1, v2, v1, vcc
 v_mov_b32 v2, 1
 s_add_u32 m0, s51, 49152
 s_nop 0
 buffer_load_dwordx4 v14, s[8:11], s31 offen  lds
 buffer_load_dwordx4 v15, s[8:11], s31 offen offset:1024  lds
 buffer_load_dwordx4 v16, s[8:11], s31 offen offset:2048  lds
 buffer_load_dwordx4 v17, s[8:11], s31 offen offset:3072  lds
 s_mov_b64 vcc, -1
 s_cmp_ge_u32 s26, 4
 s_cbranch_scc1 Lwarm_t
 s_cmp_lg_u32 s24, 0
 s_cbranch_scc1 Lhb0
 s_call_b64 s[22:23], Lpg3
 s_call_b64 s[22:23], Lpg7
 s_branch Lhbe
Lhb0:
 s_cmp_lg_u32 s24, 1
 s_cbranch_scc1 Lhb1
 s_call_b64 s[22:23], Lpg4
 s_call_b64 s[22:23], Lpg8
 s_branch Lhbe
Lhb1:
 s_cmp_lg_u32 s24, 2
 s_cbranch_scc1 Lhb2
 s_call_b64 s[22:23], Lpg1
 s_call_b64 s[22:23], Lpg5
 s_branch Lhbe
Lhb2:
 s_call_b64 s[22:23], Lpg2
 s_call_b64 s[22:23], Lpg6
Lhbe:
 s_branch Lwarm_end
Lwarm_t:
 s_cmp_lg_u32 s24, 0
 s_cbranch_scc1 Lhc0
 s_call_b64 s[22:23], Lpg9
 s_call_b64 s[22:23], Lpg13
 s_branch Lhce
Lhc0:
 s_cmp_lg_u32 s24, 1
 s_cbranch_scc1 Lhc1
 s_call_b64 s[22:23], Lpg10
 s_call_b64 s[22:23], Lpg14
 s_branch Lhce
Lhc1:
 s_cmp_lg_u32 s24, 2
 s_cbranch_scc1 Lhc2
 s_call_b64 s[22:23], Lpg1
 s_call_b64 s[22:23], Lpg11
 s_call_b64 s[22:23], Lpg15
 s_branch Lhce
Lhc2:
 s_call_b64 s[22:23], Lj_L1_g10
 s_call_b64 s[22:23], Lpg12
Lhce:
 s_branch Lwarm_end
.p2align 12
Lwarm_end:
 s_mov_b64 vcc, 0
 s_mov_b32 s22, 5308416
 s_mov_b32 s23, 0x20000
 s_add_u32 m0, s50, 49152
 s_nop 0
 buffer_load_dwordx4 v10, s[12:15], s41 offen  lds
 buffer_load_dwordx4 v11, s[12:15], s41 offen offset:1024  lds
 buffer_load_dwordx4 v12, s[12:15], s41 offen offset:2048  lds
 buffer_load_dwordx4 v13, s[12:15], s41 offen offset:3072  lds
 s_add_u32 m0, s50, 53248
 s_add_u32 s41, s41, 147456
 buffer_load_dwordx4 v10, s[12:15], s41 offen  lds
 buffer_load_dwordx4 v11, s[12:15], s41 offen offset:1024  lds
 buffer_load_dwordx4 v12, s[12:15], s41 offen offset:2048  lds
 buffer_load_dwordx4 v13, s[12:15], s41 offen offset:3072  lds
 s_waitcnt vmcnt(12)
 s_barrier
 ds_read_b128 v[32:35], v20 offset:32768
 ds_read_b128 v[36:39], v21 offset:32768
 ds_read_b64_tr_b16 a[0:1], v26 offset:0
 ds_read_b64_tr_b16 a[2:3], v26 offset:1024
 ds_read_b64_tr_b16 a[4:5], v26 offset:8192
 ds_read_b64_tr_b16 a[6:7], v26 offset:9216
 ds_read_b64_tr_b16 a[144:145], v26 offset:16384
 ds_read_b64_tr_b16 a[146:147], v26 offset:17408
 ds_read_b64_tr_b16 a[148:149], v26 offset:24576
 ds_read_b64_tr_b16 a[150:151], v26 offset:25600
 ds_read_b64_tr_b16 a[72:73], v27 offset:0
 ds_read_b64_tr_b16 a[74:75], v27 offset:1024
 ds_read_b64_tr_b16 a[76:77], v27 offset:8192
 ds_read_b64_tr_b16 a[78:79], v27 offset:9216
 ds_read_b64_tr_b16 a[216:217], v27 offset:16384
 ds_read_b64_tr_b16 a[218:219], v27 offset:17408
 ds_read_b64_tr_b16 a[220:221], v27 offset:24576
 ds_read_b64_tr_b16 a[222:223], v27 offset:25600
 ds_read_b128 v[40:43], v20 offset:34816
 ds_read_b128 v[44:47], v21 offset:34816
 s_add_u32 m0, s51, 98304
 ds_read_b128 v[48:51], v20 offset:36864
 ds_read_b128 v[52:55], v21 offset:36864
 buffer_load_dwordx4 v14, s[8:11], s32 offen  lds
 s_waitcnt lgkmcnt(4)
 v_mfma_f32_16x16x32_bf16 v[96:99], a[0:3], v[32:35], 0
 ds_read_b128 v[56:59], v20 offset:38912
 v_mfma_f32_16x16x32_bf16 v[96:99], a[4:7], v[36:39], v[96:99]
 buffer_load_dwordx4 v15, s[8:11], s32 offen offset:1024  lds
 v_mfma_f32_16x16x32_bf16 v[100:103], a[144:147], v[32:35], 0
 v_mfma_f32_16x16x32_bf16 v[100:103], a[148:151], v[36:39], v[100:103]
 buffer_load_dwordx4 v16, s[8:11], s32 offen offset:2048  lds
 v_mfma_f32_16x16x32_bf16 v[104:107], a[72:75], v[32:35], 0
 ds_read_b128 v[60:63], v21 offset:38912
 v_mfma_f32_16x16x32_bf16 v[104:107], a[76:79], v[36:39], v[104:107]
 buffer_load_dwordx4 v17, s[8:11], s32 offen offset:3072  lds
 s_add_u32 m0, s50, 98304
 v_mfma_f32_16x16x32_bf16 v[108:111], a[216:219], v[32:35], 0
 v_mfma_f32_16x16x32_bf16 v[108:111], a[220:223], v[36:39], v[108:111]
 s_waitcnt lgkmcnt(2)
 v_mfma_f32_16x16x32_bf16 v[112:115], a[0:3], v[40:43], 0
 ds_read_b128 v[32:35], v20 offset:40960
 v_mfma_f32_16x16x32_bf16 v[112:115], a[4:7], v[44:47], v[112:115]
 buffer_load_dwordx4 v10, s[12:15], s42 offen  lds
 v_mfma_f32_16x16x32_bf16 v[116:119], a[144:147], v[40:43], 0
 v_mfma_f32_16x16x32_bf16 v[116:119], a[148:151], v[44:47], v[116:119]
 buffer_load_dwordx4 v11, s[12:15], s42 offen offset:1024  lds
 v_mfma_f32_16x16x32_bf16 v[120:123], a[72:75], v[40:43], 0
 ds_read_b128 v[36:39], v21 offset:40960
 v_mfma_f32_16x16x32_bf16 v[120:123], a[76:79], v[44:47], v[120:123]
 buffer_load_dwordx4 v12, s[12:15], s42 offen offset:2048  lds
 v_mfma_f32_16x16x32_bf16 v[124:127], a[216:219], v[40:43], 0
 v_mfma_f32_16x16x32_bf16 v[124:127], a[220:223], v[44:47], v[124:127]
 buffer_load_dwordx4 v13, s[12:15], s42 offen offset:3072  lds
 s_add_u32 m0, s50, 102400
 v_mfma_f32_16x16x32_bf16 v[128:131], a[0:3], v[48:51], 0
 ds_read_b128 v[40:43], v20 offset:43008
 s_add_u32 s42, s42, 147456
 v_mfma_f32_16x16x32_bf16 v[128:131], a[4:7], v[52:55], v[128:131]
 buffer_load_dwordx4 v10, s[12:15], s42 offen  lds
 v_mfma_f32_16x16x32_bf16 v[132:135], a[144:147], v[48:51], 0
 v_mfma_f32_16x16x32_bf16 v[132:135], a[148:151], v[52:55], v[132:135]
 buffer_load_dwordx4 v11, s[12:15], s42 offen offset:1024  lds
 v_mfma_f32_16x16x32_bf16 v[136:139], a[72:75], v[48:51], 0
 ds_read_b128 v[44:47], v21 offset:43008
 v_mfma_f32_16x16x32_bf16 v[136:139], a[76:79], v[52:55], v[136:139]
 buffer_load_dwordx4 v12, s[12:15], s42 offen offset:2048  lds
 v_mfma_f32_16x16x32_bf16 v[140:143], a[216:219], v[48:51], 0
 v_mfma_f32_16x16x32_bf16 v[140:143], a[220:223], v[52:55], v[140:143]
 s_waitcnt lgkmcnt(2)
 v_mfma_f32_16x16x32_bf16 v[144:147], a[0:3], v[56:59], 0
 ds_read_b128 v[48:51], v20 offset:45056
 v_mfma_f32_16x16x32_bf16 v[144:147], a[4:7], v[60:63], v[144:147]
 buffer_load_dwordx4 v13, s[12:15], s42 offen offset:3072  lds
 v_mfma_f32_16x16x32_bf16 v[148:151], a[144:147], v[56:59], 0
 v_mfma_f32_16x16x32_bf16 v[148:151], a[148:151], v[60:63], v[148:151]
 v_mfma_f32_16x16x32_bf16 v[152:155], a[72:75], v[56:59], 0
 ds_read_b128 v[52:55], v21 offset:45056
 v_mfma_f32_16x16x32_bf16 v[152:155], a[76:79], v[60:63], v[152:155]
 v_mfma_f32_16x16x32_bf16 v[156:159], a[216:219], v[56:59], 0
 v_mfma_f32_16x16x32_bf16 v[156:159], a[220:223], v[60:63], v[156:159]
 v_mfma_f32_16x16x32_bf16 v[160:163], a[0:3], v[32:35], 0
 ds_read_b128 v[56:59], v20 offset:47104
 v_mfma_f32_16x16x32_bf16 v[160:163], a[4:7], v[36:39], v[160:163]
 v_mfma_f32_16x16x32_bf16 v[164:167], a[144:147], v[32:35], 0
 v_mfma_f32_16x16x32_bf16 v[164:167], a[148:151], v[36:39], v[164:167]
 v_mfma_f32_16x16x32_bf16 v[168:171], a[72:75], v[32:35], 0
 ds_read_b128 v[60:63], v21 offset:47104
 v_mfma_f32_16x16x32_bf16 v[168:171], a[76:79], v[36:39], v[168:171]
 v_mfma_f32_16x16x32_bf16 v[172:175], a[216:219], v[32:35], 0
 v_mfma_f32_16x16x32_bf16 v[172:175], a[220:223], v[36:39], v[172:175]
 s_waitcnt lgkmcnt(2)
 v_mfma_f32_16x16x32_bf16 v[176:179], a[0:3], v[40:43], 0
 v_mfma_f32_16x16x32_bf16 v[176:179], a[4:7], v[44:47], v[176:179]
 v_mfma_f32_16x16x32_bf16 v[180:183], a[144:147], v[40:43], 0
 v_mfma_f32_16x16x32_bf16 v[180:183], a[148:151], v[44:47], v[180:183]
 v_mfma_f32_16x16x32_bf16 v[184:187], a[72:75], v[40:43], 0
 v_mfma_f32_16x16x32_bf16 v[184:187], a[76:79], v[44:47], v[184:187]
 v_mfma_f32_16x16x32_bf16 v[188:191], a[216:219], v[40:43], 0
 s_waitcnt vmcnt(12) lgkmcnt(0)
 s_barrier
 v_mfma_f32_16x16x32_bf16 v[188:191], a[220:223], v[44:47], v[188:191]
 ds_read_b128 v[32:35], v22 offset:32768
 v_mfma_f32_16x16x32_bf16 v[192:195], a[0:3], v[48:51], 0
 ds_read_b128 v[36:39], v23 offset:32768
 ds_read_b64_tr_b16 a[8:9], v28 offset:0
 v_mfma_f32_16x16x32_bf16 v[192:195], a[4:7], v[52:55], v[192:195]
 ds_read_b64_tr_b16 a[10:11], v28 offset:1024
 ds_read_b64_tr_b16 a[12:13], v28 offset:8192
 v_mfma_f32_16x16x32_bf16 v[196:199], a[144:147], v[48:51], 0
 ds_read_b64_tr_b16 a[14:15], v28 offset:9216
 ds_read_b64_tr_b16 a[152:153], v28 offset:16384
 v_mfma_f32_16x16x32_bf16 v[196:199], a[148:151], v[52:55], v[196:199]
 ds_read_b64_tr_b16 a[154:155], v28 offset:17408
 ds_read_b64_tr_b16 a[156:157], v28 offset:24576
 v_mfma_f32_16x16x32_bf16 v[200:203], a[72:75], v[48:51], 0
 ds_read_b64_tr_b16 a[158:159], v28 offset:25600
 ds_read_b64_tr_b16 a[80:81], v29 offset:0
 v_mfma_f32_16x16x32_bf16 v[200:203], a[76:79], v[52:55], v[200:203]
 ds_read_b64_tr_b16 a[82:83], v29 offset:1024
 ds_read_b64_tr_b16 a[84:85], v29 offset:8192
 v_mfma_f32_16x16x32_bf16 v[204:207], a[216:219], v[48:51], 0
 ds_read_b64_tr_b16 a[86:87], v29 offset:9216
 ds_read_b64_tr_b16 a[224:225], v29 offset:16384
 v_mfma_f32_16x16x32_bf16 v[204:207], a[220:223], v[52:55], v[204:207]
 ds_read_b64_tr_b16 a[226:227], v29 offset:17408
 ds_read_b64_tr_b16 a[228:229], v29 offset:24576
 s_waitcnt lgkmcnt(15)
 v_mfma_f32_16x16x32_bf16 v[208:211], a[0:3], v[56:59], 0
 ds_read_b64_tr_b16 a[230:231], v29 offset:25600
 v_mfma_f32_16x16x32_bf16 v[208:211], a[4:7], v[60:63], v[208:211]
 ds_read_b128 v[40:43], v22 offset:34816
 v_mfma_f32_16x16x32_bf16 v[212:215], a[144:147], v[56:59], 0
 ds_read_b128 v[44:47], v23 offset:34816
 s_add_u32 m0, s51, 0
 v_mfma_f32_16x16x32_bf16 v[212:215], a[148:151], v[60:63], v[212:215]
 ds_read_b128 v[48:51], v22 offset:36864
 v_mfma_f32_16x16x32_bf16 v[216:219], a[72:75], v[56:59], 0
 ds_read_b128 v[52:55], v23 offset:36864
 v_mfma_f32_16x16x32_bf16 v[216:219], a[76:79], v[60:63], v[216:219]
 buffer_load_dwordx4 v14, s[8:11], s33 offen  lds
 v_mfma_f32_16x16x32_bf16 v[220:223], a[216:219], v[56:59], 0
 v_mfma_f32_16x16x32_bf16 v[220:223], a[220:223], v[60:63], v[220:223]
 s_waitcnt lgkmcnt(4)
 v_mfma_f32_16x16x32_bf16 v[96:99], a[8:11], v[32:35], v[96:99]
 ds_read_b128 v[56:59], v22 offset:38912
 s_mul_i32 s80, s58, 21846
 v_mfma_f32_16x16x32_bf16 v[96:99], a[12:15], v[36:39], v[96:99]
 buffer_load_dwordx4 v15, s[8:11], s33 offen offset:1024  lds
 s_lshr_b32 s80, s80, 16
 v_mfma_f32_16x16x32_bf16 v[100:103], a[152:155], v[32:35], v[100:103]
 v_mfma_f32_16x16x32_bf16 v[100:103], a[156:159], v[36:39], v[100:103]
 s_mul_i32 s3, s80, 9
 v_mfma_f32_16x16x32_bf16 v[104:107], a[80:83], v[32:35], v[104:107]
 ds_read_b128 v[60:63], v23 offset:38912
 v_mfma_f32_16x16x32_bf16 v[104:107], a[84:87], v[36:39], v[104:107]
 buffer_load_dwordx4 v16, s[8:11], s33 offen offset:2048  lds
 s_sub_u32 s3, s25, s3
 v_mfma_f32_16x16x32_bf16 v[108:111], a[224:227], v[32:35], v[108:111]
 v_mfma_f32_16x16x32_bf16 v[108:111], a[228:231], v[36:39], v[108:111]
 s_waitcnt lgkmcnt(2)
 s_lshl_b32 s80, s80, 2
 v_mfma_f32_16x16x32_bf16 v[112:115], a[8:11], v[40:43], v[112:115]
 ds_read_b128 v[32:35], v22 offset:40960
 s_add_u32 s80, s80, s26
 v_mfma_f32_16x16x32_bf16 v[112:115], a[12:15], v[44:47], v[112:115]
 buffer_load_dwordx4 v17, s[8:11], s33 offen offset:3072  lds
 s_add_u32 m0, s50, 0
 v_mfma_f32_16x16x32_bf16 v[116:119], a[152:155], v[40:43], v[116:119]
 s_sub_u32 s80, s80, 0
 v_mfma_f32_16x16x32_bf16 v[116:119], a[156:159], v[44:47], v[116:119]
 v_mfma_f32_16x16x32_bf16 v[120:123], a[80:83], v[40:43], v[120:123]
 ds_read_b128 v[36:39], v23 offset:40960
 s_lshl_b32 s80, s80, 8
 v_mfma_f32_16x16x32_bf16 v[120:123], a[84:87], v[44:47], v[120:123]
 buffer_load_dwordx4 v10, s[12:15], s43 offen  lds
 v_mfma_f32_16x16x32_bf16 v[124:127], a[224:227], v[40:43], v[124:127]
 s_add_u32 s59, s80, s3
 v_mfma_f32_16x16x32_bf16 v[124:127], a[228:231], v[44:47], v[124:127]
 s_add_u32 s59, s59, 40964096
 v_mfma_f32_16x16x32_bf16 v[128:131], a[8:11], v[48:51], v[128:131]
 ds_read_b128 v[40:43], v22 offset:43008
 v_mfma_f32_16x16x32_bf16 v[128:131], a[12:15], v[52:55], v[128:131]
 buffer_load_dwordx4 v11, s[12:15], s43 offen offset:1024  lds
 s_mul_i32 s3, s58, 3
 v_mfma_f32_16x16x32_bf16 v[132:135], a[152:155], v[48:51], v[132:135]
 v_mfma_f32_16x16x32_bf16 v[132:135], a[156:159], v[52:55], v[132:135]
 s_sub_u32 s3, s25, s3
 v_mfma_f32_16x16x32_bf16 v[136:139], a[80:83], v[48:51], v[136:139]
 ds_read_b128 v[44:47], v23 offset:43008
 v_mfma_f32_16x16x32_bf16 v[136:139], a[84:87], v[52:55], v[136:139]
 buffer_load_dwordx4 v12, s[12:15], s43 offen offset:2048  lds
 s_mul_i32 s80, s58, 6
 v_mfma_f32_16x16x32_bf16 v[140:143], a[224:227], v[48:51], v[140:143]
 s_add_u32 s80, s80, s26
 v_mfma_f32_16x16x32_bf16 v[140:143], a[228:231], v[52:55], v[140:143]
 s_waitcnt lgkmcnt(2)
 v_mfma_f32_16x16x32_bf16 v[144:147], a[8:11], v[56:59], v[144:147]
 ds_read_b128 v[48:51], v22 offset:45056
 s_lshl_b32 s80, s80, 8
 v_mfma_f32_16x16x32_bf16 v[144:147], a[12:15], v[60:63], v[144:147]
 buffer_load_dwordx4 v13, s[12:15], s43 offen offset:3072  lds
 s_add_u32 m0, s50, 4096
 v_mfma_f32_16x16x32_bf16 v[148:151], a[152:155], v[56:59], v[148:151]
 s_add_u32 s43, s43, 147456
 s_add_u32 s80, s80, s3
 v_mfma_f32_16x16x32_bf16 v[148:151], a[156:159], v[60:63], v[148:151]
 v_mfma_f32_16x16x32_bf16 v[152:155], a[80:83], v[56:59], v[152:155]
 ds_read_b128 v[52:55], v23 offset:45056
 s_lshl_b32 s58, s25, 2
 v_mfma_f32_16x16x32_bf16 v[152:155], a[84:87], v[60:63], v[152:155]
 buffer_load_dwordx4 v10, s[12:15], s43 offen  lds
 s_add_u32 s58, s58, s26
 v_mfma_f32_16x16x32_bf16 v[156:159], a[224:227], v[56:59], v[156:159]
 v_mfma_f32_16x16x32_bf16 v[156:159], a[228:231], v[60:63], v[156:159]
 s_sub_u32 s58, s58, 0
 v_mfma_f32_16x16x32_bf16 v[160:163], a[8:11], v[32:35], v[160:163]
 ds_read_b128 v[56:59], v22 offset:47104
 v_mfma_f32_16x16x32_bf16 v[160:163], a[12:15], v[36:39], v[160:163]
 buffer_load_dwordx4 v11, s[12:15], s43 offen offset:1024  lds
 s_mul_i32 s58, s58, 36864
 v_mfma_f32_16x16x32_bf16 v[164:167], a[152:155], v[32:35], v[164:167]
 v_mfma_f32_16x16x32_bf16 v[164:167], a[156:159], v[36:39], v[164:167]
 s_add_u32 s57, s58, s81
 v_mfma_f32_16x16x32_bf16 v[168:171], a[80:83], v[32:35], v[168:171]
 ds_read_b128 v[60:63], v23 offset:47104
 s_lshl_b32 s3, s24, 10
 v_mfma_f32_16x16x32_bf16 v[168:171], a[84:87], v[36:39], v[168:171]
 buffer_load_dwordx4 v12, s[12:15], s43 offen offset:2048  lds
 v_mfma_f32_16x16x32_bf16 v[172:175], a[224:227], v[32:35], v[172:175]
 s_add_u32 s58, s58, s3
 v_mfma_f32_16x16x32_bf16 v[172:175], a[228:231], v[36:39], v[172:175]
 s_waitcnt lgkmcnt(2)
 v_mfma_f32_16x16x32_bf16 v[176:179], a[8:11], v[40:43], v[176:179]
 buffer_load_dwordx4 v13, s[12:15], s43 offen offset:3072  lds
 s_add_u32 s58, s58, 20971520
 v_mfma_f32_16x16x32_bf16 v[176:179], a[12:15], v[44:47], v[176:179]
 v_mfma_f32_16x16x32_bf16 v[180:183], a[152:155], v[40:43], v[180:183]
 s_add_u32 s25, s80, 40968192
 v_mfma_f32_16x16x32_bf16 v[180:183], a[156:159], v[44:47], v[180:183]
 s_and_b32 s3, s2, 7
 v_mfma_f32_16x16x32_bf16 v[184:187], a[80:83], v[40:43], v[184:187]
 v_mfma_f32_16x16x32_bf16 v[184:187], a[84:87], v[44:47], v[184:187]
 s_lshr_b32 s49, s3, 1
 v_mfma_f32_16x16x32_bf16 v[188:191], a[224:227], v[40:43], v[188:191]
 s_waitcnt vmcnt(12) lgkmcnt(0)
 s_barrier
 v_mfma_f32_16x16x32_bf16 v[188:191], a[228:231], v[44:47], v[188:191]
 ds_read_b128 v[32:35], v24 offset:32768
 s_and_b32 s3, s3, 1
 v_mfma_f32_16x16x32_bf16 v[192:195], a[8:11], v[48:51], v[192:195]
 ds_read_b128 v[36:39], v25 offset:32768
 ds_read_b64_tr_b16 a[16:17], v30 offset:0
 v_mfma_f32_16x16x32_bf16 v[192:195], a[12:15], v[52:55], v[192:195]
 ds_read_b64_tr_b16 a[18:19], v30 offset:1024
 ds_read_b64_tr_b16 a[20:21], v30 offset:8192
 v_mfma_f32_16x16x32_bf16 v[196:199], a[152:155], v[48:51], v[196:199]
 ds_read_b64_tr_b16 a[22:23], v30 offset:9216
 ds_read_b64_tr_b16 a[160:161], v30 offset:16384
 v_mfma_f32_16x16x32_bf16 v[196:199], a[156:159], v[52:55], v[196:199]
 ds_read_b64_tr_b16 a[162:163], v30 offset:17408
 ds_read_b64_tr_b16 a[164:165], v30 offset:24576
 v_mfma_f32_16x16x32_bf16 v[200:203], a[80:83], v[48:51], v[200:203]
 ds_read_b64_tr_b16 a[166:167], v30 offset:25600
 ds_read_b64_tr_b16 a[88:89], v31 offset:0
 v_mfma_f32_16x16x32_bf16 v[200:203], a[84:87], v[52:55], v[200:203]
 ds_read_b64_tr_b16 a[90:91], v31 offset:1024
 ds_read_b64_tr_b16 a[92:93], v31 offset:8192
 v_mfma_f32_16x16x32_bf16 v[204:207], a[224:227], v[48:51], v[204:207]
 ds_read_b64_tr_b16 a[94:95], v31 offset:9216
 ds_read_b64_tr_b16 a[232:233], v31 offset:16384
 v_mfma_f32_16x16x32_bf16 v[204:207], a[228:231], v[52:55], v[204:207]
 ds_read_b64_tr_b16 a[234:235], v31 offset:17408
 ds_read_b64_tr_b16 a[236:237], v31 offset:24576
 s_waitcnt lgkmcnt(15)
 v_mfma_f32_16x16x32_bf16 v[208:211], a[8:11], v[56:59], v[208:211]
 ds_read_b64_tr_b16 a[238:239], v31 offset:25600
 s_lshl_b32 s3, s3, 3
 v_mfma_f32_16x16x32_bf16 v[208:211], a[12:15], v[60:63], v[208:211]
 ds_read_b128 v[40:43], v24 offset:34816
 s_lshr_b32 s80, s2, 5
 v_mfma_f32_16x16x32_bf16 v[212:215], a[152:155], v[56:59], v[212:215]
 ds_read_b128 v[44:47], v25 offset:34816
 s_add_u32 m0, s51, 49152
 v_mfma_f32_16x16x32_bf16 v[212:215], a[156:159], v[60:63], v[212:215]
 ds_read_b128 v[48:51], v24 offset:36864
 s_add_u32 s80, s80, s3
 v_mfma_f32_16x16x32_bf16 v[216:219], a[80:83], v[56:59], v[216:219]
 ds_read_b128 v[52:55], v25 offset:36864
 s_lshr_b32 s3, s2, 3
 v_mfma_f32_16x16x32_bf16 v[216:219], a[84:87], v[60:63], v[216:219]
 buffer_load_dwordx4 v14, s[8:11], s34 offen  lds
 s_and_b32 s60, s3, 3
 v_mfma_f32_16x16x32_bf16 v[220:223], a[224:227], v[56:59], v[220:223]
 s_lshl_b32 s61, s80, 2
 s_add_u32 s61, s61, s60
 s_sub_u32 s81, s80, 11
 v_mfma_f32_16x16x32_bf16 v[220:223], a[228:231], v[60:63], v[220:223]
 s_waitcnt lgkmcnt(4)
 s_lshl_b32 s81, s81, 1
 v_mfma_f32_16x16x32_bf16 v[96:99], a[16:19], v[32:35], v[96:99]
 ds_read_b128 v[56:59], v24 offset:38912
 s_mul_i32 s28, s24, 11
 v_mfma_f32_16x16x32_bf16 v[96:99], a[20:23], v[36:39], v[96:99]
 buffer_load_dwordx4 v15, s[8:11], s34 offen offset:1024  lds
 v_mfma_f32_16x16x32_bf16 v[100:103], a[160:163], v[32:35], v[100:103]
 s_add_u32 s28, s28, s80
 v_mfma_f32_16x16x32_bf16 v[100:103], a[164:167], v[36:39], v[100:103]
 v_mfma_f32_16x16x32_bf16 v[104:107], a[88:91], v[32:35], v[104:107]
 ds_read_b128 v[60:63], v25 offset:38912
 s_lshr_b32 s3, s24, 1
 v_mfma_f32_16x16x32_bf16 v[104:107], a[92:95], v[36:39], v[104:107]
 buffer_load_dwordx4 v16, s[8:11], s34 offen offset:2048  lds
 v_mfma_f32_16x16x32_bf16 v[108:111], a[232:235], v[32:35], v[108:111]
 s_mul_i32 s3, s3, 10
 v_mfma_f32_16x16x32_bf16 v[108:111], a[236:239], v[36:39], v[108:111]
 s_waitcnt lgkmcnt(2)
 s_and_b32 s82, s24, 1
 v_mfma_f32_16x16x32_bf16 v[112:115], a[16:19], v[40:43], v[112:115]
 ds_read_b128 v[32:35], v24 offset:40960
 v_mfma_f32_16x16x32_bf16 v[112:115], a[20:23], v[44:47], v[112:115]
 buffer_load_dwordx4 v17, s[8:11], s34 offen offset:3072  lds
 s_add_u32 m0, s50, 49152
 v_mfma_f32_16x16x32_bf16 v[116:119], a[160:163], v[40:43], v[116:119]
 s_add_u32 s3, s3, s82
 v_mfma_f32_16x16x32_bf16 v[116:119], a[164:167], v[44:47], v[116:119]
 s_add_u32 s3, s3, s81
 v_mfma_f32_16x16x32_bf16 v[120:123], a[88:91], v[40:43], v[120:123]
 ds_read_b128 v[36:39], v25 offset:40960
 v_mfma_f32_16x16x32_bf16 v[120:123], a[92:95], v[44:47], v[120:123]
 buffer_load_dwordx4 v10, s[12:15], s44 offen  lds
 s_add_u32 s3, s3, 44
 v_mfma_f32_16x16x32_bf16 v[124:127], a[232:235], v[40:43], v[124:127]
 s_cmp_lt_u32 s80, 11
 s_cselect_b32 s28, s28, s3
 v_mfma_f32_16x16x32_bf16 v[124:127], a[236:239], v[44:47], v[124:127]
 v_mfma_f32_16x16x32_bf16 v[128:131], a[16:19], v[48:51], v[128:131]
 ds_read_b128 v[40:43], v24 offset:43008
 s_mul_i32 s39, s49, 11
 v_mfma_f32_16x16x32_bf16 v[128:131], a[20:23], v[52:55], v[128:131]
 buffer_load_dwordx4 v11, s[12:15], s44 offen offset:1024  lds
 v_mfma_f32_16x16x32_bf16 v[132:135], a[160:163], v[48:51], v[132:135]
 s_add_u32 s39, s39, s80
 v_mfma_f32_16x16x32_bf16 v[132:135], a[164:167], v[52:55], v[132:135]
 v_mfma_f32_16x16x32_bf16 v[136:139], a[88:91], v[48:51], v[136:139]
 ds_read_b128 v[44:47], v25 offset:43008
 s_lshr_b32 s3, s49, 1
 v_mfma_f32_16x16x32_bf16 v[136:139], a[92:95], v[52:55], v[136:139]
 buffer_load_dwordx4 v12, s[12:15], s44 offen offset:2048  lds
 s_mul_i32 s3, s3, 10
 v_mfma_f32_16x16x32_bf16 v[140:143], a[232:235], v[48:51], v[140:143]
 v_mfma_f32_16x16x32_bf16 v[140:143], a[236:239], v[52:55], v[140:143]
 s_waitcnt lgkmcnt(2)
 s_and_b32 s82, s49, 1
 v_mfma_f32_16x16x32_bf16 v[144:147], a[16:19], v[56:59], v[144:147]
 ds_read_b128 v[48:51], v24 offset:45056
 v_mfma_f32_16x16x32_bf16 v[144:147], a[20:23], v[60:63], v[144:147]
 buffer_load_dwordx4 v13, s[12:15], s44 offen offset:3072  lds
 s_add_u32 m0, s50, 53248
 v_mfma_f32_16x16x32_bf16 v[148:151], a[160:163], v[56:59], v[148:151]
 s_add_u32 s44, s44, 147456
 s_add_u32 s3, s3, s82
 v_mfma_f32_16x16x32_bf16 v[148:151], a[164:167], v[60:63], v[148:151]
 s_add_u32 s3, s3, s81
 v_mfma_f32_16x16x32_bf16 v[152:155], a[88:91], v[56:59], v[152:155]
 ds_read_b128 v[52:55], v25 offset:45056
 s_add_u32 s3, s3, 44
 v_mfma_f32_16x16x32_bf16 v[152:155], a[92:95], v[60:63], v[152:155]
 buffer_load_dwordx4 v10, s[12:15], s44 offen  lds
 v_mfma_f32_16x16x32_bf16 v[156:159], a[232:235], v[56:59], v[156:159]
 s_cmp_lt_u32 s80, 11
 s_cselect_b32 s39, s39, s3
 v_mfma_f32_16x16x32_bf16 v[156:159], a[236:239], v[60:63], v[156:159]
 v_mfma_f32_16x16x32_bf16 v[160:163], a[16:19], v[32:35], v[160:163]
 ds_read_b128 v[56:59], v24 offset:47104
 s_lshr_b32 s3, s24, 1
 v_mfma_f32_16x16x32_bf16 v[160:163], a[20:23], v[36:39], v[160:163]
 buffer_load_dwordx4 v11, s[12:15], s44 offen offset:1024  lds
 v_mfma_f32_16x16x32_bf16 v[164:167], a[160:163], v[32:35], v[164:167]
 s_add_u32 s3, s3, 4
 v_mfma_f32_16x16x32_bf16 v[164:167], a[164:167], v[36:39], v[164:167]
 s_cmp_lt_u32 s80, 11
 s_cselect_b32 s29, s24, s3
 s_cselect_b32 s81, s80, s81
 s_cselect_b32 s82, 8, 6
 v_mfma_f32_16x16x32_bf16 v[168:171], a[88:91], v[32:35], v[168:171]
 ds_read_b128 v[60:63], v25 offset:47104
 v_mfma_f32_16x16x32_bf16 v[168:171], a[92:95], v[36:39], v[168:171]
 buffer_load_dwordx4 v12, s[12:15], s44 offen offset:2048  lds
 v_mfma_f32_16x16x32_bf16 v[172:175], a[232:235], v[32:35], v[172:175]
 s_cmp_ge_u32 s81, 4
 s_cselect_b32 s62, 1, 0
 s_cselect_b32 s63, 0, 2
 s_cselect_b32 s83, 2, 1
 v_mfma_f32_16x16x32_bf16 v[172:175], a[236:239], v[36:39], v[172:175]
 s_waitcnt lgkmcnt(2)
 v_mfma_f32_16x16x32_bf16 v[176:179], a[16:19], v[40:43], v[176:179]
 buffer_load_dwordx4 v13, s[12:15], s44 offen offset:3072  lds
 v_mfma_f32_16x16x32_bf16 v[176:179], a[20:23], v[44:47], v[176:179]
 s_cmp_ge_u32 s81, s82
 s_cselect_b32 s62, 2, s62
 s_cselect_b32 s63, 1, s63
 s_cselect_b32 s83, 0, s83
 v_mfma_f32_16x16x32_bf16 v[180:183], a[160:163], v[40:43], v[180:183]
 s_mul_i32 s56, s24, 9216
 s_mul_i32 s55, s24, 49152
 v_mfma_f32_16x16x32_bf16 v[180:183], a[164:167], v[44:47], v[180:183]
 v_mfma_f32_16x16x32_bf16 v[184:187], a[88:91], v[40:43], v[184:187]
 s_add_u32 s55, s55, 36864
 v_mfma_f32_16x16x32_bf16 v[184:187], a[92:95], v[44:47], v[184:187]
 v_mfma_f32_16x16x32_bf16 v[188:191], a[232:235], v[40:43], v[188:191]
 s_waitcnt vmcnt(12) lgkmcnt(0)
 s_barrier
 s_min_u32 s55, s55, 144384
 v_mfma_f32_16x16x32_bf16 v[188:191], a[236:239], v[44:47], v[188:191]
 ds_read_b128 v[32:35], v20 offset:32768
 v_mfma_f32_16x16x32_bf16 v[192:195], a[16:19], v[48:51], v[192:195]
 ds_read_b128 v[36:39], v21 offset:32768
 ds_read_b64_tr_b16 a[24:25], v26 offset:0
 v_mfma_f32_16x16x32_bf16 v[192:195], a[20:23], v[52:55], v[192:195]
 ds_read_b64_tr_b16 a[26:27], v26 offset:1024
 ds_read_b64_tr_b16 a[28:29], v26 offset:8192
 v_mfma_f32_16x16x32_bf16 v[196:199], a[160:163], v[48:51], v[196:199]
 ds_read_b64_tr_b16 a[30:31], v26 offset:9216
 ds_read_b64_tr_b16 a[168:169], v26 offset:16384
 v_mfma_f32_16x16x32_bf16 v[196:199], a[164:167], v[52:55], v[196:199]
 ds_read_b64_tr_b16 a[170:171], v26 offset:17408
 ds_read_b64_tr_b16 a[172:173], v26 offset:24576
 v_mfma_f32_16x16x32_bf16 v[200:203], a[88:91], v[48:51], v[200:203]
 ds_read_b64_tr_b16 a[174:175], v26 offset:25600
 ds_read_b64_tr_b16 a[96:97], v27 offset:0
 v_mfma_f32_16x16x32_bf16 v[200:203], a[92:95], v[52:55], v[200:203]
 ds_read_b64_tr_b16 a[98:99], v27 offset:1024
 ds_read_b64_tr_b16 a[100:101], v27 offset:8192
 v_mfma_f32_16x16x32_bf16 v[204:207], a[232:235], v[48:51], v[204:207]
 ds_read_b64_tr_b16 a[102:103], v27 offset:9216
 ds_read_b64_tr_b16 a[240:241], v27 offset:16384
 v_mfma_f32_16x16x32_bf16 v[204:207], a[236:239], v[52:55], v[204:207]
 ds_read_b64_tr_b16 a[242:243], v27 offset:17408
 ds_read_b64_tr_b16 a[244:245], v27 offset:24576
 s_waitcnt lgkmcnt(15)
 v_mfma_f32_16x16x32_bf16 v[208:211], a[16:19], v[56:59], v[208:211]
 ds_read_b64_tr_b16 a[246:247], v27 offset:25600
 s_mul_i32 s3, s49, 36
 v_mfma_f32_16x16x32_bf16 v[208:211], a[20:23], v[60:63], v[208:211]
 ds_read_b128 v[40:43], v20 offset:34816
 s_add_u32 s86, s3, s24
 v_mfma_f32_16x16x32_bf16 v[212:215], a[160:163], v[56:59], v[212:215]
 ds_read_b128 v[44:47], v21 offset:34816
 s_add_u32 m0, s51, 98304
 v_mfma_f32_16x16x32_bf16 v[212:215], a[164:167], v[60:63], v[212:215]
 ds_read_b128 v[48:51], v20 offset:36864
 s_mul_i32 s86, s86, 36864
 v_mfma_f32_16x16x32_bf16 v[216:219], a[88:91], v[56:59], v[216:219]
 ds_read_b128 v[52:55], v21 offset:36864
 s_mul_i32 s81, s60, 9216
 v_mfma_f32_16x16x32_bf16 v[216:219], a[92:95], v[60:63], v[216:219]
 buffer_load_dwordx4 v14, s[8:11], s35 offen  lds
 s_add_u32 s86, s86, s81
 v_mfma_f32_16x16x32_bf16 v[220:223], a[232:235], v[56:59], v[220:223]
 s_add_u32 s86, s86, 20971520
 s_mul_i32 s87, s28, 294912
 s_lshl_b32 s3, s3, 10
 v_mfma_f32_16x16x32_bf16 v[220:223], a[236:239], v[60:63], v[220:223]
 s_waitcnt lgkmcnt(4)
 s_add_u32 s87, s87, s3
 s_add_u32 s87, s87, 1048576
 v_mfma_f32_16x16x32_bf16 v[96:99], a[24:27], v[32:35], v[96:99]
 ds_read_b128 v[56:59], v20 offset:38912
 v_mfma_f32_16x16x32_bf16 v[96:99], a[28:31], v[36:39], v[96:99]
 buffer_load_dwordx4 v15, s[8:11], s35 offen offset:1024  lds
 s_lshl_b32 s80, s61, 11
 v_mfma_f32_16x16x32_bf16 v[100:103], a[168:171], v[32:35], v[100:103]
 v_mfma_f32_16x16x32_bf16 v[100:103], a[172:175], v[36:39], v[100:103]
 s_add_u32 s80, s80, 41025536
 v_mfma_f32_16x16x32_bf16 v[104:107], a[96:99], v[32:35], v[104:107]
 ds_read_b128 v[60:63], v21 offset:38912
 v_mfma_f32_16x16x32_bf16 v[104:107], a[100:103], v[36:39], v[104:107]
 buffer_load_dwordx4 v16, s[8:11], s35 offen offset:2048  lds
 s_lshl_b32 s74, s24, 9
 v_mfma_f32_16x16x32_bf16 v[108:111], a[240:243], v[32:35], v[108:111]
 s_add_u32 s74, s74, s80
 v_mfma_f32_16x16x32_bf16 v[108:111], a[244:247], v[36:39], v[108:111]
 s_waitcnt lgkmcnt(2)
 v_mfma_f32_16x16x32_bf16 v[112:115], a[24:27], v[40:43], v[112:115]
 ds_read_b128 v[32:35], v20 offset:40960
 s_lshl_b32 s3, s49, 7
 v_mfma_f32_16x16x32_bf16 v[112:115], a[28:31], v[44:47], v[112:115]
 buffer_load_dwordx4 v17, s[8:11], s35 offen offset:3072  lds
 s_add_u32 m0, s50, 98304
 v_mfma_f32_16x16x32_bf16 v[116:119], a[168:171], v[40:43], v[116:119]
 s_add_u32 s74, s74, s3
 v_mfma_f32_16x16x32_bf16 v[116:119], a[172:175], v[44:47], v[116:119]
 v_mfma_f32_16x16x32_bf16 v[120:123], a[96:99], v[40:43], v[120:123]
 ds_read_b128 v[36:39], v21 offset:40960
 s_lshl_b32 s75, s49, 9
 v_mfma_f32_16x16x32_bf16 v[120:123], a[100:103], v[44:47], v[120:123]
 buffer_load_dwordx4 v10, s[12:15], s45 offen  lds
 s_add_u32 s75, s75, s80
 v_mfma_f32_16x16x32_bf16 v[124:127], a[240:243], v[40:43], v[124:127]
 v_mfma_f32_16x16x32_bf16 v[124:127], a[244:247], v[44:47], v[124:127]
 s_mul_i32 s81, s60, 9216
 v_mfma_f32_16x16x32_bf16 v[128:131], a[24:27], v[48:51], v[128:131]
 ds_read_b128 v[40:43], v20 offset:43008
 v_mfma_f32_16x16x32_bf16 v[128:131], a[28:31], v[52:55], v[128:131]
 buffer_load_dwordx4 v11, s[12:15], s45 offen offset:1024  lds
 s_lshl_b32 s77, s49, 6
 v_mfma_f32_16x16x32_bf16 v[132:135], a[168:171], v[48:51], v[132:135]
 v_mfma_f32_16x16x32_bf16 v[132:135], a[172:175], v[52:55], v[132:135]
 s_add_u32 s77, s77, s28
 v_mfma_f32_16x16x32_bf16 v[136:139], a[96:99], v[48:51], v[136:139]
 ds_read_b128 v[44:47], v21 offset:43008
 s_mul_i32 s77, s77, 36864
 v_mfma_f32_16x16x32_bf16 v[136:139], a[100:103], v[52:55], v[136:139]
 buffer_load_dwordx4 v12, s[12:15], s45 offen offset:2048  lds
 v_mfma_f32_16x16x32_bf16 v[140:143], a[240:243], v[48:51], v[140:143]
 s_add_u32 s77, s77, s81
 v_mfma_f32_16x16x32_bf16 v[140:143], a[244:247], v[52:55], v[140:143]
 s_waitcnt lgkmcnt(2)
 v_mfma_f32_16x16x32_bf16 v[144:147], a[24:27], v[56:59], v[144:147]
 ds_read_b128 v[48:51], v20 offset:45056
 s_add_u32 s77, s77, 30408704
 v_mfma_f32_16x16x32_bf16 v[144:147], a[28:31], v[60:63], v[144:147]
 buffer_load_dwordx4 v13, s[12:15], s45 offen offset:3072  lds
 s_add_u32 m0, s50, 102400
 v_mfma_f32_16x16x32_bf16 v[148:151], a[168:171], v[56:59], v[148:151]
 s_add_u32 s45, s45, 147456
 s_cmp_eq_u32 s24, s49
 s_cselect_b32 s77, 1073741824, s77
 s_cselect_b32 s74, 1073741824, s74
 v_mfma_f32_16x16x32_bf16 v[148:151], a[172:175], v[60:63], v[148:151]
 s_mul_i32 s80, s39, 36864
 v_mfma_f32_16x16x32_bf16 v[152:155], a[96:99], v[56:59], v[152:155]
 ds_read_b128 v[52:55], v21 offset:45056
 v_mfma_f32_16x16x32_bf16 v[152:155], a[100:103], v[60:63], v[152:155]
 buffer_load_dwordx4 v10, s[12:15], s45 offen  lds
 s_mul_i32 s76, s60, 288
 v_mfma_f32_16x16x32_bf16 v[156:159], a[240:243], v[56:59], v[156:159]
 v_mfma_f32_16x16x32_bf16 v[156:159], a[244:247], v[60:63], v[156:159]
 s_add_u32 s76, s76, s80
 v_mfma_f32_16x16x32_bf16 v[160:163], a[24:27], v[32:35], v[160:163]
 ds_read_b128 v[56:59], v20 offset:47104
 v_mfma_f32_16x16x32_bf16 v[160:163], a[28:31], v[36:39], v[160:163]
 buffer_load_dwordx4 v11, s[12:15], s45 offen offset:1024  lds
 s_add_u32 s80, s80, s81
 v_mfma_f32_16x16x32_bf16 v[164:167], a[168:171], v[32:35], v[164:167]
 s_add_u32 s72, s80, 27262976
 v_mfma_f32_16x16x32_bf16 v[164:167], a[172:175], v[36:39], v[164:167]
 v_mfma_f32_16x16x32_bf16 v[168:171], a[96:99], v[32:35], v[168:171]
 ds_read_b128 v[60:63], v21 offset:47104
 s_add_u32 s80, s80, 30408704
 v_mfma_f32_16x16x32_bf16 v[168:171], a[100:103], v[36:39], v[168:171]
 buffer_load_dwordx4 v12, s[12:15], s45 offen offset:2048  lds
 v_mfma_f32_16x16x32_bf16 v[172:175], a[240:243], v[32:35], v[172:175]
Lpg1:
 s_cbranch_vccnz Lj_Lfin
 s_lshl_b32 s73, s39, 7
 v_mfma_f32_16x16x32_bf16 v[172:175], a[244:247], v[36:39], v[172:175]
 s_waitcnt lgkmcnt(2)
 v_mfma_f32_16x16x32_bf16 v[176:179], a[24:27], v[40:43], v[176:179]
 buffer_load_dwordx4 v13, s[12:15], s45 offen offset:3072  lds
 s_add_u32 s73, s73, 40894464
 v_mfma_f32_16x16x32_bf16 v[176:179], a[28:31], v[44:47], v[176:179]
 s_lshl_b32 s61, s60, 2
 v_mfma_f32_16x16x32_bf16 v[180:183], a[168:171], v[40:43], v[180:183]
 v_mfma_f32_16x16x32_bf16 v[180:183], a[172:175], v[44:47], v[180:183]
 s_lshr_b32 s3, s39, 4
 v_mfma_f32_16x16x32_bf16 v[184:187], a[96:99], v[40:43], v[184:187]
 v_mfma_f32_16x16x32_bf16 v[184:187], a[100:103], v[44:47], v[184:187]
 s_add_u32 s61, s61, s3
 v_mfma_f32_16x16x32_bf16 v[188:191], a[240:243], v[40:43], v[188:191]
 s_waitcnt vmcnt(12) lgkmcnt(0)
 s_barrier
 v_mfma_f32_16x16x32_bf16 v[188:191], a[244:247], v[44:47], v[188:191]
 ds_read_b128 v[32:35], v22 offset:32768
 s_lshl_b32 s61, s61, 7
 v_mfma_f32_16x16x32_bf16 v[192:195], a[24:27], v[48:51], v[192:195]
 ds_read_b128 v[36:39], v23 offset:32768
 ds_read_b64_tr_b16 a[32:33], v28 offset:0
 v_mfma_f32_16x16x32_bf16 v[192:195], a[28:31], v[52:55], v[192:195]
 ds_read_b64_tr_b16 a[34:35], v28 offset:1024
 ds_read_b64_tr_b16 a[36:37], v28 offset:8192
 v_mfma_f32_16x16x32_bf16 v[196:199], a[168:171], v[48:51], v[196:199]
 ds_read_b64_tr_b16 a[38:39], v28 offset:9216
 ds_read_b64_tr_b16 a[176:177], v28 offset:16384
 v_mfma_f32_16x16x32_bf16 v[196:199], a[172:175], v[52:55], v[196:199]
 ds_read_b64_tr_b16 a[178:179], v28 offset:17408
 ds_read_b64_tr_b16 a[180:181], v28 offset:24576
 v_mfma_f32_16x16x32_bf16 v[200:203], a[96:99], v[48:51], v[200:203]
 ds_read_b64_tr_b16 a[182:183], v28 offset:25600
 ds_read_b64_tr_b16 a[104:105], v29 offset:0
 v_mfma_f32_16x16x32_bf16 v[200:203], a[100:103], v[52:55], v[200:203]
 ds_read_b64_tr_b16 a[106:107], v29 offset:1024
 ds_read_b64_tr_b16 a[108:109], v29 offset:8192
 v_mfma_f32_16x16x32_bf16 v[204:207], a[240:243], v[48:51], v[204:207]
 ds_read_b64_tr_b16 a[110:111], v29 offset:9216
 ds_read_b64_tr_b16 a[248:249], v29 offset:16384
 v_mfma_f32_16x16x32_bf16 v[204:207], a[244:247], v[52:55], v[204:207]
 ds_read_b64_tr_b16 a[250:251], v29 offset:17408
 ds_read_b64_tr_b16 a[252:253], v29 offset:24576
 s_waitcnt lgkmcnt(15)
 v_mfma_f32_16x16x32_bf16 v[208:211], a[24:27], v[56:59], v[208:211]
 ds_read_b64_tr_b16 a[254:255], v29 offset:25600
 s_lshl_b32 s60, s49, 2
 v_mfma_f32_16x16x32_bf16 v[208:211], a[28:31], v[60:63], v[208:211]
 ds_read_b128 v[40:43], v22 offset:34816
 s_add_u32 s60, s60, s24
 v_mfma_f32_16x16x32_bf16 v[212:215], a[168:171], v[56:59], v[212:215]
 ds_read_b128 v[44:47], v23 offset:34816
 s_add_u32 m0, s51, 0
 v_mfma_f32_16x16x32_bf16 v[212:215], a[172:175], v[60:63], v[212:215]
 ds_read_b128 v[48:51], v22 offset:36864
 s_lshl_b32 s60, s60, 8
 v_mfma_f32_16x16x32_bf16 v[216:219], a[96:99], v[56:59], v[216:219]
 ds_read_b128 v[52:55], v23 offset:36864
 s_mul_i32 s81, s49, 18
 v_mfma_f32_16x16x32_bf16 v[216:219], a[100:103], v[60:63], v[216:219]
 buffer_load_dwordx4 v14, s[8:11], s36 offen  lds
 s_add_u32 s81, s81, s29
 v_mfma_f32_16x16x32_bf16 v[220:223], a[240:243], v[56:59], v[220:223]
 s_add_u32 s3, s49, 1
 s_and_b32 s3, s3, 3
 s_mul_i32 s3, s3, 2359296
 v_mfma_f32_16x16x32_bf16 v[220:223], a[244:247], v[60:63], v[220:223]
 s_waitcnt lgkmcnt(4)
 s_add_u32 s78, s80, s3
 v_mfma_f32_16x16x32_bf16 v[96:99], a[32:35], v[32:35], v[96:99]
 ds_read_b128 v[56:59], v22 offset:38912
 s_mul_i32 s3, s62, 6
 v_mfma_f32_16x16x32_bf16 v[96:99], a[36:39], v[36:39], v[96:99]
 buffer_load_dwordx4 v15, s[8:11], s36 offen offset:1024  lds
 v_mfma_f32_16x16x32_bf16 v[100:103], a[176:179], v[32:35], v[100:103]
 s_add_u32 s3, s3, s81
 v_mfma_f32_16x16x32_bf16 v[100:103], a[180:183], v[36:39], v[100:103]
 v_mfma_f32_16x16x32_bf16 v[104:107], a[104:107], v[32:35], v[104:107]
 ds_read_b128 v[60:63], v23 offset:38912
 s_lshl_b32 s28, s3, 8
 v_mfma_f32_16x16x32_bf16 v[104:107], a[108:111], v[36:39], v[104:107]
 buffer_load_dwordx4 v16, s[8:11], s36 offen offset:2048  lds
 s_add_u32 s3, s49, 2
 v_mfma_f32_16x16x32_bf16 v[108:111], a[248:251], v[32:35], v[108:111]
 v_mfma_f32_16x16x32_bf16 v[108:111], a[252:255], v[36:39], v[108:111]
 s_waitcnt lgkmcnt(2)
 s_and_b32 s3, s3, 3
 v_mfma_f32_16x16x32_bf16 v[112:115], a[32:35], v[40:43], v[112:115]
 ds_read_b128 v[32:35], v22 offset:40960
 v_mfma_f32_16x16x32_bf16 v[112:115], a[36:39], v[44:47], v[112:115]
 buffer_load_dwordx4 v17, s[8:11], s36 offen offset:3072  lds
 s_add_u32 m0, s50, 0
 v_mfma_f32_16x16x32_bf16 v[116:119], a[176:179], v[40:43], v[116:119]
 s_mul_i32 s3, s3, 2359296
 v_mfma_f32_16x16x32_bf16 v[116:119], a[180:183], v[44:47], v[116:119]
 s_add_u32 s79, s80, s3
 v_mfma_f32_16x16x32_bf16 v[120:123], a[104:107], v[40:43], v[120:123]
 ds_read_b128 v[36:39], v23 offset:40960
 s_mul_i32 s3, s63, 6
 v_mfma_f32_16x16x32_bf16 v[120:123], a[108:111], v[44:47], v[120:123]
 buffer_load_dwordx4 v10, s[12:15], s46 offen  lds
 v_mfma_f32_16x16x32_bf16 v[124:127], a[248:251], v[40:43], v[124:127]
 s_add_u32 s3, s3, s81
 v_mfma_f32_16x16x32_bf16 v[124:127], a[252:255], v[44:47], v[124:127]
 v_mfma_f32_16x16x32_bf16 v[128:131], a[32:35], v[48:51], v[128:131]
 ds_read_b128 v[40:43], v22 offset:43008
 s_lshl_b32 s29, s3, 8
 v_mfma_f32_16x16x32_bf16 v[128:131], a[36:39], v[52:55], v[128:131]
 buffer_load_dwordx4 v11, s[12:15], s46 offen offset:1024  lds
 v_mfma_f32_16x16x32_bf16 v[132:135], a[176:179], v[48:51], v[132:135]
 s_add_u32 s3, s49, 3
 v_mfma_f32_16x16x32_bf16 v[132:135], a[180:183], v[52:55], v[132:135]
 s_and_b32 s3, s3, 3
 v_mfma_f32_16x16x32_bf16 v[136:139], a[104:107], v[48:51], v[136:139]
 ds_read_b128 v[44:47], v23 offset:43008
 v_mfma_f32_16x16x32_bf16 v[136:139], a[108:111], v[52:55], v[136:139]
 buffer_load_dwordx4 v12, s[12:15], s46 offen offset:2048  lds
 s_mul_i32 s3, s3, 2359296
 v_mfma_f32_16x16x32_bf16 v[140:143], a[248:251], v[48:51], v[140:143]
 v_mfma_f32_16x16x32_bf16 v[140:143], a[252:255], v[52:55], v[140:143]
 s_waitcnt lgkmcnt(2)
 s_add_u32 s0, s80, s3
 v_mfma_f32_16x16x32_bf16 v[144:147], a[32:35], v[56:59], v[144:147]
 ds_read_b128 v[48:51], v22 offset:45056
 v_mfma_f32_16x16x32_bf16 v[144:147], a[36:39], v[60:63], v[144:147]
 buffer_load_dwordx4 v13, s[12:15], s46 offen offset:3072  lds
 s_add_u32 m0, s50, 4096
 v_mfma_f32_16x16x32_bf16 v[148:151], a[176:179], v[56:59], v[148:151]
 s_add_u32 s46, s46, 147456
 s_mul_i32 s3, s83, 6
 s_add_u32 s3, s3, s81
 v_mfma_f32_16x16x32_bf16 v[148:151], a[180:183], v[60:63], v[148:151]
 v_mfma_f32_16x16x32_bf16 v[152:155], a[104:107], v[56:59], v[152:155]
 ds_read_b128 v[52:55], v23 offset:45056
 s_lshl_b32 s39, s3, 8
 v_mfma_f32_16x16x32_bf16 v[152:155], a[108:111], v[60:63], v[152:155]
 buffer_load_dwordx4 v10, s[12:15], s46 offen  lds
 v_mfma_f32_16x16x32_bf16 v[156:159], a[248:251], v[56:59], v[156:159]
 s_add_u32 s88, s88, 40960000
 s_addc_u32 s89, s89, 0
 v_mfma_f32_16x16x32_bf16 v[156:159], a[252:255], v[60:63], v[156:159]
 v_mfma_f32_16x16x32_bf16 v[160:163], a[32:35], v[32:35], v[160:163]
 ds_read_b128 v[56:59], v22 offset:47104
 s_lshl_b32 s82, s24, 10
 v_mfma_f32_16x16x32_bf16 v[160:163], a[36:39], v[36:39], v[160:163]
 buffer_load_dwordx4 v11, s[12:15], s46 offen offset:1024  lds
 v_mfma_f32_16x16x32_bf16 v[164:167], a[176:179], v[32:35], v[164:167]
 v_mfma_f32_16x16x32_bf16 v[164:167], a[180:183], v[36:39], v[164:167]
 v_mfma_f32_16x16x32_bf16 v[168:171], a[104:107], v[32:35], v[168:171]
 ds_read_b128 v[60:63], v23 offset:47104
 v_mfma_f32_16x16x32_bf16 v[168:171], a[108:111], v[36:39], v[168:171]
 buffer_load_dwordx4 v12, s[12:15], s46 offen offset:2048  lds
 v_mfma_f32_16x16x32_bf16 v[172:175], a[248:251], v[32:35], v[172:175]
 v_mfma_f32_16x16x32_bf16 v[172:175], a[252:255], v[36:39], v[172:175]
 s_waitcnt lgkmcnt(2)
 v_mfma_f32_16x16x32_bf16 v[176:179], a[32:35], v[40:43], v[176:179]
 buffer_load_dwordx4 v13, s[12:15], s46 offen offset:3072  lds
 v_mfma_f32_16x16x32_bf16 v[176:179], a[36:39], v[44:47], v[176:179]
 v_mfma_f32_16x16x32_bf16 v[180:183], a[176:179], v[40:43], v[180:183]
 v_mfma_f32_16x16x32_bf16 v[180:183], a[180:183], v[44:47], v[180:183]
 v_mfma_f32_16x16x32_bf16 v[184:187], a[104:107], v[40:43], v[184:187]
 v_mfma_f32_16x16x32_bf16 v[184:187], a[108:111], v[44:47], v[184:187]
 v_mfma_f32_16x16x32_bf16 v[188:191], a[248:251], v[40:43], v[188:191]
 s_waitcnt vmcnt(12) lgkmcnt(0)
 s_barrier
 v_mfma_f32_16x16x32_bf16 v[188:191], a[252:255], v[44:47], v[188:191]
 ds_read_b128 v[32:35], v24 offset:32768
 v_mfma_f32_16x16x32_bf16 v[192:195], a[32:35], v[48:51], v[192:195]
 ds_read_b128 v[36:39], v25 offset:32768
 ds_read_b64_tr_b16 a[40:41], v30 offset:0
 v_mfma_f32_16x16x32_bf16 v[192:195], a[36:39], v[52:55], v[192:195]
 ds_read_b64_tr_b16 a[42:43], v30 offset:1024
 ds_read_b64_tr_b16 a[44:45], v30 offset:8192
 v_mfma_f32_16x16x32_bf16 v[196:199], a[176:179], v[48:51], v[196:199]
 ds_read_b64_tr_b16 a[46:47], v30 offset:9216
 ds_read_b64_tr_b16 a[184:185], v30 offset:16384
 v_mfma_f32_16x16x32_bf16 v[196:199], a[180:183], v[52:55], v[196:199]
 ds_read_b64_tr_b16 a[186:187], v30 offset:17408
 ds_read_b64_tr_b16 a[188:189], v30 offset:24576
 v_mfma_f32_16x16x32_bf16 v[200:203], a[104:107], v[48:51], v[200:203]
 ds_read_b64_tr_b16 a[190:191], v30 offset:25600
 ds_read_b64_tr_b16 a[112:113], v31 offset:0
 v_mfma_f32_16x16x32_bf16 v[200:203], a[108:111], v[52:55], v[200:203]
 ds_read_b64_tr_b16 a[114:115], v31 offset:1024
 ds_read_b64_tr_b16 a[116:117], v31 offset:8192
 v_mfma_f32_16x16x32_bf16 v[204:207], a[248:251], v[48:51], v[204:207]
 ds_read_b64_tr_b16 a[118:119], v31 offset:9216
 ds_read_b64_tr_b16 v[224:225], v31 offset:16384
 v_mfma_f32_16x16x32_bf16 v[204:207], a[252:255], v[52:55], v[204:207]
 ds_read_b64_tr_b16 v[226:227], v31 offset:17408
 ds_read_b64_tr_b16 v[228:229], v31 offset:24576
 s_waitcnt lgkmcnt(15)
 v_mfma_f32_16x16x32_bf16 v[208:211], a[32:35], v[56:59], v[208:211]
 ds_read_b64_tr_b16 v[230:231], v31 offset:25600
 v_mfma_f32_16x16x32_bf16 v[208:211], a[36:39], v[60:63], v[208:211]
 ds_read_b128 v[40:43], v24 offset:34816
 v_mfma_f32_16x16x32_bf16 v[212:215], a[176:179], v[56:59], v[212:215]
 ds_read_b128 v[44:47], v25 offset:34816
 s_add_u32 m0, s51, 49152
 v_mfma_f32_16x16x32_bf16 v[212:215], a[180:183], v[60:63], v[212:215]
 ds_read_b128 v[48:51], v24 offset:36864
 v_mfma_f32_16x16x32_bf16 v[216:219], a[104:107], v[56:59], v[216:219]
 ds_read_b128 v[52:55], v25 offset:36864
 v_mfma_f32_16x16x32_bf16 v[216:219], a[108:111], v[60:63], v[216:219]
 buffer_load_dwordx4 v14, s[8:11], s37 offen  lds
 v_mfma_f32_16x16x32_bf16 v[220:223], a[248:251], v[56:59], v[220:223]
 v_mfma_f32_16x16x32_bf16 v[220:223], a[252:255], v[60:63], v[220:223]
 s_waitcnt lgkmcnt(4)
 v_mfma_f32_16x16x32_bf16 v[96:99], a[40:43], v[32:35], v[96:99]
 ds_read_b128 v[56:59], v24 offset:38912
 v_mfma_f32_16x16x32_bf16 v[96:99], a[44:47], v[36:39], v[96:99]
 buffer_load_dwordx4 v15, s[8:11], s37 offen offset:1024  lds
 v_mfma_f32_16x16x32_bf16 v[100:103], a[184:187], v[32:35], v[100:103]
 v_mfma_f32_16x16x32_bf16 v[100:103], a[188:191], v[36:39], v[100:103]
 v_mfma_f32_16x16x32_bf16 v[104:107], a[112:115], v[32:35], v[104:107]
 ds_read_b128 v[60:63], v25 offset:38912
 v_mfma_f32_16x16x32_bf16 v[104:107], a[116:119], v[36:39], v[104:107]
 buffer_load_dwordx4 v16, s[8:11], s37 offen offset:2048  lds
 v_mfma_f32_16x16x32_bf16 v[108:111], v[224:227], v[32:35], v[108:111]
 v_mfma_f32_16x16x32_bf16 v[108:111], v[228:231], v[36:39], v[108:111]
 s_waitcnt lgkmcnt(2)
 v_mfma_f32_16x16x32_bf16 v[112:115], a[40:43], v[40:43], v[112:115]
 ds_read_b128 v[32:35], v24 offset:40960
 v_mfma_f32_16x16x32_bf16 v[112:115], a[44:47], v[44:47], v[112:115]
 buffer_load_dwordx4 v17, s[8:11], s37 offen offset:3072  lds
 s_add_u32 m0, s50, 49152
 v_mfma_f32_16x16x32_bf16 v[116:119], a[184:187], v[40:43], v[116:119]
 v_mfma_f32_16x16x32_bf16 v[116:119], a[188:191], v[44:47], v[116:119]
 v_mfma_f32_16x16x32_bf16 v[120:123], a[112:115], v[40:43], v[120:123]
 ds_read_b128 v[36:39], v25 offset:40960
 v_mfma_f32_16x16x32_bf16 v[120:123], a[116:119], v[44:47], v[120:123]
 buffer_load_dwordx4 v10, s[12:15], s47 offen  lds
 v_mfma_f32_16x16x32_bf16 v[124:127], v[224:227], v[40:43], v[124:127]
 v_mfma_f32_16x16x32_bf16 v[124:127], v[228:231], v[44:47], v[124:127]
 v_mfma_f32_16x16x32_bf16 v[128:131], a[40:43], v[48:51], v[128:131]
 ds_read_b128 v[40:43], v24 offset:43008
 v_mfma_f32_16x16x32_bf16 v[128:131], a[44:47], v[52:55], v[128:131]
 buffer_load_dwordx4 v11, s[12:15], s47 offen offset:1024  lds
 v_mfma_f32_16x16x32_bf16 v[132:135], a[184:187], v[48:51], v[132:135]
 v_mfma_f32_16x16x32_bf16 v[132:135], a[188:191], v[52:55], v[132:135]
 v_mfma_f32_16x16x32_bf16 v[136:139], a[112:115], v[48:51], v[136:139]
 ds_read_b128 v[44:47], v25 offset:43008
 v_mfma_f32_16x16x32_bf16 v[136:139], a[116:119], v[52:55], v[136:139]
 buffer_load_dwordx4 v12, s[12:15], s47 offen offset:2048  lds
 v_mfma_f32_16x16x32_bf16 v[140:143], v[224:227], v[48:51], v[140:143]
 v_mfma_f32_16x16x32_bf16 v[140:143], v[228:231], v[52:55], v[140:143]
 s_waitcnt lgkmcnt(2)
 v_mfma_f32_16x16x32_bf16 v[144:147], a[40:43], v[56:59], v[144:147]
 ds_read_b128 v[48:51], v24 offset:45056
 v_mfma_f32_16x16x32_bf16 v[144:147], a[44:47], v[60:63], v[144:147]
 buffer_load_dwordx4 v13, s[12:15], s47 offen offset:3072  lds
 s_add_u32 m0, s50, 53248
 v_mfma_f32_16x16x32_bf16 v[148:151], a[184:187], v[56:59], v[148:151]
 s_add_u32 s47, s47, 147456
 v_mfma_f32_16x16x32_bf16 v[148:151], a[188:191], v[60:63], v[148:151]
 v_mfma_f32_16x16x32_bf16 v[152:155], a[112:115], v[56:59], v[152:155]
 ds_read_b128 v[52:55], v25 offset:45056
 v_mfma_f32_16x16x32_bf16 v[152:155], a[116:119], v[60:63], v[152:155]
 buffer_load_dwordx4 v10, s[12:15], s47 offen  lds
 v_mfma_f32_16x16x32_bf16 v[156:159], v[224:227], v[56:59], v[156:159]
 v_mfma_f32_16x16x32_bf16 v[156:159], v[228:231], v[60:63], v[156:159]
 v_mfma_f32_16x16x32_bf16 v[160:163], a[40:43], v[32:35], v[160:163]
 ds_read_b128 v[56:59], v24 offset:47104
 v_mfma_f32_16x16x32_bf16 v[160:163], a[44:47], v[36:39], v[160:163]
 buffer_load_dwordx4 v11, s[12:15], s47 offen offset:1024  lds
 v_mfma_f32_16x16x32_bf16 v[164:167], a[184:187], v[32:35], v[164:167]
 v_mfma_f32_16x16x32_bf16 v[164:167], a[188:191], v[36:39], v[164:167]
 v_mfma_f32_16x16x32_bf16 v[168:171], a[112:115], v[32:35], v[168:171]
 ds_read_b128 v[60:63], v25 offset:47104
 v_mfma_f32_16x16x32_bf16 v[168:171], a[116:119], v[36:39], v[168:171]
 buffer_load_dwordx4 v12, s[12:15], s47 offen offset:2048  lds
 v_mfma_f32_16x16x32_bf16 v[172:175], v[224:227], v[32:35], v[172:175]
 v_mfma_f32_16x16x32_bf16 v[172:175], v[228:231], v[36:39], v[172:175]
 s_waitcnt lgkmcnt(2)
 v_mfma_f32_16x16x32_bf16 v[176:179], a[40:43], v[40:43], v[176:179]
 buffer_load_dwordx4 v13, s[12:15], s47 offen offset:3072  lds
 v_mfma_f32_16x16x32_bf16 v[176:179], a[44:47], v[44:47], v[176:179]
 v_mfma_f32_16x16x32_bf16 v[180:183], a[184:187], v[40:43], v[180:183]
 v_mfma_f32_16x16x32_bf16 v[180:183], a[188:191], v[44:47], v[180:183]
 v_mfma_f32_16x16x32_bf16 v[184:187], a[112:115], v[40:43], v[184:187]
 v_mfma_f32_16x16x32_bf16 v[184:187], a[116:119], v[44:47], v[184:187]
 v_mfma_f32_16x16x32_bf16 v[188:191], v[224:227], v[40:43], v[188:191]
 s_waitcnt vmcnt(12) lgkmcnt(0)
 s_barrier
 v_mfma_f32_16x16x32_bf16 v[188:191], v[228:231], v[44:47], v[188:191]
 ds_read_b128 v[32:35], v20 offset:32768
 v_mfma_f32_16x16x32_bf16 v[192:195], a[40:43], v[48:51], v[192:195]
 ds_read_b128 v[36:39], v21 offset:32768
 ds_read_b64_tr_b16 a[48:49], v26 offset:0
 v_mfma_f32_16x16x32_bf16 v[192:195], a[44:47], v[52:55], v[192:195]
 ds_read_b64_tr_b16 a[50:51], v26 offset:1024
 ds_read_b64_tr_b16 a[52:53], v26 offset:8192
 v_mfma_f32_16x16x32_bf16 v[196:199], a[184:187], v[48:51], v[196:199]
 ds_read_b64_tr_b16 a[54:55], v26 offset:9216
 ds_read_b64_tr_b16 a[192:193], v26 offset:16384
 v_mfma_f32_16x16x32_bf16 v[196:199], a[188:191], v[52:55], v[196:199]
 ds_read_b64_tr_b16 a[194:195], v26 offset:17408
 ds_read_b64_tr_b16 a[196:197], v26 offset:24576
 v_mfma_f32_16x16x32_bf16 v[200:203], a[112:115], v[48:51], v[200:203]
 ds_read_b64_tr_b16 a[198:199], v26 offset:25600
 ds_read_b64_tr_b16 a[120:121], v27 offset:0
 v_mfma_f32_16x16x32_bf16 v[200:203], a[116:119], v[52:55], v[200:203]
 ds_read_b64_tr_b16 a[122:123], v27 offset:1024
 ds_read_b64_tr_b16 a[124:125], v27 offset:8192
 v_mfma_f32_16x16x32_bf16 v[204:207], v[224:227], v[48:51], v[204:207]
 ds_read_b64_tr_b16 a[126:127], v27 offset:9216
 ds_read_b64_tr_b16 v[232:233], v27 offset:16384
 v_mfma_f32_16x16x32_bf16 v[204:207], v[228:231], v[52:55], v[204:207]
 ds_read_b64_tr_b16 v[234:235], v27 offset:17408
 ds_read_b64_tr_b16 v[236:237], v27 offset:24576
 s_waitcnt lgkmcnt(15)
 v_mfma_f32_16x16x32_bf16 v[208:211], a[40:43], v[56:59], v[208:211]
 ds_read_b64_tr_b16 v[238:239], v27 offset:25600
 v_mfma_f32_16x16x32_bf16 v[208:211], a[44:47], v[60:63], v[208:211]
 ds_read_b128 v[40:43], v20 offset:34816
 v_mfma_f32_16x16x32_bf16 v[212:215], a[184:187], v[56:59], v[212:215]
 ds_read_b128 v[44:47], v21 offset:34816
 s_add_u32 m0, s51, 98304
 v_mfma_f32_16x16x32_bf16 v[212:215], a[188:191], v[60:63], v[212:215]
 ds_read_b128 v[48:51], v20 offset:36864
 v_mfma_f32_16x16x32_bf16 v[216:219], a[112:115], v[56:59], v[216:219]
 ds_read_b128 v[52:55], v21 offset:36864
 v_mfma_f32_16x16x32_bf16 v[216:219], a[116:119], v[60:63], v[216:219]
 buffer_load_dwordx4 v14, s[8:11], s38 offen  lds
 v_mfma_f32_16x16x32_bf16 v[220:223], v[224:227], v[56:59], v[220:223]
 v_mfma_f32_16x16x32_bf16 v[220:223], v[228:231], v[60:63], v[220:223]
 s_waitcnt lgkmcnt(4)
 v_mfma_f32_16x16x32_bf16 v[96:99], a[48:51], v[32:35], v[96:99]
 ds_read_b128 v[56:59], v20 offset:38912
 v_mfma_f32_16x16x32_bf16 v[96:99], a[52:55], v[36:39], v[96:99]
 buffer_load_dwordx4 v15, s[8:11], s38 offen offset:1024  lds
 v_mfma_f32_16x16x32_bf16 v[100:103], a[192:195], v[32:35], v[100:103]
 v_mfma_f32_16x16x32_bf16 v[100:103], a[196:199], v[36:39], v[100:103]
 v_mfma_f32_16x16x32_bf16 v[104:107], a[120:123], v[32:35], v[104:107]
 ds_read_b128 v[60:63], v21 offset:38912
 v_mfma_f32_16x16x32_bf16 v[104:107], a[124:127], v[36:39], v[104:107]
 buffer_load_dwordx4 v16, s[8:11], s38 offen offset:2048  lds
 v_mfma_f32_16x16x32_bf16 v[108:111], v[232:235], v[32:35], v[108:111]
 v_mfma_f32_16x16x32_bf16 v[108:111], v[236:239], v[36:39], v[108:111]
 s_waitcnt lgkmcnt(2)
 v_mfma_f32_16x16x32_bf16 v[112:115], a[48:51], v[40:43], v[112:115]
 ds_read_b128 v[32:35], v20 offset:40960
 v_mfma_f32_16x16x32_bf16 v[112:115], a[52:55], v[44:47], v[112:115]
 buffer_load_dwordx4 v17, s[8:11], s38 offen offset:3072  lds
 s_add_u32 m0, s50, 98304
 v_mfma_f32_16x16x32_bf16 v[116:119], a[192:195], v[40:43], v[116:119]
 v_mfma_f32_16x16x32_bf16 v[116:119], a[196:199], v[44:47], v[116:119]
 v_mfma_f32_16x16x32_bf16 v[120:123], a[120:123], v[40:43], v[120:123]
 ds_read_b128 v[36:39], v21 offset:40960
 v_mfma_f32_16x16x32_bf16 v[120:123], a[124:127], v[44:47], v[120:123]
 buffer_load_dwordx4 v10, s[12:15], s48 offen  lds
 v_mfma_f32_16x16x32_bf16 v[124:127], v[232:235], v[40:43], v[124:127]
 v_mfma_f32_16x16x32_bf16 v[124:127], v[236:239], v[44:47], v[124:127]
 v_mfma_f32_16x16x32_bf16 v[128:131], a[48:51], v[48:51], v[128:131]
 ds_read_b128 v[40:43], v20 offset:43008
 v_mfma_f32_16x16x32_bf16 v[128:131], a[52:55], v[52:55], v[128:131]
 buffer_load_dwordx4 v11, s[12:15], s48 offen offset:1024  lds
 v_mfma_f32_16x16x32_bf16 v[132:135], a[192:195], v[48:51], v[132:135]
 v_mfma_f32_16x16x32_bf16 v[132:135], a[196:199], v[52:55], v[132:135]
 v_mfma_f32_16x16x32_bf16 v[136:139], a[120:123], v[48:51], v[136:139]
 ds_read_b128 v[44:47], v21 offset:43008
 v_mfma_f32_16x16x32_bf16 v[136:139], a[124:127], v[52:55], v[136:139]
 buffer_load_dwordx4 v12, s[12:15], s48 offen offset:2048  lds
 v_mfma_f32_16x16x32_bf16 v[140:143], v[232:235], v[48:51], v[140:143]
 v_mfma_f32_16x16x32_bf16 v[140:143], v[236:239], v[52:55], v[140:143]
 s_waitcnt lgkmcnt(2)
 v_mfma_f32_16x16x32_bf16 v[144:147], a[48:51], v[56:59], v[144:147]
 ds_read_b128 v[48:51], v20 offset:45056
 v_mfma_f32_16x16x32_bf16 v[144:147], a[52:55], v[60:63], v[144:147]
 buffer_load_dwordx4 v13, s[12:15], s48 offen offset:3072  lds
 s_add_u32 m0, s50, 102400
 v_mfma_f32_16x16x32_bf16 v[148:151], a[192:195], v[56:59], v[148:151]
 s_add_u32 s48, s48, 147456
 v_mfma_f32_16x16x32_bf16 v[148:151], a[196:199], v[60:63], v[148:151]
 v_mfma_f32_16x16x32_bf16 v[152:155], a[120:123], v[56:59], v[152:155]
 ds_read_b128 v[52:55], v21 offset:45056
 v_mfma_f32_16x16x32_bf16 v[152:155], a[124:127], v[60:63], v[152:155]
 buffer_load_dwordx4 v10, s[12:15], s48 offen  lds
 v_mfma_f32_16x16x32_bf16 v[156:159], v[232:235], v[56:59], v[156:159]
 v_mfma_f32_16x16x32_bf16 v[156:159], v[236:239], v[60:63], v[156:159]
 v_mfma_f32_16x16x32_bf16 v[160:163], a[48:51], v[32:35], v[160:163]
 ds_read_b128 v[56:59], v20 offset:47104
 v_mfma_f32_16x16x32_bf16 v[160:163], a[52:55], v[36:39], v[160:163]
 buffer_load_dwordx4 v11, s[12:15], s48 offen offset:1024  lds
 v_mfma_f32_16x16x32_bf16 v[164:167], a[192:195], v[32:35], v[164:167]
 v_mfma_f32_16x16x32_bf16 v[164:167], a[196:199], v[36:39], v[164:167]
 v_mfma_f32_16x16x32_bf16 v[168:171], a[120:123], v[32:35], v[168:171]
 ds_read_b128 v[60:63], v21 offset:47104
 v_mfma_f32_16x16x32_bf16 v[168:171], a[124:127], v[36:39], v[168:171]
 buffer_load_dwordx4 v12, s[12:15], s48 offen offset:2048  lds
 v_mfma_f32_16x16x32_bf16 v[172:175], v[232:235], v[32:35], v[172:175]
 v_mfma_f32_16x16x32_bf16 v[172:175], v[236:239], v[36:39], v[172:175]
 s_waitcnt lgkmcnt(2)
 v_mfma_f32_16x16x32_bf16 v[176:179], a[48:51], v[40:43], v[176:179]
 buffer_load_dwordx4 v13, s[12:15], s48 offen offset:3072  lds
 v_mfma_f32_16x16x32_bf16 v[176:179], a[52:55], v[44:47], v[176:179]
 v_mfma_f32_16x16x32_bf16 v[180:183], a[192:195], v[40:43], v[180:183]
 v_mfma_f32_16x16x32_bf16 v[180:183], a[196:199], v[44:47], v[180:183]
 v_mfma_f32_16x16x32_bf16 v[184:187], a[120:123], v[40:43], v[184:187]
 v_mfma_f32_16x16x32_bf16 v[184:187], a[124:127], v[44:47], v[184:187]
 v_mfma_f32_16x16x32_bf16 v[188:191], v[232:235], v[40:43], v[188:191]
 s_waitcnt vmcnt(12) lgkmcnt(0)
 s_barrier
 v_mfma_f32_16x16x32_bf16 v[188:191], v[236:239], v[44:47], v[188:191]
 ds_read_b128 v[32:35], v22 offset:32768
 v_mfma_f32_16x16x32_bf16 v[192:195], a[48:51], v[48:51], v[192:195]
 ds_read_b128 v[36:39], v23 offset:32768
 ds_read_b64_tr_b16 a[56:57], v28 offset:0
 v_mfma_f32_16x16x32_bf16 v[192:195], a[52:55], v[52:55], v[192:195]
 ds_read_b64_tr_b16 a[58:59], v28 offset:1024
 ds_read_b64_tr_b16 a[60:61], v28 offset:8192
 v_mfma_f32_16x16x32_bf16 v[196:199], a[192:195], v[48:51], v[196:199]
 ds_read_b64_tr_b16 a[62:63], v28 offset:9216
 ds_read_b64_tr_b16 a[200:201], v28 offset:16384
 v_mfma_f32_16x16x32_bf16 v[196:199], a[196:199], v[52:55], v[196:199]
 ds_read_b64_tr_b16 a[202:203], v28 offset:17408
 ds_read_b64_tr_b16 a[204:205], v28 offset:24576
 v_mfma_f32_16x16x32_bf16 v[200:203], a[120:123], v[48:51], v[200:203]
 ds_read_b64_tr_b16 a[206:207], v28 offset:25600
 ds_read_b64_tr_b16 a[128:129], v29 offset:0
 v_mfma_f32_16x16x32_bf16 v[200:203], a[124:127], v[52:55], v[200:203]
 ds_read_b64_tr_b16 a[130:131], v29 offset:1024
 ds_read_b64_tr_b16 a[132:133], v29 offset:8192
 v_mfma_f32_16x16x32_bf16 v[204:207], v[232:235], v[48:51], v[204:207]
 ds_read_b64_tr_b16 a[134:135], v29 offset:9216
 ds_read_b64_tr_b16 v[240:241], v29 offset:16384
 v_mfma_f32_16x16x32_bf16 v[204:207], v[236:239], v[52:55], v[204:207]
 ds_read_b64_tr_b16 v[242:243], v29 offset:17408
 ds_read_b64_tr_b16 v[244:245], v29 offset:24576
 s_waitcnt lgkmcnt(15)
 v_mfma_f32_16x16x32_bf16 v[208:211], a[48:51], v[56:59], v[208:211]
 ds_read_b64_tr_b16 v[246:247], v29 offset:25600
 v_mfma_f32_16x16x32_bf16 v[208:211], a[52:55], v[60:63], v[208:211]
 ds_read_b128 v[40:43], v22 offset:34816
 v_mfma_f32_16x16x32_bf16 v[212:215], a[192:195], v[56:59], v[212:215]
 s_sub_u32 s8, s8, 3072
 s_subb_u32 s9, s9, 0
 v_add_u32 v20, v5, v20
 v_mfma_f32_16x16x32_bf16 v[212:215], a[196:199], v[60:63], v[212:215]
 s_add_u32 s10, s10, 3072
 s_add_u32 s30, s30, 3072
 v_add_u32 v21, v5, v21
 v_mfma_f32_16x16x32_bf16 v[216:219], a[120:123], v[56:59], v[216:219]
 ds_read_b128 v[44:47], v23 offset:34816
 s_add_u32 s31, s31, 2048
 v_mfma_f32_16x16x32_bf16 v[216:219], a[124:127], v[60:63], v[216:219]
 ds_read_b128 v[48:51], v22 offset:36864
 s_add_u32 s32, s32, 1024
 v_mfma_f32_16x16x32_bf16 v[220:223], v[232:235], v[56:59], v[220:223]
 ds_read_b128 v[52:55], v23 offset:36864
 s_waitcnt lgkmcnt(8)
 v_mfma_f32_16x16x32_bf16 v[220:223], v[236:239], v[60:63], v[220:223]
 s_add_u32 s34, s34, 3072
 s_add_u32 s35, s35, 2048
 s_add_u32 s36, s36, 1024
 v_mfma_f32_16x16x32_bf16 v[96:99], a[56:59], v[32:35], v[96:99]
 ds_read_b128 v[56:59], v22 offset:38912
 s_add_u32 s38, s38, 3072
 v_mfma_f32_16x16x32_bf16 v[96:99], a[60:63], v[36:39], v[96:99]
 s_add_u32 m0, s56, 0
 v_mfma_f32_16x16x32_bf16 v[100:103], a[200:203], v[32:35], v[100:103]
 buffer_load_dwordx4 v18, s[8:11], s30 offen  lds
 v_mfma_f32_16x16x32_bf16 v[100:103], a[204:207], v[36:39], v[100:103]
 v_mfma_f32_16x16x32_bf16 v[104:107], a[128:131], v[32:35], v[104:107]
 ds_read_b128 v[60:63], v23 offset:38912
 s_waitcnt lgkmcnt(4)
 v_mfma_f32_16x16x32_bf16 v[104:107], a[132:135], v[36:39], v[104:107]
 s_cmp_ge_u32 s26, 4
 s_cbranch_scc1 L1_g10
 buffer_load_dwordx4 v18, s[8:11], s31 offen offset:1024  lds
 v_mfma_f32_16x16x32_bf16 v[108:111], v[240:243], v[32:35], v[108:111]
 v_mfma_f32_16x16x32_bf16 v[108:111], v[244:247], v[36:39], v[108:111]
 buffer_load_dwordx4 v18, s[8:11], s32 offen offset:2048  lds
 v_mfma_f32_16x16x32_bf16 v[112:115], a[56:59], v[40:43], v[112:115]
 ds_read_b128 v[32:35], v22 offset:40960
 v_mfma_f32_16x16x32_bf16 v[112:115], a[60:63], v[44:47], v[112:115]
 buffer_load_dwordx4 v18, s[8:11], s33 offen offset:3072  lds
 v_mfma_f32_16x16x32_bf16 v[116:119], a[200:203], v[40:43], v[116:119]
 v_mfma_f32_16x16x32_bf16 v[116:119], a[204:207], v[44:47], v[116:119]
 s_add_u32 m0, s56, 4096
 v_mfma_f32_16x16x32_bf16 v[120:123], a[128:131], v[40:43], v[120:123]
 ds_read_b128 v[36:39], v23 offset:40960
 v_mfma_f32_16x16x32_bf16 v[120:123], a[132:135], v[44:47], v[120:123]
 buffer_load_dwordx4 v18, s[8:11], s34 offen  lds
 v_mfma_f32_16x16x32_bf16 v[124:127], v[240:243], v[40:43], v[124:127]
 v_mfma_f32_16x16x32_bf16 v[124:127], v[244:247], v[44:47], v[124:127]
 s_waitcnt lgkmcnt(2)
 v_mfma_f32_16x16x32_bf16 v[128:131], a[56:59], v[48:51], v[128:131]
 ds_read_b128 v[40:43], v22 offset:43008
 v_mfma_f32_16x16x32_bf16 v[128:131], a[60:63], v[52:55], v[128:131]
 buffer_load_dwordx4 v18, s[8:11], s35 offen offset:1024  lds
 v_mfma_f32_16x16x32_bf16 v[132:135], a[200:203], v[48:51], v[132:135]
 v_mfma_f32_16x16x32_bf16 v[132:135], a[204:207], v[52:55], v[132:135]
 buffer_load_dwordx4 v18, s[8:11], s36 offen offset:2048  lds
 v_mfma_f32_16x16x32_bf16 v[136:139], a[128:131], v[48:51], v[136:139]
 ds_read_b128 v[44:47], v23 offset:43008
 v_mfma_f32_16x16x32_bf16 v[136:139], a[132:135], v[52:55], v[136:139]
 buffer_load_dwordx4 v18, s[8:11], s37 offen offset:3072  lds
 v_mfma_f32_16x16x32_bf16 v[140:143], v[240:243], v[48:51], v[140:143]
 v_mfma_f32_16x16x32_bf16 v[140:143], v[244:247], v[52:55], v[140:143]
 s_add_u32 m0, s56, 8192
 v_mfma_f32_16x16x32_bf16 v[144:147], a[56:59], v[56:59], v[144:147]
 ds_read_b128 v[48:51], v22 offset:45056
 v_mfma_f32_16x16x32_bf16 v[144:147], a[60:63], v[60:63], v[144:147]
 buffer_load_dwordx4 v18, s[8:11], s38 offen  lds
 v_mfma_f32_16x16x32_bf16 v[148:151], a[200:203], v[56:59], v[148:151]
 v_mfma_f32_16x16x32_bf16 v[148:151], a[204:207], v[60:63], v[148:151]
 v_add_u32 v18, 36864, v18
 v_mfma_f32_16x16x32_bf16 v[152:155], a[128:131], v[56:59], v[152:155]
 ds_read_b128 v[52:55], v23 offset:45056
 s_add_u32 m0, s82, 146688
 v_mfma_f32_16x16x32_bf16 v[152:155], a[132:135], v[60:63], v[152:155]
 buffer_load_dwordx4 v7, s[20:23], s57 offen offset:768 lds
 v_mfma_f32_16x16x32_bf16 v[156:159], v[240:243], v[56:59], v[156:159]
 s_add_u32 m0, s82, 150656
 v_mfma_f32_16x16x32_bf16 v[156:159], v[244:247], v[60:63], v[156:159]
 s_waitcnt lgkmcnt(2)
 v_mfma_f32_16x16x32_bf16 v[160:163], a[56:59], v[32:35], v[160:163]
 ds_read_b128 v[56:59], v22 offset:47104
 v_mfma_f32_16x16x32_bf16 v[160:163], a[60:63], v[36:39], v[160:163]
 buffer_load_dwordx4 v7, s[20:23], s57 offen offset:896 lds
 v_mfma_f32_16x16x32_bf16 v[164:167], a[200:203], v[32:35], v[164:167]
 v_mfma_f32_16x16x32_bf16 v[164:167], a[204:207], v[36:39], v[164:167]
 v_mfma_f32_16x16x32_bf16 v[168:171], a[128:131], v[32:35], v[168:171]
 ds_read_b128 v[60:63], v23 offset:47104
 v_mfma_f32_16x16x32_bf16 v[168:171], a[132:135], v[36:39], v[168:171]
 v_mfma_f32_16x16x32_bf16 v[172:175], v[240:243], v[32:35], v[172:175]
 v_mfma_f32_16x16x32_bf16 v[172:175], v[244:247], v[36:39], v[172:175]
 v_mfma_f32_16x16x32_bf16 v[176:179], a[56:59], v[40:43], v[176:179]
 v_mfma_f32_16x16x32_bf16 v[176:179], a[60:63], v[44:47], v[176:179]
 v_mfma_f32_16x16x32_bf16 v[180:183], a[200:203], v[40:43], v[180:183]
 v_mfma_f32_16x16x32_bf16 v[180:183], a[204:207], v[44:47], v[180:183]
 v_mfma_f32_16x16x32_bf16 v[184:187], a[128:131], v[40:43], v[184:187]
 v_mfma_f32_16x16x32_bf16 v[184:187], a[132:135], v[44:47], v[184:187]
 v_mfma_f32_16x16x32_bf16 v[188:191], v[240:243], v[40:43], v[188:191]
 s_waitcnt vmcnt(11) lgkmcnt(0)
 s_barrier
 v_mfma_f32_16x16x32_bf16 v[188:191], v[244:247], v[44:47], v[188:191]
 ds_read_b128 v[32:35], v24 offset:32768
 v_mfma_f32_16x16x32_bf16 v[192:195], a[56:59], v[48:51], v[192:195]
 ds_read_b128 v[36:39], v25 offset:32768
 ds_read_b64_tr_b16 a[64:65], v30 offset:0
 v_mfma_f32_16x16x32_bf16 v[192:195], a[60:63], v[52:55], v[192:195]
 ds_read_b64_tr_b16 a[66:67], v30 offset:1024
 ds_read_b64_tr_b16 a[68:69], v30 offset:8192
 v_mfma_f32_16x16x32_bf16 v[196:199], a[200:203], v[48:51], v[196:199]
Lpg2:
 s_cbranch_vccnz Lj_Lfin
 ds_read_b64_tr_b16 a[70:71], v30 offset:9216
 ds_read_b64_tr_b16 a[208:209], v30 offset:16384
 v_mfma_f32_16x16x32_bf16 v[196:199], a[204:207], v[52:55], v[196:199]
 ds_read_b64_tr_b16 a[210:211], v30 offset:17408
 ds_read_b64_tr_b16 a[212:213], v30 offset:24576
 v_mfma_f32_16x16x32_bf16 v[200:203], a[128:131], v[48:51], v[200:203]
 ds_read_b64_tr_b16 a[214:215], v30 offset:25600
 ds_read_b64_tr_b16 a[136:137], v31 offset:0
 v_mfma_f32_16x16x32_bf16 v[200:203], a[132:135], v[52:55], v[200:203]
 ds_read_b64_tr_b16 a[138:139], v31 offset:1024
 ds_read_b64_tr_b16 a[140:141], v31 offset:8192
 v_mfma_f32_16x16x32_bf16 v[204:207], v[240:243], v[48:51], v[204:207]
 ds_read_b64_tr_b16 a[142:143], v31 offset:9216
 ds_read_b64_tr_b16 v[248:249], v31 offset:16384
 v_mfma_f32_16x16x32_bf16 v[204:207], v[244:247], v[52:55], v[204:207]
 ds_read_b64_tr_b16 v[250:251], v31 offset:17408
 ds_read_b64_tr_b16 v[252:253], v31 offset:24576
 v_mfma_f32_16x16x32_bf16 v[208:211], a[56:59], v[56:59], v[208:211]
 ds_read_b64_tr_b16 v[254:255], v31 offset:25600
 v_mfma_f32_16x16x32_bf16 v[208:211], a[60:63], v[60:63], v[208:211]
 ds_read_b128 v[40:43], v24 offset:34816
 v_mfma_f32_16x16x32_bf16 v[212:215], a[200:203], v[56:59], v[212:215]
 s_add_u32 m0, s56, 49152
 v_add_u32 v22, v5, v22
 v_mfma_f32_16x16x32_bf16 v[212:215], a[204:207], v[60:63], v[212:215]
 v_add_u32 v23, v5, v23
 v_mfma_f32_16x16x32_bf16 v[216:219], a[128:131], v[56:59], v[216:219]
 ds_read_b128 v[44:47], v25 offset:34816
 v_mfma_f32_16x16x32_bf16 v[216:219], a[132:135], v[60:63], v[216:219]
 ds_read_b128 v[48:51], v24 offset:36864
 v_mfma_f32_16x16x32_bf16 v[220:223], v[240:243], v[56:59], v[220:223]
 ds_read_b128 v[52:55], v25 offset:36864
 v_mfma_f32_16x16x32_bf16 v[220:223], v[244:247], v[60:63], v[220:223]
 s_waitcnt lgkmcnt(4)
 v_mfma_f32_16x16x32_bf16 v[96:99], a[64:67], v[32:35], v[96:99]
 ds_read_b128 v[56:59], v24 offset:38912
 v_mfma_f32_16x16x32_bf16 v[96:99], a[68:71], v[36:39], v[96:99]
 buffer_load_dwordx4 v18, s[8:11], s30 offen  lds
 v_mfma_f32_16x16x32_bf16 v[100:103], a[208:211], v[32:35], v[100:103]
 v_mfma_f32_16x16x32_bf16 v[100:103], a[212:215], v[36:39], v[100:103]
 buffer_load_dwordx4 v18, s[8:11], s31 offen offset:1024  lds
 v_mfma_f32_16x16x32_bf16 v[104:107], a[136:139], v[32:35], v[104:107]
 ds_read_b128 v[60:63], v25 offset:38912
 v_mfma_f32_16x16x32_bf16 v[104:107], a[140:143], v[36:39], v[104:107]
 buffer_load_dwordx4 v18, s[8:11], s32 offen offset:2048  lds
 v_mfma_f32_16x16x32_bf16 v[108:111], v[248:251], v[32:35], v[108:111]
 v_mfma_f32_16x16x32_bf16 v[108:111], v[252:255], v[36:39], v[108:111]
 s_waitcnt lgkmcnt(2)
 v_mfma_f32_16x16x32_bf16 v[112:115], a[64:67], v[40:43], v[112:115]
 ds_read_b128 v[32:35], v24 offset:40960
 v_mfma_f32_16x16x32_bf16 v[112:115], a[68:71], v[44:47], v[112:115]
 buffer_load_dwordx4 v18, s[8:11], s33 offen offset:3072  lds
 v_mfma_f32_16x16x32_bf16 v[116:119], a[208:211], v[40:43], v[116:119]
 v_mfma_f32_16x16x32_bf16 v[116:119], a[212:215], v[44:47], v[116:119]
 s_add_u32 m0, s56, 53248
 v_mfma_f32_16x16x32_bf16 v[120:123], a[136:139], v[40:43], v[120:123]
 ds_read_b128 v[36:39], v25 offset:40960
 v_mfma_f32_16x16x32_bf16 v[120:123], a[140:143], v[44:47], v[120:123]
 buffer_load_dwordx4 v18, s[8:11], s34 offen  lds
 v_mul_f32 v100, v96, v100
 v_mfma_f32_16x16x32_bf16 v[124:127], v[248:251], v[40:43], v[124:127]
 v_mul_f32 v96, s54, v96
 v_mul_f32 v101, v97, v101
 v_mfma_f32_16x16x32_bf16 v[124:127], v[252:255], v[44:47], v[124:127]
 buffer_load_dwordx4 v18, s[8:11], s35 offen offset:1024  lds
 v_mul_f32 v97, s54, v97
 v_mfma_f32_16x16x32_bf16 v[128:131], a[64:67], v[48:51], v[128:131]
 ds_read_b128 v[40:43], v24 offset:43008
 v_mul_f32 v102, v98, v102
 v_mfma_f32_16x16x32_bf16 v[128:131], a[68:71], v[52:55], v[128:131]
 buffer_load_dwordx4 v18, s[8:11], s36 offen offset:2048  lds
 v_mul_f32 v98, s54, v98
 v_mfma_f32_16x16x32_bf16 v[132:135], a[208:211], v[48:51], v[132:135]
 v_exp_f32 v96, v96
 v_mfma_f32_16x16x32_bf16 v[132:135], a[212:215], v[52:55], v[132:135]
 buffer_load_dwordx4 v18, s[8:11], s37 offen offset:3072  lds
 v_add_f32 v96, 1.0, v96
 v_mfma_f32_16x16x32_bf16 v[136:139], a[136:139], v[48:51], v[136:139]
 ds_read_b128 v[44:47], v25 offset:43008
 v_mul_f32 v103, v99, v103
 v_mfma_f32_16x16x32_bf16 v[136:139], a[140:143], v[52:55], v[136:139]
 s_add_u32 m0, s56, 57344
 v_rcp_f32 v96, v96
 v_mfma_f32_16x16x32_bf16 v[140:143], v[248:251], v[48:51], v[140:143]
 buffer_load_dwordx4 v18, s[8:11], s38 offen  lds
 v_mul_f32 v100, v96, v100
 v_mfma_f32_16x16x32_bf16 v[140:143], v[252:255], v[52:55], v[140:143]
 s_waitcnt lgkmcnt(2)
 v_exp_f32 v97, v97
 v_mfma_f32_16x16x32_bf16 v[144:147], a[64:67], v[56:59], v[144:147]
 ds_read_b128 v[48:51], v24 offset:45056
 v_add_u32 v18, 36864, v18
 v_mfma_f32_16x16x32_bf16 v[144:147], a[68:71], v[60:63], v[144:147]
 s_add_u32 m0, s82, 154624
 v_exp_f32 v98, v98
 v_mfma_f32_16x16x32_bf16 v[148:151], a[208:211], v[56:59], v[148:151]
 buffer_load_dwordx4 v7, s[20:23], s57 offen offset:1024 lds
 v_add_f32 v97, 1.0, v97
 v_mfma_f32_16x16x32_bf16 v[148:151], a[212:215], v[60:63], v[148:151]
 s_add_u32 m0, s82, 36864
 v_rcp_f32 v97, v97
 v_mfma_f32_16x16x32_bf16 v[152:155], a[136:139], v[56:59], v[152:155]
 ds_read_b128 v[52:55], v25 offset:45056
 v_mul_f32 v101, v97, v101
 v_mfma_f32_16x16x32_bf16 v[152:155], a[140:143], v[60:63], v[152:155]
 buffer_load_dwordx4 v7, s[20:23], s57 offen lds
 v_add_f32 v98, 1.0, v98
 v_mfma_f32_16x16x32_bf16 v[156:159], v[248:251], v[56:59], v[156:159]
 s_add_u32 m0, s82, 40832
 v_rcp_f32 v98, v98
 v_mfma_f32_16x16x32_bf16 v[156:159], v[252:255], v[60:63], v[156:159]
 buffer_load_dwordx4 v7, s[20:23], s57 offen offset:128 lds
 v_mul_f32 v102, v98, v102
 v_mfma_f32_16x16x32_bf16 v[160:163], a[64:67], v[32:35], v[160:163]
 ds_read_b128 v[56:59], v24 offset:47104
 v_mul_f32 v99, s54, v99
 v_mfma_f32_16x16x32_bf16 v[160:163], a[68:71], v[36:39], v[160:163]
 v_exp_f32 v99, v99
 v_mfma_f32_16x16x32_bf16 v[164:167], a[208:211], v[32:35], v[164:167]
 v_add_f32 v99, 1.0, v99
 v_mul_f32 v108, v104, v108
 v_mfma_f32_16x16x32_bf16 v[164:167], a[212:215], v[36:39], v[164:167]
 v_rcp_f32 v99, v99
 v_mfma_f32_16x16x32_bf16 v[168:171], a[136:139], v[32:35], v[168:171]
 ds_read_b128 v[60:63], v25 offset:47104
 v_mul_f32 v103, v99, v103
 v_mfma_f32_16x16x32_bf16 v[168:171], a[140:143], v[36:39], v[168:171]
 v_mul_f32 v104, s54, v104
 v_mul_f32 v109, v105, v109
 v_mfma_f32_16x16x32_bf16 v[172:175], v[248:251], v[32:35], v[172:175]
 v_exp_f32 v104, v104
 v_mfma_f32_16x16x32_bf16 v[172:175], v[252:255], v[36:39], v[172:175]
 s_waitcnt lgkmcnt(2)
 v_add_f32 v104, 1.0, v104
 v_mul_f32 v105, s54, v105
 v_mfma_f32_16x16x32_bf16 v[176:179], a[64:67], v[40:43], v[176:179]
 v_rcp_f32 v104, v104
 v_mfma_f32_16x16x32_bf16 v[176:179], a[68:71], v[44:47], v[176:179]
 v_exp_f32 v105, v105
 v_mfma_f32_16x16x32_bf16 v[180:183], a[208:211], v[40:43], v[180:183]
 v_mul_f32 v108, v104, v108
 v_add_f32 v105, 1.0, v105
 v_mfma_f32_16x16x32_bf16 v[180:183], a[212:215], v[44:47], v[180:183]
 v_rcp_f32 v105, v105
 v_mfma_f32_16x16x32_bf16 v[184:187], a[136:139], v[40:43], v[184:187]
 v_mul_f32 v109, v105, v109
 v_mul_f32 v110, v106, v110
 v_mfma_f32_16x16x32_bf16 v[184:187], a[140:143], v[44:47], v[184:187]
 v_mul_f32 v106, s54, v106
 v_mul_f32 v111, v107, v111
 v_mfma_f32_16x16x32_bf16 v[188:191], v[248:251], v[40:43], v[188:191]
 s_waitcnt vmcnt(14) lgkmcnt(0)
 s_barrier
 v_mul_f32 v107, s54, v107
 v_mfma_f32_16x16x32_bf16 v[188:191], v[252:255], v[44:47], v[188:191]
 ds_read_b128 v[32:35], v20 offset:0
 v_cvt_pk_bf16_f32 v96, v100, v101
 v_mfma_f32_16x16x32_bf16 v[192:195], a[64:67], v[48:51], v[192:195]
 ds_read_b128 v[36:39], v21 offset:0
 v_cvt_pk_bf16_f32 v97, v102, v103
 v_mfma_f32_16x16x32_bf16 v[192:195], a[68:71], v[52:55], v[192:195]
 ds_read_b128 v[40:43], v20 offset:1024
 v_cvt_pk_bf16_f32 v98, v108, v109
 v_mfma_f32_16x16x32_bf16 v[196:199], a[208:211], v[48:51], v[196:199]
 v_exp_f32 v106, v106
 v_mfma_f32_16x16x32_bf16 v[196:199], a[212:215], v[52:55], v[196:199]
 v_exp_f32 v107, v107
 v_mfma_f32_16x16x32_bf16 v[200:203], a[136:139], v[48:51], v[200:203]
 ds_read_b128 v[44:47], v21 offset:1024
 s_add_u32 m0, s82, 44800
 v_mfma_f32_16x16x32_bf16 v[200:203], a[140:143], v[52:55], v[200:203]
 buffer_load_dwordx4 v7, s[20:23], s57 offen offset:256 lds
 v_add_f32 v106, 1.0, v106
 v_mfma_f32_16x16x32_bf16 v[204:207], v[248:251], v[48:51], v[204:207]
 v_rcp_f32 v106, v106
 v_mfma_f32_16x16x32_bf16 v[204:207], v[252:255], v[52:55], v[204:207]
 s_waitcnt lgkmcnt(2)
 v_mul_f32 v110, v106, v110
 v_add_f32 v107, 1.0, v107
 v_mfma_f32_16x16x32_bf16 v[208:211], a[64:67], v[56:59], v[208:211]
 ds_read_b128 v[48:51], v20 offset:2048
 v_mul_f32 v116, v112, v116
 v_mfma_f32_16x16x32_bf16 v[208:211], a[68:71], v[60:63], v[208:211]
 v_rcp_f32 v107, v107
 v_mfma_f32_16x16x32_bf16 v[212:215], a[208:211], v[56:59], v[212:215]
 v_add_u32 v24, v5, v24
 v_mul_f32 v111, v107, v111
 v_mfma_f32_16x16x32_bf16 v[212:215], a[212:215], v[60:63], v[212:215]
 v_add_u32 v25, v5, v25
 v_cvt_pk_bf16_f32 v99, v110, v111
 v_mfma_f32_16x16x32_bf16 v[216:219], a[136:139], v[56:59], v[216:219]
 ds_read_b128 v[52:55], v21 offset:2048
 v_mul_f32 v112, s54, v112
 v_mfma_f32_16x16x32_bf16 v[216:219], a[140:143], v[60:63], v[216:219]
 s_add_u32 m0, s82, 85632
 buffer_store_dwordx4 v[96:99], v19, s[16:19], s53 offen sc1
 v_mfma_f32_16x16x32_bf16 v[220:223], v[248:251], v[56:59], v[220:223]
 buffer_load_dwordx4 v7, s[20:23], s57 offen offset:384 lds
 s_add_u32 s53, s53, s52
 v_mfma_f32_16x16x32_bf16 v[220:223], v[252:255], v[60:63], v[220:223]
 v_exp_f32 v112, v112
 v_mfma_f32_16x16x32_bf16 v[64:67], a[0:3], v[32:35], 0
 ds_read_b128 v[56:59], v20 offset:3072
 v_add_f32 v112, 1.0, v112
 v_mfma_f32_16x16x32_bf16 v[64:67], a[4:7], v[36:39], v[64:67]
 v_rcp_f32 v112, v112
 v_mfma_f32_16x16x32_bf16 v[68:71], a[144:147], v[32:35], 0
 v_mul_f32 v116, v112, v116
 v_mul_f32 v117, v113, v117
 v_mfma_f32_16x16x32_bf16 v[68:71], a[148:151], v[36:39], v[68:71]
 v_mul_f32 v113, s54, v113
 v_mul_f32 v118, v114, v118
 v_mfma_f32_16x16x32_bf16 v[72:75], a[72:75], v[32:35], 0
 ds_read_b128 v[60:63], v21 offset:3072
 v_mul_f32 v114, s54, v114
 v_mfma_f32_16x16x32_bf16 v[72:75], a[76:79], v[36:39], v[72:75]
 v_exp_f32 v113, v113
 v_mfma_f32_16x16x32_bf16 v[76:79], a[216:219], v[32:35], 0
 s_add_u32 m0, s82, 89600
 v_exp_f32 v114, v114
 v_mfma_f32_16x16x32_bf16 v[76:79], a[220:223], v[36:39], v[76:79]
 s_waitcnt lgkmcnt(2)
 v_add_f32 v113, 1.0, v113
 v_add_f32 v114, 1.0, v114
 v_mfma_f32_16x16x32_bf16 v[64:67], a[8:11], v[40:43], v[64:67]
 ds_read_b128 v[32:35], v20 offset:4096
 v_mul_f32 v119, v115, v119
 v_mfma_f32_16x16x32_bf16 v[64:67], a[12:15], v[44:47], v[64:67]
 buffer_load_dwordx4 v7, s[20:23], s57 offen offset:512 lds
 v_mul_f32 v115, s54, v115
 v_mfma_f32_16x16x32_bf16 v[68:71], a[152:155], v[40:43], v[68:71]
 v_rcp_f32 v113, v113
 v_mfma_f32_16x16x32_bf16 v[68:71], a[156:159], v[44:47], v[68:71]
 v_rcp_f32 v114, v114
 v_mfma_f32_16x16x32_bf16 v[72:75], a[80:83], v[40:43], v[72:75]
 ds_read_b128 v[36:39], v21 offset:4096
 v_mul_f32 v117, v113, v117
 v_mfma_f32_16x16x32_bf16 v[72:75], a[84:87], v[44:47], v[72:75]
 v_exp_f32 v115, v115
 v_mfma_f32_16x16x32_bf16 v[76:79], a[224:227], v[40:43], v[76:79]
 v_mul_f32 v118, v114, v118
 v_add_f32 v115, 1.0, v115
 v_mfma_f32_16x16x32_bf16 v[76:79], a[228:231], v[44:47], v[76:79]
 v_rcp_f32 v115, v115
 v_mfma_f32_16x16x32_bf16 v[64:67], a[16:19], v[48:51], v[64:67]
 ds_read_b128 v[40:43], v20 offset:5120
 v_mul_f32 v119, v115, v119
 v_mfma_f32_16x16x32_bf16 v[64:67], a[20:23], v[52:55], v[64:67]
 s_add_u32 m0, s82, 93568
 v_mul_f32 v124, v120, v124
 v_mul_f32 v125, v121, v125
 v_mfma_f32_16x16x32_bf16 v[68:71], a[160:163], v[48:51], v[68:71]
 buffer_load_dwordx4 v7, s[20:23], s57 offen offset:640 lds
 v_mul_f32 v120, s54, v120
 v_mfma_f32_16x16x32_bf16 v[68:71], a[164:167], v[52:55], v[68:71]
 v_exp_f32 v120, v120
 v_mfma_f32_16x16x32_bf16 v[72:75], a[88:91], v[48:51], v[72:75]
 ds_read_b128 v[44:47], v21 offset:5120
 v_add_f32 v120, 1.0, v120
 v_mfma_f32_16x16x32_bf16 v[72:75], a[92:95], v[52:55], v[72:75]
 v_rcp_f32 v120, v120
 v_mfma_f32_16x16x32_bf16 v[76:79], a[232:235], v[48:51], v[76:79]
 v_mul_f32 v124, v120, v124
 v_mul_f32 v121, s54, v121
 v_mfma_f32_16x16x32_bf16 v[76:79], a[236:239], v[52:55], v[76:79]
 s_waitcnt lgkmcnt(2)
 v_exp_f32 v121, v121
 v_mfma_f32_16x16x32_bf16 v[64:67], a[24:27], v[56:59], v[64:67]
 ds_read_b128 v[48:51], v20 offset:6144
 v_add_f32 v121, 1.0, v121
 v_mfma_f32_16x16x32_bf16 v[64:67], a[28:31], v[60:63], v[64:67]
 v_rcp_f32 v121, v121
 v_mfma_f32_16x16x32_bf16 v[68:71], a[168:171], v[56:59], v[68:71]
 v_mul_f32 v125, v121, v125
 v_mul_f32 v126, v122, v126
 v_mfma_f32_16x16x32_bf16 v[68:71], a[172:175], v[60:63], v[68:71]
 v_mul_f32 v122, s54, v122
 v_mul_f32 v127, v123, v127
 v_mfma_f32_16x16x32_bf16 v[72:75], a[96:99], v[56:59], v[72:75]
 ds_read_b128 v[52:55], v21 offset:6144
 v_mul_f32 v123, s54, v123
 v_mfma_f32_16x16x32_bf16 v[72:75], a[100:103], v[60:63], v[72:75]
 v_exp_f32 v122, v122
 v_mfma_f32_16x16x32_bf16 v[76:79], a[240:243], v[56:59], v[76:79]
 v_exp_f32 v123, v123
 v_mfma_f32_16x16x32_bf16 v[76:79], a[244:247], v[60:63], v[76:79]
 v_add_f32 v122, 1.0, v122
 v_add_f32 v123, 1.0, v123
 v_mfma_f32_16x16x32_bf16 v[64:67], a[32:35], v[32:35], v[64:67]
 ds_read_b128 v[56:59], v20 offset:7168
 v_cvt_pk_bf16_f32 v112, v116, v117
 v_mfma_f32_16x16x32_bf16 v[64:67], a[36:39], v[36:39], v[64:67]
 v_rcp_f32 v122, v122
 v_mfma_f32_16x16x32_bf16 v[68:71], a[176:179], v[32:35], v[68:71]
 v_rcp_f32 v123, v123
 v_mfma_f32_16x16x32_bf16 v[68:71], a[180:183], v[36:39], v[68:71]
 v_mul_f32 v126, v122, v126
 v_mul_f32 v127, v123, v127
 v_mfma_f32_16x16x32_bf16 v[72:75], a[104:107], v[32:35], v[72:75]
 ds_read_b128 v[60:63], v21 offset:7168
 v_cvt_pk_bf16_f32 v113, v118, v119
 v_mfma_f32_16x16x32_bf16 v[72:75], a[108:111], v[36:39], v[72:75]
 v_cvt_pk_bf16_f32 v114, v124, v125
 v_cvt_pk_bf16_f32 v115, v126, v127
 v_mfma_f32_16x16x32_bf16 v[76:79], a[248:251], v[32:35], v[76:79]
 buffer_store_dwordx4 v[112:115], v19, s[16:19], s53 offen sc1
 v_mul_f32 v132, v128, v132
 v_mfma_f32_16x16x32_bf16 v[76:79], a[252:255], v[36:39], v[76:79]
 s_waitcnt lgkmcnt(2)
 s_add_u32 s53, s53, s52
 v_mul_f32 v128, s54, v128
 v_mfma_f32_16x16x32_bf16 v[64:67], a[40:43], v[40:43], v[64:67]
 ds_read_b128 v[32:35], v20 offset:8192
 v_mul_f32 v133, v129, v133
 v_mfma_f32_16x16x32_bf16 v[64:67], a[44:47], v[44:47], v[64:67]
 v_exp_f32 v128, v128
 v_mfma_f32_16x16x32_bf16 v[68:71], a[184:187], v[40:43], v[68:71]
 v_add_f32 v128, 1.0, v128
 v_mul_f32 v129, s54, v129
 v_mfma_f32_16x16x32_bf16 v[68:71], a[188:191], v[44:47], v[68:71]
 v_rcp_f32 v128, v128
 v_mfma_f32_16x16x32_bf16 v[72:75], a[112:115], v[40:43], v[72:75]
 ds_read_b128 v[36:39], v21 offset:8192
 v_mul_f32 v132, v128, v132
 v_mfma_f32_16x16x32_bf16 v[72:75], a[116:119], v[44:47], v[72:75]
 v_exp_f32 v129, v129
 v_mfma_f32_16x16x32_bf16 v[76:79], v[224:227], v[40:43], v[76:79]
 v_add_f32 v129, 1.0, v129
 v_mul_f32 v134, v130, v134
 v_mfma_f32_16x16x32_bf16 v[76:79], v[228:231], v[44:47], v[76:79]
 v_rcp_f32 v129, v129
 v_mfma_f32_16x16x32_bf16 v[64:67], a[48:51], v[48:51], v[64:67]
 ds_read_b128 v[40:43], v20 offset:18432
 v_mul_f32 v133, v129, v133
 v_mfma_f32_16x16x32_bf16 v[64:67], a[52:55], v[52:55], v[64:67]
 v_mul_f32 v130, s54, v130
 v_mul_f32 v135, v131, v135
 v_mfma_f32_16x16x32_bf16 v[68:71], a[192:195], v[48:51], v[68:71]
 v_exp_f32 v130, v130
 v_mfma_f32_16x16x32_bf16 v[68:71], a[196:199], v[52:55], v[68:71]
 v_add_f32 v130, 1.0, v130
 v_mul_f32 v131, s54, v131
 v_mfma_f32_16x16x32_bf16 v[72:75], a[120:123], v[48:51], v[72:75]
 ds_read_b128 v[44:47], v21 offset:18432
 v_mul_f32 v140, v136, v140
 v_mfma_f32_16x16x32_bf16 v[72:75], a[124:127], v[52:55], v[72:75]
 s_add_u32 m0, s56, 98304
 v_rcp_f32 v130, v130
 v_mfma_f32_16x16x32_bf16 v[76:79], v[232:235], v[48:51], v[76:79]
 buffer_load_dwordx4 v18, s[8:11], s30 offen  lds
 v_mul_f32 v134, v130, v134
 v_mfma_f32_16x16x32_bf16 v[76:79], v[236:239], v[52:55], v[76:79]
 s_waitcnt lgkmcnt(2)
 v_exp_f32 v131, v131
 v_mfma_f32_16x16x32_bf16 v[64:67], a[56:59], v[56:59], v[64:67]
 ds_read_b128 v[48:51], v20 offset:19456
 v_add_f32 v131, 1.0, v131
 v_mfma_f32_16x16x32_bf16 v[64:67], a[60:63], v[60:63], v[64:67]
 v_rcp_f32 v131, v131
 v_mfma_f32_16x16x32_bf16 v[68:71], a[200:203], v[56:59], v[68:71]
 buffer_load_dwordx4 v18, s[8:11], s31 offen offset:1024  lds
 v_mul_f32 v135, v131, v135
 v_mfma_f32_16x16x32_bf16 v[68:71], a[204:207], v[60:63], v[68:71]
 v_mul_f32 v136, s54, v136
 v_mul_f32 v141, v137, v141
 v_mfma_f32_16x16x32_bf16 v[72:75], a[128:131], v[56:59], v[72:75]
 ds_read_b128 v[52:55], v21 offset:19456
 v_mul_f32 v137, s54, v137
 v_mfma_f32_16x16x32_bf16 v[72:75], a[132:135], v[60:63], v[72:75]
 v_exp_f32 v136, v136
 v_mfma_f32_16x16x32_bf16 v[76:79], v[240:243], v[56:59], v[76:79]
 buffer_load_dwordx4 v18, s[8:11], s32 offen offset:2048  lds
 v_add_f32 v136, 1.0, v136
 v_mfma_f32_16x16x32_bf16 v[76:79], v[244:247], v[60:63], v[76:79]
 v_rcp_f32 v136, v136
 v_mfma_f32_16x16x32_bf16 v[64:67], a[64:67], v[32:35], v[64:67]
 ds_read_b128 v[56:59], v20 offset:20480
 v_mul_f32 v140, v136, v140
 v_mfma_f32_16x16x32_bf16 v[64:67], a[68:71], v[36:39], v[64:67]
 v_exp_f32 v137, v137
 v_mfma_f32_16x16x32_bf16 v[68:71], a[208:211], v[32:35], v[68:71]
 buffer_load_dwordx4 v18, s[8:11], s33 offen offset:3072  lds
 v_add_f32 v137, 1.0, v137
 v_mfma_f32_16x16x32_bf16 v[68:71], a[212:215], v[36:39], v[68:71]
 v_rcp_f32 v137, v137
 v_mfma_f32_16x16x32_bf16 v[72:75], a[136:139], v[32:35], v[72:75]
 ds_read_b128 v[60:63], v21 offset:20480
 v_mul_f32 v141, v137, v141
 v_mfma_f32_16x16x32_bf16 v[72:75], a[140:143], v[36:39], v[72:75]
 v_mul_f32 v142, v138, v142
 v_mul_f32 v143, v139, v143
 v_mfma_f32_16x16x32_bf16 v[76:79], v[248:251], v[32:35], v[76:79]
 s_add_u32 m0, s56, 102400
 v_mul_f32 v138, s54, v138
 v_mul_f32 v139, s54, v139
 v_mfma_f32_16x16x32_bf16 v[76:79], v[252:255], v[36:39], v[76:79]
 s_waitcnt lgkmcnt(2)
 v_exp_f32 v138, v138
 v_mfma_f32_16x16x32_bf16 v[80:83], a[0:3], v[40:43], 0
 ds_read_b128 v[32:35], v20 offset:21504
 v_add_f32 v138, 1.0, v138
 v_mfma_f32_16x16x32_bf16 v[80:83], a[4:7], v[44:47], v[80:83]
 buffer_load_dwordx4 v18, s[8:11], s34 offen  lds
 v_cvt_pk_bf16_f32 v128, v132, v133
 v_mfma_f32_16x16x32_bf16 v[84:87], a[144:147], v[40:43], 0
 v_rcp_f32 v138, v138
 v_mfma_f32_16x16x32_bf16 v[84:87], a[148:151], v[44:47], v[84:87]
 v_exp_f32 v139, v139
 v_mfma_f32_16x16x32_bf16 v[88:91], a[72:75], v[40:43], 0
 ds_read_b128 v[36:39], v21 offset:21504
 v_mul_f32 v142, v138, v142
 v_mfma_f32_16x16x32_bf16 v[88:91], a[76:79], v[44:47], v[88:91]
 buffer_load_dwordx4 v18, s[8:11], s35 offen offset:1024  lds
 v_add_f32 v139, 1.0, v139
 v_mfma_f32_16x16x32_bf16 v[92:95], a[216:219], v[40:43], 0
 v_rcp_f32 v139, v139
 v_mfma_f32_16x16x32_bf16 v[92:95], a[220:223], v[44:47], v[92:95]
 v_mul_f32 v143, v139, v143
 v_cvt_pk_bf16_f32 v129, v134, v135
 v_mfma_f32_16x16x32_bf16 v[80:83], a[8:11], v[48:51], v[80:83]
 ds_read_b128 v[40:43], v20 offset:22528
 v_cvt_pk_bf16_f32 v130, v140, v141
 v_mfma_f32_16x16x32_bf16 v[80:83], a[12:15], v[52:55], v[80:83]
 v_cvt_pk_bf16_f32 v131, v142, v143
 v_mul_f32 v148, v144, v148
 v_mfma_f32_16x16x32_bf16 v[84:87], a[152:155], v[48:51], v[84:87]
 buffer_store_dwordx4 v[128:131], v19, s[16:19], s53 offen sc1
 v_mul_f32 v144, s54, v144
 v_mfma_f32_16x16x32_bf16 v[84:87], a[156:159], v[52:55], v[84:87]
 s_add_u32 s53, s53, s52
 v_exp_f32 v144, v144
 v_mfma_f32_16x16x32_bf16 v[88:91], a[80:83], v[48:51], v[88:91]
 ds_read_b128 v[44:47], v21 offset:22528
 v_add_f32 v144, 1.0, v144
 v_mfma_f32_16x16x32_bf16 v[88:91], a[84:87], v[52:55], v[88:91]
 v_rcp_f32 v144, v144
 v_mfma_f32_16x16x32_bf16 v[92:95], a[224:227], v[48:51], v[92:95]
 v_mul_f32 v148, v144, v148
 v_mul_f32 v149, v145, v149
 v_mfma_f32_16x16x32_bf16 v[92:95], a[228:231], v[52:55], v[92:95]
 s_waitcnt lgkmcnt(2)
 v_mul_f32 v145, s54, v145
 v_mul_f32 v150, v146, v150
 v_mfma_f32_16x16x32_bf16 v[80:83], a[16:19], v[56:59], v[80:83]
 ds_read_b128 v[48:51], v20 offset:23552
 v_mul_f32 v146, s54, v146
 v_mfma_f32_16x16x32_bf16 v[80:83], a[20:23], v[60:63], v[80:83]
 v_exp_f32 v145, v145
 v_mfma_f32_16x16x32_bf16 v[84:87], a[160:163], v[56:59], v[84:87]
 v_exp_f32 v146, v146
 v_mfma_f32_16x16x32_bf16 v[84:87], a[164:167], v[60:63], v[84:87]
 v_add_f32 v145, 1.0, v145
 v_add_f32 v146, 1.0, v146
 v_mfma_f32_16x16x32_bf16 v[88:91], a[88:91], v[56:59], v[88:91]
 ds_read_b128 v[52:55], v21 offset:23552
 v_mul_f32 v151, v147, v151
 v_mfma_f32_16x16x32_bf16 v[88:91], a[92:95], v[60:63], v[88:91]
 v_rcp_f32 v145, v145
 v_mfma_f32_16x16x32_bf16 v[92:95], a[232:235], v[56:59], v[92:95]
 v_rcp_f32 v146, v146
 v_mfma_f32_16x16x32_bf16 v[92:95], a[236:239], v[60:63], v[92:95]
 v_mul_f32 v149, v145, v149
 v_mul_f32 v150, v146, v150
 v_mfma_f32_16x16x32_bf16 v[80:83], a[24:27], v[32:35], v[80:83]
 ds_read_b128 v[56:59], v20 offset:24576
 v_mul_f32 v147, s54, v147
 v_mfma_f32_16x16x32_bf16 v[80:83], a[28:31], v[36:39], v[80:83]
 v_exp_f32 v147, v147
 v_mfma_f32_16x16x32_bf16 v[84:87], a[168:171], v[32:35], v[84:87]
 buffer_load_dwordx4 v18, s[8:11], s36 offen offset:2048  lds
 v_add_f32 v147, 1.0, v147
 v_mfma_f32_16x16x32_bf16 v[84:87], a[172:175], v[36:39], v[84:87]
 v_rcp_f32 v147, v147
 v_mfma_f32_16x16x32_bf16 v[88:91], a[96:99], v[32:35], v[88:91]
 ds_read_b128 v[60:63], v21 offset:24576
 v_mul_f32 v151, v147, v151
 v_mfma_f32_16x16x32_bf16 v[88:91], a[100:103], v[36:39], v[88:91]
 v_mul_f32 v156, v152, v156
 v_mul_f32 v157, v153, v157
 v_mfma_f32_16x16x32_bf16 v[92:95], a[240:243], v[32:35], v[92:95]
 buffer_load_dwordx4 v18, s[8:11], s37 offen offset:3072  lds
 v_mul_f32 v152, s54, v152
 v_mfma_f32_16x16x32_bf16 v[92:95], a[244:247], v[36:39], v[92:95]
 s_waitcnt lgkmcnt(2)
 v_exp_f32 v152, v152
 v_mfma_f32_16x16x32_bf16 v[80:83], a[32:35], v[40:43], v[80:83]
 ds_read_b128 v[32:35], v20 offset:25600
 v_add_f32 v152, 1.0, v152
 v_mfma_f32_16x16x32_bf16 v[80:83], a[36:39], v[44:47], v[80:83]
 v_rcp_f32 v152, v152
 v_mfma_f32_16x16x32_bf16 v[84:87], a[176:179], v[40:43], v[84:87]
 s_add_u32 m0, s56, 106496
 v_mul_f32 v156, v152, v156
 v_mul_f32 v153, s54, v153
 v_mfma_f32_16x16x32_bf16 v[84:87], a[180:183], v[44:47], v[84:87]
 buffer_load_dwordx4 v18, s[8:11], s38 offen  lds
 v_mul_f32 v158, v154, v158
 v_mfma_f32_16x16x32_bf16 v[88:91], a[104:107], v[40:43], v[88:91]
 ds_read_b128 v[36:39], v21 offset:25600
 v_mul_f32 v154, s54, v154
 v_mfma_f32_16x16x32_bf16 v[88:91], a[108:111], v[44:47], v[88:91]
 v_exp_f32 v153, v153
 v_mfma_f32_16x16x32_bf16 v[92:95], a[248:251], v[40:43], v[92:95]
 v_exp_f32 v154, v154
 v_mfma_f32_16x16x32_bf16 v[92:95], a[252:255], v[44:47], v[92:95]
 s_mov_b32 s80, 36864
 v_add_f32 v153, 1.0, v153
 v_add_f32 v154, 1.0, v154
 v_mfma_f32_16x16x32_bf16 v[80:83], a[40:43], v[48:51], v[80:83]
 ds_read_b128 v[40:43], v20 offset:26624
 v_mul_f32 v159, v155, v159
 v_mfma_f32_16x16x32_bf16 v[80:83], a[44:47], v[52:55], v[80:83]
 s_cmp_eq_u32 s27, 4
 s_cselect_b32 s80, -368640, s80
 v_mul_f32 v155, s54, v155
 v_mfma_f32_16x16x32_bf16 v[84:87], a[184:187], v[48:51], v[84:87]
 v_add_u32 v18, s80, v18
 v_cvt_pk_bf16_f32 v144, v148, v149
 v_mfma_f32_16x16x32_bf16 v[84:87], a[188:191], v[52:55], v[84:87]
 v_rcp_f32 v153, v153
 v_mfma_f32_16x16x32_bf16 v[88:91], a[112:115], v[48:51], v[88:91]
 ds_read_b128 v[44:47], v21 offset:26624
 v_mul_f32 v157, v153, v157
 v_mfma_f32_16x16x32_bf16 v[88:91], a[116:119], v[52:55], v[88:91]
 v_rcp_f32 v154, v154
 v_mfma_f32_16x16x32_bf16 v[92:95], v[224:227], v[48:51], v[92:95]
 v_exp_f32 v155, v155
 v_mfma_f32_16x16x32_bf16 v[92:95], v[228:231], v[52:55], v[92:95]
 s_waitcnt lgkmcnt(2)
 v_mul_f32 v158, v154, v158
 v_add_f32 v155, 1.0, v155
 v_mfma_f32_16x16x32_bf16 v[80:83], a[48:51], v[56:59], v[80:83]
 v_rcp_f32 v155, v155
 v_mfma_f32_16x16x32_bf16 v[80:83], a[52:55], v[60:63], v[80:83]
 v_mul_f32 v159, v155, v159
 v_cvt_pk_bf16_f32 v145, v150, v151
 v_mfma_f32_16x16x32_bf16 v[84:87], a[192:195], v[56:59], v[84:87]
 v_cvt_pk_bf16_f32 v146, v156, v157
 v_cvt_pk_bf16_f32 v147, v158, v159
 v_mfma_f32_16x16x32_bf16 v[84:87], a[196:199], v[60:63], v[84:87]
 buffer_store_dwordx4 v[144:147], v19, s[16:19], s53 offen sc1
 v_mul_f32 v164, v160, v164
 v_mfma_f32_16x16x32_bf16 v[88:91], a[120:123], v[56:59], v[88:91]
 s_add_u32 s53, s53, s52
 v_mul_f32 v160, s54, v160
 v_mul_f32 v165, v161, v165
 v_mfma_f32_16x16x32_bf16 v[88:91], a[124:127], v[60:63], v[88:91]
 v_exp_f32 v160, v160
 v_mfma_f32_16x16x32_bf16 v[92:95], v[232:235], v[56:59], v[92:95]
 s_waitcnt vmcnt(20) lgkmcnt(0)
 s_barrier
 v_add_f32 v160, 1.0, v160
 v_mfma_f32_16x16x32_bf16 v[92:95], v[236:239], v[60:63], v[92:95]
 ds_read_b128 v[48:51], v22 offset:0
 v_mul_f32 v161, s54, v161
 v_mfma_f32_16x16x32_bf16 v[80:83], a[56:59], v[32:35], v[80:83]
 ds_read_b128 v[52:55], v23 offset:0
 v_mul_f32 v166, v162, v166
 v_mfma_f32_16x16x32_bf16 v[80:83], a[60:63], v[36:39], v[80:83]
 ds_read_b128 v[56:59], v22 offset:1024
 v_mul_f32 v162, s54, v162
 v_mfma_f32_16x16x32_bf16 v[84:87], a[200:203], v[32:35], v[84:87]
 v_rcp_f32 v160, v160
 v_mfma_f32_16x16x32_bf16 v[84:87], a[204:207], v[36:39], v[84:87]
 v_exp_f32 v161, v161
 v_mfma_f32_16x16x32_bf16 v[88:91], a[128:131], v[32:35], v[88:91]
 ds_read_b128 v[60:63], v23 offset:1024
 v_mul_f32 v164, v160, v164
 v_mfma_f32_16x16x32_bf16 v[88:91], a[132:135], v[36:39], v[88:91]
 s_load_dword s68, s[6:7], 0
 v_exp_f32 v162, v162
 v_mfma_f32_16x16x32_bf16 v[92:95], v[240:243], v[32:35], v[92:95]
 v_add_f32 v161, 1.0, v161
 v_add_f32 v162, 1.0, v162
 v_mfma_f32_16x16x32_bf16 v[92:95], v[244:247], v[36:39], v[92:95]
 v_rcp_f32 v161, v161
 v_mfma_f32_16x16x32_bf16 v[80:83], a[64:67], v[40:43], v[80:83]
 ds_read_b128 v[32:35], v22 offset:2048
 v_mul_f32 v165, v161, v165
 v_mfma_f32_16x16x32_bf16 v[80:83], a[68:71], v[44:47], v[80:83]
 v_rcp_f32 v162, v162
 v_mfma_f32_16x16x32_bf16 v[84:87], a[208:211], v[40:43], v[84:87]
 s_add_u32 m0, s56, 0
 v_mul_f32 v166, v162, v166
 v_mul_f32 v167, v163, v167
 v_mfma_f32_16x16x32_bf16 v[84:87], a[212:215], v[44:47], v[84:87]
 buffer_load_dwordx4 v18, s[8:11], s30 offen  lds
 v_mul_f32 v163, s54, v163
 v_mfma_f32_16x16x32_bf16 v[88:91], a[136:139], v[40:43], v[88:91]
 ds_read_b128 v[36:39], v23 offset:2048
 v_mul_f32 v172, v168, v172
 v_mfma_f32_16x16x32_bf16 v[88:91], a[140:143], v[44:47], v[88:91]
 v_exp_f32 v163, v163
 v_mfma_f32_16x16x32_bf16 v[92:95], v[248:251], v[40:43], v[92:95]
 v_add_f32 v163, 1.0, v163
 v_mul_f32 v168, s54, v168
 v_mfma_f32_16x16x32_bf16 v[92:95], v[252:255], v[44:47], v[92:95]
 s_waitcnt lgkmcnt(4)
 v_rcp_f32 v163, v163
 v_mfma_f32_16x16x32_bf16 v[96:99], a[0:3], v[48:51], 0
 ds_read_b128 v[40:43], v22 offset:3072
 v_mul_f32 v167, v163, v167
 v_mfma_f32_16x16x32_bf16 v[96:99], a[4:7], v[52:55], v[96:99]
 buffer_load_dwordx4 v18, s[8:11], s31 offen offset:1024  lds
 v_mul_f32 v173, v169, v173
 v_mfma_f32_16x16x32_bf16 v[100:103], a[144:147], v[48:51], 0
 v_exp_f32 v168, v168
 v_mfma_f32_16x16x32_bf16 v[100:103], a[148:151], v[52:55], v[100:103]
 v_add_f32 v168, 1.0, v168
 v_mul_f32 v169, s54, v169
 v_mfma_f32_16x16x32_bf16 v[104:107], a[72:75], v[48:51], 0
 ds_read_b128 v[44:47], v23 offset:3072
 v_mul_f32 v174, v170, v174
 v_mfma_f32_16x16x32_bf16 v[104:107], a[76:79], v[52:55], v[104:107]
 buffer_load_dwordx4 v18, s[8:11], s32 offen offset:2048  lds
 v_mul_f32 v170, s54, v170
 v_mfma_f32_16x16x32_bf16 v[108:111], a[216:219], v[48:51], 0
 v_rcp_f32 v168, v168
 v_mfma_f32_16x16x32_bf16 v[108:111], a[220:223], v[52:55], v[108:111]
 s_waitcnt lgkmcnt(4)
 v_exp_f32 v169, v169
 v_mfma_f32_16x16x32_bf16 v[96:99], a[8:11], v[56:59], v[96:99]
 ds_read_b128 v[48:51], v22 offset:4096
 v_mul_f32 v172, v168, v172
 v_mfma_f32_16x16x32_bf16 v[96:99], a[12:15], v[60:63], v[96:99]
 buffer_load_dwordx4 v18, s[8:11], s33 offen offset:3072  lds
 v_add_f32 v169, 1.0, v169
 v_mfma_f32_16x16x32_bf16 v[100:103], a[152:155], v[56:59], v[100:103]
 v_rcp_f32 v169, v169
 v_mfma_f32_16x16x32_bf16 v[100:103], a[156:159], v[60:63], v[100:103]
 v_exp_f32 v170, v170
 v_mfma_f32_16x16x32_bf16 v[104:107], a[80:83], v[56:59], v[104:107]
 ds_read_b128 v[52:55], v23 offset:4096
 v_mul_f32 v173, v169, v173
 v_mfma_f32_16x16x32_bf16 v[104:107], a[84:87], v[60:63], v[104:107]
 s_add_u32 m0, s56, 4096
 v_add_f32 v170, 1.0, v170
 v_mul_f32 v175, v171, v175
 v_mfma_f32_16x16x32_bf16 v[108:111], a[224:227], v[56:59], v[108:111]
 buffer_load_dwordx4 v18, s[8:11], s34 offen  lds
 v_mul_f32 v171, s54, v171
 v_mfma_f32_16x16x32_bf16 v[108:111], a[228:231], v[60:63], v[108:111]
Lpg3:
 s_cbranch_vccnz Lj_Lfin
 s_waitcnt lgkmcnt(4)
 v_rcp_f32 v170, v170
 v_mfma_f32_16x16x32_bf16 v[96:99], a[16:19], v[32:35], v[96:99]
 ds_read_b128 v[56:59], v22 offset:5120
 v_mul_f32 v174, v170, v174
 v_mfma_f32_16x16x32_bf16 v[96:99], a[20:23], v[36:39], v[96:99]
 v_exp_f32 v171, v171
 v_mfma_f32_16x16x32_bf16 v[100:103], a[160:163], v[32:35], v[100:103]
 buffer_load_dwordx4 v18, s[8:11], s35 offen offset:1024  lds
 v_add_f32 v171, 1.0, v171
 v_mfma_f32_16x16x32_bf16 v[100:103], a[164:167], v[36:39], v[100:103]
 v_rcp_f32 v171, v171
 v_mfma_f32_16x16x32_bf16 v[104:107], a[88:91], v[32:35], v[104:107]
 ds_read_b128 v[60:63], v23 offset:5120
 v_mul_f32 v175, v171, v175
 v_mfma_f32_16x16x32_bf16 v[104:107], a[92:95], v[36:39], v[104:107]
 v_cvt_pk_bf16_f32 v160, v164, v165
 v_cvt_pk_bf16_f32 v161, v166, v167
 v_mfma_f32_16x16x32_bf16 v[108:111], a[232:235], v[32:35], v[108:111]
 buffer_load_dwordx4 v18, s[8:11], s36 offen offset:2048  lds
 v_cvt_pk_bf16_f32 v162, v172, v173
 v_mfma_f32_16x16x32_bf16 v[108:111], a[236:239], v[36:39], v[108:111]
 s_waitcnt lgkmcnt(4)
 v_cvt_pk_bf16_f32 v163, v174, v175
 v_mul_f32 v180, v176, v180
 v_mfma_f32_16x16x32_bf16 v[96:99], a[24:27], v[40:43], v[96:99]
 ds_read_b128 v[32:35], v22 offset:6144
 v_mul_f32 v176, s54, v176
 v_mfma_f32_16x16x32_bf16 v[96:99], a[28:31], v[44:47], v[96:99]
 buffer_store_dwordx4 v[160:163], v19, s[16:19], s53 offen sc1
 v_mul_f32 v181, v177, v181
 v_mfma_f32_16x16x32_bf16 v[100:103], a[168:171], v[40:43], v[100:103]
 s_add_u32 s53, s53, s52
 v_exp_f32 v176, v176
 v_mfma_f32_16x16x32_bf16 v[100:103], a[172:175], v[44:47], v[100:103]
 v_add_f32 v176, 1.0, v176
 v_mul_f32 v177, s54, v177
 v_mfma_f32_16x16x32_bf16 v[104:107], a[96:99], v[40:43], v[104:107]
 ds_read_b128 v[36:39], v23 offset:6144
 v_mul_f32 v182, v178, v182
 v_mfma_f32_16x16x32_bf16 v[104:107], a[100:103], v[44:47], v[104:107]
 v_rcp_f32 v176, v176
 v_mfma_f32_16x16x32_bf16 v[108:111], a[240:243], v[40:43], v[108:111]
 v_exp_f32 v177, v177
 v_mfma_f32_16x16x32_bf16 v[108:111], a[244:247], v[44:47], v[108:111]
 s_waitcnt lgkmcnt(4)
 v_mul_f32 v180, v176, v180
 v_add_f32 v177, 1.0, v177
 v_mfma_f32_16x16x32_bf16 v[96:99], a[32:35], v[48:51], v[96:99]
 ds_read_b128 v[40:43], v22 offset:7168
 v_mul_f32 v178, s54, v178
 v_mfma_f32_16x16x32_bf16 v[96:99], a[36:39], v[52:55], v[96:99]
 v_rcp_f32 v177, v177
 v_mfma_f32_16x16x32_bf16 v[100:103], a[176:179], v[48:51], v[100:103]
 v_exp_f32 v178, v178
 v_mfma_f32_16x16x32_bf16 v[100:103], a[180:183], v[52:55], v[100:103]
 v_mul_f32 v181, v177, v181
 v_add_f32 v178, 1.0, v178
 v_mfma_f32_16x16x32_bf16 v[104:107], a[104:107], v[48:51], v[104:107]
 ds_read_b128 v[44:47], v23 offset:7168
 v_mul_f32 v183, v179, v183
 v_mfma_f32_16x16x32_bf16 v[104:107], a[108:111], v[52:55], v[104:107]
 v_rcp_f32 v178, v178
 v_mfma_f32_16x16x32_bf16 v[108:111], a[248:251], v[48:51], v[108:111]
 v_mul_f32 v182, v178, v182
 v_mul_f32 v179, s54, v179
 v_mfma_f32_16x16x32_bf16 v[108:111], a[252:255], v[52:55], v[108:111]
 s_waitcnt lgkmcnt(4)
 v_exp_f32 v179, v179
 v_mfma_f32_16x16x32_bf16 v[96:99], a[40:43], v[56:59], v[96:99]
 ds_read_b128 v[48:51], v22 offset:8192
 v_add_f32 v179, 1.0, v179
 v_mfma_f32_16x16x32_bf16 v[96:99], a[44:47], v[60:63], v[96:99]
 buffer_load_dwordx4 v18, s[8:11], s37 offen offset:3072  lds
 v_mul_f32 v188, v184, v188
 v_mfma_f32_16x16x32_bf16 v[100:103], a[184:187], v[56:59], v[100:103]
 v_rcp_f32 v179, v179
 v_mfma_f32_16x16x32_bf16 v[100:103], a[188:191], v[60:63], v[100:103]
 v_mul_f32 v183, v179, v183
 v_mul_f32 v184, s54, v184
 v_mfma_f32_16x16x32_bf16 v[104:107], a[112:115], v[56:59], v[104:107]
 ds_read_b128 v[52:55], v23 offset:8192
 v_mul_f32 v189, v185, v189
 v_mfma_f32_16x16x32_bf16 v[104:107], a[116:119], v[60:63], v[104:107]
 s_add_u32 m0, s56, 8192
 v_exp_f32 v184, v184
 v_mfma_f32_16x16x32_bf16 v[108:111], v[224:227], v[56:59], v[108:111]
 buffer_load_dwordx4 v18, s[8:11], s38 offen  lds
 v_add_f32 v184, 1.0, v184
 v_mfma_f32_16x16x32_bf16 v[108:111], v[228:231], v[60:63], v[108:111]
 s_waitcnt lgkmcnt(4)
 v_rcp_f32 v184, v184
 v_mfma_f32_16x16x32_bf16 v[96:99], a[48:51], v[32:35], v[96:99]
 ds_read_b128 v[56:59], v22 offset:18432
 v_mul_f32 v188, v184, v188
 v_mfma_f32_16x16x32_bf16 v[96:99], a[52:55], v[36:39], v[96:99]
 v_mul_f32 v185, s54, v185
 v_mul_f32 v190, v186, v190
 v_mfma_f32_16x16x32_bf16 v[100:103], a[192:195], v[32:35], v[100:103]
 v_add_u32 v18, 36864, v18
 v_mul_f32 v186, s54, v186
 v_mfma_f32_16x16x32_bf16 v[100:103], a[196:199], v[36:39], v[100:103]
 v_exp_f32 v185, v185
 v_mfma_f32_16x16x32_bf16 v[104:107], a[120:123], v[32:35], v[104:107]
 ds_read_b128 v[60:63], v23 offset:18432
 v_add_f32 v185, 1.0, v185
 v_mfma_f32_16x16x32_bf16 v[104:107], a[124:127], v[36:39], v[104:107]
 v_rcp_f32 v185, v185
 v_mfma_f32_16x16x32_bf16 v[108:111], v[232:235], v[32:35], v[108:111]
 v_exp_f32 v186, v186
 v_mfma_f32_16x16x32_bf16 v[108:111], v[236:239], v[36:39], v[108:111]
 s_waitcnt lgkmcnt(2)
 v_mul_f32 v189, v185, v189
 v_add_f32 v186, 1.0, v186
 v_mfma_f32_16x16x32_bf16 v[96:99], a[56:59], v[40:43], v[96:99]
 ds_read_b128 v[32:35], v22 offset:19456
 v_mul_f32 v191, v187, v191
 v_mfma_f32_16x16x32_bf16 v[96:99], a[60:63], v[44:47], v[96:99]
 v_rcp_f32 v186, v186
 v_mfma_f32_16x16x32_bf16 v[100:103], a[200:203], v[40:43], v[100:103]
 v_mul_f32 v190, v186, v190
 v_mul_f32 v187, s54, v187
 v_mfma_f32_16x16x32_bf16 v[100:103], a[204:207], v[44:47], v[100:103]
 v_exp_f32 v187, v187
 v_mfma_f32_16x16x32_bf16 v[104:107], a[128:131], v[40:43], v[104:107]
 ds_read_b128 v[36:39], v23 offset:19456
 v_add_f32 v187, 1.0, v187
 v_mfma_f32_16x16x32_bf16 v[104:107], a[132:135], v[44:47], v[104:107]
 v_rcp_f32 v187, v187
 v_mfma_f32_16x16x32_bf16 v[108:111], v[240:243], v[40:43], v[108:111]
 v_mul_f32 v191, v187, v191
 v_cvt_pk_bf16_f32 v176, v180, v181
 v_mfma_f32_16x16x32_bf16 v[108:111], v[244:247], v[44:47], v[108:111]
 v_cvt_pk_bf16_f32 v177, v182, v183
 v_cvt_pk_bf16_f32 v178, v188, v189
 v_mfma_f32_16x16x32_bf16 v[96:99], a[64:67], v[48:51], v[96:99]
 ds_read_b128 v[40:43], v22 offset:20480
 v_cvt_pk_bf16_f32 v179, v190, v191
 v_mfma_f32_16x16x32_bf16 v[96:99], a[68:71], v[52:55], v[96:99]
 buffer_store_dwordx4 v[176:179], v19, s[16:19], s53 offen sc1
 v_mul_f32 v196, v192, v196
 v_mfma_f32_16x16x32_bf16 v[100:103], a[208:211], v[48:51], v[100:103]
 s_add_u32 s53, s53, s52
 v_mul_f32 v192, s54, v192
 v_mul_f32 v197, v193, v197
 v_mfma_f32_16x16x32_bf16 v[100:103], a[212:215], v[52:55], v[100:103]
 s_cmp_eq_u32 s27, 8
 s_cselect_b32 s3, 3244032, 0
 s_sub_u32 s53, s53, s3
 v_mfma_f32_16x16x32_bf16 v[104:107], a[136:139], v[48:51], v[104:107]
 ds_read_b128 v[44:47], v23 offset:20480
 v_mul_f32 v193, s54, v193
 v_mfma_f32_16x16x32_bf16 v[104:107], a[140:143], v[52:55], v[104:107]
 v_exp_f32 v192, v192
 v_mfma_f32_16x16x32_bf16 v[108:111], v[248:251], v[48:51], v[108:111]
 v_exp_f32 v193, v193
 v_mfma_f32_16x16x32_bf16 v[108:111], v[252:255], v[52:55], v[108:111]
 s_waitcnt lgkmcnt(2)
 v_add_f32 v192, 1.0, v192
 v_add_f32 v193, 1.0, v193
 v_mfma_f32_16x16x32_bf16 v[112:115], a[0:3], v[56:59], 0
 ds_read_b128 v[48:51], v22 offset:21504
 v_mul_f32 v198, v194, v198
 v_mfma_f32_16x16x32_bf16 v[112:115], a[4:7], v[60:63], v[112:115]
 v_rcp_f32 v192, v192
 v_mfma_f32_16x16x32_bf16 v[116:119], a[144:147], v[56:59], 0
 v_rcp_f32 v193, v193
 v_mfma_f32_16x16x32_bf16 v[116:119], a[148:151], v[60:63], v[116:119]
 v_mul_f32 v196, v192, v196
 v_mul_f32 v197, v193, v197
 v_mfma_f32_16x16x32_bf16 v[120:123], a[72:75], v[56:59], 0
 ds_read_b128 v[52:55], v23 offset:21504
 v_mul_f32 v194, s54, v194
 v_mfma_f32_16x16x32_bf16 v[120:123], a[76:79], v[60:63], v[120:123]
 v_exp_f32 v194, v194
 v_mfma_f32_16x16x32_bf16 v[124:127], a[216:219], v[56:59], 0
 v_add_f32 v194, 1.0, v194
 v_mul_f32 v199, v195, v199
 v_mfma_f32_16x16x32_bf16 v[124:127], a[220:223], v[60:63], v[124:127]
 v_rcp_f32 v194, v194
 v_mfma_f32_16x16x32_bf16 v[112:115], a[8:11], v[32:35], v[112:115]
 ds_read_b128 v[56:59], v22 offset:22528
 v_mul_f32 v198, v194, v198
 v_mfma_f32_16x16x32_bf16 v[112:115], a[12:15], v[36:39], v[112:115]
 v_mul_f32 v195, s54, v195
 v_mul_f32 v204, v200, v204
 v_mfma_f32_16x16x32_bf16 v[116:119], a[152:155], v[32:35], v[116:119]
 v_exp_f32 v195, v195
 v_mfma_f32_16x16x32_bf16 v[116:119], a[156:159], v[36:39], v[116:119]
 v_add_f32 v195, 1.0, v195
 v_mul_f32 v200, s54, v200
 v_mfma_f32_16x16x32_bf16 v[120:123], a[80:83], v[32:35], v[120:123]
 ds_read_b128 v[60:63], v23 offset:22528
 v_mul_f32 v205, v201, v205
 v_mfma_f32_16x16x32_bf16 v[120:123], a[84:87], v[36:39], v[120:123]
 v_rcp_f32 v195, v195
 v_mfma_f32_16x16x32_bf16 v[124:127], a[224:227], v[32:35], v[124:127]
 v_exp_f32 v200, v200
 v_mfma_f32_16x16x32_bf16 v[124:127], a[228:231], v[36:39], v[124:127]
 s_waitcnt lgkmcnt(2)
 v_mul_f32 v199, v195, v199
 v_add_f32 v200, 1.0, v200
 v_mfma_f32_16x16x32_bf16 v[112:115], a[16:19], v[40:43], v[112:115]
 ds_read_b128 v[32:35], v22 offset:23552
 v_mul_f32 v201, s54, v201
 v_mfma_f32_16x16x32_bf16 v[112:115], a[20:23], v[44:47], v[112:115]
 v_rcp_f32 v200, v200
 v_mfma_f32_16x16x32_bf16 v[116:119], a[160:163], v[40:43], v[116:119]
 v_exp_f32 v201, v201
 v_mfma_f32_16x16x32_bf16 v[116:119], a[164:167], v[44:47], v[116:119]
 v_mul_f32 v204, v200, v204
 v_add_f32 v201, 1.0, v201
 v_mfma_f32_16x16x32_bf16 v[120:123], a[88:91], v[40:43], v[120:123]
 ds_read_b128 v[36:39], v23 offset:23552
 v_mul_f32 v206, v202, v206
 v_mfma_f32_16x16x32_bf16 v[120:123], a[92:95], v[44:47], v[120:123]
 v_rcp_f32 v201, v201
 v_mfma_f32_16x16x32_bf16 v[124:127], a[232:235], v[40:43], v[124:127]
 v_mul_f32 v205, v201, v205
 v_mul_f32 v202, s54, v202
 v_mfma_f32_16x16x32_bf16 v[124:127], a[236:239], v[44:47], v[124:127]
 v_exp_f32 v202, v202
 v_mfma_f32_16x16x32_bf16 v[112:115], a[24:27], v[48:51], v[112:115]
 ds_read_b128 v[40:43], v22 offset:24576
 v_add_f32 v202, 1.0, v202
 v_mfma_f32_16x16x32_bf16 v[112:115], a[28:31], v[52:55], v[112:115]
 v_rcp_f32 v202, v202
 v_mfma_f32_16x16x32_bf16 v[116:119], a[168:171], v[48:51], v[116:119]
 v_mul_f32 v206, v202, v206
 v_mul_f32 v207, v203, v207
 v_mfma_f32_16x16x32_bf16 v[116:119], a[172:175], v[52:55], v[116:119]
 v_mul_f32 v203, s54, v203
 v_cvt_pk_bf16_f32 v192, v196, v197
 v_mfma_f32_16x16x32_bf16 v[120:123], a[96:99], v[48:51], v[120:123]
 ds_read_b128 v[44:47], v23 offset:24576
 v_cvt_pk_bf16_f32 v193, v198, v199
 v_mfma_f32_16x16x32_bf16 v[120:123], a[100:103], v[52:55], v[120:123]
 v_exp_f32 v203, v203
 v_mfma_f32_16x16x32_bf16 v[124:127], a[240:243], v[48:51], v[124:127]
 v_add_f32 v203, 1.0, v203
 v_cvt_pk_bf16_f32 v194, v204, v205
 v_mfma_f32_16x16x32_bf16 v[124:127], a[244:247], v[52:55], v[124:127]
 s_waitcnt lgkmcnt(2)
 v_rcp_f32 v203, v203
 v_mfma_f32_16x16x32_bf16 v[112:115], a[32:35], v[56:59], v[112:115]
 ds_read_b128 v[48:51], v22 offset:25600
 v_mul_f32 v207, v203, v207
 v_mfma_f32_16x16x32_bf16 v[112:115], a[36:39], v[60:63], v[112:115]
 v_cvt_pk_bf16_f32 v195, v206, v207
 v_mul_f32 v212, v208, v212
 v_mfma_f32_16x16x32_bf16 v[116:119], a[176:179], v[56:59], v[116:119]
 buffer_store_dwordx4 v[192:195], v19, s[16:19], s53 offen sc1
 v_mul_f32 v208, s54, v208
 v_mfma_f32_16x16x32_bf16 v[116:119], a[180:183], v[60:63], v[116:119]
 s_add_u32 s53, s53, s52
 v_exp_f32 v208, v208
 v_mfma_f32_16x16x32_bf16 v[120:123], a[104:107], v[56:59], v[120:123]
 ds_read_b128 v[52:55], v23 offset:25600
 v_add_f32 v208, 1.0, v208
 v_mfma_f32_16x16x32_bf16 v[120:123], a[108:111], v[60:63], v[120:123]
 v_rcp_f32 v208, v208
 v_mfma_f32_16x16x32_bf16 v[124:127], a[248:251], v[56:59], v[124:127]
 v_mul_f32 v212, v208, v212
 v_mul_f32 v213, v209, v213
 v_mfma_f32_16x16x32_bf16 v[124:127], a[252:255], v[60:63], v[124:127]
 v_mul_f32 v209, s54, v209
 v_mul_f32 v214, v210, v214
 v_mfma_f32_16x16x32_bf16 v[112:115], a[40:43], v[32:35], v[112:115]
 ds_read_b128 v[56:59], v22 offset:26624
 v_mul_f32 v210, s54, v210
 v_mfma_f32_16x16x32_bf16 v[112:115], a[44:47], v[36:39], v[112:115]
 v_exp_f32 v209, v209
 v_mfma_f32_16x16x32_bf16 v[116:119], a[184:187], v[32:35], v[116:119]
 v_exp_f32 v210, v210
 v_mfma_f32_16x16x32_bf16 v[116:119], a[188:191], v[36:39], v[116:119]
 v_add_f32 v209, 1.0, v209
 v_add_f32 v210, 1.0, v210
 v_mfma_f32_16x16x32_bf16 v[120:123], a[112:115], v[32:35], v[120:123]
 ds_read_b128 v[60:63], v23 offset:26624
 v_mul_f32 v215, v211, v215
 v_mfma_f32_16x16x32_bf16 v[120:123], a[116:119], v[36:39], v[120:123]
 v_rcp_f32 v209, v209
 v_mfma_f32_16x16x32_bf16 v[124:127], v[224:227], v[32:35], v[124:127]
 v_rcp_f32 v210, v210
 v_mfma_f32_16x16x32_bf16 v[124:127], v[228:231], v[36:39], v[124:127]
 s_waitcnt lgkmcnt(2)
 v_mul_f32 v213, v209, v213
 v_mul_f32 v214, v210, v214
 v_mfma_f32_16x16x32_bf16 v[112:115], a[48:51], v[40:43], v[112:115]
 v_mul_f32 v211, s54, v211
 v_mul_f32 v220, v216, v220
 v_mfma_f32_16x16x32_bf16 v[112:115], a[52:55], v[44:47], v[112:115]
 v_exp_f32 v211, v211
 v_mfma_f32_16x16x32_bf16 v[116:119], a[192:195], v[40:43], v[116:119]
 v_add_f32 v211, 1.0, v211
 v_mul_f32 v216, s54, v216
 v_mfma_f32_16x16x32_bf16 v[116:119], a[196:199], v[44:47], v[116:119]
 v_rcp_f32 v211, v211
 v_mfma_f32_16x16x32_bf16 v[120:123], a[120:123], v[40:43], v[120:123]
 v_exp_f32 v216, v216
 v_mfma_f32_16x16x32_bf16 v[120:123], a[124:127], v[44:47], v[120:123]
 v_mul_f32 v215, v211, v215
 v_add_f32 v216, 1.0, v216
 v_mfma_f32_16x16x32_bf16 v[124:127], v[232:235], v[40:43], v[124:127]
 s_waitcnt vmcnt(13) lgkmcnt(0)
 s_barrier
 v_mfma_f32_16x16x32_bf16 v[124:127], v[236:239], v[44:47], v[124:127]
 ds_read_b128 v[32:35], v24 offset:0
 v_mul_f32 v221, v217, v221
 v_mfma_f32_16x16x32_bf16 v[112:115], a[56:59], v[48:51], v[112:115]
 ds_read_b128 v[36:39], v25 offset:0
 v_mul_f32 v217, s54, v217
 v_mfma_f32_16x16x32_bf16 v[112:115], a[60:63], v[52:55], v[112:115]
 ds_read_b128 v[40:43], v24 offset:1024
 v_mul_f32 v222, v218, v222
 v_mfma_f32_16x16x32_bf16 v[116:119], a[200:203], v[48:51], v[116:119]
 ds_read_b64_tr_b16 v[10:11], v8 offset:0
 v_mul_f32 v218, s54, v218
 v_mfma_f32_16x16x32_bf16 v[116:119], a[204:207], v[52:55], v[116:119]
 ds_read_b64_tr_b16 v[12:13], v8 offset:2048
 v_mul_f32 v223, v219, v223
 v_mfma_f32_16x16x32_bf16 v[120:123], a[128:131], v[48:51], v[120:123]
 ds_read_b128 v[44:47], v25 offset:1024
 v_mul_f32 v219, s54, v219
 v_mfma_f32_16x16x32_bf16 v[120:123], a[132:135], v[52:55], v[120:123]
 s_cmp_eq_u32 s68, 16843009
 s_cbranch_scc0 Lsp_g11i
Lrt_g11i:
 v_cvt_pk_bf16_f32 v208, v212, v213
 v_mfma_f32_16x16x32_bf16 v[124:127], v[240:243], v[48:51], v[124:127]
 v_rcp_f32 v216, v216
 v_mfma_f32_16x16x32_bf16 v[124:127], v[244:247], v[52:55], v[124:127]
 s_waitcnt lgkmcnt(4)
 v_exp_f32 v217, v217
 v_mfma_f32_16x16x32_bf16 v[112:115], a[64:67], v[56:59], v[112:115]
 ds_read_b128 v[48:51], v24 offset:2048
 v_mul_f32 v220, v216, v220
 v_mfma_f32_16x16x32_bf16 v[112:115], a[68:71], v[60:63], v[112:115]
 s_waitcnt lgkmcnt(2)
 v_exp_f32 v218, v218
 v_mfma_f32_16x16x32_bf16 v[116:119], a[208:211], v[56:59], v[116:119]
 buffer_store_dwordx4 v[10:13], v19, s[16:19], s58 offen sc1
 s_add_u32 s58, s58, 4096
 v_mfma_f32_16x16x32_bf16 v[116:119], a[212:215], v[60:63], v[116:119]
 ds_read_b64_tr_b16 v[14:15], v8 offset:4096
 v_add_f32 v217, 1.0, v217
 v_mfma_f32_16x16x32_bf16 v[120:123], a[136:139], v[56:59], v[120:123]
 ds_read_b128 v[52:55], v25 offset:2048
 v_add_f32 v218, 1.0, v218
 v_mfma_f32_16x16x32_bf16 v[120:123], a[140:143], v[60:63], v[120:123]
 ds_read_b64_tr_b16 v[16:17], v8 offset:6144
 v_cvt_pk_bf16_f32 v209, v214, v215
 v_mfma_f32_16x16x32_bf16 v[124:127], v[248:251], v[56:59], v[124:127]
 v_rcp_f32 v217, v217
 v_mfma_f32_16x16x32_bf16 v[124:127], v[252:255], v[60:63], v[124:127]
 v_rcp_f32 v218, v218
 v_mfma_f32_16x16x32_bf16 v[128:131], a[0:3], v[32:35], 0
 ds_read_b128 v[56:59], v24 offset:3072
 v_mul_f32 v221, v217, v221
 v_mfma_f32_16x16x32_bf16 v[128:131], a[4:7], v[36:39], v[128:131]
 ds_read_b64_tr_b16 v[28:29], v8 offset:8192
 v_mul_f32 v222, v218, v222
 v_mfma_f32_16x16x32_bf16 v[132:135], a[144:147], v[32:35], 0
 ds_read_b64_tr_b16 v[30:31], v8 offset:10240
 v_cvt_pk_bf16_f32 v210, v220, v221
 v_mfma_f32_16x16x32_bf16 v[132:135], a[148:151], v[36:39], v[132:135]
 s_waitcnt lgkmcnt(3)
 v_exp_f32 v219, v219
 v_mfma_f32_16x16x32_bf16 v[136:139], a[72:75], v[32:35], 0
 ds_read_b128 v[60:63], v25 offset:3072
 v_add_f32 v219, 1.0, v219
 v_mfma_f32_16x16x32_bf16 v[136:139], a[76:79], v[36:39], v[136:139]
 buffer_store_dwordx4 v[14:17], v19, s[16:19], s58 offen sc1
 s_add_u32 s58, s58, 4096
 v_mfma_f32_16x16x32_bf16 v[140:143], a[216:219], v[32:35], 0
 v_rcp_f32 v219, v219
 v_mfma_f32_16x16x32_bf16 v[140:143], a[220:223], v[36:39], v[140:143]
 v_mul_f32 v223, v219, v223
 v_mul_f32 v68, v64, v68
 v_mfma_f32_16x16x32_bf16 v[128:131], a[8:11], v[40:43], v[128:131]
 ds_read_b128 v[32:35], v24 offset:4096
 s_waitcnt lgkmcnt(2)
 v_mfma_f32_16x16x32_bf16 v[128:131], a[12:15], v[44:47], v[128:131]
 buffer_store_dwordx4 v[28:31], v19, s[16:19], s58 offen sc1
 s_add_u32 s58, s58, 4096
 v_mfma_f32_16x16x32_bf16 v[132:135], a[152:155], v[40:43], v[132:135]
 ds_read_b64_tr_b16 v[10:11], v8 offset:49152
 v_cvt_pk_bf16_f32 v211, v222, v223
 v_mfma_f32_16x16x32_bf16 v[132:135], a[156:159], v[44:47], v[132:135]
 ds_read_b64_tr_b16 v[12:13], v8 offset:51200
 v_mul_f32 v64, s54, v64
 v_mfma_f32_16x16x32_bf16 v[136:139], a[80:83], v[40:43], v[136:139]
 ds_read_b128 v[36:39], v25 offset:4096
 v_mul_f32 v69, v65, v69
 v_mfma_f32_16x16x32_bf16 v[136:139], a[84:87], v[44:47], v[136:139]
 buffer_store_dwordx4 v[208:211], v19, s[16:19], s53 offen sc1
 v_mul_f32 v65, s54, v65
 v_mfma_f32_16x16x32_bf16 v[140:143], a[224:227], v[40:43], v[140:143]
 ds_read_b64_tr_b16 v[14:15], v8 offset:53248
 s_add_u32 s53, s53, s52
 v_mfma_f32_16x16x32_bf16 v[140:143], a[228:231], v[44:47], v[140:143]
 ds_read_b64_tr_b16 v[16:17], v8 offset:55296
 v_mul_f32 v70, v66, v70
 v_mfma_f32_16x16x32_bf16 v[128:131], a[16:19], v[48:51], v[128:131]
 ds_read_b128 v[40:43], v24 offset:5120
 v_mul_f32 v66, s54, v66
 v_mfma_f32_16x16x32_bf16 v[128:131], a[20:23], v[52:55], v[128:131]
 s_waitcnt lgkmcnt(4)
 v_exp_f32 v64, v64
 v_mfma_f32_16x16x32_bf16 v[132:135], a[160:163], v[48:51], v[132:135]
 buffer_store_dwordx4 v[10:13], v19, s[16:19], s58 offen sc1
 s_add_u32 s58, s58, 4096
 v_mfma_f32_16x16x32_bf16 v[132:135], a[164:167], v[52:55], v[132:135]
 v_exp_f32 v65, v65
 v_mfma_f32_16x16x32_bf16 v[136:139], a[88:91], v[48:51], v[136:139]
 ds_read_b128 v[44:47], v25 offset:5120
 v_add_f32 v64, 1.0, v64
 v_mfma_f32_16x16x32_bf16 v[136:139], a[92:95], v[52:55], v[136:139]
 s_waitcnt lgkmcnt(2)
 v_rcp_f32 v64, v64
 v_mfma_f32_16x16x32_bf16 v[140:143], a[232:235], v[48:51], v[140:143]
 buffer_store_dwordx4 v[14:17], v19, s[16:19], s58 offen sc1
 s_add_u32 s58, s58, 4096
 v_mfma_f32_16x16x32_bf16 v[140:143], a[236:239], v[52:55], v[140:143]
 v_exp_f32 v66, v66
 v_mfma_f32_16x16x32_bf16 v[128:131], a[24:27], v[56:59], v[128:131]
 ds_read_b128 v[48:51], v24 offset:6144
 v_mul_f32 v68, v64, v68
 v_mfma_f32_16x16x32_bf16 v[128:131], a[28:31], v[60:63], v[128:131]
 ds_read_b64_tr_b16 v[28:29], v8 offset:57344
 v_add_f32 v65, 1.0, v65
 v_mfma_f32_16x16x32_bf16 v[132:135], a[168:171], v[56:59], v[132:135]
 ds_read_b64_tr_b16 v[30:31], v8 offset:59392
 v_add_f32 v66, 1.0, v66
 v_mfma_f32_16x16x32_bf16 v[132:135], a[172:175], v[60:63], v[132:135]
 v_rcp_f32 v65, v65
 v_mfma_f32_16x16x32_bf16 v[136:139], a[96:99], v[56:59], v[136:139]
 ds_read_b128 v[52:55], v25 offset:6144
 v_mul_f32 v69, v65, v69
 v_mfma_f32_16x16x32_bf16 v[136:139], a[100:103], v[60:63], v[136:139]
 ds_read_b64_tr_b16 v[10:11], v9 offset:0
 v_mul_f32 v71, v67, v71
 v_mfma_f32_16x16x32_bf16 v[140:143], a[240:243], v[56:59], v[140:143]
 ds_read_b64_tr_b16 v[12:13], v9 offset:2048
 v_mul_f32 v67, s54, v67
 v_mfma_f32_16x16x32_bf16 v[140:143], a[244:247], v[60:63], v[140:143]
 v_rcp_f32 v66, v66
 v_mfma_f32_16x16x32_bf16 v[128:131], a[32:35], v[32:35], v[128:131]
 ds_read_b128 v[56:59], v24 offset:7168
 s_waitcnt lgkmcnt(4)
 v_mfma_f32_16x16x32_bf16 v[128:131], a[36:39], v[36:39], v[128:131]
 buffer_store_dwordx4 v[28:31], v19, s[16:19], s58 offen sc1
 s_add_u32 s58, s58, 4096
 v_mfma_f32_16x16x32_bf16 v[132:135], a[176:179], v[32:35], v[132:135]
 v_exp_f32 v67, v67
 v_mfma_f32_16x16x32_bf16 v[132:135], a[180:183], v[36:39], v[132:135]
 ds_read_b64_tr_b16 v[14:15], v9 offset:4096
 v_mul_f32 v70, v66, v70
 v_mfma_f32_16x16x32_bf16 v[136:139], a[104:107], v[32:35], v[136:139]
 ds_read_b128 v[60:63], v25 offset:7168
 s_waitcnt lgkmcnt(3)
 v_mfma_f32_16x16x32_bf16 v[136:139], a[108:111], v[36:39], v[136:139]
 buffer_store_dwordx4 v[10:13], v19, s[16:19], s58 offen sc1
 s_add_u32 s58, s58, 4096
 v_mfma_f32_16x16x32_bf16 v[140:143], a[248:251], v[32:35], v[140:143]
 ds_read_b64_tr_b16 v[16:17], v9 offset:6144
 v_add_f32 v67, 1.0, v67
 v_mfma_f32_16x16x32_bf16 v[140:143], a[252:255], v[36:39], v[140:143]
 v_rcp_f32 v67, v67
 v_mfma_f32_16x16x32_bf16 v[128:131], a[40:43], v[40:43], v[128:131]
 ds_read_b128 v[32:35], v24 offset:8192
 v_mul_f32 v71, v67, v71
 v_mfma_f32_16x16x32_bf16 v[128:131], a[44:47], v[44:47], v[128:131]
 v_mul_f32 v76, v72, v76
 v_mul_f32 v77, v73, v77
 v_mfma_f32_16x16x32_bf16 v[132:135], a[184:187], v[40:43], v[132:135]
 ds_read_b64_tr_b16 v[28:29], v9 offset:8192
 v_mul_f32 v72, s54, v72
 v_mfma_f32_16x16x32_bf16 v[132:135], a[188:191], v[44:47], v[132:135]
 ds_read_b64_tr_b16 v[30:31], v9 offset:10240
 v_mul_f32 v73, s54, v73
 v_mfma_f32_16x16x32_bf16 v[136:139], a[112:115], v[40:43], v[136:139]
 ds_read_b128 v[36:39], v25 offset:8192
 s_waitcnt lgkmcnt(4)
 v_mfma_f32_16x16x32_bf16 v[136:139], a[116:119], v[44:47], v[136:139]
 buffer_store_dwordx4 v[14:17], v19, s[16:19], s58 offen sc1
 s_add_u32 s58, s58, 4096
 v_mfma_f32_16x16x32_bf16 v[140:143], v[224:227], v[40:43], v[140:143]
 v_exp_f32 v72, v72
 v_mfma_f32_16x16x32_bf16 v[140:143], v[228:231], v[44:47], v[140:143]
 v_exp_f32 v73, v73
 v_mfma_f32_16x16x32_bf16 v[128:131], a[48:51], v[48:51], v[128:131]
 ds_read_b128 v[40:43], v24 offset:18432
 v_add_f32 v72, 1.0, v72
 v_mfma_f32_16x16x32_bf16 v[128:131], a[52:55], v[52:55], v[128:131]
 s_waitcnt lgkmcnt(2)
 v_rcp_f32 v72, v72
 v_mfma_f32_16x16x32_bf16 v[132:135], a[192:195], v[48:51], v[132:135]
 buffer_store_dwordx4 v[28:31], v19, s[16:19], s58 offen sc1
 s_add_u32 s58, s58, 4096
 v_mfma_f32_16x16x32_bf16 v[132:135], a[196:199], v[52:55], v[132:135]
 v_mul_f32 v76, v72, v76
 v_add_f32 v73, 1.0, v73
 v_mfma_f32_16x16x32_bf16 v[136:139], a[120:123], v[48:51], v[136:139]
 ds_read_b128 v[44:47], v25 offset:18432
 v_mul_f32 v78, v74, v78
 v_mfma_f32_16x16x32_bf16 v[136:139], a[124:127], v[52:55], v[136:139]
 v_rcp_f32 v73, v73
 v_mfma_f32_16x16x32_bf16 v[140:143], v[232:235], v[48:51], v[140:143]
 v_mul_f32 v77, v73, v77
 v_mul_f32 v74, s54, v74
 v_mfma_f32_16x16x32_bf16 v[140:143], v[236:239], v[52:55], v[140:143]
 s_waitcnt lgkmcnt(2)
 v_exp_f32 v74, v74
 v_mfma_f32_16x16x32_bf16 v[128:131], a[56:59], v[56:59], v[128:131]
 ds_read_b128 v[48:51], v24 offset:19456
 v_add_f32 v74, 1.0, v74
 v_mfma_f32_16x16x32_bf16 v[128:131], a[60:63], v[60:63], v[128:131]
 v_rcp_f32 v74, v74
 v_mfma_f32_16x16x32_bf16 v[132:135], a[200:203], v[56:59], v[132:135]
 v_mul_f32 v78, v74, v78
 v_mul_f32 v79, v75, v79
 v_mfma_f32_16x16x32_bf16 v[132:135], a[204:207], v[60:63], v[132:135]
 v_mul_f32 v75, s54, v75
 v_cvt_pk_bf16_f32 v64, v68, v69
 v_mfma_f32_16x16x32_bf16 v[136:139], a[128:131], v[56:59], v[136:139]
 ds_read_b128 v[52:55], v25 offset:19456
 v_cvt_pk_bf16_f32 v65, v70, v71
 v_mfma_f32_16x16x32_bf16 v[136:139], a[132:135], v[60:63], v[136:139]
 v_exp_f32 v75, v75
 v_mfma_f32_16x16x32_bf16 v[140:143], v[240:243], v[56:59], v[140:143]
 v_add_f32 v75, 1.0, v75
 v_cvt_pk_bf16_f32 v66, v76, v77
 v_mfma_f32_16x16x32_bf16 v[140:143], v[244:247], v[60:63], v[140:143]
 v_rcp_f32 v75, v75
 v_mfma_f32_16x16x32_bf16 v[128:131], a[64:67], v[32:35], v[128:131]
 ds_read_b128 v[56:59], v24 offset:20480
 v_mul_f32 v79, v75, v79
 v_mfma_f32_16x16x32_bf16 v[128:131], a[68:71], v[36:39], v[128:131]
 v_cvt_pk_bf16_f32 v67, v78, v79
 v_mul_f32 v84, v80, v84
 v_mfma_f32_16x16x32_bf16 v[132:135], a[208:211], v[32:35], v[132:135]
 buffer_store_dwordx4 v[64:67], v19, s[16:19], s53 offen sc1
 v_mul_f32 v80, s54, v80
 v_mfma_f32_16x16x32_bf16 v[132:135], a[212:215], v[36:39], v[132:135]
 s_add_u32 m0, s56, 49152
 s_add_u32 s53, s53, s52
 v_mul_f32 v85, v81, v85
 v_mfma_f32_16x16x32_bf16 v[136:139], a[136:139], v[32:35], v[136:139]
 ds_read_b128 v[60:63], v25 offset:20480
 v_mul_f32 v81, s54, v81
 v_mfma_f32_16x16x32_bf16 v[136:139], a[140:143], v[36:39], v[136:139]
 v_exp_f32 v80, v80
 v_mfma_f32_16x16x32_bf16 v[140:143], v[248:251], v[32:35], v[140:143]
 v_exp_f32 v81, v81
 v_mfma_f32_16x16x32_bf16 v[140:143], v[252:255], v[36:39], v[140:143]
 s_waitcnt lgkmcnt(2)
 v_add_f32 v80, 1.0, v80
 v_add_f32 v81, 1.0, v81
 v_mfma_f32_16x16x32_bf16 v[64:67], a[0:3], v[40:43], 0
 ds_read_b128 v[32:35], v24 offset:21504
 v_mul_f32 v86, v82, v86
 v_mfma_f32_16x16x32_bf16 v[64:67], a[4:7], v[44:47], v[64:67]
 v_rcp_f32 v80, v80
 v_mfma_f32_16x16x32_bf16 v[68:71], a[144:147], v[40:43], 0
 v_rcp_f32 v81, v81
 v_mfma_f32_16x16x32_bf16 v[68:71], a[148:151], v[44:47], v[68:71]
 v_mul_f32 v84, v80, v84
 v_mul_f32 v85, v81, v85
 v_mfma_f32_16x16x32_bf16 v[72:75], a[72:75], v[40:43], 0
 ds_read_b128 v[36:39], v25 offset:21504
 v_mul_f32 v82, s54, v82
 v_mfma_f32_16x16x32_bf16 v[72:75], a[76:79], v[44:47], v[72:75]
 v_exp_f32 v82, v82
 v_mfma_f32_16x16x32_bf16 v[76:79], a[216:219], v[40:43], 0
 v_add_f32 v82, 1.0, v82
 v_mul_f32 v87, v83, v87
 v_mfma_f32_16x16x32_bf16 v[76:79], a[220:223], v[44:47], v[76:79]
 v_rcp_f32 v82, v82
 v_mfma_f32_16x16x32_bf16 v[64:67], a[8:11], v[48:51], v[64:67]
 ds_read_b128 v[40:43], v24 offset:22528
 v_mul_f32 v86, v82, v86
 v_mfma_f32_16x16x32_bf16 v[64:67], a[12:15], v[52:55], v[64:67]
 v_mul_f32 v83, s54, v83
 v_mul_f32 v92, v88, v92
 v_mfma_f32_16x16x32_bf16 v[68:71], a[152:155], v[48:51], v[68:71]
 buffer_load_dwordx4 v18, s[8:11], s30 offen  lds
 v_mul_f32 v88, s54, v88
 v_mfma_f32_16x16x32_bf16 v[68:71], a[156:159], v[52:55], v[68:71]
 v_exp_f32 v83, v83
 v_mfma_f32_16x16x32_bf16 v[72:75], a[80:83], v[48:51], v[72:75]
 ds_read_b128 v[44:47], v25 offset:22528
 v_add_f32 v83, 1.0, v83
 v_mfma_f32_16x16x32_bf16 v[72:75], a[84:87], v[52:55], v[72:75]
 buffer_load_dwordx4 v18, s[8:11], s31 offen offset:1024  lds
 v_mul_f32 v93, v89, v93
 v_mfma_f32_16x16x32_bf16 v[76:79], a[224:227], v[48:51], v[76:79]
 v_rcp_f32 v83, v83
 v_mfma_f32_16x16x32_bf16 v[76:79], a[228:231], v[52:55], v[76:79]
 s_waitcnt lgkmcnt(2)
 v_exp_f32 v88, v88
 v_mfma_f32_16x16x32_bf16 v[64:67], a[16:19], v[56:59], v[64:67]
 ds_read_b128 v[48:51], v24 offset:23552
 v_mul_f32 v87, v83, v87
 v_mfma_f32_16x16x32_bf16 v[64:67], a[20:23], v[60:63], v[64:67]
 buffer_load_dwordx4 v18, s[8:11], s32 offen offset:2048  lds
 v_add_f32 v88, 1.0, v88
 v_mfma_f32_16x16x32_bf16 v[68:71], a[160:163], v[56:59], v[68:71]
 v_rcp_f32 v88, v88
 v_mfma_f32_16x16x32_bf16 v[68:71], a[164:167], v[60:63], v[68:71]
 v_mul_f32 v92, v88, v92
 v_mul_f32 v89, s54, v89
 v_mfma_f32_16x16x32_bf16 v[72:75], a[88:91], v[56:59], v[72:75]
 ds_read_b128 v[52:55], v25 offset:23552
 v_mul_f32 v94, v90, v94
 v_mfma_f32_16x16x32_bf16 v[72:75], a[92:95], v[60:63], v[72:75]
 buffer_load_dwordx4 v18, s[8:11], s33 offen offset:3072  lds
 v_mul_f32 v90, s54, v90
 v_mfma_f32_16x16x32_bf16 v[76:79], a[232:235], v[56:59], v[76:79]
 v_exp_f32 v89, v89
 v_mfma_f32_16x16x32_bf16 v[76:79], a[236:239], v[60:63], v[76:79]
 v_exp_f32 v90, v90
 v_mfma_f32_16x16x32_bf16 v[64:67], a[24:27], v[32:35], v[64:67]
 ds_read_b128 v[56:59], v24 offset:24576
 v_add_f32 v89, 1.0, v89
 v_mfma_f32_16x16x32_bf16 v[64:67], a[28:31], v[36:39], v[64:67]
 s_add_u32 m0, s56, 53248
 v_rcp_f32 v89, v89
 v_mfma_f32_16x16x32_bf16 v[68:71], a[168:171], v[32:35], v[68:71]
 buffer_load_dwordx4 v18, s[8:11], s34 offen  lds
 v_mul_f32 v93, v89, v93
 v_mfma_f32_16x16x32_bf16 v[68:71], a[172:175], v[36:39], v[68:71]
 v_add_f32 v90, 1.0, v90
 v_mul_f32 v95, v91, v95
 v_mfma_f32_16x16x32_bf16 v[72:75], a[96:99], v[32:35], v[72:75]
 ds_read_b128 v[60:63], v25 offset:24576
 v_mul_f32 v91, s54, v91
 v_mfma_f32_16x16x32_bf16 v[72:75], a[100:103], v[36:39], v[72:75]
 buffer_load_dwordx4 v18, s[8:11], s35 offen offset:1024  lds
 v_cvt_pk_bf16_f32 v80, v84, v85
 v_mfma_f32_16x16x32_bf16 v[76:79], a[240:243], v[32:35], v[76:79]
 v_rcp_f32 v90, v90
 v_mfma_f32_16x16x32_bf16 v[76:79], a[244:247], v[36:39], v[76:79]
 s_waitcnt lgkmcnt(2)
 v_exp_f32 v91, v91
 v_mfma_f32_16x16x32_bf16 v[64:67], a[32:35], v[40:43], v[64:67]
 ds_read_b128 v[32:35], v24 offset:25600
 v_mul_f32 v94, v90, v94
 v_mfma_f32_16x16x32_bf16 v[64:67], a[36:39], v[44:47], v[64:67]
 buffer_load_dwordx4 v18, s[8:11], s36 offen offset:2048  lds
 v_add_f32 v91, 1.0, v91
 v_mfma_f32_16x16x32_bf16 v[68:71], a[176:179], v[40:43], v[68:71]
Lpg4:
 s_cbranch_vccnz Lj_Lfin
 v_rcp_f32 v91, v91
 v_mfma_f32_16x16x32_bf16 v[68:71], a[180:183], v[44:47], v[68:71]
 v_mul_f32 v95, v91, v95
 v_cvt_pk_bf16_f32 v81, v86, v87
 v_mfma_f32_16x16x32_bf16 v[72:75], a[104:107], v[40:43], v[72:75]
 ds_read_b128 v[36:39], v25 offset:25600
 v_cvt_pk_bf16_f32 v82, v92, v93
 v_mfma_f32_16x16x32_bf16 v[72:75], a[108:111], v[44:47], v[72:75]
 v_cvt_pk_bf16_f32 v83, v94, v95
 v_mul_f32 v100, v96, v100
 v_mfma_f32_16x16x32_bf16 v[76:79], a[248:251], v[40:43], v[76:79]
 buffer_store_dwordx4 v[80:83], v19, s[16:19], s53 offen sc1
 v_mul_f32 v96, s54, v96
 v_mfma_f32_16x16x32_bf16 v[76:79], a[252:255], v[44:47], v[76:79]
 s_add_u32 s53, s53, s52
 v_exp_f32 v96, v96
 v_mfma_f32_16x16x32_bf16 v[64:67], a[40:43], v[48:51], v[64:67]
 ds_read_b128 v[40:43], v24 offset:26624
 v_add_f32 v96, 1.0, v96
 v_mfma_f32_16x16x32_bf16 v[64:67], a[44:47], v[52:55], v[64:67]
 v_rcp_f32 v96, v96
 v_mfma_f32_16x16x32_bf16 v[68:71], a[184:187], v[48:51], v[68:71]
 v_mul_f32 v100, v96, v100
 v_mul_f32 v101, v97, v101
 v_mfma_f32_16x16x32_bf16 v[68:71], a[188:191], v[52:55], v[68:71]
 v_mul_f32 v97, s54, v97
 v_mul_f32 v102, v98, v102
 v_mfma_f32_16x16x32_bf16 v[72:75], a[112:115], v[48:51], v[72:75]
 ds_read_b128 v[44:47], v25 offset:26624
 v_mul_f32 v98, s54, v98
 v_mfma_f32_16x16x32_bf16 v[72:75], a[116:119], v[52:55], v[72:75]
 v_exp_f32 v97, v97
 v_mfma_f32_16x16x32_bf16 v[76:79], v[224:227], v[48:51], v[76:79]
 v_exp_f32 v98, v98
 v_mfma_f32_16x16x32_bf16 v[76:79], v[228:231], v[52:55], v[76:79]
 s_waitcnt lgkmcnt(2)
 v_add_f32 v97, 1.0, v97
 v_add_f32 v98, 1.0, v98
 v_mfma_f32_16x16x32_bf16 v[64:67], a[48:51], v[56:59], v[64:67]
 v_rcp_f32 v97, v97
 v_mfma_f32_16x16x32_bf16 v[64:67], a[52:55], v[60:63], v[64:67]
 v_rcp_f32 v98, v98
 v_mfma_f32_16x16x32_bf16 v[68:71], a[192:195], v[56:59], v[68:71]
 v_mul_f32 v101, v97, v101
 v_mul_f32 v102, v98, v102
 v_mfma_f32_16x16x32_bf16 v[68:71], a[196:199], v[60:63], v[68:71]
 v_mul_f32 v103, v99, v103
 v_mul_f32 v108, v104, v108
 v_mfma_f32_16x16x32_bf16 v[72:75], a[120:123], v[56:59], v[72:75]
 v_mul_f32 v99, s54, v99
 v_mul_f32 v104, s54, v104
 v_mfma_f32_16x16x32_bf16 v[72:75], a[124:127], v[60:63], v[72:75]
 v_exp_f32 v99, v99
 v_mfma_f32_16x16x32_bf16 v[76:79], v[232:235], v[56:59], v[76:79]
 s_waitcnt vmcnt(21) lgkmcnt(0)
 s_waitcnt vmcnt(9)
 s_barrier
 v_mfma_f32_16x16x32_bf16 v[76:79], v[236:239], v[60:63], v[76:79]
 ds_read_b128 v[48:51], v20 offset:0
 v_add_f32 v99, 1.0, v99
 v_mfma_f32_16x16x32_bf16 v[64:67], a[56:59], v[32:35], v[64:67]
 ds_read_b128 v[52:55], v21 offset:0
 v_mul_f32 v109, v105, v109
 v_mfma_f32_16x16x32_bf16 v[64:67], a[60:63], v[36:39], v[64:67]
 ds_read_b128 v[56:59], v20 offset:1024
 v_mul_f32 v105, s54, v105
 v_mfma_f32_16x16x32_bf16 v[68:71], a[200:203], v[32:35], v[68:71]
 buffer_load_dwordx4 v18, s[8:11], s37 offen offset:3072  lds
 v_mul_f32 v110, v106, v110
 v_mfma_f32_16x16x32_bf16 v[68:71], a[204:207], v[36:39], v[68:71]
 buffer_store_byte v2, v1, s[16:19], s59 offen sc1
 v_mul_f32 v106, s54, v106
 v_mfma_f32_16x16x32_bf16 v[72:75], a[128:131], v[32:35], v[72:75]
 ds_read_b128 v[60:63], v21 offset:1024
 v_mul_f32 v111, v107, v111
 v_mfma_f32_16x16x32_bf16 v[72:75], a[132:135], v[36:39], v[72:75]
 s_add_u32 m0, s56, 57344
 v_rcp_f32 v99, v99
 v_mfma_f32_16x16x32_bf16 v[76:79], v[240:243], v[32:35], v[76:79]
 buffer_load_dwordx4 v18, s[8:11], s38 offen  lds
 v_mul_f32 v103, v99, v103
 v_mfma_f32_16x16x32_bf16 v[76:79], v[244:247], v[36:39], v[76:79]
 s_waitcnt lgkmcnt(2)
 v_exp_f32 v104, v104
 v_mfma_f32_16x16x32_bf16 v[64:67], a[64:67], v[40:43], v[64:67]
 ds_read_b128 v[32:35], v20 offset:2048
 v_add_f32 v104, 1.0, v104
 v_mfma_f32_16x16x32_bf16 v[64:67], a[68:71], v[44:47], v[64:67]
 v_add_u32 v18, 36864, v18
 v_mul_f32 v107, s54, v107
 v_mfma_f32_16x16x32_bf16 v[68:71], a[208:211], v[40:43], v[68:71]
 buffer_store_byte v2, v1, s[16:19], s25 offen sc1
 v_cvt_pk_bf16_f32 v96, v100, v101
 v_mfma_f32_16x16x32_bf16 v[68:71], a[212:215], v[44:47], v[68:71]
 s_add_u32 s25, s25, 18432
 v_rcp_f32 v104, v104
 v_mfma_f32_16x16x32_bf16 v[72:75], a[136:139], v[40:43], v[72:75]
 ds_read_b128 v[36:39], v21 offset:2048
 v_mul_f32 v108, v104, v108
 v_mfma_f32_16x16x32_bf16 v[72:75], a[140:143], v[44:47], v[72:75]
 s_add_u32 m0, s56, 98304
 v_exp_f32 v105, v105
 v_mfma_f32_16x16x32_bf16 v[76:79], v[248:251], v[40:43], v[76:79]
 buffer_load_dwordx4 v18, s[8:11], s30 offen  lds
 v_add_f32 v105, 1.0, v105
 v_mfma_f32_16x16x32_bf16 v[76:79], v[252:255], v[44:47], v[76:79]
 v_rcp_f32 v105, v105
 v_mfma_f32_16x16x32_bf16 v[80:83], a[0:3], v[48:51], 0
 ds_read_b128 v[40:43], v20 offset:3072
 v_add_u32 v5, 4096, v19
 v_mfma_f32_16x16x32_bf16 v[80:83], a[4:7], v[52:55], v[80:83]
 v_add_u32 v6, 8192, v19
 v_mul_f32 v109, v105, v109
 v_mfma_f32_16x16x32_bf16 v[84:87], a[144:147], v[48:51], 0
 buffer_load_dwordx4 v18, s[8:11], s31 offen offset:1024  lds
 v_add_u32 v7, 147456, v19
 v_mfma_f32_16x16x32_bf16 v[84:87], a[148:151], v[52:55], v[84:87]
 v_add_u32 v8, 36864, v19
 v_cvt_pk_bf16_f32 v97, v102, v103
 v_mfma_f32_16x16x32_bf16 v[88:91], a[72:75], v[48:51], 0
 ds_read_b128 v[44:47], v21 offset:3072
 v_add_u32 v9, 135168, v19
 v_mfma_f32_16x16x32_bf16 v[88:91], a[76:79], v[52:55], v[88:91]
 v_add_u32 v26, 49152, v19
 v_cvt_pk_bf16_f32 v98, v108, v109
 v_mfma_f32_16x16x32_bf16 v[92:95], a[216:219], v[48:51], 0
 buffer_load_dwordx4 v18, s[8:11], s32 offen offset:2048  lds
 v_add_u32 v27, 98304, v19
 v_mfma_f32_16x16x32_bf16 v[92:95], a[220:223], v[52:55], v[92:95]
 s_waitcnt lgkmcnt(2)
 v_add_u32 v28, 0, v19
 v_mul_f32 v116, v112, v116
 v_mfma_f32_16x16x32_bf16 v[80:83], a[8:11], v[56:59], v[80:83]
 ds_read_b128 v[48:51], v20 offset:4096
 v_mul_f32 v112, s54, v112
 v_mfma_f32_16x16x32_bf16 v[80:83], a[12:15], v[60:63], v[80:83]
 v_exp_f32 v106, v106
 v_mfma_f32_16x16x32_bf16 v[84:87], a[152:155], v[56:59], v[84:87]
 buffer_load_dwordx4 v18, s[8:11], s33 offen offset:3072  lds
 v_add_f32 v106, 1.0, v106
 v_mfma_f32_16x16x32_bf16 v[84:87], a[156:159], v[60:63], v[84:87]
 v_rcp_f32 v106, v106
 v_mfma_f32_16x16x32_bf16 v[88:91], a[80:83], v[56:59], v[88:91]
 ds_read_b128 v[52:55], v21 offset:4096
 v_mul_f32 v110, v106, v110
 v_mfma_f32_16x16x32_bf16 v[88:91], a[84:87], v[60:63], v[88:91]
 v_exp_f32 v107, v107
 v_mfma_f32_16x16x32_bf16 v[92:95], a[224:227], v[56:59], v[92:95]
 s_add_u32 m0, s56, 102400
 v_exp_f32 v112, v112
 v_mfma_f32_16x16x32_bf16 v[92:95], a[228:231], v[60:63], v[92:95]
 buffer_load_dwordx4 v18, s[8:11], s34 offen  lds
 v_add_f32 v107, 1.0, v107
 v_mfma_f32_16x16x32_bf16 v[80:83], a[16:19], v[32:35], v[80:83]
 ds_read_b128 v[56:59], v20 offset:5120
 v_add_f32 v112, 1.0, v112
 v_mfma_f32_16x16x32_bf16 v[80:83], a[20:23], v[36:39], v[80:83]
 v_rcp_f32 v107, v107
 v_mfma_f32_16x16x32_bf16 v[84:87], a[160:163], v[32:35], v[84:87]
 v_rcp_f32 v112, v112
 v_mfma_f32_16x16x32_bf16 v[84:87], a[164:167], v[36:39], v[84:87]
 v_mul_f32 v111, v107, v111
 v_mul_f32 v116, v112, v116
 v_mfma_f32_16x16x32_bf16 v[88:91], a[88:91], v[32:35], v[88:91]
 ds_read_b128 v[60:63], v21 offset:5120
 v_cvt_pk_bf16_f32 v99, v110, v111
 v_mfma_f32_16x16x32_bf16 v[88:91], a[92:95], v[36:39], v[88:91]
 buffer_store_dwordx4 v[96:99], v19, s[16:19], s53 offen sc1
 v_mul_f32 v117, v113, v117
 v_mfma_f32_16x16x32_bf16 v[92:95], a[232:235], v[32:35], v[92:95]
 s_add_u32 s53, s53, s52
 v_mul_f32 v113, s54, v113
 v_mul_f32 v118, v114, v118
 v_mfma_f32_16x16x32_bf16 v[92:95], a[236:239], v[36:39], v[92:95]
 s_waitcnt lgkmcnt(2)
 v_exp_f32 v113, v113
 v_mfma_f32_16x16x32_bf16 v[80:83], a[24:27], v[40:43], v[80:83]
 ds_read_b128 v[32:35], v20 offset:6144
 v_add_f32 v113, 1.0, v113
 v_mfma_f32_16x16x32_bf16 v[80:83], a[28:31], v[44:47], v[80:83]
 v_rcp_f32 v113, v113
 v_mfma_f32_16x16x32_bf16 v[84:87], a[168:171], v[40:43], v[84:87]
 v_mul_f32 v117, v113, v117
 v_mul_f32 v114, s54, v114
 v_mfma_f32_16x16x32_bf16 v[84:87], a[172:175], v[44:47], v[84:87]
 v_exp_f32 v114, v114
 v_mfma_f32_16x16x32_bf16 v[88:91], a[96:99], v[40:43], v[88:91]
 ds_read_b128 v[36:39], v21 offset:6144
 v_add_f32 v114, 1.0, v114
 v_mfma_f32_16x16x32_bf16 v[88:91], a[100:103], v[44:47], v[88:91]
 v_rcp_f32 v114, v114
 v_mfma_f32_16x16x32_bf16 v[92:95], a[240:243], v[40:43], v[92:95]
 v_mul_f32 v118, v114, v118
 v_mul_f32 v119, v115, v119
 v_mfma_f32_16x16x32_bf16 v[92:95], a[244:247], v[44:47], v[92:95]
 v_mul_f32 v115, s54, v115
 v_mul_f32 v124, v120, v124
 v_mfma_f32_16x16x32_bf16 v[80:83], a[32:35], v[48:51], v[80:83]
 ds_read_b128 v[40:43], v20 offset:7168
 v_mul_f32 v120, s54, v120
 v_mfma_f32_16x16x32_bf16 v[80:83], a[36:39], v[52:55], v[80:83]
 v_exp_f32 v115, v115
 v_mfma_f32_16x16x32_bf16 v[84:87], a[176:179], v[48:51], v[84:87]
 v_exp_f32 v120, v120
 v_mfma_f32_16x16x32_bf16 v[84:87], a[180:183], v[52:55], v[84:87]
 v_add_f32 v115, 1.0, v115
 v_add_f32 v120, 1.0, v120
 v_mfma_f32_16x16x32_bf16 v[88:91], a[104:107], v[48:51], v[88:91]
 ds_read_b128 v[44:47], v21 offset:7168
 v_mul_f32 v125, v121, v125
 v_mfma_f32_16x16x32_bf16 v[88:91], a[108:111], v[52:55], v[88:91]
 buffer_load_dwordx4 v18, s[8:11], s35 offen offset:1024  lds
 v_mul_f32 v121, s54, v121
 v_mfma_f32_16x16x32_bf16 v[92:95], a[248:251], v[48:51], v[92:95]
 v_rcp_f32 v115, v115
 v_mfma_f32_16x16x32_bf16 v[92:95], a[252:255], v[52:55], v[92:95]
 s_waitcnt lgkmcnt(2)
 v_rcp_f32 v120, v120
 v_mfma_f32_16x16x32_bf16 v[80:83], a[40:43], v[56:59], v[80:83]
 ds_read_b128 v[48:51], v20 offset:8192
 v_mul_f32 v119, v115, v119
 v_mfma_f32_16x16x32_bf16 v[80:83], a[44:47], v[60:63], v[80:83]
 buffer_load_dwordx4 v18, s[8:11], s36 offen offset:2048  lds
 v_mul_f32 v124, v120, v124
 v_mfma_f32_16x16x32_bf16 v[84:87], a[184:187], v[56:59], v[84:87]
 v_exp_f32 v121, v121
 v_mfma_f32_16x16x32_bf16 v[84:87], a[188:191], v[60:63], v[84:87]
 v_add_f32 v121, 1.0, v121
 v_mul_f32 v126, v122, v126
 v_mfma_f32_16x16x32_bf16 v[88:91], a[112:115], v[56:59], v[88:91]
 ds_read_b128 v[52:55], v21 offset:8192
 v_mul_f32 v122, s54, v122
 v_mfma_f32_16x16x32_bf16 v[88:91], a[116:119], v[60:63], v[88:91]
 buffer_load_dwordx4 v18, s[8:11], s37 offen offset:3072  lds
 v_mul_f32 v127, v123, v127
 v_mfma_f32_16x16x32_bf16 v[92:95], v[224:227], v[56:59], v[92:95]
 v_rcp_f32 v121, v121
 v_mfma_f32_16x16x32_bf16 v[92:95], v[228:231], v[60:63], v[92:95]
 v_exp_f32 v122, v122
 v_mfma_f32_16x16x32_bf16 v[80:83], a[48:51], v[32:35], v[80:83]
 ds_read_b128 v[56:59], v20 offset:18432
 v_mul_f32 v125, v121, v125
 v_mfma_f32_16x16x32_bf16 v[80:83], a[52:55], v[36:39], v[80:83]
 s_add_u32 m0, s56, 106496
 v_add_f32 v122, 1.0, v122
 v_mul_f32 v123, s54, v123
 v_mfma_f32_16x16x32_bf16 v[84:87], a[192:195], v[32:35], v[84:87]
 buffer_load_dwordx4 v18, s[8:11], s38 offen  lds
 v_cvt_pk_bf16_f32 v112, v116, v117
 v_mfma_f32_16x16x32_bf16 v[84:87], a[196:199], v[36:39], v[84:87]
 v_rcp_f32 v122, v122
 v_mfma_f32_16x16x32_bf16 v[88:91], a[120:123], v[32:35], v[88:91]
 ds_read_b128 v[60:63], v21 offset:18432
 v_mul_f32 v126, v122, v126
 v_mfma_f32_16x16x32_bf16 v[88:91], a[124:127], v[36:39], v[88:91]
 v_exp_f32 v123, v123
 v_mfma_f32_16x16x32_bf16 v[92:95], v[232:235], v[32:35], v[92:95]
 v_add_u32 v18, 36864, v18
 v_add_f32 v123, 1.0, v123
 v_mfma_f32_16x16x32_bf16 v[92:95], v[236:239], v[36:39], v[92:95]
 s_waitcnt lgkmcnt(2)
 v_rcp_f32 v123, v123
 v_mfma_f32_16x16x32_bf16 v[80:83], a[56:59], v[40:43], v[80:83]
 ds_read_b128 v[32:35], v20 offset:19456
 v_mul_f32 v127, v123, v127
 v_mfma_f32_16x16x32_bf16 v[80:83], a[60:63], v[44:47], v[80:83]
 v_cvt_pk_bf16_f32 v113, v118, v119
 v_cvt_pk_bf16_f32 v114, v124, v125
 v_mfma_f32_16x16x32_bf16 v[84:87], a[200:203], v[40:43], v[84:87]
 v_cvt_pk_bf16_f32 v115, v126, v127
 v_mul_f32 v132, v128, v132
 v_mfma_f32_16x16x32_bf16 v[84:87], a[204:207], v[44:47], v[84:87]
 buffer_store_dwordx4 v[112:115], v19, s[16:19], s53 offen sc1
 v_mul_f32 v128, s54, v128
 v_mfma_f32_16x16x32_bf16 v[88:91], a[128:131], v[40:43], v[88:91]
 ds_read_b128 v[36:39], v21 offset:19456
 s_add_u32 s53, s53, s52
 v_mfma_f32_16x16x32_bf16 v[88:91], a[132:135], v[44:47], v[88:91]
 v_exp_f32 v128, v128
 v_mfma_f32_16x16x32_bf16 v[92:95], v[240:243], v[40:43], v[92:95]
 v_add_f32 v128, 1.0, v128
 v_mul_f32 v133, v129, v133
 v_mfma_f32_16x16x32_bf16 v[92:95], v[244:247], v[44:47], v[92:95]
 v_rcp_f32 v128, v128
 v_mfma_f32_16x16x32_bf16 v[80:83], a[64:67], v[48:51], v[80:83]
 ds_read_b128 v[40:43], v20 offset:20480
 v_mul_f32 v132, v128, v132
 v_mfma_f32_16x16x32_bf16 v[80:83], a[68:71], v[52:55], v[80:83]
 v_mul_f32 v129, s54, v129
 v_mul_f32 v134, v130, v134
 v_mfma_f32_16x16x32_bf16 v[84:87], a[208:211], v[48:51], v[84:87]
 v_exp_f32 v129, v129
 v_mfma_f32_16x16x32_bf16 v[84:87], a[212:215], v[52:55], v[84:87]
 v_add_f32 v129, 1.0, v129
 v_mul_f32 v130, s54, v130
 v_mfma_f32_16x16x32_bf16 v[88:91], a[136:139], v[48:51], v[88:91]
 ds_read_b128 v[44:47], v21 offset:20480
 v_mul_f32 v135, v131, v135
 v_mfma_f32_16x16x32_bf16 v[88:91], a[140:143], v[52:55], v[88:91]
 v_rcp_f32 v129, v129
 v_mfma_f32_16x16x32_bf16 v[92:95], v[248:251], v[48:51], v[92:95]
 v_exp_f32 v130, v130
 v_mfma_f32_16x16x32_bf16 v[92:95], v[252:255], v[52:55], v[92:95]
 s_waitcnt lgkmcnt(2)
 v_mul_f32 v133, v129, v133
 v_add_f32 v130, 1.0, v130
 v_mfma_f32_16x16x32_bf16 v[96:99], a[0:3], v[56:59], 0
 ds_read_b128 v[48:51], v20 offset:21504
 v_mul_f32 v131, s54, v131
 v_mfma_f32_16x16x32_bf16 v[96:99], a[4:7], v[60:63], v[96:99]
 v_rcp_f32 v130, v130
 v_mfma_f32_16x16x32_bf16 v[100:103], a[144:147], v[56:59], 0
 v_exp_f32 v131, v131
 v_mfma_f32_16x16x32_bf16 v[100:103], a[148:151], v[60:63], v[100:103]
 v_mul_f32 v134, v130, v134
 v_add_f32 v131, 1.0, v131
 v_mfma_f32_16x16x32_bf16 v[104:107], a[72:75], v[56:59], 0
 ds_read_b128 v[52:55], v21 offset:21504
 v_mul_f32 v140, v136, v140
 v_mfma_f32_16x16x32_bf16 v[104:107], a[76:79], v[60:63], v[104:107]
 v_rcp_f32 v131, v131
 v_mfma_f32_16x16x32_bf16 v[108:111], a[216:219], v[56:59], 0
 v_mul_f32 v135, v131, v135
 v_mul_f32 v136, s54, v136
 v_mfma_f32_16x16x32_bf16 v[108:111], a[220:223], v[60:63], v[108:111]
 v_exp_f32 v136, v136
 v_mfma_f32_16x16x32_bf16 v[96:99], a[8:11], v[32:35], v[96:99]
 ds_read_b128 v[56:59], v20 offset:22528
 v_add_f32 v136, 1.0, v136
 v_mfma_f32_16x16x32_bf16 v[96:99], a[12:15], v[36:39], v[96:99]
 v_rcp_f32 v136, v136
 v_mfma_f32_16x16x32_bf16 v[100:103], a[152:155], v[32:35], v[100:103]
 v_mul_f32 v140, v136, v140
 v_mul_f32 v141, v137, v141
 v_mfma_f32_16x16x32_bf16 v[100:103], a[156:159], v[36:39], v[100:103]
 v_mul_f32 v137, s54, v137
 v_mul_f32 v142, v138, v142
 v_mfma_f32_16x16x32_bf16 v[104:107], a[80:83], v[32:35], v[104:107]
 ds_read_b128 v[60:63], v21 offset:22528
 v_mul_f32 v138, s54, v138
 v_mfma_f32_16x16x32_bf16 v[104:107], a[84:87], v[36:39], v[104:107]
 v_exp_f32 v137, v137
 v_mfma_f32_16x16x32_bf16 v[108:111], a[224:227], v[32:35], v[108:111]
 v_exp_f32 v138, v138
 v_mfma_f32_16x16x32_bf16 v[108:111], a[228:231], v[36:39], v[108:111]
 s_waitcnt lgkmcnt(2)
 v_add_f32 v137, 1.0, v137
 v_add_f32 v138, 1.0, v138
 v_mfma_f32_16x16x32_bf16 v[96:99], a[16:19], v[40:43], v[96:99]
 ds_read_b128 v[32:35], v20 offset:23552
 v_mul_f32 v143, v139, v143
 v_mfma_f32_16x16x32_bf16 v[96:99], a[20:23], v[44:47], v[96:99]
 v_rcp_f32 v137, v137
 v_mfma_f32_16x16x32_bf16 v[100:103], a[160:163], v[40:43], v[100:103]
 v_rcp_f32 v138, v138
 v_mfma_f32_16x16x32_bf16 v[100:103], a[164:167], v[44:47], v[100:103]
 v_mul_f32 v141, v137, v141
 v_mul_f32 v142, v138, v142
 v_mfma_f32_16x16x32_bf16 v[104:107], a[88:91], v[40:43], v[104:107]
 ds_read_b128 v[36:39], v21 offset:23552
 v_mul_f32 v139, s54, v139
 v_mfma_f32_16x16x32_bf16 v[104:107], a[92:95], v[44:47], v[104:107]
 v_exp_f32 v139, v139
 v_mfma_f32_16x16x32_bf16 v[108:111], a[232:235], v[40:43], v[108:111]
 v_add_f32 v139, 1.0, v139
 v_cvt_pk_bf16_f32 v128, v132, v133
 v_mfma_f32_16x16x32_bf16 v[108:111], a[236:239], v[44:47], v[108:111]
 v_rcp_f32 v139, v139
 v_mfma_f32_16x16x32_bf16 v[96:99], a[24:27], v[48:51], v[96:99]
 ds_read_b128 v[40:43], v20 offset:24576
 v_mul_f32 v143, v139, v143
 v_mfma_f32_16x16x32_bf16 v[96:99], a[28:31], v[52:55], v[96:99]
 v_cvt_pk_bf16_f32 v129, v134, v135
 v_cvt_pk_bf16_f32 v130, v140, v141
 v_mfma_f32_16x16x32_bf16 v[100:103], a[168:171], v[48:51], v[100:103]
 v_cvt_pk_bf16_f32 v131, v142, v143
 v_mul_f32 v68, v64, v68
 v_mfma_f32_16x16x32_bf16 v[100:103], a[172:175], v[52:55], v[100:103]
 buffer_store_dwordx4 v[128:131], v19, s[16:19], s53 offen sc1
 v_mul_f32 v64, s54, v64
 v_mfma_f32_16x16x32_bf16 v[104:107], a[96:99], v[48:51], v[104:107]
 ds_read_b128 v[44:47], v21 offset:24576
 s_add_u32 s53, s53, s52
 v_mfma_f32_16x16x32_bf16 v[104:107], a[100:103], v[52:55], v[104:107]
 v_exp_f32 v64, v64
 v_mfma_f32_16x16x32_bf16 v[108:111], a[240:243], v[48:51], v[108:111]
 v_add_f32 v64, 1.0, v64
 v_mul_f32 v69, v65, v69
 v_mfma_f32_16x16x32_bf16 v[108:111], a[244:247], v[52:55], v[108:111]
 s_waitcnt lgkmcnt(2)
 v_rcp_f32 v64, v64
 v_mfma_f32_16x16x32_bf16 v[96:99], a[32:35], v[56:59], v[96:99]
 ds_read_b128 v[48:51], v20 offset:25600
 v_mul_f32 v68, v64, v68
 v_mfma_f32_16x16x32_bf16 v[96:99], a[36:39], v[60:63], v[96:99]
 v_mul_f32 v65, s54, v65
 v_mul_f32 v70, v66, v70
 v_mfma_f32_16x16x32_bf16 v[100:103], a[176:179], v[56:59], v[100:103]
 v_exp_f32 v65, v65
 v_mfma_f32_16x16x32_bf16 v[100:103], a[180:183], v[60:63], v[100:103]
 v_add_f32 v65, 1.0, v65
 v_mul_f32 v66, s54, v66
 v_mfma_f32_16x16x32_bf16 v[104:107], a[104:107], v[56:59], v[104:107]
 ds_read_b128 v[52:55], v21 offset:25600
 v_mul_f32 v71, v67, v71
 v_mfma_f32_16x16x32_bf16 v[104:107], a[108:111], v[60:63], v[104:107]
 v_rcp_f32 v65, v65
 v_mfma_f32_16x16x32_bf16 v[108:111], a[248:251], v[56:59], v[108:111]
 v_exp_f32 v66, v66
 v_mfma_f32_16x16x32_bf16 v[108:111], a[252:255], v[60:63], v[108:111]
 v_mul_f32 v69, v65, v69
 v_add_f32 v66, 1.0, v66
 v_mfma_f32_16x16x32_bf16 v[96:99], a[40:43], v[32:35], v[96:99]
 ds_read_b128 v[56:59], v20 offset:26624
 v_mul_f32 v67, s54, v67
 v_mfma_f32_16x16x32_bf16 v[96:99], a[44:47], v[36:39], v[96:99]
 v_rcp_f32 v66, v66
 v_mfma_f32_16x16x32_bf16 v[100:103], a[184:187], v[32:35], v[100:103]
 v_exp_f32 v67, v67
 v_mfma_f32_16x16x32_bf16 v[100:103], a[188:191], v[36:39], v[100:103]
 v_mul_f32 v70, v66, v70
 v_add_f32 v67, 1.0, v67
 v_mfma_f32_16x16x32_bf16 v[104:107], a[112:115], v[32:35], v[104:107]
 ds_read_b128 v[60:63], v21 offset:26624
 v_mul_f32 v76, v72, v76
 v_mfma_f32_16x16x32_bf16 v[104:107], a[116:119], v[36:39], v[104:107]
 v_rcp_f32 v67, v67
 v_mfma_f32_16x16x32_bf16 v[108:111], v[224:227], v[32:35], v[108:111]
 v_mul_f32 v71, v67, v71
 v_mul_f32 v72, s54, v72
 v_mfma_f32_16x16x32_bf16 v[108:111], v[228:231], v[36:39], v[108:111]
 s_waitcnt lgkmcnt(2)
 v_exp_f32 v72, v72
 v_mfma_f32_16x16x32_bf16 v[96:99], a[48:51], v[40:43], v[96:99]
 v_add_f32 v72, 1.0, v72
 v_mul_f32 v77, v73, v77
 v_mfma_f32_16x16x32_bf16 v[96:99], a[52:55], v[44:47], v[96:99]
 v_rcp_f32 v72, v72
 v_mfma_f32_16x16x32_bf16 v[100:103], a[192:195], v[40:43], v[100:103]
 v_mul_f32 v76, v72, v76
 v_mul_f32 v73, s54, v73
 v_mfma_f32_16x16x32_bf16 v[100:103], a[196:199], v[44:47], v[100:103]
 v_exp_f32 v73, v73
 v_mfma_f32_16x16x32_bf16 v[104:107], a[120:123], v[40:43], v[104:107]
 v_add_f32 v73, 1.0, v73
 v_mul_f32 v78, v74, v78
 v_mfma_f32_16x16x32_bf16 v[104:107], a[124:127], v[44:47], v[104:107]
 v_rcp_f32 v73, v73
 v_mfma_f32_16x16x32_bf16 v[108:111], v[232:235], v[40:43], v[108:111]
 s_waitcnt vmcnt(13) lgkmcnt(0)
 s_barrier
 v_mul_f32 v77, v73, v77
 v_mfma_f32_16x16x32_bf16 v[108:111], v[236:239], v[44:47], v[108:111]
 ds_read_b128 v[32:35], v22 offset:0
 v_mul_f32 v74, s54, v74
 v_mfma_f32_16x16x32_bf16 v[96:99], a[56:59], v[48:51], v[96:99]
 ds_read_b128 v[36:39], v23 offset:0
 v_mul_f32 v79, v75, v79
 v_mfma_f32_16x16x32_bf16 v[96:99], a[60:63], v[52:55], v[96:99]
 ds_read_b128 v[40:43], v22 offset:1024
 v_mul_f32 v75, s54, v75
 v_mfma_f32_16x16x32_bf16 v[100:103], a[200:203], v[48:51], v[100:103]
 v_exp_f32 v74, v74
 v_mfma_f32_16x16x32_bf16 v[100:103], a[204:207], v[52:55], v[100:103]
 v_exp_f32 v75, v75
 v_mfma_f32_16x16x32_bf16 v[104:107], a[128:131], v[48:51], v[104:107]
 ds_read_b128 v[44:47], v23 offset:1024
 v_add_f32 v74, 1.0, v74
 v_mfma_f32_16x16x32_bf16 v[104:107], a[132:135], v[52:55], v[104:107]
 v_rcp_f32 v74, v74
 v_mfma_f32_16x16x32_bf16 v[108:111], v[240:243], v[48:51], v[108:111]
 v_mul_f32 v78, v74, v78
 v_add_f32 v75, 1.0, v75
 v_mfma_f32_16x16x32_bf16 v[108:111], v[244:247], v[52:55], v[108:111]
 s_waitcnt lgkmcnt(2)
 v_rcp_f32 v75, v75
 v_mfma_f32_16x16x32_bf16 v[96:99], a[64:67], v[56:59], v[96:99]
 ds_read_b128 v[48:51], v22 offset:2048
 v_mul_f32 v79, v75, v79
 v_mfma_f32_16x16x32_bf16 v[96:99], a[68:71], v[60:63], v[96:99]
 v_cvt_pk_bf16_f32 v64, v68, v69
 v_cvt_pk_bf16_f32 v65, v70, v71
 v_mfma_f32_16x16x32_bf16 v[100:103], a[208:211], v[56:59], v[100:103]
 s_add_u32 m0, s56, 0
 v_cvt_pk_bf16_f32 v66, v76, v77
 v_cvt_pk_bf16_f32 v67, v78, v79
 v_mfma_f32_16x16x32_bf16 v[100:103], a[212:215], v[60:63], v[100:103]
 buffer_store_dwordx4 v[64:67], v19, s[16:19], s53 offen sc1
 v_mul_f32 v84, v80, v84
 v_mfma_f32_16x16x32_bf16 v[104:107], a[136:139], v[56:59], v[104:107]
 ds_read_b128 v[52:55], v23 offset:2048
 s_add_u32 s53, s53, s52
 v_mfma_f32_16x16x32_bf16 v[104:107], a[140:143], v[60:63], v[104:107]
 s_cmp_eq_u32 s27, 4
 s_cselect_b32 s3, 3244032, 0
 s_sub_u32 s53, s53, s3
 v_mfma_f32_16x16x32_bf16 v[108:111], v[248:251], v[56:59], v[108:111]
 v_mul_f32 v80, s54, v80
 v_mul_f32 v85, v81, v85
 v_mfma_f32_16x16x32_bf16 v[108:111], v[252:255], v[60:63], v[108:111]
 v_exp_f32 v80, v80
 v_mfma_f32_16x16x32_bf16 v[64:67], a[0:3], v[32:35], 0
 ds_read_b128 v[56:59], v22 offset:3072
 v_add_f32 v80, 1.0, v80
 v_mfma_f32_16x16x32_bf16 v[64:67], a[4:7], v[36:39], v[64:67]
 v_rcp_f32 v80, v80
 v_mfma_f32_16x16x32_bf16 v[68:71], a[144:147], v[32:35], 0
 v_mul_f32 v84, v80, v84
 v_mul_f32 v81, s54, v81
 v_mfma_f32_16x16x32_bf16 v[68:71], a[148:151], v[36:39], v[68:71]
 v_exp_f32 v81, v81
 v_mfma_f32_16x16x32_bf16 v[72:75], a[72:75], v[32:35], 0
 ds_read_b128 v[60:63], v23 offset:3072
 v_add_f32 v81, 1.0, v81
 v_mfma_f32_16x16x32_bf16 v[72:75], a[76:79], v[36:39], v[72:75]
 v_rcp_f32 v81, v81
 v_mfma_f32_16x16x32_bf16 v[76:79], a[216:219], v[32:35], 0
 v_mul_f32 v85, v81, v85
 v_mul_f32 v86, v82, v86
 v_mfma_f32_16x16x32_bf16 v[76:79], a[220:223], v[36:39], v[76:79]
 s_waitcnt lgkmcnt(2)
 v_mul_f32 v82, s54, v82
 v_mul_f32 v87, v83, v87
 v_mfma_f32_16x16x32_bf16 v[64:67], a[8:11], v[40:43], v[64:67]
 ds_read_b128 v[32:35], v22 offset:4096
 v_mul_f32 v83, s54, v83
 v_mfma_f32_16x16x32_bf16 v[64:67], a[12:15], v[44:47], v[64:67]
 v_exp_f32 v82, v82
 v_mfma_f32_16x16x32_bf16 v[68:71], a[152:155], v[40:43], v[68:71]
 v_exp_f32 v83, v83
 v_mfma_f32_16x16x32_bf16 v[68:71], a[156:159], v[44:47], v[68:71]
 buffer_load_dwordx4 v18, s[8:11], s30 offen  lds
 v_add_f32 v82, 1.0, v82
 v_mfma_f32_16x16x32_bf16 v[72:75], a[80:83], v[40:43], v[72:75]
 ds_read_b128 v[36:39], v23 offset:4096
 v_add_f32 v83, 1.0, v83
 v_mfma_f32_16x16x32_bf16 v[72:75], a[84:87], v[44:47], v[72:75]
 v_rcp_f32 v82, v82
 v_mfma_f32_16x16x32_bf16 v[76:79], a[224:227], v[40:43], v[76:79]
 v_rcp_f32 v83, v83
 v_mfma_f32_16x16x32_bf16 v[76:79], a[228:231], v[44:47], v[76:79]
 buffer_load_dwordx4 v18, s[8:11], s31 offen offset:1024  lds
 v_mul_f32 v86, v82, v86
 v_mfma_f32_16x16x32_bf16 v[64:67], a[16:19], v[48:51], v[64:67]
 ds_read_b128 v[40:43], v22 offset:5120
 v_mul_f32 v87, v83, v87
 v_mfma_f32_16x16x32_bf16 v[64:67], a[20:23], v[52:55], v[64:67]
 v_mul_f32 v92, v88, v92
 v_mul_f32 v93, v89, v93
 v_mfma_f32_16x16x32_bf16 v[68:71], a[160:163], v[48:51], v[68:71]
 v_mul_f32 v88, s54, v88
 v_mul_f32 v89, s54, v89
 v_mfma_f32_16x16x32_bf16 v[68:71], a[164:167], v[52:55], v[68:71]
 buffer_load_dwordx4 v18, s[8:11], s32 offen offset:2048  lds
 v_mul_f32 v94, v90, v94
 v_mfma_f32_16x16x32_bf16 v[72:75], a[88:91], v[48:51], v[72:75]
 ds_read_b128 v[44:47], v23 offset:5120
 v_mul_f32 v90, s54, v90
 v_mfma_f32_16x16x32_bf16 v[72:75], a[92:95], v[52:55], v[72:75]
 v_exp_f32 v88, v88
 v_mfma_f32_16x16x32_bf16 v[76:79], a[232:235], v[48:51], v[76:79]
 v_exp_f32 v89, v89
 v_mfma_f32_16x16x32_bf16 v[76:79], a[236:239], v[52:55], v[76:79]
 s_waitcnt lgkmcnt(2)
 v_exp_f32 v90, v90
 v_mfma_f32_16x16x32_bf16 v[64:67], a[24:27], v[56:59], v[64:67]
 ds_read_b128 v[48:51], v22 offset:6144
 v_add_f32 v88, 1.0, v88
 v_mfma_f32_16x16x32_bf16 v[64:67], a[28:31], v[60:63], v[64:67]
 buffer_load_dwordx4 v18, s[8:11], s33 offen offset:3072  lds
 v_add_f32 v89, 1.0, v89
 v_mfma_f32_16x16x32_bf16 v[68:71], a[168:171], v[56:59], v[68:71]
 v_rcp_f32 v88, v88
 v_mfma_f32_16x16x32_bf16 v[68:71], a[172:175], v[60:63], v[68:71]
 v_rcp_f32 v89, v89
 v_mfma_f32_16x16x32_bf16 v[72:75], a[96:99], v[56:59], v[72:75]
 ds_read_b128 v[52:55], v23 offset:6144
 v_mul_f32 v92, v88, v92
 v_mfma_f32_16x16x32_bf16 v[72:75], a[100:103], v[60:63], v[72:75]
 s_add_u32 m0, s56, 4096
 v_mul_f32 v93, v89, v93
 v_add_f32 v90, 1.0, v90
 v_mfma_f32_16x16x32_bf16 v[76:79], a[240:243], v[56:59], v[76:79]
 buffer_load_dwordx4 v18, s[8:11], s34 offen  lds
 v_mul_f32 v95, v91, v95
 v_mfma_f32_16x16x32_bf16 v[76:79], a[244:247], v[60:63], v[76:79]
 v_rcp_f32 v90, v90
 v_mfma_f32_16x16x32_bf16 v[64:67], a[32:35], v[32:35], v[64:67]
 ds_read_b128 v[56:59], v22 offset:7168
 v_mul_f32 v94, v90, v94
 v_mfma_f32_16x16x32_bf16 v[64:67], a[36:39], v[36:39], v[64:67]
 v_mul_f32 v91, s54, v91
 v_cvt_pk_bf16_f32 v80, v84, v85
 v_mfma_f32_16x16x32_bf16 v[68:71], a[176:179], v[32:35], v[68:71]
 buffer_load_dwordx4 v18, s[8:11], s35 offen offset:1024  lds
 v_cvt_pk_bf16_f32 v81, v86, v87
 v_mfma_f32_16x16x32_bf16 v[68:71], a[180:183], v[36:39], v[68:71]
 v_exp_f32 v91, v91
 v_mfma_f32_16x16x32_bf16 v[72:75], a[104:107], v[32:35], v[72:75]
 ds_read_b128 v[60:63], v23 offset:7168
 v_add_f32 v91, 1.0, v91
 v_mfma_f32_16x16x32_bf16 v[72:75], a[108:111], v[36:39], v[72:75]
 v_rcp_f32 v91, v91
 v_mfma_f32_16x16x32_bf16 v[76:79], a[248:251], v[32:35], v[76:79]
 buffer_load_dwordx4 v18, s[8:11], s36 offen offset:2048  lds
 v_mul_f32 v95, v91, v95
 v_mfma_f32_16x16x32_bf16 v[76:79], a[252:255], v[36:39], v[76:79]
 s_waitcnt lgkmcnt(2)
 v_cvt_pk_bf16_f32 v82, v92, v93
 v_cvt_pk_bf16_f32 v83, v94, v95
 v_mfma_f32_16x16x32_bf16 v[64:67], a[40:43], v[40:43], v[64:67]
 ds_read_b128 v[32:35], v22 offset:8192
 v_mul_f32 v100, v96, v100
 v_mfma_f32_16x16x32_bf16 v[64:67], a[44:47], v[44:47], v[64:67]
 buffer_store_dwordx4 v[80:83], v19, s[16:19], s53 offen sc1
 v_mul_f32 v96, s54, v96
 v_mfma_f32_16x16x32_bf16 v[68:71], a[184:187], v[40:43], v[68:71]
 s_add_u32 s53, s53, s52
 v_exp_f32 v96, v96
 v_mfma_f32_16x16x32_bf16 v[68:71], a[188:191], v[44:47], v[68:71]
 v_add_f32 v96, 1.0, v96
 v_mul_f32 v101, v97, v101
 v_mfma_f32_16x16x32_bf16 v[72:75], a[112:115], v[40:43], v[72:75]
 ds_read_b128 v[36:39], v23 offset:8192
 v_mul_f32 v97, s54, v97
 v_mfma_f32_16x16x32_bf16 v[72:75], a[116:119], v[44:47], v[72:75]
 v_rcp_f32 v96, v96
 v_mfma_f32_16x16x32_bf16 v[76:79], v[224:227], v[40:43], v[76:79]
 v_exp_f32 v97, v97
 v_mfma_f32_16x16x32_bf16 v[76:79], v[228:231], v[44:47], v[76:79]
 v_mul_f32 v100, v96, v100
 v_add_f32 v97, 1.0, v97
 v_mfma_f32_16x16x32_bf16 v[64:67], a[48:51], v[48:51], v[64:67]
 ds_read_b128 v[40:43], v22 offset:18432
 v_mul_f32 v102, v98, v102
 v_mfma_f32_16x16x32_bf16 v[64:67], a[52:55], v[52:55], v[64:67]
 v_rcp_f32 v97, v97
 v_mfma_f32_16x16x32_bf16 v[68:71], a[192:195], v[48:51], v[68:71]
 s_load_dword s64, s[88:89], s28 offset:8192
 v_mul_f32 v101, v97, v101
 v_mul_f32 v98, s54, v98
 v_mfma_f32_16x16x32_bf16 v[68:71], a[196:199], v[52:55], v[68:71]
 v_exp_f32 v98, v98
 v_mfma_f32_16x16x32_bf16 v[72:75], a[120:123], v[48:51], v[72:75]
 ds_read_b128 v[44:47], v23 offset:18432
 v_add_f32 v98, 1.0, v98
 v_mfma_f32_16x16x32_bf16 v[72:75], a[124:127], v[52:55], v[72:75]
 v_rcp_f32 v98, v98
 v_mfma_f32_16x16x32_bf16 v[76:79], v[232:235], v[48:51], v[76:79]
 v_mul_f32 v102, v98, v102
 v_mul_f32 v103, v99, v103
 v_mfma_f32_16x16x32_bf16 v[76:79], v[236:239], v[52:55], v[76:79]
 s_waitcnt lgkmcnt(4)
 v_mul_f32 v99, s54, v99
 v_mul_f32 v108, v104, v108
 v_mfma_f32_16x16x32_bf16 v[64:67], a[56:59], v[56:59], v[64:67]
 ds_read_b128 v[48:51], v22 offset:19456
 v_mul_f32 v104, s54, v104
 v_mfma_f32_16x16x32_bf16 v[64:67], a[60:63], v[60:63], v[64:67]
Lpg5:
 s_cbranch_vccnz Lj_Lfin
 buffer_load_dwordx4 v18, s[8:11], s37 offen offset:3072  lds
 v_mul_f32 v109, v105, v109
 v_mfma_f32_16x16x32_bf16 v[68:71], a[200:203], v[56:59], v[68:71]
 v_exp_f32 v99, v99
 v_mfma_f32_16x16x32_bf16 v[68:71], a[204:207], v[60:63], v[68:71]
 v_exp_f32 v104, v104
 v_mfma_f32_16x16x32_bf16 v[72:75], a[128:131], v[56:59], v[72:75]
 ds_read_b128 v[52:55], v23 offset:19456
 v_add_f32 v99, 1.0, v99
 v_mfma_f32_16x16x32_bf16 v[72:75], a[132:135], v[60:63], v[72:75]
 s_add_u32 m0, s56, 8192
 v_rcp_f32 v99, v99
 v_mfma_f32_16x16x32_bf16 v[76:79], v[240:243], v[56:59], v[76:79]
 buffer_load_dwordx4 v18, s[8:11], s38 offen  lds
 v_mul_f32 v103, v99, v103
 v_mfma_f32_16x16x32_bf16 v[76:79], v[244:247], v[60:63], v[76:79]
 s_waitcnt lgkmcnt(4)
 v_add_f32 v104, 1.0, v104
 v_mul_f32 v105, s54, v105
 v_mfma_f32_16x16x32_bf16 v[64:67], a[64:67], v[32:35], v[64:67]
 ds_read_b128 v[56:59], v22 offset:20480
 v_mul_f32 v110, v106, v110
 v_mfma_f32_16x16x32_bf16 v[64:67], a[68:71], v[36:39], v[64:67]
 v_rcp_f32 v104, v104
 v_mfma_f32_16x16x32_bf16 v[68:71], a[208:211], v[32:35], v[68:71]
 v_exp_f32 v105, v105
 v_mfma_f32_16x16x32_bf16 v[68:71], a[212:215], v[36:39], v[68:71]
 v_mul_f32 v108, v104, v108
 v_add_f32 v105, 1.0, v105
 v_mfma_f32_16x16x32_bf16 v[72:75], a[136:139], v[32:35], v[72:75]
 ds_read_b128 v[60:63], v23 offset:20480
 v_mul_f32 v106, s54, v106
 v_mfma_f32_16x16x32_bf16 v[72:75], a[140:143], v[36:39], v[72:75]
 v_rcp_f32 v105, v105
 v_mfma_f32_16x16x32_bf16 v[76:79], v[248:251], v[32:35], v[76:79]
 v_exp_f32 v106, v106
 v_mfma_f32_16x16x32_bf16 v[76:79], v[252:255], v[36:39], v[76:79]
 s_waitcnt lgkmcnt(4)
 v_mul_f32 v109, v105, v109
 v_add_f32 v106, 1.0, v106
 v_mfma_f32_16x16x32_bf16 v[80:83], a[0:3], v[40:43], 0
 ds_read_b128 v[32:35], v22 offset:21504
 v_mul_f32 v111, v107, v111
 v_mfma_f32_16x16x32_bf16 v[80:83], a[4:7], v[44:47], v[80:83]
 v_rcp_f32 v106, v106
 v_mfma_f32_16x16x32_bf16 v[84:87], a[144:147], v[40:43], 0
 v_mul_f32 v110, v106, v110
 v_mul_f32 v107, s54, v107
 v_mfma_f32_16x16x32_bf16 v[84:87], a[148:151], v[44:47], v[84:87]
 v_exp_f32 v107, v107
 v_mfma_f32_16x16x32_bf16 v[88:91], a[72:75], v[40:43], 0
 ds_read_b128 v[36:39], v23 offset:21504
 v_add_f32 v107, 1.0, v107
 v_mfma_f32_16x16x32_bf16 v[88:91], a[76:79], v[44:47], v[88:91]
 v_rcp_f32 v107, v107
 v_mfma_f32_16x16x32_bf16 v[92:95], a[216:219], v[40:43], 0
 v_mul_f32 v111, v107, v111
 v_cvt_pk_bf16_f32 v96, v100, v101
 v_mfma_f32_16x16x32_bf16 v[92:95], a[220:223], v[44:47], v[92:95]
 s_waitcnt lgkmcnt(4)
 v_cvt_pk_bf16_f32 v97, v102, v103
 v_cvt_pk_bf16_f32 v98, v108, v109
 v_mfma_f32_16x16x32_bf16 v[80:83], a[8:11], v[48:51], v[80:83]
 ds_read_b128 v[40:43], v22 offset:22528
 v_cvt_pk_bf16_f32 v99, v110, v111
 v_mfma_f32_16x16x32_bf16 v[80:83], a[12:15], v[52:55], v[80:83]
 buffer_store_dwordx4 v[96:99], v19, s[16:19], s53 offen sc1
 v_mul_f32 v68, v64, v68
 v_mfma_f32_16x16x32_bf16 v[84:87], a[152:155], v[48:51], v[84:87]
 s_add_u32 s53, s53, s52
 v_mul_f32 v64, s54, v64
 v_mul_f32 v69, v65, v69
 v_mfma_f32_16x16x32_bf16 v[84:87], a[156:159], v[52:55], v[84:87]
 v_exp_f32 v64, v64
 v_mfma_f32_16x16x32_bf16 v[88:91], a[80:83], v[48:51], v[88:91]
 ds_read_b128 v[44:47], v23 offset:22528
 v_add_f32 v64, 1.0, v64
 v_mfma_f32_16x16x32_bf16 v[88:91], a[84:87], v[52:55], v[88:91]
 v_rcp_f32 v64, v64
 v_mfma_f32_16x16x32_bf16 v[92:95], a[224:227], v[48:51], v[92:95]
 v_mul_f32 v68, v64, v68
 v_mul_f32 v65, s54, v65
 v_mfma_f32_16x16x32_bf16 v[92:95], a[228:231], v[52:55], v[92:95]
 s_waitcnt lgkmcnt(4)
 v_exp_f32 v65, v65
 v_mfma_f32_16x16x32_bf16 v[80:83], a[16:19], v[56:59], v[80:83]
 ds_read_b128 v[48:51], v22 offset:23552
 v_add_f32 v65, 1.0, v65
 v_mfma_f32_16x16x32_bf16 v[80:83], a[20:23], v[60:63], v[80:83]
 v_rcp_f32 v65, v65
 v_mfma_f32_16x16x32_bf16 v[84:87], a[160:163], v[56:59], v[84:87]
 v_mul_f32 v69, v65, v69
 v_mul_f32 v70, v66, v70
 v_mfma_f32_16x16x32_bf16 v[84:87], a[164:167], v[60:63], v[84:87]
 v_mul_f32 v66, s54, v66
 v_mul_f32 v71, v67, v71
 v_mfma_f32_16x16x32_bf16 v[88:91], a[88:91], v[56:59], v[88:91]
 ds_read_b128 v[52:55], v23 offset:23552
 v_mul_f32 v67, s54, v67
 v_mfma_f32_16x16x32_bf16 v[88:91], a[92:95], v[60:63], v[88:91]
 v_exp_f32 v66, v66
 v_mfma_f32_16x16x32_bf16 v[92:95], a[232:235], v[56:59], v[92:95]
 v_exp_f32 v67, v67
 v_mfma_f32_16x16x32_bf16 v[92:95], a[236:239], v[60:63], v[92:95]
 s_waitcnt lgkmcnt(4)
 v_add_f32 v66, 1.0, v66
 v_add_f32 v67, 1.0, v67
 v_mfma_f32_16x16x32_bf16 v[80:83], a[24:27], v[32:35], v[80:83]
 ds_read_b128 v[56:59], v22 offset:24576
 v_mul_f32 v76, v72, v76
 v_mfma_f32_16x16x32_bf16 v[80:83], a[28:31], v[36:39], v[80:83]
 v_rcp_f32 v66, v66
 v_mfma_f32_16x16x32_bf16 v[84:87], a[168:171], v[32:35], v[84:87]
 v_rcp_f32 v67, v67
 v_mfma_f32_16x16x32_bf16 v[84:87], a[172:175], v[36:39], v[84:87]
 v_mul_f32 v70, v66, v70
 v_mul_f32 v71, v67, v71
 v_mfma_f32_16x16x32_bf16 v[88:91], a[96:99], v[32:35], v[88:91]
 ds_read_b128 v[60:63], v23 offset:24576
 v_mul_f32 v72, s54, v72
 v_mfma_f32_16x16x32_bf16 v[88:91], a[100:103], v[36:39], v[88:91]
 v_exp_f32 v72, v72
 v_mfma_f32_16x16x32_bf16 v[92:95], a[240:243], v[32:35], v[92:95]
 v_add_f32 v72, 1.0, v72
 v_mul_f32 v77, v73, v77
 v_mfma_f32_16x16x32_bf16 v[92:95], a[244:247], v[36:39], v[92:95]
 s_waitcnt lgkmcnt(4)
 v_rcp_f32 v72, v72
 v_mfma_f32_16x16x32_bf16 v[80:83], a[32:35], v[40:43], v[80:83]
 ds_read_b128 v[32:35], v22 offset:25600
 v_mul_f32 v76, v72, v76
 v_mfma_f32_16x16x32_bf16 v[80:83], a[36:39], v[44:47], v[80:83]
 v_mul_f32 v73, s54, v73
 v_mul_f32 v78, v74, v78
 v_mfma_f32_16x16x32_bf16 v[84:87], a[176:179], v[40:43], v[84:87]
 v_exp_f32 v73, v73
 v_mfma_f32_16x16x32_bf16 v[84:87], a[180:183], v[44:47], v[84:87]
 v_add_f32 v73, 1.0, v73
 v_mul_f32 v74, s54, v74
 v_mfma_f32_16x16x32_bf16 v[88:91], a[104:107], v[40:43], v[88:91]
 ds_read_b128 v[36:39], v23 offset:25600
 v_mul_f32 v79, v75, v79
 v_mfma_f32_16x16x32_bf16 v[88:91], a[108:111], v[44:47], v[88:91]
 v_rcp_f32 v73, v73
 v_mfma_f32_16x16x32_bf16 v[92:95], a[248:251], v[40:43], v[92:95]
 v_exp_f32 v74, v74
 v_mfma_f32_16x16x32_bf16 v[92:95], a[252:255], v[44:47], v[92:95]
 s_waitcnt lgkmcnt(4)
 v_mul_f32 v77, v73, v77
 v_add_f32 v74, 1.0, v74
 v_mfma_f32_16x16x32_bf16 v[80:83], a[40:43], v[48:51], v[80:83]
 ds_read_b128 v[40:43], v22 offset:26624
 v_mul_f32 v75, s54, v75
 v_mfma_f32_16x16x32_bf16 v[80:83], a[44:47], v[52:55], v[80:83]
 v_rcp_f32 v74, v74
 v_mfma_f32_16x16x32_bf16 v[84:87], a[184:187], v[48:51], v[84:87]
 v_exp_f32 v75, v75
 v_mfma_f32_16x16x32_bf16 v[84:87], a[188:191], v[52:55], v[84:87]
 v_mul_f32 v78, v74, v78
 v_add_f32 v75, 1.0, v75
 v_mfma_f32_16x16x32_bf16 v[88:91], a[112:115], v[48:51], v[88:91]
 ds_read_b128 v[44:47], v23 offset:26624
 v_cvt_pk_bf16_f32 v64, v68, v69
 v_mfma_f32_16x16x32_bf16 v[88:91], a[116:119], v[52:55], v[88:91]
 v_rcp_f32 v75, v75
 v_mfma_f32_16x16x32_bf16 v[92:95], v[224:227], v[48:51], v[92:95]
 v_mul_f32 v79, v75, v79
 v_cvt_pk_bf16_f32 v65, v70, v71
 v_mfma_f32_16x16x32_bf16 v[92:95], v[228:231], v[52:55], v[92:95]
 s_waitcnt lgkmcnt(4)
 v_cvt_pk_bf16_f32 v66, v76, v77
 v_cvt_pk_bf16_f32 v67, v78, v79
 v_mfma_f32_16x16x32_bf16 v[80:83], a[48:51], v[56:59], v[80:83]
 buffer_store_dwordx4 v[64:67], v19, s[16:19], s53 offen sc1
 v_mfma_f32_16x16x32_bf16 v[80:83], a[52:55], v[60:63], v[80:83]
 s_add_u32 s53, s53, s52
 v_mfma_f32_16x16x32_bf16 v[84:87], a[192:195], v[56:59], v[84:87]
 v_mfma_f32_16x16x32_bf16 v[84:87], a[196:199], v[60:63], v[84:87]
 s_movk_i32 s30, 4096
 v_mfma_f32_16x16x32_bf16 v[88:91], a[120:123], v[56:59], v[88:91]
 s_mov_b32 s31, 147456
 v_mfma_f32_16x16x32_bf16 v[88:91], a[124:127], v[60:63], v[88:91]
 v_mfma_f32_16x16x32_bf16 v[92:95], v[232:235], v[56:59], v[92:95]
 s_waitcnt vmcnt(15) lgkmcnt(0)
 s_waitcnt vmcnt(1)
 s_barrier
 v_mfma_f32_16x16x32_bf16 v[92:95], v[236:239], v[60:63], v[92:95]
 ds_read_b128 v[48:51], v24 offset:0
 v_mfma_f32_16x16x32_bf16 v[80:83], a[56:59], v[32:35], v[80:83]
 ds_read_b128 v[52:55], v25 offset:0
 v_mfma_f32_16x16x32_bf16 v[80:83], a[60:63], v[36:39], v[80:83]
 ds_read_b128 v[56:59], v24 offset:1024
 v_mfma_f32_16x16x32_bf16 v[84:87], a[200:203], v[32:35], v[84:87]
 buffer_store_byte v2, v1, s[16:19], s25 offen sc1
 v_mfma_f32_16x16x32_bf16 v[84:87], a[204:207], v[36:39], v[84:87]
 s_add_u32 s25, s25, 18432
 v_mfma_f32_16x16x32_bf16 v[88:91], a[128:131], v[32:35], v[88:91]
 ds_read_b128 v[60:63], v25 offset:1024
 v_mfma_f32_16x16x32_bf16 v[88:91], a[132:135], v[36:39], v[88:91]
 s_cmp_eq_u32 s64, 0x10101
 s_cbranch_scc0 Lsp_g11p0
Lrt_g11p0:
 s_mul_i32 s85, s62, 12288
 v_mfma_f32_16x16x32_bf16 v[92:95], v[240:243], v[32:35], v[92:95]
 s_load_dwordx4 s[40:43], s[88:89], s60 offset:4096
 s_add_u32 s85, s85, s87
 v_mfma_f32_16x16x32_bf16 v[92:95], v[244:247], v[36:39], v[92:95]
 v_mfma_f32_16x16x32_bf16 v[80:83], a[64:67], v[40:43], v[80:83]
 ds_read_b128 v[32:35], v24 offset:2048
 v_mfma_f32_16x16x32_bf16 v[80:83], a[68:71], v[44:47], v[80:83]
 buffer_load_dwordx4 v[160:163], v19, s[16:19], s85 offen sc1
 v_mfma_f32_16x16x32_bf16 v[84:87], a[208:211], v[40:43], v[84:87]
 buffer_load_dwordx4 v[164:167], v7, s[16:19], s85 offen sc1
 v_mfma_f32_16x16x32_bf16 v[84:87], a[212:215], v[44:47], v[84:87]
 v_mfma_f32_16x16x32_bf16 v[88:91], a[136:139], v[40:43], v[88:91]
 ds_read_b128 v[36:39], v25 offset:2048
 v_mfma_f32_16x16x32_bf16 v[88:91], a[140:143], v[44:47], v[88:91]
 buffer_load_dwordx4 v[168:171], v19, s[16:19], s85 offen offset:1024 sc1
 v_mfma_f32_16x16x32_bf16 v[92:95], v[248:251], v[40:43], v[92:95]
 v_mfma_f32_16x16x32_bf16 v[92:95], v[252:255], v[44:47], v[92:95]
 s_waitcnt lgkmcnt(4)
 v_mfma_f32_16x16x32_bf16 v[64:67], a[0:3], v[48:51], 0
 ds_read_b128 v[40:43], v24 offset:3072
 v_mfma_f32_16x16x32_bf16 v[64:67], a[4:7], v[52:55], v[64:67]
 v_mfma_f32_16x16x32_bf16 v[68:71], a[144:147], v[48:51], 0
 buffer_load_dwordx4 v[172:175], v7, s[16:19], s85 offen offset:1024 sc1
 v_mfma_f32_16x16x32_bf16 v[68:71], a[148:151], v[52:55], v[68:71]
 v_mfma_f32_16x16x32_bf16 v[72:75], a[72:75], v[48:51], 0
 ds_read_b128 v[44:47], v25 offset:3072
 v_mfma_f32_16x16x32_bf16 v[72:75], a[76:79], v[52:55], v[72:75]
 v_mul_f32 v84, v80, v84
 v_mul_f32 v85, v81, v85
 v_mfma_f32_16x16x32_bf16 v[76:79], a[216:219], v[48:51], 0
 v_mul_f32 v80, s54, v80
 v_mul_f32 v81, s54, v81
 v_mfma_f32_16x16x32_bf16 v[76:79], a[220:223], v[52:55], v[76:79]
 s_waitcnt lgkmcnt(4)
 v_exp_f32 v80, v80
 v_mfma_f32_16x16x32_bf16 v[64:67], a[8:11], v[56:59], v[64:67]
 ds_read_b128 v[48:51], v24 offset:4096
 v_add_f32 v80, 1.0, v80
 v_mfma_f32_16x16x32_bf16 v[64:67], a[12:15], v[60:63], v[64:67]
 buffer_load_dwordx4 v[176:179], v19, s[16:19], s85 offen offset:2048 sc1
 v_mul_f32 v86, v82, v86
 v_mfma_f32_16x16x32_bf16 v[68:71], a[152:155], v[56:59], v[68:71]
 v_rcp_f32 v80, v80
 v_mfma_f32_16x16x32_bf16 v[68:71], a[156:159], v[60:63], v[68:71]
 buffer_load_dwordx4 v[180:183], v7, s[16:19], s85 offen offset:2048 sc1
 v_mul_f32 v84, v80, v84
 v_mfma_f32_16x16x32_bf16 v[72:75], a[80:83], v[56:59], v[72:75]
 ds_read_b128 v[52:55], v25 offset:4096
 v_mul_f32 v82, s54, v82
 v_mfma_f32_16x16x32_bf16 v[72:75], a[84:87], v[60:63], v[72:75]
 v_exp_f32 v81, v81
 v_mfma_f32_16x16x32_bf16 v[76:79], a[224:227], v[56:59], v[76:79]
 v_exp_f32 v82, v82
 v_mfma_f32_16x16x32_bf16 v[76:79], a[228:231], v[60:63], v[76:79]
 s_waitcnt lgkmcnt(4)
 v_add_f32 v81, 1.0, v81
 v_add_f32 v82, 1.0, v82
 v_mfma_f32_16x16x32_bf16 v[64:67], a[16:19], v[32:35], v[64:67]
 ds_read_b128 v[56:59], v24 offset:5120
 v_mul_f32 v87, v83, v87
 v_mfma_f32_16x16x32_bf16 v[64:67], a[20:23], v[36:39], v[64:67]
 buffer_load_dwordx4 v[184:187], v19, s[16:19], s85 offen offset:3072 sc1
 v_mul_f32 v83, s54, v83
 v_mfma_f32_16x16x32_bf16 v[68:71], a[160:163], v[32:35], v[68:71]
 v_rcp_f32 v81, v81
 v_mfma_f32_16x16x32_bf16 v[68:71], a[164:167], v[36:39], v[68:71]
 v_rcp_f32 v82, v82
 v_mfma_f32_16x16x32_bf16 v[72:75], a[88:91], v[32:35], v[72:75]
 ds_read_b128 v[60:63], v25 offset:5120
 v_mul_f32 v85, v81, v85
 v_mfma_f32_16x16x32_bf16 v[72:75], a[92:95], v[36:39], v[72:75]
 buffer_load_dwordx4 v[188:191], v7, s[16:19], s85 offen offset:3072 sc1
 s_add_u32 s85, s85, s30
 v_mfma_f32_16x16x32_bf16 v[76:79], a[232:235], v[32:35], v[76:79]
 v_exp_f32 v83, v83
 v_mfma_f32_16x16x32_bf16 v[76:79], a[236:239], v[36:39], v[76:79]
 s_waitcnt lgkmcnt(4)
 v_mul_f32 v86, v82, v86
 v_add_f32 v83, 1.0, v83
 v_mfma_f32_16x16x32_bf16 v[64:67], a[24:27], v[40:43], v[64:67]
 ds_read_b128 v[32:35], v24 offset:6144
 v_mul_f32 v92, v88, v92
 v_mfma_f32_16x16x32_bf16 v[64:67], a[28:31], v[44:47], v[64:67]
 v_rcp_f32 v83, v83
 v_mfma_f32_16x16x32_bf16 v[68:71], a[168:171], v[40:43], v[68:71]
 buffer_load_dwordx4 v[192:195], v19, s[16:19], s85 offen sc1
 v_mul_f32 v87, v83, v87
 v_mfma_f32_16x16x32_bf16 v[68:71], a[172:175], v[44:47], v[68:71]
 v_mul_f32 v88, s54, v88
 v_mul_f32 v93, v89, v93
 v_mfma_f32_16x16x32_bf16 v[72:75], a[96:99], v[40:43], v[72:75]
 ds_read_b128 v[36:39], v25 offset:6144
 v_mul_f32 v89, s54, v89
 v_mfma_f32_16x16x32_bf16 v[72:75], a[100:103], v[44:47], v[72:75]
 v_exp_f32 v88, v88
 v_mfma_f32_16x16x32_bf16 v[76:79], a[240:243], v[40:43], v[76:79]
 v_exp_f32 v89, v89
 v_mfma_f32_16x16x32_bf16 v[76:79], a[244:247], v[44:47], v[76:79]
 s_waitcnt lgkmcnt(4)
 v_add_f32 v88, 1.0, v88
 v_add_f32 v89, 1.0, v89
 v_mfma_f32_16x16x32_bf16 v[64:67], a[32:35], v[48:51], v[64:67]
 ds_read_b128 v[40:43], v24 offset:7168
 v_mul_f32 v94, v90, v94
 v_mfma_f32_16x16x32_bf16 v[64:67], a[36:39], v[52:55], v[64:67]
 buffer_load_dwordx4 v[196:199], v7, s[16:19], s85 offen sc1
 v_mul_f32 v90, s54, v90
 v_mfma_f32_16x16x32_bf16 v[68:71], a[176:179], v[48:51], v[68:71]
 v_rcp_f32 v88, v88
 v_mfma_f32_16x16x32_bf16 v[68:71], a[180:183], v[52:55], v[68:71]
 buffer_load_dwordx4 v[200:203], v19, s[16:19], s85 offen offset:1024 sc1
 v_mul_f32 v92, v88, v92
 v_mfma_f32_16x16x32_bf16 v[72:75], a[104:107], v[48:51], v[72:75]
 ds_read_b128 v[44:47], v25 offset:7168
 v_mul_f32 v95, v91, v95
 v_mfma_f32_16x16x32_bf16 v[72:75], a[108:111], v[52:55], v[72:75]
 v_rcp_f32 v89, v89
 v_mfma_f32_16x16x32_bf16 v[76:79], a[248:251], v[48:51], v[76:79]
 v_exp_f32 v90, v90
 v_mfma_f32_16x16x32_bf16 v[76:79], a[252:255], v[52:55], v[76:79]
 s_waitcnt lgkmcnt(4)
 v_mul_f32 v93, v89, v93
 v_add_f32 v90, 1.0, v90
 v_mfma_f32_16x16x32_bf16 v[64:67], a[40:43], v[56:59], v[64:67]
 ds_read_b128 v[48:51], v24 offset:8192
 v_mul_f32 v91, s54, v91
 v_mfma_f32_16x16x32_bf16 v[64:67], a[44:47], v[60:63], v[64:67]
 buffer_load_dwordx4 v[204:207], v7, s[16:19], s85 offen offset:1024 sc1
 v_cvt_pk_bf16_f32 v80, v84, v85
 v_mfma_f32_16x16x32_bf16 v[68:71], a[184:187], v[56:59], v[68:71]
 v_rcp_f32 v90, v90
 v_mfma_f32_16x16x32_bf16 v[68:71], a[188:191], v[60:63], v[68:71]
 v_exp_f32 v91, v91
 v_mfma_f32_16x16x32_bf16 v[72:75], a[112:115], v[56:59], v[72:75]
 ds_read_b128 v[52:55], v25 offset:8192
 v_mul_f32 v94, v90, v94
 v_mfma_f32_16x16x32_bf16 v[72:75], a[116:119], v[60:63], v[72:75]
 buffer_load_dwordx4 v[208:211], v19, s[16:19], s85 offen offset:2048 sc1
 v_add_f32 v91, 1.0, v91
 v_mfma_f32_16x16x32_bf16 v[76:79], v[224:227], v[56:59], v[76:79]
 v_rcp_f32 v91, v91
 v_mfma_f32_16x16x32_bf16 v[76:79], v[228:231], v[60:63], v[76:79]
 s_waitcnt lgkmcnt(4)
 v_mul_f32 v95, v91, v95
 v_cvt_pk_bf16_f32 v81, v86, v87
 v_mfma_f32_16x16x32_bf16 v[64:67], a[48:51], v[32:35], v[64:67]
 ds_read_b128 v[56:59], v24 offset:18432
 v_cvt_pk_bf16_f32 v82, v92, v93
 v_mfma_f32_16x16x32_bf16 v[64:67], a[52:55], v[36:39], v[64:67]
 v_cvt_pk_bf16_f32 v83, v94, v95
 v_mfma_f32_16x16x32_bf16 v[68:71], a[192:195], v[32:35], v[68:71]
 buffer_store_dwordx4 v[80:83], v19, s[16:19], s53 offen sc1
 v_mfma_f32_16x16x32_bf16 v[68:71], a[196:199], v[36:39], v[68:71]
 s_add_u32 s53, s53, s52
 v_mfma_f32_16x16x32_bf16 v[72:75], a[120:123], v[32:35], v[72:75]
 ds_read_b128 v[60:63], v25 offset:18432
 v_mfma_f32_16x16x32_bf16 v[72:75], a[124:127], v[36:39], v[72:75]
 v_mfma_f32_16x16x32_bf16 v[76:79], v[232:235], v[32:35], v[76:79]
 v_mfma_f32_16x16x32_bf16 v[76:79], v[236:239], v[36:39], v[76:79]
 s_waitcnt lgkmcnt(2)
 v_mfma_f32_16x16x32_bf16 v[64:67], a[56:59], v[40:43], v[64:67]
 ds_read_b128 v[32:35], v24 offset:19456
 v_mfma_f32_16x16x32_bf16 v[64:67], a[60:63], v[44:47], v[64:67]
 v_mfma_f32_16x16x32_bf16 v[68:71], a[200:203], v[40:43], v[68:71]
 v_mfma_f32_16x16x32_bf16 v[68:71], a[204:207], v[44:47], v[68:71]
 v_mfma_f32_16x16x32_bf16 v[72:75], a[128:131], v[40:43], v[72:75]
 ds_read_b128 v[36:39], v25 offset:19456
 v_mfma_f32_16x16x32_bf16 v[72:75], a[132:135], v[44:47], v[72:75]
 v_mfma_f32_16x16x32_bf16 v[76:79], v[240:243], v[40:43], v[76:79]
 buffer_load_dwordx4 v[212:215], v7, s[16:19], s85 offen offset:2048 sc1
 v_mfma_f32_16x16x32_bf16 v[76:79], v[244:247], v[44:47], v[76:79]
 buffer_load_dwordx4 v[216:219], v19, s[16:19], s85 offen offset:3072 sc1
 v_mfma_f32_16x16x32_bf16 v[64:67], a[64:67], v[48:51], v[64:67]
 ds_read_b128 v[40:43], v24 offset:20480
 v_mfma_f32_16x16x32_bf16 v[64:67], a[68:71], v[52:55], v[64:67]
 buffer_load_dwordx4 v[220:223], v7, s[16:19], s85 offen offset:3072 sc1
 v_mfma_f32_16x16x32_bf16 v[68:71], a[208:211], v[48:51], v[68:71]
 v_mfma_f32_16x16x32_bf16 v[68:71], a[212:215], v[52:55], v[68:71]
 v_mfma_f32_16x16x32_bf16 v[72:75], a[136:139], v[48:51], v[72:75]
 ds_read_b128 v[44:47], v25 offset:20480
 v_mfma_f32_16x16x32_bf16 v[72:75], a[140:143], v[52:55], v[72:75]
 v_mfma_f32_16x16x32_bf16 v[76:79], v[248:251], v[48:51], v[76:79]
 v_mfma_f32_16x16x32_bf16 v[76:79], v[252:255], v[52:55], v[76:79]
 s_waitcnt lgkmcnt(2)
 s_waitcnt lgkmcnt(0)
 v_mfma_f32_16x16x32_bf16 v[80:83], a[0:3], v[56:59], 0
 ds_read_b128 v[48:51], v24 offset:21504
 v_mfma_f32_16x16x32_bf16 v[80:83], a[4:7], v[60:63], v[80:83]
 s_mul_i32 s42, s42, 16843009
 v_mfma_f32_16x16x32_bf16 v[84:87], a[144:147], v[56:59], 0
 s_and_b32 s40, s40, s41
 v_mfma_f32_16x16x32_bf16 v[84:87], a[148:151], v[60:63], v[84:87]
 s_and_b32 s40, s40, s42
 v_mfma_f32_16x16x32_bf16 v[88:91], a[72:75], v[56:59], 0
 ds_read_b128 v[52:55], v25 offset:21504
 v_mfma_f32_16x16x32_bf16 v[88:91], a[76:79], v[60:63], v[88:91]
 s_cmp_eq_u32 s40, 16843009
 s_cbranch_scc0 Lsp_g11w
Lrt_g11w:
 s_mul_i32 s84, s62, 442368
 v_mfma_f32_16x16x32_bf16 v[92:95], a[216:219], v[56:59], 0
 s_add_u32 s84, s84, s86
 s_add_u32 m0, s55, 0
 v_mul_f32 v68, v64, v68
 v_mfma_f32_16x16x32_bf16 v[92:95], a[220:223], v[60:63], v[92:95]
 buffer_load_dwordx4 v19, s[16:19], s84 offen sc1 lds
 v_mul_f32 v64, s54, v64
 v_mfma_f32_16x16x32_bf16 v[80:83], a[8:11], v[32:35], v[80:83]
 ds_read_b128 v[56:59], v24 offset:22528
 v_mul_f32 v69, v65, v69
 v_mfma_f32_16x16x32_bf16 v[80:83], a[12:15], v[36:39], v[80:83]
 buffer_load_dwordx4 v19, s[16:19], s84 offen offset:1024 sc1 lds
 v_mul_f32 v65, s54, v65
 v_mfma_f32_16x16x32_bf16 v[84:87], a[152:155], v[32:35], v[84:87]
 v_exp_f32 v64, v64
 v_mfma_f32_16x16x32_bf16 v[84:87], a[156:159], v[36:39], v[84:87]
 v_exp_f32 v65, v65
 v_mfma_f32_16x16x32_bf16 v[88:91], a[80:83], v[32:35], v[88:91]
 ds_read_b128 v[60:63], v25 offset:22528
 v_add_f32 v64, 1.0, v64
 v_mfma_f32_16x16x32_bf16 v[88:91], a[84:87], v[36:39], v[88:91]
 buffer_load_dwordx4 v19, s[16:19], s84 offen offset:2048 sc1 lds
 v_add_f32 v65, 1.0, v65
 v_mfma_f32_16x16x32_bf16 v[92:95], a[224:227], v[32:35], v[92:95]
 v_rcp_f32 v64, v64
 v_mfma_f32_16x16x32_bf16 v[92:95], a[228:231], v[36:39], v[92:95]
 s_waitcnt lgkmcnt(2)
 v_rcp_f32 v65, v65
 v_mfma_f32_16x16x32_bf16 v[80:83], a[16:19], v[40:43], v[80:83]
 ds_read_b128 v[32:35], v24 offset:23552
 v_mul_f32 v68, v64, v68
 v_mfma_f32_16x16x32_bf16 v[80:83], a[20:23], v[44:47], v[80:83]
 v_mul_f32 v69, v65, v69
 v_mul_f32 v70, v66, v70
 v_mfma_f32_16x16x32_bf16 v[84:87], a[160:163], v[40:43], v[84:87]
 buffer_load_dwordx4 v19, s[16:19], s84 offen offset:3072 sc1 lds
 s_add_u32 m0, m0, s30
 v_mfma_f32_16x16x32_bf16 v[84:87], a[164:167], v[44:47], v[84:87]
 v_mul_f32 v66, s54, v66
 v_mul_f32 v71, v67, v71
 v_mfma_f32_16x16x32_bf16 v[88:91], a[88:91], v[40:43], v[88:91]
 ds_read_b128 v[36:39], v25 offset:23552
 v_mul_f32 v67, s54, v67
 v_mfma_f32_16x16x32_bf16 v[88:91], a[92:95], v[44:47], v[88:91]
 v_exp_f32 v66, v66
 v_mfma_f32_16x16x32_bf16 v[92:95], a[232:235], v[40:43], v[92:95]
 v_exp_f32 v67, v67
 v_mfma_f32_16x16x32_bf16 v[92:95], a[236:239], v[44:47], v[92:95]
 buffer_load_dwordx4 v5, s[16:19], s84 offen sc1 lds
 v_add_f32 v66, 1.0, v66
 v_mfma_f32_16x16x32_bf16 v[80:83], a[24:27], v[48:51], v[80:83]
 ds_read_b128 v[40:43], v24 offset:24576
 v_add_f32 v67, 1.0, v67
 v_mfma_f32_16x16x32_bf16 v[80:83], a[28:31], v[52:55], v[80:83]
 v_rcp_f32 v66, v66
 v_mfma_f32_16x16x32_bf16 v[84:87], a[168:171], v[48:51], v[84:87]
 v_rcp_f32 v67, v67
 v_mfma_f32_16x16x32_bf16 v[84:87], a[172:175], v[52:55], v[84:87]
 buffer_load_dwordx4 v5, s[16:19], s84 offen offset:1024 sc1 lds
 v_mul_f32 v70, v66, v70
 v_mfma_f32_16x16x32_bf16 v[88:91], a[96:99], v[48:51], v[88:91]
 ds_read_b128 v[44:47], v25 offset:24576
 v_mul_f32 v71, v67, v71
 v_mfma_f32_16x16x32_bf16 v[88:91], a[100:103], v[52:55], v[88:91]
 v_mul_f32 v76, v72, v76
 v_mul_f32 v77, v73, v77
 v_mfma_f32_16x16x32_bf16 v[92:95], a[240:243], v[48:51], v[92:95]
 v_mul_f32 v72, s54, v72
 v_mul_f32 v73, s54, v73
 v_mfma_f32_16x16x32_bf16 v[92:95], a[244:247], v[52:55], v[92:95]
 s_waitcnt lgkmcnt(2)
 v_exp_f32 v72, v72
 v_mfma_f32_16x16x32_bf16 v[80:83], a[32:35], v[56:59], v[80:83]
 ds_read_b128 v[48:51], v24 offset:25600
 v_add_f32 v72, 1.0, v72
 v_mfma_f32_16x16x32_bf16 v[80:83], a[36:39], v[60:63], v[80:83]
 buffer_load_dwordx4 v5, s[16:19], s84 offen offset:2048 sc1 lds
 v_mul_f32 v78, v74, v78
 v_mfma_f32_16x16x32_bf16 v[84:87], a[176:179], v[56:59], v[84:87]
 v_rcp_f32 v72, v72
 v_mfma_f32_16x16x32_bf16 v[84:87], a[180:183], v[60:63], v[84:87]
 v_exp_f32 v73, v73
 v_mfma_f32_16x16x32_bf16 v[88:91], a[104:107], v[56:59], v[88:91]
 ds_read_b128 v[52:55], v25 offset:25600
 v_mul_f32 v76, v72, v76
 v_mfma_f32_16x16x32_bf16 v[88:91], a[108:111], v[60:63], v[88:91]
 buffer_load_dwordx4 v5, s[16:19], s84 offen offset:3072 sc1 lds
 s_add_u32 m0, m0, s30
 v_mfma_f32_16x16x32_bf16 v[92:95], a[248:251], v[56:59], v[92:95]
 v_add_f32 v73, 1.0, v73
 v_mul_f32 v74, s54, v74
 v_mfma_f32_16x16x32_bf16 v[92:95], a[252:255], v[60:63], v[92:95]
 v_rcp_f32 v73, v73
 v_mfma_f32_16x16x32_bf16 v[80:83], a[40:43], v[32:35], v[80:83]
 ds_read_b128 v[56:59], v24 offset:26624
 v_mul_f32 v77, v73, v77
 v_mfma_f32_16x16x32_bf16 v[80:83], a[44:47], v[36:39], v[80:83]
 v_exp_f32 v74, v74
 v_mfma_f32_16x16x32_bf16 v[84:87], a[184:187], v[32:35], v[84:87]
 buffer_load_dwordx4 v6, s[16:19], s84 offen sc1 lds
 s_add_u32 s84, s84, s31
 v_mfma_f32_16x16x32_bf16 v[84:87], a[188:191], v[36:39], v[84:87]
 s_add_u32 m0, s56, 49152
 v_add_f32 v74, 1.0, v74
 v_mul_f32 v79, v75, v79
 v_mfma_f32_16x16x32_bf16 v[88:91], a[112:115], v[32:35], v[88:91]
 ds_read_b128 v[60:63], v25 offset:26624
 v_mul_f32 v75, s54, v75
 v_mfma_f32_16x16x32_bf16 v[88:91], a[116:119], v[36:39], v[88:91]
 v_rcp_f32 v74, v74
 v_mfma_f32_16x16x32_bf16 v[92:95], v[224:227], v[32:35], v[92:95]
 v_exp_f32 v75, v75
 v_mfma_f32_16x16x32_bf16 v[92:95], v[228:231], v[36:39], v[92:95]
 s_waitcnt lgkmcnt(2)
 v_mul_f32 v78, v74, v78
 v_add_f32 v75, 1.0, v75
 v_mfma_f32_16x16x32_bf16 v[80:83], a[48:51], v[40:43], v[80:83]
 buffer_load_dwordx4 v19, s[16:19], s84 offen sc1 lds
 v_cvt_pk_bf16_f32 v64, v68, v69
 v_mfma_f32_16x16x32_bf16 v[80:83], a[52:55], v[44:47], v[80:83]
 v_rcp_f32 v75, v75
 v_mfma_f32_16x16x32_bf16 v[84:87], a[192:195], v[40:43], v[84:87]
 v_mul_f32 v79, v75, v79
 v_cvt_pk_bf16_f32 v65, v70, v71
 v_mfma_f32_16x16x32_bf16 v[84:87], a[196:199], v[44:47], v[84:87]
 v_cvt_pk_bf16_f32 v66, v76, v77
 v_cvt_pk_bf16_f32 v67, v78, v79
 v_mfma_f32_16x16x32_bf16 v[88:91], a[120:123], v[40:43], v[88:91]
 buffer_store_dwordx4 v[64:67], v19, s[16:19], s53 offen sc1
 v_mfma_f32_16x16x32_bf16 v[88:91], a[124:127], v[44:47], v[88:91]
 s_add_u32 s53, s53, s52
 v_mfma_f32_16x16x32_bf16 v[92:95], v[232:235], v[40:43], v[92:95]
 s_waitcnt lgkmcnt(0)
 s_barrier
 v_mfma_f32_16x16x32_bf16 v[92:95], v[236:239], v[44:47], v[92:95]
 ds_read_b128 v[32:35], v20 offset:0
 v_mfma_f32_16x16x32_bf16 v[80:83], a[56:59], v[48:51], v[80:83]
 ds_read_b128 v[36:39], v21 offset:0
 v_mfma_f32_16x16x32_bf16 v[80:83], a[60:63], v[52:55], v[80:83]
 ds_read_b128 v[40:43], v20 offset:1024
 v_mfma_f32_16x16x32_bf16 v[84:87], a[200:203], v[48:51], v[84:87]
 v_mfma_f32_16x16x32_bf16 v[84:87], a[204:207], v[52:55], v[84:87]
 v_mfma_f32_16x16x32_bf16 v[88:91], a[128:131], v[48:51], v[88:91]
 ds_read_b128 v[44:47], v21 offset:1024
 v_mfma_f32_16x16x32_bf16 v[88:91], a[132:135], v[52:55], v[88:91]
 v_mfma_f32_16x16x32_bf16 v[92:95], v[240:243], v[48:51], v[92:95]
 v_mfma_f32_16x16x32_bf16 v[92:95], v[244:247], v[52:55], v[92:95]
 s_waitcnt lgkmcnt(2)
 v_mfma_f32_16x16x32_bf16 v[80:83], a[64:67], v[56:59], v[80:83]
 ds_read_b128 v[48:51], v20 offset:2048
 v_mfma_f32_16x16x32_bf16 v[80:83], a[68:71], v[60:63], v[80:83]
 buffer_load_dwordx4 v19, s[16:19], s84 offen offset:1024 sc1 lds
 v_mfma_f32_16x16x32_bf16 v[84:87], a[208:211], v[56:59], v[84:87]
 buffer_load_dwordx4 v19, s[16:19], s84 offen offset:2048 sc1 lds
 v_mfma_f32_16x16x32_bf16 v[84:87], a[212:215], v[60:63], v[84:87]
 buffer_load_dwordx4 v19, s[16:19], s84 offen offset:3072 sc1 lds
 s_add_u32 m0, m0, s30
 v_mfma_f32_16x16x32_bf16 v[88:91], a[136:139], v[56:59], v[88:91]
 ds_read_b128 v[52:55], v21 offset:2048
 v_mfma_f32_16x16x32_bf16 v[88:91], a[140:143], v[60:63], v[88:91]
 v_mfma_f32_16x16x32_bf16 v[92:95], v[248:251], v[56:59], v[92:95]
 v_mfma_f32_16x16x32_bf16 v[92:95], v[252:255], v[60:63], v[92:95]
 v_mfma_f32_16x16x32_bf16 v[64:67], a[0:3], v[32:35], 0
 ds_read_b128 v[56:59], v20 offset:3072
 v_mfma_f32_16x16x32_bf16 v[64:67], a[4:7], v[36:39], v[64:67]
 buffer_load_dwordx4 v5, s[16:19], s84 offen sc1 lds
 v_mfma_f32_16x16x32_bf16 v[68:71], a[144:147], v[32:35], 0
 v_mfma_f32_16x16x32_bf16 v[68:71], a[148:151], v[36:39], v[68:71]
 v_mfma_f32_16x16x32_bf16 v[72:75], a[72:75], v[32:35], 0
 ds_read_b128 v[60:63], v21 offset:3072
 v_mfma_f32_16x16x32_bf16 v[72:75], a[76:79], v[36:39], v[72:75]
 buffer_load_dwordx4 v5, s[16:19], s84 offen offset:1024 sc1 lds
 v_mul_f32 v84, v80, v84
 v_mfma_f32_16x16x32_bf16 v[76:79], a[216:219], v[32:35], 0
 v_mul_f32 v80, s54, v80
 v_mul_f32 v85, v81, v85
 v_mfma_f32_16x16x32_bf16 v[76:79], a[220:223], v[36:39], v[76:79]
 s_waitcnt lgkmcnt(2)
 v_exp_f32 v80, v80
 v_mfma_f32_16x16x32_bf16 v[64:67], a[8:11], v[40:43], v[64:67]
 ds_read_b128 v[32:35], v20 offset:4096
 v_add_f32 v80, 1.0, v80
 v_mfma_f32_16x16x32_bf16 v[64:67], a[12:15], v[44:47], v[64:67]
 v_rcp_f32 v80, v80
 v_mfma_f32_16x16x32_bf16 v[68:71], a[152:155], v[40:43], v[68:71]
 buffer_load_dwordx4 v5, s[16:19], s84 offen offset:2048 sc1 lds
 v_mul_f32 v84, v80, v84
 v_mfma_f32_16x16x32_bf16 v[68:71], a[156:159], v[44:47], v[68:71]
 v_mul_f32 v81, s54, v81
 v_mul_f32 v86, v82, v86
 v_mfma_f32_16x16x32_bf16 v[72:75], a[80:83], v[40:43], v[72:75]
 ds_read_b128 v[36:39], v21 offset:4096
 v_mul_f32 v82, s54, v82
 v_mfma_f32_16x16x32_bf16 v[72:75], a[84:87], v[44:47], v[72:75]
 v_exp_f32 v81, v81
 v_mfma_f32_16x16x32_bf16 v[76:79], a[224:227], v[40:43], v[76:79]
 buffer_load_dwordx4 v5, s[16:19], s84 offen offset:3072 sc1 lds
 s_add_u32 m0, m0, s30
 v_mfma_f32_16x16x32_bf16 v[76:79], a[228:231], v[44:47], v[76:79]
 v_exp_f32 v82, v82
 v_mfma_f32_16x16x32_bf16 v[64:67], a[16:19], v[48:51], v[64:67]
 ds_read_b128 v[40:43], v20 offset:5120
 v_add_f32 v81, 1.0, v81
 v_mfma_f32_16x16x32_bf16 v[64:67], a[20:23], v[52:55], v[64:67]
 v_rcp_f32 v81, v81
 v_mfma_f32_16x16x32_bf16 v[68:71], a[160:163], v[48:51], v[68:71]
 v_mul_f32 v85, v81, v85
 v_add_f32 v82, 1.0, v82
 v_mfma_f32_16x16x32_bf16 v[68:71], a[164:167], v[52:55], v[68:71]
 buffer_load_dwordx4 v6, s[16:19], s84 offen sc1 lds
 s_add_u32 s84, s84, s31
 v_mfma_f32_16x16x32_bf16 v[72:75], a[88:91], v[48:51], v[72:75]
 ds_read_b128 v[44:47], v21 offset:5120
 s_add_u32 m0, s56, 98304
 v_mfma_f32_16x16x32_bf16 v[72:75], a[92:95], v[52:55], v[72:75]
 v_rcp_f32 v82, v82
 v_mfma_f32_16x16x32_bf16 v[76:79], a[232:235], v[48:51], v[76:79]
 v_mul_f32 v86, v82, v86
 v_mul_f32 v87, v83, v87
 v_mfma_f32_16x16x32_bf16 v[76:79], a[236:239], v[52:55], v[76:79]
 s_waitcnt lgkmcnt(2)
 v_mul_f32 v83, s54, v83
 v_mul_f32 v92, v88, v92
 v_mfma_f32_16x16x32_bf16 v[64:67], a[24:27], v[56:59], v[64:67]
 ds_read_b128 v[48:51], v20 offset:6144
 v_mul_f32 v88, s54, v88
 v_mfma_f32_16x16x32_bf16 v[64:67], a[28:31], v[60:63], v[64:67]
 buffer_load_dwordx4 v19, s[16:19], s84 offen sc1 lds
 v_mul_f32 v93, v89, v93
 v_mfma_f32_16x16x32_bf16 v[68:71], a[168:171], v[56:59], v[68:71]
Lpg6:
 s_cbranch_vccnz Lj_Lfin
 v_exp_f32 v83, v83
 v_mfma_f32_16x16x32_bf16 v[68:71], a[172:175], v[60:63], v[68:71]
 v_exp_f32 v88, v88
 v_mfma_f32_16x16x32_bf16 v[72:75], a[96:99], v[56:59], v[72:75]
 ds_read_b128 v[52:55], v21 offset:6144
 v_add_f32 v83, 1.0, v83
 v_mfma_f32_16x16x32_bf16 v[72:75], a[100:103], v[60:63], v[72:75]
 buffer_load_dwordx4 v19, s[16:19], s84 offen offset:1024 sc1 lds
 v_add_f32 v88, 1.0, v88
 v_mfma_f32_16x16x32_bf16 v[76:79], a[240:243], v[56:59], v[76:79]
 v_rcp_f32 v83, v83
 v_mfma_f32_16x16x32_bf16 v[76:79], a[244:247], v[60:63], v[76:79]
 v_rcp_f32 v88, v88
 v_mfma_f32_16x16x32_bf16 v[64:67], a[32:35], v[32:35], v[64:67]
 ds_read_b128 v[56:59], v20 offset:7168
 v_mul_f32 v87, v83, v87
 v_mfma_f32_16x16x32_bf16 v[64:67], a[36:39], v[36:39], v[64:67]
 v_mul_f32 v92, v88, v92
 v_mul_f32 v89, s54, v89
 v_mfma_f32_16x16x32_bf16 v[68:71], a[176:179], v[32:35], v[68:71]
 buffer_load_dwordx4 v19, s[16:19], s84 offen offset:2048 sc1 lds
 v_mul_f32 v94, v90, v94
 v_mfma_f32_16x16x32_bf16 v[68:71], a[180:183], v[36:39], v[68:71]
 v_exp_f32 v89, v89
 v_mfma_f32_16x16x32_bf16 v[72:75], a[104:107], v[32:35], v[72:75]
 ds_read_b128 v[60:63], v21 offset:7168
 v_add_f32 v89, 1.0, v89
 v_mfma_f32_16x16x32_bf16 v[72:75], a[108:111], v[36:39], v[72:75]
 v_rcp_f32 v89, v89
 v_mfma_f32_16x16x32_bf16 v[76:79], a[248:251], v[32:35], v[76:79]
 buffer_load_dwordx4 v19, s[16:19], s84 offen offset:3072 sc1 lds
 s_add_u32 m0, m0, s30
 v_mfma_f32_16x16x32_bf16 v[76:79], a[252:255], v[36:39], v[76:79]
 s_waitcnt lgkmcnt(2)
 v_mul_f32 v93, v89, v93
 v_mul_f32 v90, s54, v90
 v_mfma_f32_16x16x32_bf16 v[64:67], a[40:43], v[40:43], v[64:67]
 ds_read_b128 v[32:35], v20 offset:8192
 v_mul_f32 v95, v91, v95
 v_mfma_f32_16x16x32_bf16 v[64:67], a[44:47], v[44:47], v[64:67]
 v_exp_f32 v90, v90
 v_mfma_f32_16x16x32_bf16 v[68:71], a[184:187], v[40:43], v[68:71]
 v_add_f32 v90, 1.0, v90
 v_mul_f32 v91, s54, v91
 v_mfma_f32_16x16x32_bf16 v[68:71], a[188:191], v[44:47], v[68:71]
 buffer_load_dwordx4 v5, s[16:19], s84 offen sc1 lds
 v_cvt_pk_bf16_f32 v80, v84, v85
 v_mfma_f32_16x16x32_bf16 v[72:75], a[112:115], v[40:43], v[72:75]
 ds_read_b128 v[36:39], v21 offset:8192
 v_cvt_pk_bf16_f32 v81, v86, v87
 v_mfma_f32_16x16x32_bf16 v[72:75], a[116:119], v[44:47], v[72:75]
 v_rcp_f32 v90, v90
 v_mfma_f32_16x16x32_bf16 v[76:79], v[224:227], v[40:43], v[76:79]
 v_exp_f32 v91, v91
 v_mfma_f32_16x16x32_bf16 v[76:79], v[228:231], v[44:47], v[76:79]
 v_mul_f32 v94, v90, v94
 v_add_f32 v91, 1.0, v91
 v_mfma_f32_16x16x32_bf16 v[64:67], a[48:51], v[48:51], v[64:67]
 ds_read_b128 v[40:43], v20 offset:18432
 v_cvt_pk_bf16_f32 v82, v92, v93
 v_mfma_f32_16x16x32_bf16 v[64:67], a[52:55], v[52:55], v[64:67]
 buffer_load_dwordx4 v5, s[16:19], s84 offen offset:1024 sc1 lds
 v_mfma_f32_16x16x32_bf16 v[68:71], a[192:195], v[48:51], v[68:71]
 v_rcp_f32 v91, v91
 v_mfma_f32_16x16x32_bf16 v[68:71], a[196:199], v[52:55], v[68:71]
 v_mul_f32 v95, v91, v95
 v_mfma_f32_16x16x32_bf16 v[72:75], a[120:123], v[48:51], v[72:75]
 ds_read_b128 v[44:47], v21 offset:18432
 v_cvt_pk_bf16_f32 v83, v94, v95
 v_mfma_f32_16x16x32_bf16 v[72:75], a[124:127], v[52:55], v[72:75]
 buffer_store_dwordx4 v[80:83], v19, s[16:19], s53 offen sc1
 v_mfma_f32_16x16x32_bf16 v[76:79], v[232:235], v[48:51], v[76:79]
 s_add_u32 s53, s53, s52
 v_mfma_f32_16x16x32_bf16 v[76:79], v[236:239], v[52:55], v[76:79]
 s_waitcnt lgkmcnt(2)
 v_mfma_f32_16x16x32_bf16 v[64:67], a[56:59], v[56:59], v[64:67]
 ds_read_b128 v[48:51], v20 offset:19456
 v_mfma_f32_16x16x32_bf16 v[64:67], a[60:63], v[60:63], v[64:67]
 v_mfma_f32_16x16x32_bf16 v[68:71], a[200:203], v[56:59], v[68:71]
 v_mfma_f32_16x16x32_bf16 v[68:71], a[204:207], v[60:63], v[68:71]
 v_mfma_f32_16x16x32_bf16 v[72:75], a[128:131], v[56:59], v[72:75]
 ds_read_b128 v[52:55], v21 offset:19456
 v_mfma_f32_16x16x32_bf16 v[72:75], a[132:135], v[60:63], v[72:75]
 v_mfma_f32_16x16x32_bf16 v[76:79], v[240:243], v[56:59], v[76:79]
 v_mfma_f32_16x16x32_bf16 v[76:79], v[244:247], v[60:63], v[76:79]
 v_mfma_f32_16x16x32_bf16 v[64:67], a[64:67], v[32:35], v[64:67]
 ds_read_b128 v[56:59], v20 offset:20480
 v_mfma_f32_16x16x32_bf16 v[64:67], a[68:71], v[36:39], v[64:67]
 buffer_load_dwordx4 v5, s[16:19], s84 offen offset:2048 sc1 lds
 v_mfma_f32_16x16x32_bf16 v[68:71], a[208:211], v[32:35], v[68:71]
 buffer_load_dwordx4 v5, s[16:19], s84 offen offset:3072 sc1 lds
 s_add_u32 m0, m0, s30
 v_mfma_f32_16x16x32_bf16 v[68:71], a[212:215], v[36:39], v[68:71]
 buffer_load_dwordx4 v6, s[16:19], s84 offen sc1 lds
 v_mfma_f32_16x16x32_bf16 v[72:75], a[136:139], v[32:35], v[72:75]
 ds_read_b128 v[60:63], v21 offset:20480
 v_mfma_f32_16x16x32_bf16 v[72:75], a[140:143], v[36:39], v[72:75]
 s_load_dword s64, s[88:89], s29 offset:26624
 v_mfma_f32_16x16x32_bf16 v[76:79], v[248:251], v[32:35], v[76:79]
 v_mfma_f32_16x16x32_bf16 v[76:79], v[252:255], v[36:39], v[76:79]
 s_waitcnt lgkmcnt(4)
 v_mfma_f32_16x16x32_bf16 v[80:83], a[0:3], v[40:43], 0
 ds_read_b128 v[32:35], v20 offset:21504
 v_mfma_f32_16x16x32_bf16 v[80:83], a[4:7], v[44:47], v[80:83]
 v_mfma_f32_16x16x32_bf16 v[84:87], a[144:147], v[40:43], 0
 v_mfma_f32_16x16x32_bf16 v[84:87], a[148:151], v[44:47], v[84:87]
 v_mfma_f32_16x16x32_bf16 v[88:91], a[72:75], v[40:43], 0
 ds_read_b128 v[36:39], v21 offset:21504
 v_mfma_f32_16x16x32_bf16 v[88:91], a[76:79], v[44:47], v[88:91]
 v_mul_f32 v68, v64, v68
 v_mul_f32 v69, v65, v69
 v_mfma_f32_16x16x32_bf16 v[92:95], a[216:219], v[40:43], 0
 v_mul_f32 v64, s54, v64
 v_mul_f32 v65, s54, v65
 v_mfma_f32_16x16x32_bf16 v[92:95], a[220:223], v[44:47], v[92:95]
 s_waitcnt lgkmcnt(4)
 v_exp_f32 v64, v64
 v_mfma_f32_16x16x32_bf16 v[80:83], a[8:11], v[48:51], v[80:83]
 ds_read_b128 v[40:43], v20 offset:22528
 v_add_f32 v64, 1.0, v64
 v_mfma_f32_16x16x32_bf16 v[80:83], a[12:15], v[52:55], v[80:83]
 v_rcp_f32 v64, v64
 v_mfma_f32_16x16x32_bf16 v[84:87], a[152:155], v[48:51], v[84:87]
 v_exp_f32 v65, v65
 v_mfma_f32_16x16x32_bf16 v[84:87], a[156:159], v[52:55], v[84:87]
 v_mul_f32 v68, v64, v68
 v_add_f32 v65, 1.0, v65
 v_mfma_f32_16x16x32_bf16 v[88:91], a[80:83], v[48:51], v[88:91]
 ds_read_b128 v[44:47], v21 offset:22528
 v_mul_f32 v70, v66, v70
 v_mfma_f32_16x16x32_bf16 v[88:91], a[84:87], v[52:55], v[88:91]
 v_rcp_f32 v65, v65
 v_mfma_f32_16x16x32_bf16 v[92:95], a[224:227], v[48:51], v[92:95]
 v_mul_f32 v69, v65, v69
 v_mul_f32 v66, s54, v66
 v_mfma_f32_16x16x32_bf16 v[92:95], a[228:231], v[52:55], v[92:95]
 s_waitcnt lgkmcnt(4)
 v_exp_f32 v66, v66
 v_mfma_f32_16x16x32_bf16 v[80:83], a[16:19], v[56:59], v[80:83]
 ds_read_b128 v[48:51], v20 offset:23552
 s_add_u32 s85, s85, s30
 v_mfma_f32_16x16x32_bf16 v[80:83], a[20:23], v[60:63], v[80:83]
 buffer_load_dwordx4 a[0:3], v19, s[16:19], s85 offen sc1
 v_add_f32 v66, 1.0, v66
 v_mfma_f32_16x16x32_bf16 v[84:87], a[160:163], v[56:59], v[84:87]
 buffer_load_dwordx4 a[4:7], v7, s[16:19], s85 offen sc1
 v_mul_f32 v71, v67, v71
 v_mfma_f32_16x16x32_bf16 v[84:87], a[164:167], v[60:63], v[84:87]
 v_rcp_f32 v66, v66
 v_mfma_f32_16x16x32_bf16 v[88:91], a[88:91], v[56:59], v[88:91]
 ds_read_b128 v[52:55], v21 offset:23552
 v_mul_f32 v70, v66, v70
 v_mfma_f32_16x16x32_bf16 v[88:91], a[92:95], v[60:63], v[88:91]
 v_mul_f32 v67, s54, v67
 v_mul_f32 v76, v72, v76
 v_mfma_f32_16x16x32_bf16 v[92:95], a[232:235], v[56:59], v[92:95]
 v_exp_f32 v67, v67
 v_mfma_f32_16x16x32_bf16 v[92:95], a[236:239], v[60:63], v[92:95]
 s_waitcnt lgkmcnt(4)
 v_add_f32 v67, 1.0, v67
 v_mul_f32 v72, s54, v72
 v_mfma_f32_16x16x32_bf16 v[80:83], a[24:27], v[32:35], v[80:83]
 ds_read_b128 v[56:59], v20 offset:24576
 v_mul_f32 v77, v73, v77
 v_mfma_f32_16x16x32_bf16 v[80:83], a[28:31], v[36:39], v[80:83]
 buffer_load_dwordx4 a[72:75], v19, s[16:19], s85 offen offset:1024 sc1
 v_mul_f32 v73, s54, v73
 v_mfma_f32_16x16x32_bf16 v[84:87], a[168:171], v[32:35], v[84:87]
 v_rcp_f32 v67, v67
 v_mfma_f32_16x16x32_bf16 v[84:87], a[172:175], v[36:39], v[84:87]
 v_exp_f32 v72, v72
 v_mfma_f32_16x16x32_bf16 v[88:91], a[96:99], v[32:35], v[88:91]
 ds_read_b128 v[60:63], v21 offset:24576
 v_mul_f32 v71, v67, v71
 v_mfma_f32_16x16x32_bf16 v[88:91], a[100:103], v[36:39], v[88:91]
 buffer_load_dwordx4 a[76:79], v7, s[16:19], s85 offen offset:1024 sc1
 v_add_f32 v72, 1.0, v72
 v_mfma_f32_16x16x32_bf16 v[92:95], a[240:243], v[32:35], v[92:95]
 v_rcp_f32 v72, v72
 v_mfma_f32_16x16x32_bf16 v[92:95], a[244:247], v[36:39], v[92:95]
 s_waitcnt lgkmcnt(4)
 v_exp_f32 v73, v73
 v_mfma_f32_16x16x32_bf16 v[80:83], a[32:35], v[40:43], v[80:83]
 ds_read_b128 v[32:35], v20 offset:25600
 v_mul_f32 v76, v72, v76
 v_mfma_f32_16x16x32_bf16 v[80:83], a[36:39], v[44:47], v[80:83]
 buffer_load_dwordx4 a[144:147], v19, s[16:19], s85 offen offset:2048 sc1
 v_add_f32 v73, 1.0, v73
 v_mfma_f32_16x16x32_bf16 v[84:87], a[176:179], v[40:43], v[84:87]
 v_rcp_f32 v73, v73
 v_mfma_f32_16x16x32_bf16 v[84:87], a[180:183], v[44:47], v[84:87]
 v_mul_f32 v77, v73, v77
 v_mul_f32 v78, v74, v78
 v_mfma_f32_16x16x32_bf16 v[88:91], a[104:107], v[40:43], v[88:91]
 ds_read_b128 v[36:39], v21 offset:25600
 v_mul_f32 v74, s54, v74
 v_mfma_f32_16x16x32_bf16 v[88:91], a[108:111], v[44:47], v[88:91]
 buffer_load_dwordx4 a[148:151], v7, s[16:19], s85 offen offset:2048 sc1
 v_mul_f32 v79, v75, v79
 v_mfma_f32_16x16x32_bf16 v[92:95], a[248:251], v[40:43], v[92:95]
 v_exp_f32 v74, v74
 v_mfma_f32_16x16x32_bf16 v[92:95], a[252:255], v[44:47], v[92:95]
 s_waitcnt lgkmcnt(4)
 v_add_f32 v74, 1.0, v74
 v_mul_f32 v75, s54, v75
 v_mfma_f32_16x16x32_bf16 v[80:83], a[40:43], v[48:51], v[80:83]
 ds_read_b128 v[40:43], v20 offset:26624
 v_cvt_pk_bf16_f32 v64, v68, v69
 v_mfma_f32_16x16x32_bf16 v[80:83], a[44:47], v[52:55], v[80:83]
 v_rcp_f32 v74, v74
 v_mfma_f32_16x16x32_bf16 v[84:87], a[184:187], v[48:51], v[84:87]
 buffer_load_dwordx4 a[216:219], v19, s[16:19], s85 offen offset:3072 sc1
 v_mul_f32 v78, v74, v78
 v_mfma_f32_16x16x32_bf16 v[84:87], a[188:191], v[52:55], v[84:87]
 v_exp_f32 v75, v75
 v_mfma_f32_16x16x32_bf16 v[88:91], a[112:115], v[48:51], v[88:91]
 ds_read_b128 v[44:47], v21 offset:26624
 v_add_f32 v75, 1.0, v75
 v_mfma_f32_16x16x32_bf16 v[88:91], a[116:119], v[52:55], v[88:91]
 v_rcp_f32 v75, v75
 v_mfma_f32_16x16x32_bf16 v[92:95], v[224:227], v[48:51], v[92:95]
 v_mul_f32 v79, v75, v79
 v_cvt_pk_bf16_f32 v65, v70, v71
 v_mfma_f32_16x16x32_bf16 v[92:95], v[228:231], v[52:55], v[92:95]
 s_waitcnt lgkmcnt(4)
 v_cvt_pk_bf16_f32 v66, v76, v77
 v_cvt_pk_bf16_f32 v67, v78, v79
 v_mfma_f32_16x16x32_bf16 v[80:83], a[48:51], v[56:59], v[80:83]
 buffer_store_dwordx4 v[64:67], v19, s[16:19], s53 offen sc1
 v_mfma_f32_16x16x32_bf16 v[80:83], a[52:55], v[60:63], v[80:83]
 s_add_u32 s53, s53, s52
 v_mfma_f32_16x16x32_bf16 v[84:87], a[192:195], v[56:59], v[84:87]
 v_mfma_f32_16x16x32_bf16 v[84:87], a[196:199], v[60:63], v[84:87]
 v_mfma_f32_16x16x32_bf16 v[88:91], a[120:123], v[56:59], v[88:91]
 v_mfma_f32_16x16x32_bf16 v[88:91], a[124:127], v[60:63], v[88:91]
 v_mfma_f32_16x16x32_bf16 v[92:95], v[232:235], v[56:59], v[92:95]
 v_mfma_f32_16x16x32_bf16 v[92:95], v[236:239], v[60:63], v[92:95]
 s_waitcnt lgkmcnt(2)
 v_mfma_f32_16x16x32_bf16 v[80:83], a[56:59], v[32:35], v[80:83]
 s_waitcnt vmcnt(28) lgkmcnt(0)
 s_barrier
 v_mfma_f32_16x16x32_bf16 v[80:83], a[60:63], v[36:39], v[80:83]
 ds_read_b128 v[96:99], v8 offset:0
 v_mfma_f32_16x16x32_bf16 v[84:87], a[200:203], v[32:35], v[84:87]
 ds_read_b128 v[100:103], v8 offset:49152
 v_mfma_f32_16x16x32_bf16 v[84:87], a[204:207], v[36:39], v[84:87]
 ds_read_b128 v[104:107], v8 offset:1024
 v_mfma_f32_16x16x32_bf16 v[88:91], a[128:131], v[32:35], v[88:91]
 ds_read_b128 v[108:111], v8 offset:50176
 v_mfma_f32_16x16x32_bf16 v[88:91], a[132:135], v[36:39], v[88:91]
 ds_read_b128 v[112:115], v8 offset:2048
 v_mfma_f32_16x16x32_bf16 v[92:95], v[240:243], v[32:35], v[92:95]
 ds_read_b128 v[116:119], v8 offset:51200
 v_mfma_f32_16x16x32_bf16 v[92:95], v[244:247], v[36:39], v[92:95]
 s_cmp_eq_u32 s64, 0x10101
 s_cbranch_scc0 Lsp_g11p1
Lrt_g11p1:
 v_mfma_f32_16x16x32_bf16 v[80:83], a[64:67], v[40:43], v[80:83]
 ds_read_b128 v[120:123], v8 offset:3072
 v_mfma_f32_16x16x32_bf16 v[80:83], a[68:71], v[44:47], v[80:83]
 ds_read_b128 v[124:127], v8 offset:52224
 v_mfma_f32_16x16x32_bf16 v[84:87], a[208:211], v[40:43], v[84:87]
 ds_read_b128 v[128:131], v8 offset:4096
 v_mfma_f32_16x16x32_bf16 v[84:87], a[212:215], v[44:47], v[84:87]
 ds_read_b128 v[132:135], v8 offset:53248
 v_mfma_f32_16x16x32_bf16 v[88:91], a[136:139], v[40:43], v[88:91]
 ds_read_b128 v[136:139], v8 offset:5120
 v_mfma_f32_16x16x32_bf16 v[88:91], a[140:143], v[44:47], v[88:91]
 buffer_load_dwordx4 a[220:223], v7, s[16:19], s85 offen offset:3072 sc1
 s_mul_i32 s84, s63, 442368
 v_mfma_f32_16x16x32_bf16 v[92:95], v[248:251], v[40:43], v[92:95]
 ds_read_b128 v[140:143], v8 offset:54272
 s_waitcnt lgkmcnt(8)
 v_mfma_f32_16x16x32_bf16 v[92:95], v[252:255], v[44:47], v[92:95]
 s_add_u32 s84, s84, s86
 s_add_u32 m0, s56, 0
 v_mfma_f32_16x16x32_bf16 v[224:227], v[96:99], v[160:163], 0
 ds_read_b128 v[144:147], v8 offset:6144
 v_mfma_f32_16x16x32_bf16 v[224:227], v[100:103], v[168:171], v[224:227]
 buffer_load_dwordx4 v19, s[16:19], s84 offen sc1 lds
 v_mfma_f32_16x16x32_bf16 v[228:231], v[96:99], v[164:167], 0
 ds_read_b128 v[148:151], v8 offset:55296
 v_mfma_f32_16x16x32_bf16 v[228:231], v[100:103], v[172:175], v[228:231]
 buffer_load_dwordx4 v19, s[16:19], s84 offen offset:1024 sc1 lds
 v_mfma_f32_16x16x32_bf16 v[232:235], v[104:107], v[160:163], 0
 ds_read_b128 v[152:155], v8 offset:7168
 v_mfma_f32_16x16x32_bf16 v[232:235], v[108:111], v[168:171], v[232:235]
 buffer_load_dwordx4 v19, s[16:19], s84 offen offset:2048 sc1 lds
 v_mul_f32 v84, v80, v84
 v_mfma_f32_16x16x32_bf16 v[236:239], v[104:107], v[164:167], 0
 ds_read_b128 v[156:159], v8 offset:56320
 s_waitcnt lgkmcnt(8)
 v_mul_f32 v80, s54, v80
 v_mfma_f32_16x16x32_bf16 v[236:239], v[108:111], v[172:175], v[236:239]
 v_exp_f32 v80, v80
 v_mfma_f32_16x16x32_bf16 v[240:243], v[112:115], v[160:163], 0
 ds_read_b128 v[96:99], v8 offset:8192
 v_add_f32 v80, 1.0, v80
 v_mul_f32 v85, v81, v85
 v_mfma_f32_16x16x32_bf16 v[240:243], v[116:119], v[168:171], v[240:243]
 v_rcp_f32 v80, v80
 v_mfma_f32_16x16x32_bf16 v[244:247], v[112:115], v[164:167], 0
 ds_read_b128 v[100:103], v8 offset:57344
 v_mul_f32 v84, v80, v84
 v_mul_f32 v81, s54, v81
 v_mfma_f32_16x16x32_bf16 v[244:247], v[116:119], v[172:175], v[244:247]
 buffer_load_dwordx4 v19, s[16:19], s84 offen offset:3072 sc1 lds
 s_add_u32 m0, m0, s30
 v_mfma_f32_16x16x32_bf16 v[248:251], v[120:123], v[160:163], 0
 ds_read_b128 v[104:107], v9 offset:0
 v_exp_f32 v81, v81
 v_mfma_f32_16x16x32_bf16 v[248:251], v[124:127], v[168:171], v[248:251]
 v_add_f32 v81, 1.0, v81
 v_mul_f32 v86, v82, v86
 v_mfma_f32_16x16x32_bf16 v[252:255], v[120:123], v[164:167], 0
 ds_read_b128 v[108:111], v9 offset:9216
 s_waitcnt lgkmcnt(8)
 v_mul_f32 v82, s54, v82
 v_mfma_f32_16x16x32_bf16 v[252:255], v[124:127], v[172:175], v[252:255]
 buffer_load_dwordx4 v5, s[16:19], s84 offen sc1 lds
 v_mul_f32 v87, v83, v87
 v_mfma_f32_16x16x32_bf16 v[32:35], v[128:131], v[160:163], 0
 ds_read_b128 v[112:115], v9 offset:1024
 v_rcp_f32 v81, v81
 v_mfma_f32_16x16x32_bf16 v[32:35], v[132:135], v[168:171], v[32:35]
 v_exp_f32 v82, v82
 v_mfma_f32_16x16x32_bf16 v[36:39], v[128:131], v[164:167], 0
 ds_read_b128 v[116:119], v9 offset:10240
 v_mul_f32 v85, v81, v85
 v_add_f32 v82, 1.0, v82
 v_mfma_f32_16x16x32_bf16 v[36:39], v[132:135], v[172:175], v[36:39]
 buffer_load_dwordx4 v5, s[16:19], s84 offen offset:1024 sc1 lds
 v_mul_f32 v83, s54, v83
 v_mfma_f32_16x16x32_bf16 v[40:43], v[136:139], v[160:163], 0
 ds_read_b128 v[120:123], v9 offset:2048
 v_rcp_f32 v82, v82
 v_mfma_f32_16x16x32_bf16 v[40:43], v[140:143], v[168:171], v[40:43]
 v_exp_f32 v83, v83
 v_mfma_f32_16x16x32_bf16 v[44:47], v[136:139], v[164:167], 0
 ds_read_b128 v[124:127], v9 offset:11264
 s_waitcnt lgkmcnt(8)
 v_mul_f32 v86, v82, v86
 v_mfma_f32_16x16x32_bf16 v[44:47], v[140:143], v[172:175], v[44:47]
 buffer_load_dwordx4 v5, s[16:19], s84 offen offset:2048 sc1 lds
 v_add_f32 v83, 1.0, v83
 v_mfma_f32_16x16x32_bf16 v[48:51], v[144:147], v[160:163], 0
 ds_read_b128 v[128:131], v9 offset:3072
 v_rcp_f32 v83, v83
 v_mfma_f32_16x16x32_bf16 v[48:51], v[148:151], v[168:171], v[48:51]
 v_mul_f32 v87, v83, v87
 v_mul_f32 v92, v88, v92
 v_mfma_f32_16x16x32_bf16 v[52:55], v[144:147], v[164:167], 0
 ds_read_b128 v[132:135], v9 offset:12288
 v_mul_f32 v88, s54, v88
 v_mul_f32 v93, v89, v93
 v_mfma_f32_16x16x32_bf16 v[52:55], v[148:151], v[172:175], v[52:55]
 buffer_load_dwordx4 v5, s[16:19], s84 offen offset:3072 sc1 lds
 s_add_u32 m0, m0, s30
 v_mfma_f32_16x16x32_bf16 v[56:59], v[152:155], v[160:163], 0
 ds_read_b128 v[136:139], v9 offset:4096
 v_exp_f32 v88, v88
 v_mfma_f32_16x16x32_bf16 v[56:59], v[156:159], v[168:171], v[56:59]
 v_add_f32 v88, 1.0, v88
 v_mul_f32 v89, s54, v89
 v_mfma_f32_16x16x32_bf16 v[60:63], v[152:155], v[164:167], 0
 ds_read_b128 v[140:143], v9 offset:13312
 s_waitcnt lgkmcnt(8)
 v_mul_f32 v94, v90, v94
 v_mfma_f32_16x16x32_bf16 v[60:63], v[156:159], v[172:175], v[60:63]
 v_rcp_f32 v88, v88
 v_mfma_f32_16x16x32_bf16 v[64:67], v[96:99], v[160:163], 0
 ds_read_b128 v[144:147], v9 offset:5120
 v_exp_f32 v89, v89
 v_mfma_f32_16x16x32_bf16 v[64:67], v[100:103], v[168:171], v[64:67]
 buffer_load_dwordx4 v6, s[16:19], s84 offen sc1 lds
 s_mul_i32 s85, s63, 12288
 v_mfma_f32_16x16x32_bf16 v[68:71], v[96:99], v[164:167], 0
 ds_read_b128 v[148:151], v9 offset:14336
 s_add_u32 s85, s85, s87
 v_mul_f32 v92, v88, v92
 v_mfma_f32_16x16x32_bf16 v[68:71], v[100:103], v[172:175], v[68:71]
 v_add_f32 v89, 1.0, v89
 v_mul_f32 v90, s54, v90
 v_mfma_f32_16x16x32_bf16 v[224:227], v[104:107], v[176:179], v[224:227]
 ds_read_b128 v[152:155], v9 offset:6144
 v_rcp_f32 v89, v89
 v_mfma_f32_16x16x32_bf16 v[224:227], v[108:111], v[184:187], v[224:227]
 buffer_load_dwordx4 a[8:11], v19, s[16:19], s85 offen sc1
 v_mul_f32 v93, v89, v93
 v_mfma_f32_16x16x32_bf16 v[228:231], v[104:107], v[180:183], v[228:231]
 ds_read_b128 v[156:159], v9 offset:15360
 s_waitcnt lgkmcnt(8)
 v_mul_f32 v95, v91, v95
 v_mfma_f32_16x16x32_bf16 v[228:231], v[108:111], v[188:191], v[228:231]
 v_exp_f32 v90, v90
 v_mfma_f32_16x16x32_bf16 v[232:235], v[112:115], v[176:179], v[232:235]
 ds_read_b128 v[96:99], v9 offset:7168
 v_add_f32 v90, 1.0, v90
 v_mul_f32 v91, s54, v91
 v_mfma_f32_16x16x32_bf16 v[232:235], v[116:119], v[184:187], v[232:235]
 buffer_load_dwordx4 a[12:15], v7, s[16:19], s85 offen sc1
 v_cvt_pk_bf16_f32 v80, v84, v85
 v_mfma_f32_16x16x32_bf16 v[236:239], v[112:115], v[180:183], v[236:239]
 ds_read_b128 v[100:103], v9 offset:16384
 v_rcp_f32 v90, v90
 v_mfma_f32_16x16x32_bf16 v[236:239], v[116:119], v[188:191], v[236:239]
 v_exp_f32 v91, v91
 v_mfma_f32_16x16x32_bf16 v[240:243], v[120:123], v[176:179], v[240:243]
 ds_read_b128 v[104:107], v9 offset:8192
 v_mul_f32 v94, v90, v94
 v_add_f32 v91, 1.0, v91
 v_mfma_f32_16x16x32_bf16 v[240:243], v[124:127], v[184:187], v[240:243]
 buffer_load_dwordx4 a[80:83], v19, s[16:19], s85 offen offset:1024 sc1
 v_cvt_pk_bf16_f32 v81, v86, v87
 v_mfma_f32_16x16x32_bf16 v[244:247], v[120:123], v[180:183], v[244:247]
 ds_read_b128 v[108:111], v9 offset:17408
 s_waitcnt lgkmcnt(8)
 v_cvt_pk_bf16_f32 v82, v92, v93
 v_mfma_f32_16x16x32_bf16 v[244:247], v[124:127], v[188:191], v[244:247]
 v_rcp_f32 v91, v91
 v_mfma_f32_16x16x32_bf16 v[248:251], v[128:131], v[176:179], v[248:251]
 v_mul_f32 v95, v91, v95
 v_mfma_f32_16x16x32_bf16 v[248:251], v[132:135], v[184:187], v[248:251]
 v_cvt_pk_bf16_f32 v83, v94, v95
 v_mfma_f32_16x16x32_bf16 v[252:255], v[128:131], v[180:183], v[252:255]
 buffer_store_dwordx4 v[80:83], v19, s[16:19], s53 offen sc1
 v_mfma_f32_16x16x32_bf16 v[252:255], v[132:135], v[188:191], v[252:255]
 s_add_u32 s53, s53, s52
 v_mfma_f32_16x16x32_bf16 v[32:35], v[136:139], v[176:179], v[32:35]
 v_mfma_f32_16x16x32_bf16 v[32:35], v[140:143], v[184:187], v[32:35]
 v_mfma_f32_16x16x32_bf16 v[36:39], v[136:139], v[180:183], v[36:39]
 v_mfma_f32_16x16x32_bf16 v[36:39], v[140:143], v[188:191], v[36:39]
 s_waitcnt lgkmcnt(4)
 v_mfma_f32_16x16x32_bf16 v[40:43], v[144:147], v[176:179], v[40:43]
 s_waitcnt vmcnt(32) lgkmcnt(0)
 s_barrier
 v_mfma_f32_16x16x32_bf16 v[40:43], v[148:151], v[184:187], v[40:43]
 ds_read_b128 v[112:115], v26 offset:0
 v_mfma_f32_16x16x32_bf16 v[44:47], v[144:147], v[180:183], v[44:47]
 ds_read_b128 v[116:119], v26 offset:9216
 v_mfma_f32_16x16x32_bf16 v[44:47], v[148:151], v[188:191], v[44:47]
 ds_read_b128 v[120:123], v26 offset:1024
 v_mfma_f32_16x16x32_bf16 v[48:51], v[152:155], v[176:179], v[48:51]
 ds_read_b128 v[124:127], v26 offset:10240
 v_mfma_f32_16x16x32_bf16 v[48:51], v[156:159], v[184:187], v[48:51]
 ds_read_b128 v[128:131], v26 offset:2048
 v_mfma_f32_16x16x32_bf16 v[52:55], v[152:155], v[180:183], v[52:55]
 ds_read_b128 v[132:135], v26 offset:11264
 v_mfma_f32_16x16x32_bf16 v[52:55], v[156:159], v[188:191], v[52:55]
 ds_read_b128 v[136:139], v26 offset:3072
 v_mfma_f32_16x16x32_bf16 v[56:59], v[96:99], v[176:179], v[56:59]
 ds_read_b128 v[140:143], v26 offset:12288
 v_mfma_f32_16x16x32_bf16 v[56:59], v[100:103], v[184:187], v[56:59]
 ds_read_b128 v[144:147], v26 offset:4096
 v_mfma_f32_16x16x32_bf16 v[60:63], v[96:99], v[180:183], v[60:63]
 ds_read_b128 v[148:151], v26 offset:13312
 v_mfma_f32_16x16x32_bf16 v[60:63], v[100:103], v[188:191], v[60:63]
 buffer_load_dwordx4 a[84:87], v7, s[16:19], s85 offen offset:1024 sc1
 v_mfma_f32_16x16x32_bf16 v[64:67], v[104:107], v[176:179], v[64:67]
 ds_read_b128 v[152:155], v26 offset:5120
 v_mfma_f32_16x16x32_bf16 v[64:67], v[108:111], v[184:187], v[64:67]
 buffer_load_dwordx4 a[152:155], v19, s[16:19], s85 offen offset:2048 sc1
 v_mfma_f32_16x16x32_bf16 v[68:71], v[104:107], v[180:183], v[68:71]
 ds_read_b128 v[156:159], v26 offset:14336
 s_waitcnt lgkmcnt(6)
 v_mfma_f32_16x16x32_bf16 v[68:71], v[108:111], v[188:191], v[68:71]
 buffer_load_dwordx4 a[156:159], v7, s[16:19], s85 offen offset:2048 sc1
 v_mfma_f32_16x16x32_bf16 v[224:227], v[112:115], v[192:195], v[224:227]
 ds_read_b128 v[96:99], v26 offset:6144
 v_mfma_f32_16x16x32_bf16 v[224:227], v[116:119], v[200:203], v[224:227]
 buffer_load_dwordx4 a[224:227], v19, s[16:19], s85 offen offset:3072 sc1
 v_mfma_f32_16x16x32_bf16 v[228:231], v[112:115], v[196:199], v[228:231]
 ds_read_b128 v[100:103], v26 offset:15360
 v_mfma_f32_16x16x32_bf16 v[228:231], v[116:119], v[204:207], v[228:231]
 v_mfma_f32_16x16x32_bf16 v[232:235], v[120:123], v[192:195], v[232:235]
 ds_read_b128 v[104:107], v26 offset:7168
 v_mfma_f32_16x16x32_bf16 v[232:235], v[124:127], v[200:203], v[232:235]
 v_mfma_f32_16x16x32_bf16 v[236:239], v[120:123], v[196:199], v[236:239]
 ds_read_b128 v[108:111], v26 offset:16384
 v_mfma_f32_16x16x32_bf16 v[236:239], v[124:127], v[204:207], v[236:239]
 buffer_load_dwordx4 a[228:231], v7, s[16:19], s85 offen offset:3072 sc1
 s_add_u32 s84, s84, s31
 v_mfma_f32_16x16x32_bf16 v[240:243], v[128:131], v[192:195], v[240:243]
 ds_read_b128 v[112:115], v26 offset:8192
 s_add_u32 m0, s55, 0
 v_mfma_f32_16x16x32_bf16 v[240:243], v[132:135], v[200:203], v[240:243]
 v_mfma_f32_16x16x32_bf16 v[244:247], v[128:131], v[196:199], v[244:247]
 ds_read_b128 v[116:119], v26 offset:17408
 s_waitcnt lgkmcnt(4)
 v_mfma_f32_16x16x32_bf16 v[244:247], v[132:135], v[204:207], v[244:247]
 buffer_load_dwordx4 v19, s[16:19], s84 offen sc1 lds
 v_mfma_f32_16x16x32_bf16 v[248:251], v[136:139], v[192:195], v[248:251]
 ds_read_b128 v[120:123], v26 offset:18432
 v_mfma_f32_16x16x32_bf16 v[248:251], v[140:143], v[200:203], v[248:251]
 v_mfma_f32_16x16x32_bf16 v[252:255], v[136:139], v[196:199], v[252:255]
 ds_read_b128 v[124:127], v26 offset:27648
 v_mfma_f32_16x16x32_bf16 v[252:255], v[140:143], v[204:207], v[252:255]
 buffer_load_dwordx4 v19, s[16:19], s84 offen offset:1024 sc1 lds
 v_mfma_f32_16x16x32_bf16 v[32:35], v[144:147], v[192:195], v[32:35]
 ds_read_b128 v[128:131], v26 offset:19456
 v_mfma_f32_16x16x32_bf16 v[32:35], v[148:151], v[200:203], v[32:35]
 v_mfma_f32_16x16x32_bf16 v[36:39], v[144:147], v[196:199], v[36:39]
 ds_read_b128 v[132:135], v26 offset:28672
 v_mfma_f32_16x16x32_bf16 v[36:39], v[148:151], v[204:207], v[36:39]
 buffer_load_dwordx4 v19, s[16:19], s84 offen offset:2048 sc1 lds
 v_mfma_f32_16x16x32_bf16 v[40:43], v[152:155], v[192:195], v[40:43]
 ds_read_b128 v[136:139], v26 offset:20480
 v_mfma_f32_16x16x32_bf16 v[40:43], v[156:159], v[200:203], v[40:43]
 v_mfma_f32_16x16x32_bf16 v[44:47], v[152:155], v[196:199], v[44:47]
 ds_read_b128 v[140:143], v26 offset:29696
 v_mfma_f32_16x16x32_bf16 v[44:47], v[156:159], v[204:207], v[44:47]
 buffer_load_dwordx4 v19, s[16:19], s84 offen offset:3072 sc1 lds
 s_add_u32 m0, m0, s30
 v_mfma_f32_16x16x32_bf16 v[48:51], v[96:99], v[192:195], v[48:51]
 ds_read_b128 v[144:147], v26 offset:21504
 v_mfma_f32_16x16x32_bf16 v[48:51], v[100:103], v[200:203], v[48:51]
 v_mfma_f32_16x16x32_bf16 v[52:55], v[96:99], v[196:199], v[52:55]
 ds_read_b128 v[148:151], v26 offset:30720
 s_waitcnt lgkmcnt(4)
 v_mfma_f32_16x16x32_bf16 v[52:55], v[100:103], v[204:207], v[52:55]
 v_mfma_f32_16x16x32_bf16 v[56:59], v[104:107], v[192:195], v[56:59]
 ds_read_b128 v[152:155], v26 offset:22528
 v_mfma_f32_16x16x32_bf16 v[56:59], v[108:111], v[200:203], v[56:59]
 buffer_load_dwordx4 v5, s[16:19], s84 offen sc1 lds
 v_mfma_f32_16x16x32_bf16 v[60:63], v[104:107], v[196:199], v[60:63]
 ds_read_b128 v[156:159], v26 offset:31744
 v_mfma_f32_16x16x32_bf16 v[60:63], v[108:111], v[204:207], v[60:63]
 s_waitcnt vmcnt(10)
 s_barrier
 v_mfma_f32_16x16x32_bf16 v[64:67], v[112:115], v[192:195], v[64:67]
 ds_read_b128 v[96:99], v26 offset:23552
 v_mfma_f32_16x16x32_bf16 v[64:67], v[116:119], v[200:203], v[64:67]
 buffer_store_byte v2, v1, s[16:19], s25 offen sc1
 v_mfma_f32_16x16x32_bf16 v[68:71], v[112:115], v[196:199], v[68:71]
 ds_read_b128 v[100:103], v26 offset:32768
 v_mfma_f32_16x16x32_bf16 v[68:71], v[116:119], v[204:207], v[68:71]
 buffer_load_dwordx4 v5, s[16:19], s84 offen offset:1024 sc1 lds
 v_mfma_f32_16x16x32_bf16 v[224:227], v[120:123], v[208:211], v[224:227]
 ds_read_b128 v[104:107], v26 offset:24576
 v_mfma_f32_16x16x32_bf16 v[224:227], v[124:127], v[216:219], v[224:227]
 buffer_load_dwordx4 v5, s[16:19], s84 offen offset:2048 sc1 lds
 v_mfma_f32_16x16x32_bf16 v[228:231], v[120:123], v[212:215], v[228:231]
 ds_read_b128 v[108:111], v26 offset:33792
 v_mfma_f32_16x16x32_bf16 v[228:231], v[124:127], v[220:223], v[228:231]
 v_mfma_f32_16x16x32_bf16 v[232:235], v[128:131], v[208:211], v[232:235]
 ds_read_b128 v[112:115], v26 offset:25600
 v_mfma_f32_16x16x32_bf16 v[232:235], v[132:135], v[216:219], v[232:235]
 buffer_load_dwordx4 v5, s[16:19], s84 offen offset:3072 sc1 lds
 s_add_u32 m0, m0, s30
 v_mfma_f32_16x16x32_bf16 v[236:239], v[128:131], v[212:215], v[236:239]
 ds_read_b128 v[116:119], v26 offset:34816
 s_waitcnt lgkmcnt(4)
 v_mfma_f32_16x16x32_bf16 v[236:239], v[132:135], v[220:223], v[236:239]
 v_mfma_f32_16x16x32_bf16 v[240:243], v[136:139], v[208:211], v[240:243]
 ds_read_b128 v[120:123], v26 offset:26624
 v_mfma_f32_16x16x32_bf16 v[240:243], v[140:143], v[216:219], v[240:243]
 buffer_load_dwordx4 v6, s[16:19], s84 offen sc1 lds
 s_add_u32 s85, s85, s30
 v_mfma_f32_16x16x32_bf16 v[244:247], v[136:139], v[212:215], v[244:247]
 ds_read_b128 v[124:127], v26 offset:35840
 v_mfma_f32_16x16x32_bf16 v[244:247], v[140:143], v[220:223], v[244:247]
 v_mfma_f32_16x16x32_bf16 v[248:251], v[144:147], v[208:211], v[248:251]
 v_mfma_f32_16x16x32_bf16 v[248:251], v[148:151], v[216:219], v[248:251]
 v_mfma_f32_16x16x32_bf16 v[252:255], v[144:147], v[212:215], v[252:255]
 buffer_load_dwordx4 v[160:163], v19, s[16:19], s85 offen sc1
 v_mfma_f32_16x16x32_bf16 v[252:255], v[148:151], v[220:223], v[252:255]
 v_mfma_f32_16x16x32_bf16 v[32:35], v[152:155], v[208:211], v[32:35]
 v_mfma_f32_16x16x32_bf16 v[32:35], v[156:159], v[216:219], v[32:35]
 v_mfma_f32_16x16x32_bf16 v[36:39], v[152:155], v[212:215], v[36:39]
 buffer_load_dwordx4 v[164:167], v7, s[16:19], s85 offen sc1
 v_mfma_f32_16x16x32_bf16 v[36:39], v[156:159], v[220:223], v[36:39]
 v_mfma_f32_16x16x32_bf16 v[40:43], v[96:99], v[208:211], v[40:43]
 s_waitcnt lgkmcnt(0)
 s_barrier
 v_mfma_f32_16x16x32_bf16 v[40:43], v[100:103], v[216:219], v[40:43]
 ds_read_b128 v[128:131], v27 offset:0
 v_mfma_f32_16x16x32_bf16 v[44:47], v[96:99], v[212:215], v[44:47]
 ds_read_b128 v[132:135], v27 offset:9216
 v_mfma_f32_16x16x32_bf16 v[44:47], v[100:103], v[220:223], v[44:47]
 ds_read_b128 v[136:139], v27 offset:1024
 v_mfma_f32_16x16x32_bf16 v[48:51], v[104:107], v[208:211], v[48:51]
 ds_read_b128 v[140:143], v27 offset:10240
 v_mfma_f32_16x16x32_bf16 v[48:51], v[108:111], v[216:219], v[48:51]
 ds_read_b128 v[144:147], v27 offset:2048
 v_mfma_f32_16x16x32_bf16 v[52:55], v[104:107], v[212:215], v[52:55]
 ds_read_b128 v[148:151], v27 offset:11264
 v_mfma_f32_16x16x32_bf16 v[52:55], v[108:111], v[220:223], v[52:55]
 ds_read_b128 v[152:155], v27 offset:3072
 v_mfma_f32_16x16x32_bf16 v[56:59], v[112:115], v[208:211], v[56:59]
 ds_read_b128 v[156:159], v27 offset:12288
 v_mfma_f32_16x16x32_bf16 v[56:59], v[116:119], v[216:219], v[56:59]
 ds_read_b128 v[96:99], v27 offset:4096
 v_mfma_f32_16x16x32_bf16 v[60:63], v[112:115], v[212:215], v[60:63]
 ds_read_b128 v[100:103], v27 offset:13312
 v_mfma_f32_16x16x32_bf16 v[60:63], v[116:119], v[220:223], v[60:63]
 buffer_load_dwordx4 v[168:171], v19, s[16:19], s85 offen offset:1024 sc1
 v_mfma_f32_16x16x32_bf16 v[64:67], v[120:123], v[208:211], v[64:67]
Lpg7:
 s_cbranch_vccnz Lj_Lfin
 ds_read_b128 v[104:107], v27 offset:5120
 v_mfma_f32_16x16x32_bf16 v[64:67], v[124:127], v[216:219], v[64:67]
 buffer_load_dwordx4 v[172:175], v7, s[16:19], s85 offen offset:1024 sc1
 v_mfma_f32_16x16x32_bf16 v[68:71], v[120:123], v[212:215], v[68:71]
 ds_read_b128 v[108:111], v27 offset:14336
 s_waitcnt lgkmcnt(6)
 v_mfma_f32_16x16x32_bf16 v[68:71], v[124:127], v[220:223], v[68:71]
 buffer_load_dwordx4 v[176:179], v19, s[16:19], s85 offen offset:2048 sc1
 v_mfma_f32_16x16x32_bf16 v[224:227], v[128:131], a[0:3], v[224:227]
 ds_read_b128 v[112:115], v27 offset:6144
 v_mfma_f32_16x16x32_bf16 v[224:227], v[132:135], a[72:75], v[224:227]
 buffer_load_dwordx4 v[180:183], v7, s[16:19], s85 offen offset:2048 sc1
 v_mfma_f32_16x16x32_bf16 v[228:231], v[128:131], a[4:7], v[228:231]
 ds_read_b128 v[116:119], v27 offset:15360
 v_mfma_f32_16x16x32_bf16 v[228:231], v[132:135], a[76:79], v[228:231]
 v_mfma_f32_16x16x32_bf16 v[232:235], v[136:139], a[0:3], v[232:235]
 ds_read_b128 v[120:123], v27 offset:7168
 v_mfma_f32_16x16x32_bf16 v[232:235], v[140:143], a[72:75], v[232:235]
 v_mfma_f32_16x16x32_bf16 v[236:239], v[136:139], a[4:7], v[236:239]
 ds_read_b128 v[124:127], v27 offset:16384
 v_mfma_f32_16x16x32_bf16 v[236:239], v[140:143], a[76:79], v[236:239]
 buffer_load_dwordx4 v[184:187], v19, s[16:19], s85 offen offset:3072 sc1
 v_mfma_f32_16x16x32_bf16 v[240:243], v[144:147], a[0:3], v[240:243]
 ds_read_b128 v[128:131], v27 offset:8192
 v_mfma_f32_16x16x32_bf16 v[240:243], v[148:151], a[72:75], v[240:243]
 v_mfma_f32_16x16x32_bf16 v[244:247], v[144:147], a[4:7], v[244:247]
 ds_read_b128 v[132:135], v27 offset:17408
 s_waitcnt lgkmcnt(4)
 v_mfma_f32_16x16x32_bf16 v[244:247], v[148:151], a[76:79], v[244:247]
 buffer_load_dwordx4 v[188:191], v7, s[16:19], s85 offen offset:3072 sc1
 s_add_u32 s84, s84, s31
 v_mfma_f32_16x16x32_bf16 v[248:251], v[152:155], a[0:3], v[248:251]
 ds_read_b128 v[136:139], v27 offset:18432
 s_add_u32 m0, s56, 49152
 v_mfma_f32_16x16x32_bf16 v[248:251], v[156:159], a[72:75], v[248:251]
 v_mfma_f32_16x16x32_bf16 v[252:255], v[152:155], a[4:7], v[252:255]
 ds_read_b128 v[140:143], v27 offset:27648
 v_mfma_f32_16x16x32_bf16 v[252:255], v[156:159], a[76:79], v[252:255]
 buffer_load_dwordx4 v19, s[16:19], s84 offen sc1 lds
 v_mfma_f32_16x16x32_bf16 v[32:35], v[96:99], a[0:3], v[32:35]
 ds_read_b128 v[144:147], v27 offset:19456
 v_mfma_f32_16x16x32_bf16 v[32:35], v[100:103], a[72:75], v[32:35]
 v_mfma_f32_16x16x32_bf16 v[36:39], v[96:99], a[4:7], v[36:39]
 ds_read_b128 v[148:151], v27 offset:28672
 v_mfma_f32_16x16x32_bf16 v[36:39], v[100:103], a[76:79], v[36:39]
 buffer_load_dwordx4 v19, s[16:19], s84 offen offset:1024 sc1 lds
 v_mfma_f32_16x16x32_bf16 v[40:43], v[104:107], a[0:3], v[40:43]
 ds_read_b128 v[152:155], v27 offset:20480
 v_mfma_f32_16x16x32_bf16 v[40:43], v[108:111], a[72:75], v[40:43]
 v_mfma_f32_16x16x32_bf16 v[44:47], v[104:107], a[4:7], v[44:47]
 ds_read_b128 v[156:159], v27 offset:29696
 v_mfma_f32_16x16x32_bf16 v[44:47], v[108:111], a[76:79], v[44:47]
 buffer_load_dwordx4 v19, s[16:19], s84 offen offset:2048 sc1 lds
 v_mfma_f32_16x16x32_bf16 v[48:51], v[112:115], a[0:3], v[48:51]
 ds_read_b128 v[96:99], v27 offset:21504
 v_mfma_f32_16x16x32_bf16 v[48:51], v[116:119], a[72:75], v[48:51]
 v_mfma_f32_16x16x32_bf16 v[52:55], v[112:115], a[4:7], v[52:55]
 ds_read_b128 v[100:103], v27 offset:30720
 s_waitcnt lgkmcnt(4)
 v_mfma_f32_16x16x32_bf16 v[52:55], v[116:119], a[76:79], v[52:55]
 v_mfma_f32_16x16x32_bf16 v[56:59], v[120:123], a[0:3], v[56:59]
 ds_read_b128 v[104:107], v27 offset:22528
 v_mfma_f32_16x16x32_bf16 v[56:59], v[124:127], a[72:75], v[56:59]
 buffer_load_dwordx4 v19, s[16:19], s84 offen offset:3072 sc1 lds
 s_add_u32 m0, m0, s30
 v_mfma_f32_16x16x32_bf16 v[60:63], v[120:123], a[4:7], v[60:63]
 ds_read_b128 v[108:111], v27 offset:31744
 v_mfma_f32_16x16x32_bf16 v[60:63], v[124:127], a[76:79], v[60:63]
 v_mfma_f32_16x16x32_bf16 v[64:67], v[128:131], a[0:3], v[64:67]
 ds_read_b128 v[112:115], v27 offset:23552
 v_mfma_f32_16x16x32_bf16 v[64:67], v[132:135], a[72:75], v[64:67]
 buffer_load_dwordx4 v5, s[16:19], s84 offen sc1 lds
 v_mfma_f32_16x16x32_bf16 v[68:71], v[128:131], a[4:7], v[68:71]
 ds_read_b128 v[116:119], v27 offset:32768
 v_mfma_f32_16x16x32_bf16 v[68:71], v[132:135], a[76:79], v[68:71]
 v_mfma_f32_16x16x32_bf16 v[224:227], v[136:139], a[144:147], v[224:227]
 ds_read_b128 v[120:123], v27 offset:24576
 v_mfma_f32_16x16x32_bf16 v[224:227], v[140:143], a[216:219], v[224:227]
 buffer_load_dwordx4 v5, s[16:19], s84 offen offset:1024 sc1 lds
 v_mfma_f32_16x16x32_bf16 v[228:231], v[136:139], a[148:151], v[228:231]
 ds_read_b128 v[124:127], v27 offset:33792
 v_mfma_f32_16x16x32_bf16 v[228:231], v[140:143], a[220:223], v[228:231]
 v_mfma_f32_16x16x32_bf16 v[232:235], v[144:147], a[144:147], v[232:235]
 ds_read_b128 v[128:131], v27 offset:25600
 v_mfma_f32_16x16x32_bf16 v[232:235], v[148:151], a[216:219], v[232:235]
 buffer_load_dwordx4 v5, s[16:19], s84 offen offset:2048 sc1 lds
 v_mfma_f32_16x16x32_bf16 v[236:239], v[144:147], a[148:151], v[236:239]
 ds_read_b128 v[132:135], v27 offset:34816
 s_waitcnt lgkmcnt(4)
 v_mfma_f32_16x16x32_bf16 v[236:239], v[148:151], a[220:223], v[236:239]
 v_mfma_f32_16x16x32_bf16 v[240:243], v[152:155], a[144:147], v[240:243]
 ds_read_b128 v[136:139], v27 offset:26624
 v_mfma_f32_16x16x32_bf16 v[240:243], v[156:159], a[216:219], v[240:243]
 buffer_load_dwordx4 v5, s[16:19], s84 offen offset:3072 sc1 lds
 s_add_u32 m0, m0, s30
 v_mfma_f32_16x16x32_bf16 v[244:247], v[152:155], a[148:151], v[244:247]
 ds_read_b128 v[140:143], v27 offset:35840
 v_mfma_f32_16x16x32_bf16 v[244:247], v[156:159], a[220:223], v[244:247]
 v_mfma_f32_16x16x32_bf16 v[248:251], v[96:99], a[144:147], v[248:251]
 v_mfma_f32_16x16x32_bf16 v[248:251], v[100:103], a[216:219], v[248:251]
 v_mfma_f32_16x16x32_bf16 v[252:255], v[96:99], a[148:151], v[252:255]
 buffer_load_dwordx4 v6, s[16:19], s84 offen sc1 lds
 s_add_u32 s85, s85, s30
 v_mfma_f32_16x16x32_bf16 v[252:255], v[100:103], a[220:223], v[252:255]
 v_mfma_f32_16x16x32_bf16 v[32:35], v[104:107], a[144:147], v[32:35]
 v_mfma_f32_16x16x32_bf16 v[32:35], v[108:111], a[216:219], v[32:35]
 v_mfma_f32_16x16x32_bf16 v[36:39], v[104:107], a[148:151], v[36:39]
 buffer_load_dwordx4 v[192:195], v19, s[16:19], s85 offen sc1
 v_mfma_f32_16x16x32_bf16 v[36:39], v[108:111], a[220:223], v[36:39]
 v_mfma_f32_16x16x32_bf16 v[40:43], v[112:115], a[144:147], v[40:43]
 s_waitcnt vmcnt(28) lgkmcnt(0)
 s_barrier
 v_mfma_f32_16x16x32_bf16 v[40:43], v[116:119], a[216:219], v[40:43]
 ds_read_b128 v[144:147], v28 offset:0
 v_mfma_f32_16x16x32_bf16 v[44:47], v[112:115], a[148:151], v[44:47]
 ds_read_b128 v[148:151], v28 offset:9216
 v_mfma_f32_16x16x32_bf16 v[44:47], v[116:119], a[220:223], v[44:47]
 ds_read_b128 v[152:155], v28 offset:1024
 v_mfma_f32_16x16x32_bf16 v[48:51], v[120:123], a[144:147], v[48:51]
 ds_read_b128 v[156:159], v28 offset:10240
 v_mfma_f32_16x16x32_bf16 v[48:51], v[124:127], a[216:219], v[48:51]
 ds_read_b128 v[96:99], v28 offset:2048
 v_mfma_f32_16x16x32_bf16 v[52:55], v[120:123], a[148:151], v[52:55]
 ds_read_b128 v[100:103], v28 offset:11264
 v_mfma_f32_16x16x32_bf16 v[52:55], v[124:127], a[220:223], v[52:55]
 ds_read_b128 v[104:107], v28 offset:3072
 v_mfma_f32_16x16x32_bf16 v[56:59], v[128:131], a[144:147], v[56:59]
 ds_read_b128 v[108:111], v28 offset:12288
 v_mfma_f32_16x16x32_bf16 v[56:59], v[132:135], a[216:219], v[56:59]
 ds_read_b128 v[112:115], v28 offset:4096
 v_mfma_f32_16x16x32_bf16 v[60:63], v[128:131], a[148:151], v[60:63]
 ds_read_b128 v[116:119], v28 offset:13312
 v_mfma_f32_16x16x32_bf16 v[60:63], v[132:135], a[220:223], v[60:63]
 buffer_load_dwordx4 v[196:199], v7, s[16:19], s85 offen sc1
 v_mfma_f32_16x16x32_bf16 v[64:67], v[136:139], a[144:147], v[64:67]
 ds_read_b128 v[120:123], v28 offset:5120
 v_mfma_f32_16x16x32_bf16 v[64:67], v[140:143], a[216:219], v[64:67]
 buffer_load_dwordx4 v[200:203], v19, s[16:19], s85 offen offset:1024 sc1
 v_mfma_f32_16x16x32_bf16 v[68:71], v[136:139], a[148:151], v[68:71]
 ds_read_b128 v[124:127], v28 offset:14336
 s_waitcnt lgkmcnt(8)
 v_mfma_f32_16x16x32_bf16 v[68:71], v[140:143], a[220:223], v[68:71]
 buffer_load_dwordx4 v[204:207], v7, s[16:19], s85 offen offset:1024 sc1
 v_mfma_f32_16x16x32_bf16 v[224:227], v[144:147], a[8:11], v[224:227]
 ds_read_b128 v[128:131], v28 offset:6144
 v_mfma_f32_16x16x32_bf16 v[224:227], v[148:151], a[80:83], v[224:227]
 buffer_load_dwordx4 v[208:211], v19, s[16:19], s85 offen offset:2048 sc1
 v_mfma_f32_16x16x32_bf16 v[228:231], v[144:147], a[12:15], v[228:231]
 ds_read_b128 v[132:135], v28 offset:15360
 v_mfma_f32_16x16x32_bf16 v[228:231], v[148:151], a[84:87], v[228:231]
 v_mfma_f32_16x16x32_bf16 v[232:235], v[152:155], a[8:11], v[232:235]
 ds_read_b128 v[136:139], v28 offset:7168
 v_mfma_f32_16x16x32_bf16 v[232:235], v[156:159], a[80:83], v[232:235]
 v_mfma_f32_16x16x32_bf16 v[236:239], v[152:155], a[12:15], v[236:239]
 ds_read_b128 v[140:143], v28 offset:16384
 s_waitcnt lgkmcnt(8)
 v_mfma_f32_16x16x32_bf16 v[236:239], v[156:159], a[84:87], v[236:239]
 buffer_load_dwordx4 v[212:215], v7, s[16:19], s85 offen offset:2048 sc1
 v_mfma_f32_16x16x32_bf16 v[240:243], v[96:99], a[8:11], v[240:243]
 ds_read_b128 v[144:147], v28 offset:8192
 v_mfma_f32_16x16x32_bf16 v[240:243], v[100:103], a[80:83], v[240:243]
 v_mfma_f32_16x16x32_bf16 v[244:247], v[96:99], a[12:15], v[244:247]
 ds_read_b128 v[148:151], v28 offset:17408
 v_mfma_f32_16x16x32_bf16 v[244:247], v[100:103], a[84:87], v[244:247]
 buffer_load_dwordx4 v[216:219], v19, s[16:19], s85 offen offset:3072 sc1
 v_mfma_f32_16x16x32_bf16 v[248:251], v[104:107], a[8:11], v[248:251]
 ds_read_b128 v[152:155], v28 offset:18432
 v_mfma_f32_16x16x32_bf16 v[248:251], v[108:111], a[80:83], v[248:251]
 v_mfma_f32_16x16x32_bf16 v[252:255], v[104:107], a[12:15], v[252:255]
 ds_read_b128 v[156:159], v28 offset:27648
 s_waitcnt lgkmcnt(8)
 v_mfma_f32_16x16x32_bf16 v[252:255], v[108:111], a[84:87], v[252:255]
 s_load_dword s64, s[88:89], s39 offset:45056
 v_mfma_f32_16x16x32_bf16 v[32:35], v[112:115], a[8:11], v[32:35]
 ds_read_b128 v[96:99], v28 offset:19456
 v_mfma_f32_16x16x32_bf16 v[32:35], v[116:119], a[80:83], v[32:35]
 buffer_load_dwordx4 v[220:223], v7, s[16:19], s85 offen offset:3072 sc1
 s_mul_i32 s84, s83, 442368
 v_mfma_f32_16x16x32_bf16 v[36:39], v[112:115], a[12:15], v[36:39]
 ds_read_b128 v[100:103], v28 offset:28672
 s_add_u32 s84, s84, s86
 v_mfma_f32_16x16x32_bf16 v[36:39], v[116:119], a[84:87], v[36:39]
 s_add_u32 m0, s56, 98304
 v_mfma_f32_16x16x32_bf16 v[40:43], v[120:123], a[8:11], v[40:43]
 ds_read_b128 v[104:107], v28 offset:20480
 v_mfma_f32_16x16x32_bf16 v[40:43], v[124:127], a[80:83], v[40:43]
 buffer_load_dwordx4 v19, s[16:19], s84 offen sc1 lds
 v_mfma_f32_16x16x32_bf16 v[44:47], v[120:123], a[12:15], v[44:47]
 ds_read_b128 v[108:111], v28 offset:29696
 s_waitcnt lgkmcnt(8)
 v_mfma_f32_16x16x32_bf16 v[44:47], v[124:127], a[84:87], v[44:47]
 buffer_load_dwordx4 v19, s[16:19], s84 offen offset:1024 sc1 lds
 v_mfma_f32_16x16x32_bf16 v[48:51], v[128:131], a[8:11], v[48:51]
 ds_read_b128 v[112:115], v28 offset:21504
 v_mfma_f32_16x16x32_bf16 v[48:51], v[132:135], a[80:83], v[48:51]
 v_mfma_f32_16x16x32_bf16 v[52:55], v[128:131], a[12:15], v[52:55]
 ds_read_b128 v[116:119], v28 offset:30720
 v_mfma_f32_16x16x32_bf16 v[52:55], v[132:135], a[84:87], v[52:55]
 v_mfma_f32_16x16x32_bf16 v[56:59], v[136:139], a[8:11], v[56:59]
 ds_read_b128 v[120:123], v28 offset:22528
 v_mfma_f32_16x16x32_bf16 v[56:59], v[140:143], a[80:83], v[56:59]
 buffer_load_dwordx4 v19, s[16:19], s84 offen offset:2048 sc1 lds
 v_mfma_f32_16x16x32_bf16 v[60:63], v[136:139], a[12:15], v[60:63]
 ds_read_b128 v[124:127], v28 offset:31744
 s_waitcnt lgkmcnt(8)
 v_mfma_f32_16x16x32_bf16 v[60:63], v[140:143], a[84:87], v[60:63]
 v_mfma_f32_16x16x32_bf16 v[64:67], v[144:147], a[8:11], v[64:67]
 ds_read_b128 v[128:131], v28 offset:23552
 v_mfma_f32_16x16x32_bf16 v[64:67], v[148:151], a[80:83], v[64:67]
 buffer_load_dwordx4 v19, s[16:19], s84 offen offset:3072 sc1 lds
 s_add_u32 m0, m0, s30
 v_mfma_f32_16x16x32_bf16 v[68:71], v[144:147], a[12:15], v[68:71]
 ds_read_b128 v[132:135], v28 offset:32768
 v_mfma_f32_16x16x32_bf16 v[68:71], v[148:151], a[84:87], v[68:71]
 v_mfma_f32_16x16x32_bf16 v[224:227], v[152:155], a[152:155], v[224:227]
 ds_read_b128 v[136:139], v28 offset:24576
 v_mfma_f32_16x16x32_bf16 v[224:227], v[156:159], a[224:227], v[224:227]
 buffer_load_dwordx4 v5, s[16:19], s84 offen sc1 lds
 v_mfma_f32_16x16x32_bf16 v[228:231], v[152:155], a[156:159], v[228:231]
 ds_read_b128 v[140:143], v28 offset:33792
 s_waitcnt lgkmcnt(8)
 v_mfma_f32_16x16x32_bf16 v[228:231], v[156:159], a[228:231], v[228:231]
 v_mfma_f32_16x16x32_bf16 v[232:235], v[96:99], a[152:155], v[232:235]
 ds_read_b128 v[144:147], v28 offset:25600
 v_mfma_f32_16x16x32_bf16 v[232:235], v[100:103], a[224:227], v[232:235]
 buffer_load_dwordx4 v5, s[16:19], s84 offen offset:1024 sc1 lds
 v_mfma_f32_16x16x32_bf16 v[236:239], v[96:99], a[156:159], v[236:239]
 ds_read_b128 v[148:151], v28 offset:34816
 v_mfma_f32_16x16x32_bf16 v[236:239], v[100:103], a[228:231], v[236:239]
 v_mfma_f32_16x16x32_bf16 v[240:243], v[104:107], a[152:155], v[240:243]
 ds_read_b128 v[152:155], v28 offset:26624
 v_mfma_f32_16x16x32_bf16 v[240:243], v[108:111], a[224:227], v[240:243]
 buffer_load_dwordx4 v5, s[16:19], s84 offen offset:2048 sc1 lds
 v_mfma_f32_16x16x32_bf16 v[244:247], v[104:107], a[156:159], v[244:247]
 ds_read_b128 v[156:159], v28 offset:35840
 s_waitcnt lgkmcnt(8)
 v_mfma_f32_16x16x32_bf16 v[244:247], v[108:111], a[228:231], v[244:247]
 v_mfma_f32_16x16x32_bf16 v[248:251], v[112:115], a[152:155], v[248:251]
 v_mfma_f32_16x16x32_bf16 v[248:251], v[116:119], a[224:227], v[248:251]
 v_mfma_f32_16x16x32_bf16 v[252:255], v[112:115], a[156:159], v[252:255]
 buffer_load_dwordx4 v5, s[16:19], s84 offen offset:3072 sc1 lds
 s_add_u32 m0, m0, s30
 v_mfma_f32_16x16x32_bf16 v[252:255], v[116:119], a[228:231], v[252:255]
 v_mfma_f32_16x16x32_bf16 v[32:35], v[120:123], a[152:155], v[32:35]
 v_mfma_f32_16x16x32_bf16 v[32:35], v[124:127], a[224:227], v[32:35]
 v_mfma_f32_16x16x32_bf16 v[36:39], v[120:123], a[156:159], v[36:39]
 buffer_load_dwordx4 v6, s[16:19], s84 offen sc1 lds
 v_mfma_f32_16x16x32_bf16 v[36:39], v[124:127], a[228:231], v[36:39]
 s_waitcnt lgkmcnt(4)
 v_mfma_f32_16x16x32_bf16 v[40:43], v[128:131], a[152:155], v[40:43]
 s_waitcnt vmcnt(26) lgkmcnt(0)
 s_barrier
 v_mfma_f32_16x16x32_bf16 v[40:43], v[132:135], a[224:227], v[40:43]
 ds_read_b128 v[96:99], v8 offset:0
 v_mfma_f32_16x16x32_bf16 v[44:47], v[128:131], a[156:159], v[44:47]
 ds_read_b128 v[100:103], v8 offset:49152
 v_mfma_f32_16x16x32_bf16 v[44:47], v[132:135], a[228:231], v[44:47]
 ds_read_b128 v[104:107], v8 offset:1024
 v_mfma_f32_16x16x32_bf16 v[48:51], v[136:139], a[152:155], v[48:51]
 ds_read_b128 v[108:111], v8 offset:50176
 v_mfma_f32_16x16x32_bf16 v[48:51], v[140:143], a[224:227], v[48:51]
 ds_read_b128 v[112:115], v8 offset:2048
 v_mfma_f32_16x16x32_bf16 v[52:55], v[136:139], a[156:159], v[52:55]
 ds_read_b128 v[116:119], v8 offset:51200
 v_mfma_f32_16x16x32_bf16 v[52:55], v[140:143], a[228:231], v[52:55]
 ds_read_b128 v[120:123], v8 offset:3072
 v_mfma_f32_16x16x32_bf16 v[56:59], v[144:147], a[152:155], v[56:59]
 ds_read_b128 v[124:127], v8 offset:52224
 v_mfma_f32_16x16x32_bf16 v[56:59], v[148:151], a[224:227], v[56:59]
 ds_read_b128 v[128:131], v8 offset:4096
 v_mfma_f32_16x16x32_bf16 v[60:63], v[144:147], a[156:159], v[60:63]
 ds_read_b128 v[132:135], v8 offset:53248
 v_mfma_f32_16x16x32_bf16 v[60:63], v[148:151], a[228:231], v[60:63]
 s_cmp_eq_u32 s64, 0x10101
 s_cbranch_scc0 Lsp_g11p2
Lrt_g11p2:
 s_mul_i32 s85, s83, 12288
 v_mfma_f32_16x16x32_bf16 v[64:67], v[152:155], a[152:155], v[64:67]
 ds_read_b128 v[136:139], v8 offset:5120
 s_add_u32 s85, s85, s87
 v_mfma_f32_16x16x32_bf16 v[64:67], v[156:159], a[224:227], v[64:67]
 buffer_load_dwordx4 a[0:3], v19, s[16:19], s85 offen sc1
 v_mfma_f32_16x16x32_bf16 v[68:71], v[152:155], a[156:159], v[68:71]
 ds_read_b128 v[140:143], v8 offset:54272
 s_waitcnt lgkmcnt(6)
 v_mfma_f32_16x16x32_bf16 v[68:71], v[156:159], a[228:231], v[68:71]
 buffer_load_dwordx4 a[4:7], v7, s[16:19], s85 offen sc1
 v_mfma_f32_16x16x32_bf16 v[224:227], v[96:99], v[160:163], v[224:227]
 ds_read_b128 v[144:147], v8 offset:6144
 v_mfma_f32_16x16x32_bf16 v[224:227], v[100:103], v[168:171], v[224:227]
 v_mfma_f32_16x16x32_bf16 v[228:231], v[96:99], v[164:167], v[228:231]
 ds_read_b128 v[148:151], v8 offset:55296
 v_mfma_f32_16x16x32_bf16 v[228:231], v[100:103], v[172:175], v[228:231]
 buffer_load_dwordx4 a[72:75], v19, s[16:19], s85 offen offset:1024 sc1
 v_mfma_f32_16x16x32_bf16 v[232:235], v[104:107], v[160:163], v[232:235]
 ds_read_b128 v[152:155], v8 offset:7168
 v_mfma_f32_16x16x32_bf16 v[232:235], v[108:111], v[168:171], v[232:235]
 v_mfma_f32_16x16x32_bf16 v[236:239], v[104:107], v[164:167], v[236:239]
 ds_read_b128 v[156:159], v8 offset:56320
 v_mfma_f32_16x16x32_bf16 v[236:239], v[108:111], v[172:175], v[236:239]
 buffer_load_dwordx4 a[76:79], v7, s[16:19], s85 offen offset:1024 sc1
 v_mfma_f32_16x16x32_bf16 v[240:243], v[112:115], v[160:163], v[240:243]
 ds_read_b128 v[96:99], v8 offset:8192
 v_mfma_f32_16x16x32_bf16 v[240:243], v[116:119], v[168:171], v[240:243]
 v_mfma_f32_16x16x32_bf16 v[244:247], v[112:115], v[164:167], v[244:247]
 ds_read_b128 v[100:103], v8 offset:57344
 s_waitcnt lgkmcnt(4)
 v_mfma_f32_16x16x32_bf16 v[244:247], v[116:119], v[172:175], v[244:247]
 buffer_load_dwordx4 a[144:147], v19, s[16:19], s85 offen offset:2048 sc1
 v_mfma_f32_16x16x32_bf16 v[248:251], v[120:123], v[160:163], v[248:251]
 ds_read_b128 v[104:107], v9 offset:0
 v_mfma_f32_16x16x32_bf16 v[248:251], v[124:127], v[168:171], v[248:251]
 v_mfma_f32_16x16x32_bf16 v[252:255], v[120:123], v[164:167], v[252:255]
 ds_read_b128 v[108:111], v9 offset:9216
 v_mfma_f32_16x16x32_bf16 v[252:255], v[124:127], v[172:175], v[252:255]
 v_mfma_f32_16x16x32_bf16 v[32:35], v[128:131], v[160:163], v[32:35]
 ds_read_b128 v[112:115], v9 offset:1024
 v_mfma_f32_16x16x32_bf16 v[32:35], v[132:135], v[168:171], v[32:35]
 buffer_load_dwordx4 a[148:151], v7, s[16:19], s85 offen offset:2048 sc1
 v_mfma_f32_16x16x32_bf16 v[36:39], v[128:131], v[164:167], v[36:39]
 ds_read_b128 v[116:119], v9 offset:10240
 v_mfma_f32_16x16x32_bf16 v[36:39], v[132:135], v[172:175], v[36:39]
 v_mfma_f32_16x16x32_bf16 v[40:43], v[136:139], v[160:163], v[40:43]
 ds_read_b128 v[120:123], v9 offset:2048
 v_mfma_f32_16x16x32_bf16 v[40:43], v[140:143], v[168:171], v[40:43]
 buffer_load_dwordx4 a[216:219], v19, s[16:19], s85 offen offset:3072 sc1
 v_mfma_f32_16x16x32_bf16 v[44:47], v[136:139], v[164:167], v[44:47]
 ds_read_b128 v[124:127], v9 offset:11264
 v_mfma_f32_16x16x32_bf16 v[44:47], v[140:143], v[172:175], v[44:47]
 v_mfma_f32_16x16x32_bf16 v[48:51], v[144:147], v[160:163], v[48:51]
 ds_read_b128 v[128:131], v9 offset:3072
 v_mfma_f32_16x16x32_bf16 v[48:51], v[148:151], v[168:171], v[48:51]
 buffer_load_dwordx4 a[220:223], v7, s[16:19], s85 offen offset:3072 sc1
 s_add_u32 s84, s84, s31
 v_mfma_f32_16x16x32_bf16 v[52:55], v[144:147], v[164:167], v[52:55]
 ds_read_b128 v[132:135], v9 offset:12288
 s_waitcnt lgkmcnt(4)
 v_mfma_f32_16x16x32_bf16 v[52:55], v[148:151], v[172:175], v[52:55]
 s_add_u32 m0, s56, 0
 v_mfma_f32_16x16x32_bf16 v[56:59], v[152:155], v[160:163], v[56:59]
 ds_read_b128 v[136:139], v9 offset:4096
 v_mfma_f32_16x16x32_bf16 v[56:59], v[156:159], v[168:171], v[56:59]
 buffer_load_dwordx4 v19, s[16:19], s84 offen sc1 lds
 v_mfma_f32_16x16x32_bf16 v[60:63], v[152:155], v[164:167], v[60:63]
 ds_read_b128 v[140:143], v9 offset:13312
 v_mfma_f32_16x16x32_bf16 v[60:63], v[156:159], v[172:175], v[60:63]
 v_mfma_f32_16x16x32_bf16 v[64:67], v[96:99], v[160:163], v[64:67]
 ds_read_b128 v[144:147], v9 offset:5120
 v_mfma_f32_16x16x32_bf16 v[64:67], v[100:103], v[168:171], v[64:67]
 buffer_load_dwordx4 v19, s[16:19], s84 offen offset:1024 sc1 lds
 v_mfma_f32_16x16x32_bf16 v[68:71], v[96:99], v[164:167], v[68:71]
 ds_read_b128 v[148:151], v9 offset:14336
 v_mfma_f32_16x16x32_bf16 v[68:71], v[100:103], v[172:175], v[68:71]
 v_mfma_f32_16x16x32_bf16 v[224:227], v[104:107], v[176:179], v[224:227]
 ds_read_b128 v[152:155], v9 offset:6144
 v_mfma_f32_16x16x32_bf16 v[224:227], v[108:111], v[184:187], v[224:227]
 v_mfma_f32_16x16x32_bf16 v[228:231], v[104:107], v[180:183], v[228:231]
 ds_read_b128 v[156:159], v9 offset:15360
 v_mfma_f32_16x16x32_bf16 v[228:231], v[108:111], v[188:191], v[228:231]
 buffer_load_dwordx4 v19, s[16:19], s84 offen offset:2048 sc1 lds
 v_mfma_f32_16x16x32_bf16 v[232:235], v[112:115], v[176:179], v[232:235]
 ds_read_b128 v[96:99], v9 offset:7168
 v_mfma_f32_16x16x32_bf16 v[232:235], v[116:119], v[184:187], v[232:235]
 v_mfma_f32_16x16x32_bf16 v[236:239], v[112:115], v[180:183], v[236:239]
 ds_read_b128 v[100:103], v9 offset:16384
 s_waitcnt lgkmcnt(4)
 v_mfma_f32_16x16x32_bf16 v[236:239], v[116:119], v[188:191], v[236:239]
 buffer_load_dwordx4 v19, s[16:19], s84 offen offset:3072 sc1 lds
 s_add_u32 m0, m0, s30
 v_mfma_f32_16x16x32_bf16 v[240:243], v[120:123], v[176:179], v[240:243]
 ds_read_b128 v[104:107], v9 offset:8192
 v_mfma_f32_16x16x32_bf16 v[240:243], v[124:127], v[184:187], v[240:243]
 v_mfma_f32_16x16x32_bf16 v[244:247], v[120:123], v[180:183], v[244:247]
 ds_read_b128 v[108:111], v9 offset:17408
 v_mfma_f32_16x16x32_bf16 v[244:247], v[124:127], v[188:191], v[244:247]
 buffer_load_dwordx4 v5, s[16:19], s84 offen sc1 lds
 v_mfma_f32_16x16x32_bf16 v[248:251], v[128:131], v[176:179], v[248:251]
 v_mfma_f32_16x16x32_bf16 v[248:251], v[132:135], v[184:187], v[248:251]
 v_mfma_f32_16x16x32_bf16 v[252:255], v[128:131], v[180:183], v[252:255]
 v_mfma_f32_16x16x32_bf16 v[252:255], v[132:135], v[188:191], v[252:255]
 buffer_load_dwordx4 v5, s[16:19], s84 offen offset:1024 sc1 lds
 v_mfma_f32_16x16x32_bf16 v[32:35], v[136:139], v[176:179], v[32:35]
 v_mfma_f32_16x16x32_bf16 v[32:35], v[140:143], v[184:187], v[32:35]
 v_mfma_f32_16x16x32_bf16 v[36:39], v[136:139], v[180:183], v[36:39]
 v_mfma_f32_16x16x32_bf16 v[36:39], v[140:143], v[188:191], v[36:39]
 buffer_load_dwordx4 v5, s[16:19], s84 offen offset:2048 sc1 lds
 v_mfma_f32_16x16x32_bf16 v[40:43], v[144:147], v[176:179], v[40:43]
 s_waitcnt vmcnt(24) lgkmcnt(0)
 s_barrier
 v_mfma_f32_16x16x32_bf16 v[40:43], v[148:151], v[184:187], v[40:43]
 ds_read_b128 v[112:115], v26 offset:0
 v_mfma_f32_16x16x32_bf16 v[44:47], v[144:147], v[180:183], v[44:47]
 ds_read_b128 v[116:119], v26 offset:9216
 v_mfma_f32_16x16x32_bf16 v[44:47], v[148:151], v[188:191], v[44:47]
 ds_read_b128 v[120:123], v26 offset:1024
 v_mfma_f32_16x16x32_bf16 v[48:51], v[152:155], v[176:179], v[48:51]
 ds_read_b128 v[124:127], v26 offset:10240
 v_mfma_f32_16x16x32_bf16 v[48:51], v[156:159], v[184:187], v[48:51]
 ds_read_b128 v[128:131], v26 offset:2048
 v_mfma_f32_16x16x32_bf16 v[52:55], v[152:155], v[180:183], v[52:55]
 ds_read_b128 v[132:135], v26 offset:11264
 v_mfma_f32_16x16x32_bf16 v[52:55], v[156:159], v[188:191], v[52:55]
 ds_read_b128 v[136:139], v26 offset:3072
 v_mfma_f32_16x16x32_bf16 v[56:59], v[96:99], v[176:179], v[56:59]
 ds_read_b128 v[140:143], v26 offset:12288
 v_mfma_f32_16x16x32_bf16 v[56:59], v[100:103], v[184:187], v[56:59]
 ds_read_b128 v[144:147], v26 offset:4096
 v_mfma_f32_16x16x32_bf16 v[60:63], v[96:99], v[180:183], v[60:63]
 ds_read_b128 v[148:151], v26 offset:13312
 v_mfma_f32_16x16x32_bf16 v[60:63], v[100:103], v[188:191], v[60:63]
 buffer_load_dwordx4 v5, s[16:19], s84 offen offset:3072 sc1 lds
 s_add_u32 m0, m0, s30
 v_mfma_f32_16x16x32_bf16 v[64:67], v[104:107], v[176:179], v[64:67]
 ds_read_b128 v[152:155], v26 offset:5120
 v_mfma_f32_16x16x32_bf16 v[64:67], v[108:111], v[184:187], v[64:67]
 buffer_load_dwordx4 v6, s[16:19], s84 offen sc1 lds
 s_add_u32 s85, s85, s30
 v_mfma_f32_16x16x32_bf16 v[68:71], v[104:107], v[180:183], v[68:71]
 ds_read_b128 v[156:159], v26 offset:14336
 s_waitcnt lgkmcnt(6)
 v_mfma_f32_16x16x32_bf16 v[68:71], v[108:111], v[188:191], v[68:71]
 buffer_load_dwordx4 a[8:11], v19, s[16:19], s85 offen sc1
 v_mfma_f32_16x16x32_bf16 v[224:227], v[112:115], v[192:195], v[224:227]
 ds_read_b128 v[96:99], v26 offset:6144
 v_mfma_f32_16x16x32_bf16 v[224:227], v[116:119], v[200:203], v[224:227]
 buffer_load_dwordx4 a[12:15], v7, s[16:19], s85 offen sc1
 v_mfma_f32_16x16x32_bf16 v[228:231], v[112:115], v[196:199], v[228:231]
 ds_read_b128 v[100:103], v26 offset:15360
 v_mfma_f32_16x16x32_bf16 v[228:231], v[116:119], v[204:207], v[228:231]
 v_mfma_f32_16x16x32_bf16 v[232:235], v[120:123], v[192:195], v[232:235]
 ds_read_b128 v[104:107], v26 offset:7168
 v_mfma_f32_16x16x32_bf16 v[232:235], v[124:127], v[200:203], v[232:235]
 v_mfma_f32_16x16x32_bf16 v[236:239], v[120:123], v[196:199], v[236:239]
 ds_read_b128 v[108:111], v26 offset:16384
 v_mfma_f32_16x16x32_bf16 v[236:239], v[124:127], v[204:207], v[236:239]
 buffer_load_dwordx4 a[80:83], v19, s[16:19], s85 offen offset:1024 sc1
 v_mfma_f32_16x16x32_bf16 v[240:243], v[128:131], v[192:195], v[240:243]
 ds_read_b128 v[112:115], v26 offset:8192
 v_mfma_f32_16x16x32_bf16 v[240:243], v[132:135], v[200:203], v[240:243]
 v_mfma_f32_16x16x32_bf16 v[244:247], v[128:131], v[196:199], v[244:247]
 ds_read_b128 v[116:119], v26 offset:17408
 s_waitcnt lgkmcnt(4)
 v_mfma_f32_16x16x32_bf16 v[244:247], v[132:135], v[204:207], v[244:247]
 buffer_load_dwordx4 a[84:87], v7, s[16:19], s85 offen offset:1024 sc1
 v_mfma_f32_16x16x32_bf16 v[248:251], v[136:139], v[192:195], v[248:251]
 ds_read_b128 v[120:123], v26 offset:18432
 v_mfma_f32_16x16x32_bf16 v[248:251], v[140:143], v[200:203], v[248:251]
 v_mfma_f32_16x16x32_bf16 v[252:255], v[136:139], v[196:199], v[252:255]
 ds_read_b128 v[124:127], v26 offset:27648
 v_mfma_f32_16x16x32_bf16 v[252:255], v[140:143], v[204:207], v[252:255]
 buffer_load_dwordx4 a[152:155], v19, s[16:19], s85 offen offset:2048 sc1
 v_mfma_f32_16x16x32_bf16 v[32:35], v[144:147], v[192:195], v[32:35]
 ds_read_b128 v[128:131], v26 offset:19456
 v_mfma_f32_16x16x32_bf16 v[32:35], v[148:151], v[200:203], v[32:35]
 v_mfma_f32_16x16x32_bf16 v[36:39], v[144:147], v[196:199], v[36:39]
 ds_read_b128 v[132:135], v26 offset:28672
 v_mfma_f32_16x16x32_bf16 v[36:39], v[148:151], v[204:207], v[36:39]
 buffer_load_dwordx4 a[156:159], v7, s[16:19], s85 offen offset:2048 sc1
 v_mfma_f32_16x16x32_bf16 v[40:43], v[152:155], v[192:195], v[40:43]
 ds_read_b128 v[136:139], v26 offset:20480
 v_mfma_f32_16x16x32_bf16 v[40:43], v[156:159], v[200:203], v[40:43]
 v_mfma_f32_16x16x32_bf16 v[44:47], v[152:155], v[196:199], v[44:47]
 ds_read_b128 v[140:143], v26 offset:29696
 v_mfma_f32_16x16x32_bf16 v[44:47], v[156:159], v[204:207], v[44:47]
 buffer_load_dwordx4 a[224:227], v19, s[16:19], s85 offen offset:3072 sc1
 v_mfma_f32_16x16x32_bf16 v[48:51], v[96:99], v[192:195], v[48:51]
 ds_read_b128 v[144:147], v26 offset:21504
 v_mfma_f32_16x16x32_bf16 v[48:51], v[100:103], v[200:203], v[48:51]
 v_mfma_f32_16x16x32_bf16 v[52:55], v[96:99], v[196:199], v[52:55]
 ds_read_b128 v[148:151], v26 offset:30720
 s_waitcnt lgkmcnt(4)
 v_mfma_f32_16x16x32_bf16 v[52:55], v[100:103], v[204:207], v[52:55]
 v_mfma_f32_16x16x32_bf16 v[56:59], v[104:107], v[192:195], v[56:59]
 ds_read_b128 v[152:155], v26 offset:22528
 v_mfma_f32_16x16x32_bf16 v[56:59], v[108:111], v[200:203], v[56:59]
 buffer_load_dwordx4 a[228:231], v7, s[16:19], s85 offen offset:3072 sc1
 s_add_u32 s84, s84, s31
 v_mfma_f32_16x16x32_bf16 v[60:63], v[104:107], v[196:199], v[60:63]
 ds_read_b128 v[156:159], v26 offset:31744
 s_add_u32 m0, s55, 0
 v_mfma_f32_16x16x32_bf16 v[60:63], v[108:111], v[204:207], v[60:63]
 v_mfma_f32_16x16x32_bf16 v[64:67], v[112:115], v[192:195], v[64:67]
 ds_read_b128 v[96:99], v26 offset:23552
 v_mfma_f32_16x16x32_bf16 v[64:67], v[116:119], v[200:203], v[64:67]
 buffer_load_dwordx4 v19, s[16:19], s84 offen sc1 lds
 v_mfma_f32_16x16x32_bf16 v[68:71], v[112:115], v[196:199], v[68:71]
 ds_read_b128 v[100:103], v26 offset:32768
 v_mfma_f32_16x16x32_bf16 v[68:71], v[116:119], v[204:207], v[68:71]
 v_mfma_f32_16x16x32_bf16 v[224:227], v[120:123], v[208:211], v[224:227]
 ds_read_b128 v[104:107], v26 offset:24576
 v_mfma_f32_16x16x32_bf16 v[224:227], v[124:127], v[216:219], v[224:227]
 buffer_load_dwordx4 v19, s[16:19], s84 offen offset:1024 sc1 lds
 v_mfma_f32_16x16x32_bf16 v[228:231], v[120:123], v[212:215], v[228:231]
 ds_read_b128 v[108:111], v26 offset:33792
 v_mfma_f32_16x16x32_bf16 v[228:231], v[124:127], v[220:223], v[228:231]
 v_mfma_f32_16x16x32_bf16 v[232:235], v[128:131], v[208:211], v[232:235]
 ds_read_b128 v[112:115], v26 offset:25600
 v_mfma_f32_16x16x32_bf16 v[232:235], v[132:135], v[216:219], v[232:235]
 buffer_load_dwordx4 v19, s[16:19], s84 offen offset:2048 sc1 lds
 v_mfma_f32_16x16x32_bf16 v[236:239], v[128:131], v[212:215], v[236:239]
 ds_read_b128 v[116:119], v26 offset:34816
 s_waitcnt lgkmcnt(4)
 v_mfma_f32_16x16x32_bf16 v[236:239], v[132:135], v[220:223], v[236:239]
 v_mfma_f32_16x16x32_bf16 v[240:243], v[136:139], v[208:211], v[240:243]
 ds_read_b128 v[120:123], v26 offset:26624
 v_mfma_f32_16x16x32_bf16 v[240:243], v[140:143], v[216:219], v[240:243]
 buffer_load_dwordx4 v19, s[16:19], s84 offen offset:3072 sc1 lds
 s_add_u32 m0, m0, s30
 v_mfma_f32_16x16x32_bf16 v[244:247], v[136:139], v[212:215], v[244:247]
 ds_read_b128 v[124:127], v26 offset:35840
 v_mfma_f32_16x16x32_bf16 v[244:247], v[140:143], v[220:223], v[244:247]
 v_mfma_f32_16x16x32_bf16 v[248:251], v[144:147], v[208:211], v[248:251]
 v_mfma_f32_16x16x32_bf16 v[248:251], v[148:151], v[216:219], v[248:251]
 v_mfma_f32_16x16x32_bf16 v[252:255], v[144:147], v[212:215], v[252:255]
 buffer_load_dwordx4 v5, s[16:19], s84 offen sc1 lds
 v_mfma_f32_16x16x32_bf16 v[252:255], v[148:151], v[220:223], v[252:255]
 v_mfma_f32_16x16x32_bf16 v[32:35], v[152:155], v[208:211], v[32:35]
 v_mfma_f32_16x16x32_bf16 v[32:35], v[156:159], v[216:219], v[32:35]
 v_mfma_f32_16x16x32_bf16 v[36:39], v[152:155], v[212:215], v[36:39]
 buffer_load_dwordx4 v5, s[16:19], s84 offen offset:1024 sc1 lds
 v_mfma_f32_16x16x32_bf16 v[36:39], v[156:159], v[220:223], v[36:39]
 v_mfma_f32_16x16x32_bf16 v[40:43], v[96:99], v[208:211], v[40:43]
 s_waitcnt vmcnt(23) lgkmcnt(0)
 s_barrier
 v_mfma_f32_16x16x32_bf16 v[40:43], v[100:103], v[216:219], v[40:43]
 ds_read_b128 v[128:131], v27 offset:0
 v_mfma_f32_16x16x32_bf16 v[44:47], v[96:99], v[212:215], v[44:47]
 ds_read_b128 v[132:135], v27 offset:9216
 v_mfma_f32_16x16x32_bf16 v[44:47], v[100:103], v[220:223], v[44:47]
 ds_read_b128 v[136:139], v27 offset:1024
 v_mfma_f32_16x16x32_bf16 v[48:51], v[104:107], v[208:211], v[48:51]
 ds_read_b128 v[140:143], v27 offset:10240
 v_mfma_f32_16x16x32_bf16 v[48:51], v[108:111], v[216:219], v[48:51]
 ds_read_b128 v[144:147], v27 offset:2048
 v_mfma_f32_16x16x32_bf16 v[52:55], v[104:107], v[212:215], v[52:55]
Lpg8:
 s_cbranch_vccnz Lj_Lfin
 ds_read_b128 v[148:151], v27 offset:11264
 v_mfma_f32_16x16x32_bf16 v[52:55], v[108:111], v[220:223], v[52:55]
 ds_read_b128 v[152:155], v27 offset:3072
 v_mfma_f32_16x16x32_bf16 v[56:59], v[112:115], v[208:211], v[56:59]
 ds_read_b128 v[156:159], v27 offset:12288
 v_mfma_f32_16x16x32_bf16 v[56:59], v[116:119], v[216:219], v[56:59]
 ds_read_b128 v[96:99], v27 offset:4096
 v_mfma_f32_16x16x32_bf16 v[60:63], v[112:115], v[212:215], v[60:63]
 ds_read_b128 v[100:103], v27 offset:13312
 v_mfma_f32_16x16x32_bf16 v[60:63], v[116:119], v[220:223], v[60:63]
 buffer_load_dwordx4 v5, s[16:19], s84 offen offset:2048 sc1 lds
 v_mfma_f32_16x16x32_bf16 v[64:67], v[120:123], v[208:211], v[64:67]
 ds_read_b128 v[104:107], v27 offset:5120
 v_mfma_f32_16x16x32_bf16 v[64:67], v[124:127], v[216:219], v[64:67]
 buffer_load_dwordx4 v5, s[16:19], s84 offen offset:3072 sc1 lds
 s_add_u32 m0, m0, s30
 v_mfma_f32_16x16x32_bf16 v[68:71], v[120:123], v[212:215], v[68:71]
 ds_read_b128 v[108:111], v27 offset:14336
 s_waitcnt lgkmcnt(6)
 v_mfma_f32_16x16x32_bf16 v[68:71], v[124:127], v[220:223], v[68:71]
 buffer_load_dwordx4 v6, s[16:19], s84 offen sc1 lds
 s_add_u32 s85, s85, s30
 v_mfma_f32_16x16x32_bf16 v[224:227], v[128:131], a[0:3], v[224:227]
 ds_read_b128 v[112:115], v27 offset:6144
 v_mfma_f32_16x16x32_bf16 v[224:227], v[132:135], a[72:75], v[224:227]
 buffer_load_dwordx4 v[160:163], v19, s[16:19], s85 offen sc1
 v_mfma_f32_16x16x32_bf16 v[228:231], v[128:131], a[4:7], v[228:231]
 ds_read_b128 v[116:119], v27 offset:15360
 v_mfma_f32_16x16x32_bf16 v[228:231], v[132:135], a[76:79], v[228:231]
 v_mfma_f32_16x16x32_bf16 v[232:235], v[136:139], a[0:3], v[232:235]
 ds_read_b128 v[120:123], v27 offset:7168
 v_mfma_f32_16x16x32_bf16 v[232:235], v[140:143], a[72:75], v[232:235]
 v_mfma_f32_16x16x32_bf16 v[236:239], v[136:139], a[4:7], v[236:239]
 ds_read_b128 v[124:127], v27 offset:16384
 v_mfma_f32_16x16x32_bf16 v[236:239], v[140:143], a[76:79], v[236:239]
 buffer_load_dwordx4 v[164:167], v7, s[16:19], s85 offen sc1
 v_mfma_f32_16x16x32_bf16 v[240:243], v[144:147], a[0:3], v[240:243]
 ds_read_b128 v[128:131], v27 offset:8192
 v_mfma_f32_16x16x32_bf16 v[240:243], v[148:151], a[72:75], v[240:243]
 v_mfma_f32_16x16x32_bf16 v[244:247], v[144:147], a[4:7], v[244:247]
 ds_read_b128 v[132:135], v27 offset:17408
 s_waitcnt lgkmcnt(4)
 v_mfma_f32_16x16x32_bf16 v[244:247], v[148:151], a[76:79], v[244:247]
 buffer_load_dwordx4 v[168:171], v19, s[16:19], s85 offen offset:1024 sc1
 v_mfma_f32_16x16x32_bf16 v[248:251], v[152:155], a[0:3], v[248:251]
 ds_read_b128 v[136:139], v27 offset:18432
 v_mfma_f32_16x16x32_bf16 v[248:251], v[156:159], a[72:75], v[248:251]
 v_mfma_f32_16x16x32_bf16 v[252:255], v[152:155], a[4:7], v[252:255]
 ds_read_b128 v[140:143], v27 offset:27648
 v_mov_b32 v20, -1
 v_mfma_f32_16x16x32_bf16 v[252:255], v[156:159], a[76:79], v[252:255]
 buffer_load_dwordx4 v[172:175], v7, s[16:19], s85 offen offset:1024 sc1
 v_mov_b32 v21, -1
 v_mfma_f32_16x16x32_bf16 v[32:35], v[96:99], a[0:3], v[32:35]
 ds_read_b128 v[144:147], v27 offset:19456
 v_mov_b32 v22, -1
 v_mfma_f32_16x16x32_bf16 v[32:35], v[100:103], a[72:75], v[32:35]
 v_mov_b32 v23, -1
 v_mfma_f32_16x16x32_bf16 v[36:39], v[96:99], a[4:7], v[36:39]
 ds_read_b128 v[148:151], v27 offset:28672
 v_mfma_f32_16x16x32_bf16 v[36:39], v[100:103], a[76:79], v[36:39]
 buffer_load_dwordx4 v[176:179], v19, s[16:19], s85 offen offset:2048 sc1
 v_mfma_f32_16x16x32_bf16 v[40:43], v[104:107], a[0:3], v[40:43]
 ds_read_b128 v[152:155], v27 offset:20480
 v_mfma_f32_16x16x32_bf16 v[40:43], v[108:111], a[72:75], v[40:43]
 v_mfma_f32_16x16x32_bf16 v[44:47], v[104:107], a[4:7], v[44:47]
 ds_read_b128 v[156:159], v27 offset:29696
 v_mfma_f32_16x16x32_bf16 v[44:47], v[108:111], a[76:79], v[44:47]
 buffer_load_dwordx4 v[180:183], v7, s[16:19], s85 offen offset:2048 sc1
 v_mfma_f32_16x16x32_bf16 v[48:51], v[112:115], a[0:3], v[48:51]
 ds_read_b128 v[96:99], v27 offset:21504
 v_mfma_f32_16x16x32_bf16 v[48:51], v[116:119], a[72:75], v[48:51]
 v_mfma_f32_16x16x32_bf16 v[52:55], v[112:115], a[4:7], v[52:55]
 ds_read_b128 v[100:103], v27 offset:30720
 s_waitcnt lgkmcnt(4)
 v_mfma_f32_16x16x32_bf16 v[52:55], v[116:119], a[76:79], v[52:55]
 v_mfma_f32_16x16x32_bf16 v[56:59], v[120:123], a[0:3], v[56:59]
 ds_read_b128 v[104:107], v27 offset:22528
 v_mfma_f32_16x16x32_bf16 v[56:59], v[124:127], a[72:75], v[56:59]
 buffer_load_dwordx4 v[184:187], v19, s[16:19], s85 offen offset:3072 sc1
 v_mfma_f32_16x16x32_bf16 v[60:63], v[120:123], a[4:7], v[60:63]
 ds_read_b128 v[108:111], v27 offset:31744
 v_mfma_f32_16x16x32_bf16 v[60:63], v[124:127], a[76:79], v[60:63]
 v_mfma_f32_16x16x32_bf16 v[64:67], v[128:131], a[0:3], v[64:67]
 ds_read_b128 v[112:115], v27 offset:23552
 v_mfma_f32_16x16x32_bf16 v[64:67], v[132:135], a[72:75], v[64:67]
 buffer_load_dwordx4 v[188:191], v7, s[16:19], s85 offen offset:3072 sc1
 v_mfma_f32_16x16x32_bf16 v[68:71], v[128:131], a[4:7], v[68:71]
 ds_read_b128 v[116:119], v27 offset:32768
 v_mfma_f32_16x16x32_bf16 v[68:71], v[132:135], a[76:79], v[68:71]
 v_mfma_f32_16x16x32_bf16 v[224:227], v[136:139], a[144:147], v[224:227]
 ds_read_b128 v[120:123], v27 offset:24576
 v_mfma_f32_16x16x32_bf16 v[224:227], v[140:143], a[216:219], v[224:227]
 buffer_store_dwordx4 v[20:23], v19, s[16:19], s77 offen offset:2048 sc1
 v_mfma_f32_16x16x32_bf16 v[228:231], v[136:139], a[148:151], v[228:231]
 ds_read_b128 v[124:127], v27 offset:33792
 v_mfma_f32_16x16x32_bf16 v[228:231], v[140:143], a[220:223], v[228:231]
 v_mfma_f32_16x16x32_bf16 v[232:235], v[144:147], a[144:147], v[232:235]
 ds_read_b128 v[128:131], v27 offset:25600
 v_mfma_f32_16x16x32_bf16 v[232:235], v[148:151], a[216:219], v[232:235]
 buffer_store_dwordx4 v[20:23], v19, s[16:19], s77 offen offset:3072 sc1
 v_mfma_f32_16x16x32_bf16 v[236:239], v[144:147], a[148:151], v[236:239]
 ds_read_b128 v[132:135], v27 offset:34816
 s_waitcnt lgkmcnt(4)
 v_mfma_f32_16x16x32_bf16 v[236:239], v[148:151], a[220:223], v[236:239]
 v_mfma_f32_16x16x32_bf16 v[240:243], v[152:155], a[144:147], v[240:243]
 ds_read_b128 v[136:139], v27 offset:26624
 v_mfma_f32_16x16x32_bf16 v[240:243], v[156:159], a[216:219], v[240:243]
 buffer_store_dwordx4 v[20:23], v5, s[16:19], s77 offen sc1
 v_mfma_f32_16x16x32_bf16 v[244:247], v[152:155], a[148:151], v[244:247]
 ds_read_b128 v[140:143], v27 offset:35840
 s_mov_b32 s35, 0xffff0000
 v_mfma_f32_16x16x32_bf16 v[244:247], v[156:159], a[220:223], v[244:247]
 v_mfma_f32_16x16x32_bf16 v[248:251], v[96:99], a[144:147], v[248:251]
 s_mov_b64 s[12:13], s[4:5]
 v_mfma_f32_16x16x32_bf16 v[248:251], v[100:103], a[216:219], v[248:251]
 buffer_store_dwordx4 v[20:23], v5, s[16:19], s77 offen offset:1024 sc1
 v_mfma_f32_16x16x32_bf16 v[252:255], v[96:99], a[148:151], v[252:255]
 s_mov_b32 s14, 2359296
 v_mfma_f32_16x16x32_bf16 v[252:255], v[100:103], a[220:223], v[252:255]
 v_mfma_f32_16x16x32_bf16 v[32:35], v[104:107], a[144:147], v[32:35]
 s_mov_b32 s15, 0x20000
 v_mfma_f32_16x16x32_bf16 v[32:35], v[108:111], a[216:219], v[32:35]
 buffer_store_dwordx4 v[20:23], v5, s[16:19], s77 offen offset:2048 sc1
 v_mfma_f32_16x16x32_bf16 v[36:39], v[104:107], a[148:151], v[36:39]
 v_mfma_f32_16x16x32_bf16 v[36:39], v[108:111], a[220:223], v[36:39]
 s_lshl_b32 s32, s24, 11
 v_mfma_f32_16x16x32_bf16 v[40:43], v[112:115], a[144:147], v[40:43]
 s_waitcnt vmcnt(22) lgkmcnt(0)
 s_barrier
 v_mfma_f32_16x16x32_bf16 v[40:43], v[116:119], a[216:219], v[40:43]
 ds_read_b128 v[144:147], v28 offset:0
 s_lshl_b32 s33, s24, 8
 v_mfma_f32_16x16x32_bf16 v[44:47], v[112:115], a[148:151], v[44:47]
 ds_read_b128 v[148:151], v28 offset:9216
 v_mfma_f32_16x16x32_bf16 v[44:47], v[116:119], a[220:223], v[44:47]
 ds_read_b128 v[152:155], v28 offset:1024
 s_add_u32 s33, s33, 8192
 v_mfma_f32_16x16x32_bf16 v[48:51], v[120:123], a[144:147], v[48:51]
 ds_read_b128 v[156:159], v28 offset:10240
 v_mfma_f32_16x16x32_bf16 v[48:51], v[124:127], a[216:219], v[48:51]
 ds_read_b128 v[96:99], v28 offset:2048
 s_lshl_b32 s36, s24, 3
 v_mfma_f32_16x16x32_bf16 v[52:55], v[120:123], a[148:151], v[52:55]
 ds_read_b128 v[100:103], v28 offset:11264
 v_mfma_f32_16x16x32_bf16 v[52:55], v[124:127], a[220:223], v[52:55]
 ds_read_b128 v[104:107], v28 offset:3072
 v_mfma_f32_16x16x32_bf16 v[56:59], v[128:131], a[144:147], v[56:59]
 ds_read_b128 v[108:111], v28 offset:12288
 s_lshl_b32 s37, s24, 6
 v_mfma_f32_16x16x32_bf16 v[56:59], v[132:135], a[216:219], v[56:59]
 ds_read_b128 v[112:115], v28 offset:4096
 v_mfma_f32_16x16x32_bf16 v[60:63], v[128:131], a[148:151], v[60:63]
 ds_read_b128 v[116:119], v28 offset:13312
 v_lshlrev_b32 v19, 4, v0
 v_mfma_f32_16x16x32_bf16 v[60:63], v[132:135], a[220:223], v[60:63]
 buffer_store_dwordx4 v[20:23], v5, s[16:19], s77 offen offset:3072 sc1
 v_mfma_f32_16x16x32_bf16 v[64:67], v[136:139], a[144:147], v[64:67]
 ds_read_b128 v[120:123], v28 offset:5120
 s_load_dwordx4 s[40:43], s[88:89], s61 offset:0
 v_mfma_f32_16x16x32_bf16 v[64:67], v[140:143], a[216:219], v[64:67]
 v_mov_b32 v29, 0
 v_mfma_f32_16x16x32_bf16 v[68:71], v[136:139], a[148:151], v[68:71]
 ds_read_b128 v[124:127], v28 offset:14336
 s_waitcnt lgkmcnt(8)
 v_mfma_f32_16x16x32_bf16 v[68:71], v[140:143], a[220:223], v[68:71]
 v_mov_b32 v30, 1
 v_mfma_f32_16x16x32_bf16 v[224:227], v[144:147], a[8:11], v[224:227]
 ds_read_b128 v[128:131], v28 offset:6144
 v_mfma_f32_16x16x32_bf16 v[224:227], v[148:151], a[80:83], v[224:227]
 v_min_u32 v31, 2, v0
 v_mfma_f32_16x16x32_bf16 v[228:231], v[144:147], a[12:15], v[228:231]
 ds_read_b128 v[132:135], v28 offset:15360
 v_mfma_f32_16x16x32_bf16 v[228:231], v[148:151], a[84:87], v[228:231]
 v_add3_u32 v31, v31, 1, s49
 v_mfma_f32_16x16x32_bf16 v[232:235], v[152:155], a[8:11], v[232:235]
 ds_read_b128 v[136:139], v28 offset:7168
 v_mfma_f32_16x16x32_bf16 v[232:235], v[156:159], a[80:83], v[232:235]
 v_and_b32 v31, 3, v31
 v_mfma_f32_16x16x32_bf16 v[236:239], v[152:155], a[12:15], v[236:239]
 ds_read_b128 v[140:143], v28 offset:16384
 s_waitcnt lgkmcnt(8)
 v_mfma_f32_16x16x32_bf16 v[236:239], v[156:159], a[84:87], v[236:239]
 v_lshlrev_b32 v31, 7, v31
 v_mfma_f32_16x16x32_bf16 v[240:243], v[96:99], a[8:11], v[240:243]
 ds_read_b128 v[144:147], v28 offset:8192
 v_mfma_f32_16x16x32_bf16 v[240:243], v[100:103], a[80:83], v[240:243]
 buffer_store_dwordx4 v[20:23], v6, s[16:19], s77 offen sc1
 v_mfma_f32_16x16x32_bf16 v[244:247], v[96:99], a[12:15], v[244:247]
 ds_read_b128 v[148:151], v28 offset:17408
 v_and_b32 v10, 15, v0
 v_mfma_f32_16x16x32_bf16 v[244:247], v[100:103], a[84:87], v[244:247]
 v_mfma_f32_16x16x32_bf16 v[248:251], v[104:107], a[8:11], v[248:251]
 ds_read_b128 v[152:155], v28 offset:18432
 v_lshrrev_b32 v12, 4, v0
 v_mfma_f32_16x16x32_bf16 v[248:251], v[108:111], a[80:83], v[248:251]
 v_mfma_f32_16x16x32_bf16 v[252:255], v[104:107], a[12:15], v[252:255]
 ds_read_b128 v[156:159], v28 offset:27648
 s_waitcnt lgkmcnt(8)
 v_mfma_f32_16x16x32_bf16 v[252:255], v[108:111], a[84:87], v[252:255]
 v_mul_u32_u24 v11, 1152, v10
 v_mfma_f32_16x16x32_bf16 v[32:35], v[112:115], a[8:11], v[32:35]
 ds_read_b128 v[96:99], v28 offset:19456
 v_lshl_add_u32 v11, v12, 3, v11
 v_mfma_f32_16x16x32_bf16 v[32:35], v[116:119], a[80:83], v[32:35]
 v_mfma_f32_16x16x32_bf16 v[36:39], v[112:115], a[12:15], v[36:39]
 ds_read_b128 v[100:103], v28 offset:28672
 v_mfma_f32_16x16x32_bf16 v[36:39], v[116:119], a[84:87], v[36:39]
 v_add_u32 v11, s37, v11
 v_mfma_f32_16x16x32_bf16 v[40:43], v[120:123], a[8:11], v[40:43]
 ds_read_b128 v[104:107], v28 offset:20480
 v_mfma_f32_16x16x32_bf16 v[40:43], v[124:127], a[80:83], v[40:43]
 v_add_u32 v12, 18432, v11
 v_mfma_f32_16x16x32_bf16 v[44:47], v[120:123], a[12:15], v[44:47]
 ds_read_b128 v[108:111], v28 offset:29696
 s_waitcnt lgkmcnt(8)
 v_mfma_f32_16x16x32_bf16 v[44:47], v[124:127], a[84:87], v[44:47]
 v_lshlrev_b32 v10, 2, v10
 v_mfma_f32_16x16x32_bf16 v[48:51], v[128:131], a[8:11], v[48:51]
 ds_read_b128 v[112:115], v28 offset:21504
 v_mfma_f32_16x16x32_bf16 v[48:51], v[132:135], a[80:83], v[48:51]
 v_and_b32 v16, 2, v0
 v_mfma_f32_16x16x32_bf16 v[52:55], v[128:131], a[12:15], v[52:55]
 ds_read_b128 v[116:119], v28 offset:30720
 v_mfma_f32_16x16x32_bf16 v[52:55], v[132:135], a[84:87], v[52:55]
 v_mfma_f32_16x16x32_bf16 v[56:59], v[136:139], a[8:11], v[56:59]
 ds_read_b128 v[120:123], v28 offset:22528
 v_lshrrev_b32 v17, 2, v0
 v_mfma_f32_16x16x32_bf16 v[56:59], v[140:143], a[80:83], v[56:59]
 v_mfma_f32_16x16x32_bf16 v[60:63], v[136:139], a[12:15], v[60:63]
 ds_read_b128 v[124:127], v28 offset:31744
 s_waitcnt lgkmcnt(8)
 v_mfma_f32_16x16x32_bf16 v[60:63], v[140:143], a[84:87], v[60:63]
 v_lshl_add_u32 v17, v16, 3, v17
 v_mfma_f32_16x16x32_bf16 v[64:67], v[144:147], a[8:11], v[64:67]
 ds_read_b128 v[128:131], v28 offset:23552
 v_and_b32 v15, 1, v0
 v_mfma_f32_16x16x32_bf16 v[64:67], v[148:151], a[80:83], v[64:67]
 v_mfma_f32_16x16x32_bf16 v[68:71], v[144:147], a[12:15], v[68:71]
 ds_read_b128 v[132:135], v28 offset:32768
 v_lshl_add_u32 v15, v15, 2, s36
 v_mfma_f32_16x16x32_bf16 v[68:71], v[148:151], a[84:87], v[68:71]
 v_mfma_f32_16x16x32_bf16 v[224:227], v[152:155], a[152:155], v[224:227]
 ds_read_b128 v[136:139], v28 offset:24576
 v_mfma_f32_16x16x32_bf16 v[224:227], v[156:159], a[224:227], v[224:227]
 v_mul_u32_u24 v16, 1152, v17
 v_mfma_f32_16x16x32_bf16 v[228:231], v[152:155], a[156:159], v[228:231]
 ds_read_b128 v[140:143], v28 offset:33792
 s_waitcnt lgkmcnt(8)
 v_mfma_f32_16x16x32_bf16 v[228:231], v[156:159], a[228:231], v[228:231]
 v_add_u32 v16, v16, v15
 v_mfma_f32_16x16x32_bf16 v[232:235], v[96:99], a[152:155], v[232:235]
 ds_read_b128 v[144:147], v28 offset:25600
 v_mfma_f32_16x16x32_bf16 v[232:235], v[100:103], a[224:227], v[232:235]
 v_lshlrev_b32 v17, 2, v17
 v_mfma_f32_16x16x32_bf16 v[236:239], v[96:99], a[156:159], v[236:239]
 ds_read_b128 v[148:151], v28 offset:34816
 v_mfma_f32_16x16x32_bf16 v[236:239], v[100:103], a[228:231], v[236:239]
 v_add_u32 v14, s32, v19
 v_mfma_f32_16x16x32_bf16 v[240:243], v[104:107], a[152:155], v[240:243]
 ds_read_b128 v[152:155], v28 offset:26624
 v_mfma_f32_16x16x32_bf16 v[240:243], v[108:111], a[224:227], v[240:243]
 v_mfma_f32_16x16x32_bf16 v[244:247], v[104:107], a[156:159], v[244:247]
 ds_read_b128 v[156:159], v28 offset:35840
 s_waitcnt lgkmcnt(8)
 v_mfma_f32_16x16x32_bf16 v[244:247], v[108:111], a[228:231], v[244:247]
 v_lshl_add_u32 v15, v0, 2, s33
 v_mfma_f32_16x16x32_bf16 v[248:251], v[112:115], a[152:155], v[248:251]
 v_mfma_f32_16x16x32_bf16 v[248:251], v[116:119], a[224:227], v[248:251]
 v_mfma_f32_16x16x32_bf16 v[252:255], v[112:115], a[156:159], v[252:255]
 v_mfma_f32_16x16x32_bf16 v[252:255], v[116:119], a[228:231], v[252:255]
 v_mfma_f32_16x16x32_bf16 v[32:35], v[120:123], a[152:155], v[32:35]
 v_mfma_f32_16x16x32_bf16 v[32:35], v[124:127], a[224:227], v[32:35]
 v_mfma_f32_16x16x32_bf16 v[36:39], v[120:123], a[156:159], v[36:39]
 v_mfma_f32_16x16x32_bf16 v[36:39], v[124:127], a[228:231], v[36:39]
 s_waitcnt lgkmcnt(4)
 v_mfma_f32_16x16x32_bf16 v[40:43], v[128:131], a[152:155], v[40:43]
 s_waitcnt vmcnt(7) lgkmcnt(0)
 s_waitcnt vmcnt(0)
 s_barrier
 v_mfma_f32_16x16x32_bf16 v[40:43], v[132:135], a[224:227], v[40:43]
 ds_read_b128 v[96:99], v8 offset:0
 s_mul_i32 s42, s42, 16843009
 v_mfma_f32_16x16x32_bf16 v[44:47], v[128:131], a[156:159], v[44:47]
 ds_read_b128 v[100:103], v8 offset:49152
 s_and_b32 s40, s40, s41
 v_mfma_f32_16x16x32_bf16 v[44:47], v[132:135], a[228:231], v[44:47]
 ds_read_b128 v[104:107], v9 offset:0
 s_and_b32 s40, s40, s42
 v_mfma_f32_16x16x32_bf16 v[48:51], v[136:139], a[152:155], v[48:51]
 ds_read_b128 v[108:111], v9 offset:9216
 s_and_b32 s40, s40, s43
 v_mfma_f32_16x16x32_bf16 v[48:51], v[140:143], a[224:227], v[48:51]
 ds_read_b128 v[112:115], v8 offset:1024
 v_mfma_f32_16x16x32_bf16 v[52:55], v[136:139], a[156:159], v[52:55]
 ds_read_b128 v[116:119], v8 offset:50176
 v_mfma_f32_16x16x32_bf16 v[52:55], v[140:143], a[228:231], v[52:55]
 ds_read_b128 v[120:123], v9 offset:1024
 v_mfma_f32_16x16x32_bf16 v[56:59], v[144:147], a[152:155], v[56:59]
 ds_read_b128 v[124:127], v9 offset:10240
 v_mfma_f32_16x16x32_bf16 v[56:59], v[148:151], a[224:227], v[56:59]
 ds_read_b128 v[128:131], v8 offset:2048
 v_mfma_f32_16x16x32_bf16 v[60:63], v[144:147], a[156:159], v[60:63]
 ds_read_b128 v[132:135], v8 offset:51200
 v_mfma_f32_16x16x32_bf16 v[60:63], v[148:151], a[228:231], v[60:63]
 s_cmp_eq_u32 s40, 16843009
 s_cbranch_scc0 Lsp_g11a
Lrt_g11a:
 v_mfma_f32_16x16x32_bf16 v[64:67], v[152:155], a[152:155], v[64:67]
 ds_read_b128 v[136:139], v9 offset:2048
 v_mfma_f32_16x16x32_bf16 v[64:67], v[156:159], a[224:227], v[64:67]
 buffer_load_dwordx4 v[200:203], v14, s[16:19], s72 offen sc1
 v_mfma_f32_16x16x32_bf16 v[68:71], v[152:155], a[156:159], v[68:71]
 ds_read_b128 v[140:143], v9 offset:11264
 s_waitcnt lgkmcnt(6)
 v_mfma_f32_16x16x32_bf16 v[68:71], v[156:159], a[228:231], v[68:71]
 buffer_load_dwordx4 v[204:207], v14, s[16:19], s72 offen offset:1024 sc1
 v_mfma_f32_16x16x32_bf16 v[224:227], v[96:99], v[160:163], v[224:227]
 ds_read_b128 v[144:147], v8 offset:3072
 v_mfma_f32_16x16x32_bf16 v[224:227], v[100:103], v[168:171], v[224:227]
 buffer_load_dword v208, v15, s[16:19], s72 offen sc1
 v_mfma_f32_16x16x32_bf16 v[228:231], v[96:99], v[164:167], v[228:231]
 ds_read_b128 v[148:151], v8 offset:52224
 v_mfma_f32_16x16x32_bf16 v[228:231], v[100:103], v[172:175], v[228:231]
 buffer_load_dword v212, v10, s[16:19], s73 offen sc1
 v_mfma_f32_16x16x32_bf16 v[224:227], v[104:107], v[176:179], v[224:227]
 ds_read_b128 v[152:155], v9 offset:3072
 v_mfma_f32_16x16x32_bf16 v[224:227], v[108:111], v[184:187], v[224:227]
 buffer_load_dword v213, v10, s[16:19], s73 offen offset:64 sc1
 v_mfma_f32_16x16x32_bf16 v[228:231], v[104:107], v[180:183], v[228:231]
 ds_read_b128 v[156:159], v9 offset:12288
 v_mfma_f32_16x16x32_bf16 v[228:231], v[108:111], v[188:191], v[228:231]
 buffer_load_dword v214, v17, s[16:19], s73 offen sc1
 v_mfma_f32_16x16x32_bf16 v[232:235], v[112:115], v[160:163], v[232:235]
 ds_read_b128 v[96:99], v8 offset:4096
 v_mfma_f32_16x16x32_bf16 v[232:235], v[116:119], v[168:171], v[232:235]
 v_mfma_f32_16x16x32_bf16 v[236:239], v[112:115], v[164:167], v[236:239]
 ds_read_b128 v[100:103], v8 offset:53248
 s_waitcnt lgkmcnt(4)
 v_mfma_f32_16x16x32_bf16 v[236:239], v[116:119], v[172:175], v[236:239]
 v_mfma_f32_16x16x32_bf16 v[232:235], v[120:123], v[176:179], v[232:235]
 ds_read_b128 v[104:107], v9 offset:4096
 v_mfma_f32_16x16x32_bf16 v[232:235], v[124:127], v[184:187], v[232:235]
 v_cvt_pk_bf16_f32 v224, v224, v225
 v_mfma_f32_16x16x32_bf16 v[236:239], v[120:123], v[180:183], v[236:239]
 ds_read_b128 v[108:111], v9 offset:13312
 v_cvt_pk_bf16_f32 v225, v226, v227
 v_mfma_f32_16x16x32_bf16 v[236:239], v[124:127], v[188:191], v[236:239]
 v_cvt_pk_bf16_f32 v226, v228, v229
 v_cvt_pk_bf16_f32 v227, v230, v231
 v_mfma_f32_16x16x32_bf16 v[240:243], v[128:131], v[160:163], v[240:243]
 ds_read_b128 v[112:115], v8 offset:5120
 v_mfma_f32_16x16x32_bf16 v[240:243], v[132:135], v[168:171], v[240:243]
 buffer_store_dwordx4 v[224:227], v19, s[16:19], s77 offen sc1
 v_mfma_f32_16x16x32_bf16 v[244:247], v[128:131], v[164:167], v[244:247]
 ds_read_b128 v[116:119], v8 offset:54272
 v_mfma_f32_16x16x32_bf16 v[244:247], v[132:135], v[172:175], v[244:247]
 v_mfma_f32_16x16x32_bf16 v[240:243], v[136:139], v[176:179], v[240:243]
 ds_read_b128 v[120:123], v9 offset:5120
 v_mfma_f32_16x16x32_bf16 v[240:243], v[140:143], v[184:187], v[240:243]
 v_cvt_pk_bf16_f32 v232, v232, v233
 v_mfma_f32_16x16x32_bf16 v[244:247], v[136:139], v[180:183], v[244:247]
 ds_read_b128 v[124:127], v9 offset:14336
 v_cvt_pk_bf16_f32 v233, v234, v235
 v_mfma_f32_16x16x32_bf16 v[244:247], v[140:143], v[188:191], v[244:247]
 v_cvt_pk_bf16_f32 v234, v236, v237
 v_cvt_pk_bf16_f32 v235, v238, v239
 v_mfma_f32_16x16x32_bf16 v[248:251], v[144:147], v[160:163], v[248:251]
 ds_read_b128 v[128:131], v8 offset:6144
 v_mfma_f32_16x16x32_bf16 v[248:251], v[148:151], v[168:171], v[248:251]
 buffer_store_dwordx4 v[232:235], v19, s[16:19], s77 offen offset:1024 sc1
 v_mfma_f32_16x16x32_bf16 v[252:255], v[144:147], v[164:167], v[252:255]
 ds_read_b128 v[132:135], v8 offset:55296
 s_waitcnt lgkmcnt(4)
 v_mfma_f32_16x16x32_bf16 v[252:255], v[148:151], v[172:175], v[252:255]
 v_mfma_f32_16x16x32_bf16 v[248:251], v[152:155], v[176:179], v[248:251]
 ds_read_b128 v[136:139], v9 offset:6144
 v_mfma_f32_16x16x32_bf16 v[248:251], v[156:159], v[184:187], v[248:251]
 v_cvt_pk_bf16_f32 v240, v240, v241
 v_mfma_f32_16x16x32_bf16 v[252:255], v[152:155], v[180:183], v[252:255]
 ds_read_b128 v[140:143], v9 offset:15360
 v_cvt_pk_bf16_f32 v241, v242, v243
 v_mfma_f32_16x16x32_bf16 v[252:255], v[156:159], v[188:191], v[252:255]
 v_cvt_pk_bf16_f32 v242, v244, v245
 v_cvt_pk_bf16_f32 v243, v246, v247
 v_mfma_f32_16x16x32_bf16 v[32:35], v[96:99], v[160:163], v[32:35]
 ds_read_b128 v[144:147], v8 offset:7168
 v_mfma_f32_16x16x32_bf16 v[32:35], v[100:103], v[168:171], v[32:35]
 buffer_store_dwordx4 v[240:243], v19, s[16:19], s77 offen offset:2048 sc1
 v_mfma_f32_16x16x32_bf16 v[36:39], v[96:99], v[164:167], v[36:39]
 ds_read_b128 v[148:151], v8 offset:56320
 v_mfma_f32_16x16x32_bf16 v[36:39], v[100:103], v[172:175], v[36:39]
 v_mfma_f32_16x16x32_bf16 v[32:35], v[104:107], v[176:179], v[32:35]
 ds_read_b128 v[152:155], v9 offset:7168
 v_mfma_f32_16x16x32_bf16 v[32:35], v[108:111], v[184:187], v[32:35]
 v_cvt_pk_bf16_f32 v248, v248, v249
 v_mfma_f32_16x16x32_bf16 v[36:39], v[104:107], v[180:183], v[36:39]
 ds_read_b128 v[156:159], v9 offset:16384
 v_cvt_pk_bf16_f32 v249, v250, v251
 v_mfma_f32_16x16x32_bf16 v[36:39], v[108:111], v[188:191], v[36:39]
 v_cvt_pk_bf16_f32 v250, v252, v253
 v_cvt_pk_bf16_f32 v251, v254, v255
 v_mfma_f32_16x16x32_bf16 v[40:43], v[112:115], v[160:163], v[40:43]
 ds_read_b128 v[96:99], v8 offset:8192
 v_mfma_f32_16x16x32_bf16 v[40:43], v[116:119], v[168:171], v[40:43]
 buffer_store_dwordx4 v[248:251], v19, s[16:19], s77 offen offset:3072 sc1
 v_mfma_f32_16x16x32_bf16 v[44:47], v[112:115], v[164:167], v[44:47]
 ds_read_b128 v[100:103], v8 offset:57344
 s_waitcnt lgkmcnt(4)
 v_mfma_f32_16x16x32_bf16 v[44:47], v[116:119], v[172:175], v[44:47]
 v_mfma_f32_16x16x32_bf16 v[40:43], v[120:123], v[176:179], v[40:43]
 ds_read_b128 v[104:107], v9 offset:8192
 v_mfma_f32_16x16x32_bf16 v[40:43], v[124:127], v[184:187], v[40:43]
 v_cvt_pk_bf16_f32 v32, v32, v33
 v_mfma_f32_16x16x32_bf16 v[44:47], v[120:123], v[180:183], v[44:47]
 ds_read_b128 v[108:111], v9 offset:17408
 v_cvt_pk_bf16_f32 v33, v34, v35
 v_mfma_f32_16x16x32_bf16 v[44:47], v[124:127], v[188:191], v[44:47]
 v_cvt_pk_bf16_f32 v34, v36, v37
 v_cvt_pk_bf16_f32 v35, v38, v39
 v_mfma_f32_16x16x32_bf16 v[48:51], v[128:131], v[160:163], v[48:51]
 buffer_store_dwordx4 v[32:35], v5, s[16:19], s77 offen sc1
 v_mfma_f32_16x16x32_bf16 v[48:51], v[132:135], v[168:171], v[48:51]
 s_waitcnt vmcnt(3)
 v_mfma_f32_16x16x32_bf16 v[52:55], v[128:131], v[164:167], v[52:55]
 buffer_store_dword v30, v29, s[16:19], s74 offen sc1
 v_mfma_f32_16x16x32_bf16 v[52:55], v[132:135], v[172:175], v[52:55]
 v_mfma_f32_16x16x32_bf16 v[48:51], v[136:139], v[176:179], v[48:51]
 v_mfma_f32_16x16x32_bf16 v[48:51], v[140:143], v[184:187], v[48:51]
 v_cvt_pk_bf16_f32 v40, v40, v41
 v_mfma_f32_16x16x32_bf16 v[52:55], v[136:139], v[180:183], v[52:55]
 v_cvt_pk_bf16_f32 v41, v42, v43
 v_mfma_f32_16x16x32_bf16 v[52:55], v[140:143], v[188:191], v[52:55]
 v_cvt_pk_bf16_f32 v42, v44, v45
 v_cvt_pk_bf16_f32 v43, v46, v47
 v_mfma_f32_16x16x32_bf16 v[56:59], v[144:147], v[160:163], v[56:59]
 buffer_store_dwordx4 v[40:43], v5, s[16:19], s77 offen offset:1024 sc1
 v_mfma_f32_16x16x32_bf16 v[56:59], v[148:151], v[168:171], v[56:59]
 buffer_load_dword v20, v31, s[16:19], s75 offen sc1
 v_mfma_f32_16x16x32_bf16 v[60:63], v[144:147], v[164:167], v[60:63]
 v_mfma_f32_16x16x32_bf16 v[60:63], v[148:151], v[172:175], v[60:63]
 s_waitcnt lgkmcnt(0)
 v_mfma_f32_16x16x32_bf16 v[56:59], v[152:155], v[176:179], v[56:59]
 v_mfma_f32_16x16x32_bf16 v[56:59], v[156:159], v[184:187], v[56:59]
 v_cvt_pk_bf16_f32 v48, v48, v49
 v_mfma_f32_16x16x32_bf16 v[60:63], v[152:155], v[180:183], v[60:63]
 v_cvt_pk_bf16_f32 v49, v50, v51
 v_mfma_f32_16x16x32_bf16 v[60:63], v[156:159], v[188:191], v[60:63]
 v_cvt_pk_bf16_f32 v50, v52, v53
 v_cvt_pk_bf16_f32 v51, v54, v55
 v_mfma_f32_16x16x32_bf16 v[64:67], v[96:99], v[160:163], v[64:67]
 buffer_store_dwordx4 v[48:51], v5, s[16:19], s77 offen offset:2048 sc1
 v_mfma_f32_16x16x32_bf16 v[64:67], v[100:103], v[168:171], v[64:67]
 v_mfma_f32_16x16x32_bf16 v[68:71], v[96:99], v[164:167], v[68:71]
 v_mfma_f32_16x16x32_bf16 v[68:71], v[100:103], v[172:175], v[68:71]
 v_mfma_f32_16x16x32_bf16 v[64:67], v[104:107], v[176:179], v[64:67]
 v_mfma_f32_16x16x32_bf16 v[64:67], v[108:111], v[184:187], v[64:67]
 v_cvt_pk_bf16_f32 v56, v56, v57
 v_mfma_f32_16x16x32_bf16 v[68:71], v[104:107], v[180:183], v[68:71]
 v_cvt_pk_bf16_f32 v57, v58, v59
 v_mfma_f32_16x16x32_bf16 v[68:71], v[108:111], v[188:191], v[68:71]
 v_cvt_pk_bf16_f32 v58, v60, v61
 v_cvt_pk_bf16_f32 v59, v62, v63
 buffer_store_dwordx4 v[56:59], v5, s[16:19], s77 offen offset:3072 sc1
 s_nop 0
 v_cvt_pk_bf16_f32 v64, v64, v65
 v_cvt_pk_bf16_f32 v65, v66, v67
 s_nop 1
 v_cvt_pk_bf16_f32 v66, v68, v69
 v_cvt_pk_bf16_f32 v67, v70, v71
 buffer_store_dwordx4 v[64:67], v6, s[16:19], s77 offen sc1
 s_waitcnt vmcnt(3)
 v_cmp_eq_u32 vcc, 0, v20
 s_nop 1
 s_and_b32 s43, vcc_lo, -1
 s_cbranch_scc1 Lnl_g11
 buffer_load_dwordx4 v[96:99], v14, s[16:19], s78 offen sc1
 buffer_load_dwordx4 v[100:103], v14, s[16:19], s79 offen sc1
 buffer_load_dwordx4 v[104:107], v14, s[16:19], s0 offen sc1
 buffer_load_dwordx4 v[108:111], v14, s[16:19], s78 offen offset:1024 sc1
 buffer_load_dwordx4 v[112:115], v14, s[16:19], s79 offen offset:1024 sc1
 buffer_load_dwordx4 v[116:119], v14, s[16:19], s0 offen offset:1024 sc1
 buffer_load_dword v120, v15, s[16:19], s78 offen sc1
 buffer_load_dword v121, v15, s[16:19], s79 offen sc1
 buffer_load_dword v122, v15, s[16:19], s0 offen sc1
Lnl_g11:
 s_cmp_lg_u32 s24, s49
 s_cbranch_scc1 Lfin
 ds_write_b128 v19, v[224:227] offset:0
 ds_write_b128 v19, v[232:235] offset:1024
 ds_write_b128 v19, v[240:243] offset:2048
 ds_write_b128 v19, v[248:251] offset:3072
 ds_write_b128 v19, v[32:35] offset:4096
 ds_write_b128 v19, v[40:43] offset:5120
 ds_write_b128 v19, v[48:51] offset:6144
 ds_write_b128 v19, v[56:59] offset:7168
 ds_write_b128 v19, v[64:67] offset:8192
 s_branch Lfin
Lj_L1_g10:
 s_setpc_b64 s[22:23]
L1_g10:
 buffer_load_dwordx4 v18, s[8:11], s31 offen offset:1024  lds
 s_getpc_b64 s[20:21]
L_pcg10:
 v_mfma_f32_16x16x32_bf16 v[108:111], v[240:243], v[32:35], v[108:111]
 s_sub_u32 s20, s20, L_pcg10-gated_mix__ssm_conv_s4d__swiglu_ffn__prompt_kernel
 s_subb_u32 s21, s21, 0
 s_lshr_b32 s57, s2, 3
 v_mfma_f32_16x16x32_bf16 v[108:111], v[244:247], v[36:39], v[108:111]
 s_mul_i32 s58, s57, 43
 s_lshr_b32 s58, s58, 8
 s_lshl_b32 s58, s58, 1
 v_mfma_f32_16x16x32_bf16 v[112:115], a[56:59], v[40:43], v[112:115]
 ds_read_b128 v[32:35], v22 offset:40960
 s_and_b32 s57, s26, 1
 v_mfma_f32_16x16x32_bf16 v[112:115], a[60:63], v[44:47], v[112:115]
 buffer_load_dwordx4 v18, s[8:11], s32 offen offset:2048  lds
 s_add_u32 s57, s57, s58
 v_mfma_f32_16x16x32_bf16 v[116:119], a[200:203], v[40:43], v[116:119]
 s_and_b32 s57, s57, 3
 s_lshl_b32 s57, s57, 2
 s_add_u32 s57, s57, s24
 v_mfma_f32_16x16x32_bf16 v[116:119], a[204:207], v[44:47], v[116:119]
 s_lshl_b32 s57, s57, 13
 v_mfma_f32_16x16x32_bf16 v[120:123], a[128:131], v[40:43], v[120:123]
 ds_read_b128 v[36:39], v23 offset:40960
 v_lshl_add_u32 v3, v0, 7, s57
 v_mfma_f32_16x16x32_bf16 v[120:123], a[132:135], v[44:47], v[120:123]
 buffer_load_dwordx4 v18, s[8:11], s33 offen offset:3072  lds
 v_min_u32 v3, L_text_end-gated_mix__ssm_conv_s4d__swiglu_ffn__prompt_kernel-4, v3
 v_mfma_f32_16x16x32_bf16 v[124:127], v[240:243], v[40:43], v[124:127]
 v_mfma_f32_16x16x32_bf16 v[124:127], v[244:247], v[44:47], v[124:127]
 s_waitcnt lgkmcnt(2)
 v_mfma_f32_16x16x32_bf16 v[128:131], a[56:59], v[48:51], v[128:131]
 ds_read_b128 v[40:43], v22 offset:43008
 s_add_u32 m0, s56, 4096
 v_mfma_f32_16x16x32_bf16 v[128:131], a[60:63], v[52:55], v[128:131]
 buffer_load_dwordx4 v18, s[8:11], s34 offen  lds
 v_mfma_f32_16x16x32_bf16 v[132:135], a[200:203], v[48:51], v[132:135]
 v_mfma_f32_16x16x32_bf16 v[132:135], a[204:207], v[52:55], v[132:135]
 v_mfma_f32_16x16x32_bf16 v[136:139], a[128:131], v[48:51], v[136:139]
 ds_read_b128 v[44:47], v23 offset:43008
 v_mfma_f32_16x16x32_bf16 v[136:139], a[132:135], v[52:55], v[136:139]
 buffer_load_dwordx4 v18, s[8:11], s35 offen offset:1024  lds
 v_mfma_f32_16x16x32_bf16 v[140:143], v[240:243], v[48:51], v[140:143]
 v_mfma_f32_16x16x32_bf16 v[140:143], v[244:247], v[52:55], v[140:143]
 v_mfma_f32_16x16x32_bf16 v[144:147], a[56:59], v[56:59], v[144:147]
 ds_read_b128 v[48:51], v22 offset:45056
 v_mfma_f32_16x16x32_bf16 v[144:147], a[60:63], v[60:63], v[144:147]
 buffer_load_dwordx4 v18, s[8:11], s36 offen offset:2048  lds
 v_mfma_f32_16x16x32_bf16 v[148:151], a[200:203], v[56:59], v[148:151]
 v_mfma_f32_16x16x32_bf16 v[148:151], a[204:207], v[60:63], v[148:151]
 v_mfma_f32_16x16x32_bf16 v[152:155], a[128:131], v[56:59], v[152:155]
 ds_read_b128 v[52:55], v23 offset:45056
 v_mfma_f32_16x16x32_bf16 v[152:155], a[132:135], v[60:63], v[152:155]
Lpg9:
 s_cbranch_vccnz Lj_Lfin
 buffer_load_dwordx4 v18, s[8:11], s37 offen offset:3072  lds
 v_mfma_f32_16x16x32_bf16 v[156:159], v[240:243], v[56:59], v[156:159]
 v_mfma_f32_16x16x32_bf16 v[156:159], v[244:247], v[60:63], v[156:159]
 s_waitcnt lgkmcnt(2)
 v_mfma_f32_16x16x32_bf16 v[160:163], a[56:59], v[32:35], v[160:163]
 ds_read_b128 v[56:59], v22 offset:47104
 s_add_u32 m0, s56, 8192
 v_mfma_f32_16x16x32_bf16 v[160:163], a[60:63], v[36:39], v[160:163]
 buffer_load_dwordx4 v18, s[8:11], s38 offen  lds
 v_mfma_f32_16x16x32_bf16 v[164:167], a[200:203], v[32:35], v[164:167]
 global_load_dword v4, v3, s[20:21]
 v_mfma_f32_16x16x32_bf16 v[164:167], a[204:207], v[36:39], v[164:167]
 v_mfma_f32_16x16x32_bf16 v[168:171], a[128:131], v[32:35], v[168:171]
 ds_read_b128 v[60:63], v23 offset:47104
 v_add_u32 v18, 36864, v18
 v_mfma_f32_16x16x32_bf16 v[168:171], a[132:135], v[36:39], v[168:171]
 v_mfma_f32_16x16x32_bf16 v[172:175], v[240:243], v[32:35], v[172:175]
 v_mfma_f32_16x16x32_bf16 v[172:175], v[244:247], v[36:39], v[172:175]
 v_mfma_f32_16x16x32_bf16 v[176:179], a[56:59], v[40:43], v[176:179]
 v_mfma_f32_16x16x32_bf16 v[176:179], a[60:63], v[44:47], v[176:179]
 v_mfma_f32_16x16x32_bf16 v[180:183], a[200:203], v[40:43], v[180:183]
 v_mfma_f32_16x16x32_bf16 v[180:183], a[204:207], v[44:47], v[180:183]
 v_mfma_f32_16x16x32_bf16 v[184:187], a[128:131], v[40:43], v[184:187]
 v_mfma_f32_16x16x32_bf16 v[184:187], a[132:135], v[44:47], v[184:187]
 v_mfma_f32_16x16x32_bf16 v[188:191], v[240:243], v[40:43], v[188:191]
 s_waitcnt vmcnt(10) lgkmcnt(0)
 s_barrier
 v_mfma_f32_16x16x32_bf16 v[188:191], v[244:247], v[44:47], v[188:191]
 ds_read_b128 v[32:35], v24 offset:32768
 v_mfma_f32_16x16x32_bf16 v[192:195], a[56:59], v[48:51], v[192:195]
 ds_read_b128 v[36:39], v25 offset:32768
 ds_read_b64_tr_b16 a[64:65], v30 offset:0
 v_mfma_f32_16x16x32_bf16 v[192:195], a[60:63], v[52:55], v[192:195]
 ds_read_b64_tr_b16 a[66:67], v30 offset:1024
 ds_read_b64_tr_b16 a[68:69], v30 offset:8192
 v_mfma_f32_16x16x32_bf16 v[196:199], a[200:203], v[48:51], v[196:199]
 ds_read_b64_tr_b16 a[70:71], v30 offset:9216
 ds_read_b64_tr_b16 a[208:209], v30 offset:16384
 v_mfma_f32_16x16x32_bf16 v[196:199], a[204:207], v[52:55], v[196:199]
 ds_read_b64_tr_b16 a[210:211], v30 offset:17408
 ds_read_b64_tr_b16 a[212:213], v30 offset:24576
 v_mfma_f32_16x16x32_bf16 v[200:203], a[128:131], v[48:51], v[200:203]
 ds_read_b64_tr_b16 a[214:215], v30 offset:25600
 ds_read_b64_tr_b16 a[136:137], v31 offset:0
 v_mfma_f32_16x16x32_bf16 v[200:203], a[132:135], v[52:55], v[200:203]
 ds_read_b64_tr_b16 a[138:139], v31 offset:1024
 ds_read_b64_tr_b16 a[140:141], v31 offset:8192
 v_mfma_f32_16x16x32_bf16 v[204:207], v[240:243], v[48:51], v[204:207]
 ds_read_b64_tr_b16 a[142:143], v31 offset:9216
 ds_read_b64_tr_b16 v[248:249], v31 offset:16384
 v_mfma_f32_16x16x32_bf16 v[204:207], v[244:247], v[52:55], v[204:207]
 ds_read_b64_tr_b16 v[250:251], v31 offset:17408
 ds_read_b64_tr_b16 v[252:253], v31 offset:24576
 v_mfma_f32_16x16x32_bf16 v[208:211], a[56:59], v[56:59], v[208:211]
 ds_read_b64_tr_b16 v[254:255], v31 offset:25600
 v_mfma_f32_16x16x32_bf16 v[208:211], a[60:63], v[60:63], v[208:211]
 ds_read_b128 v[40:43], v24 offset:34816
 v_mfma_f32_16x16x32_bf16 v[212:215], a[200:203], v[56:59], v[212:215]
 s_add_u32 m0, s56, 49152
 v_add_u32 v22, v5, v22
 v_mfma_f32_16x16x32_bf16 v[212:215], a[204:207], v[60:63], v[212:215]
 v_add_u32 v23, v5, v23
 v_mfma_f32_16x16x32_bf16 v[216:219], a[128:131], v[56:59], v[216:219]
 ds_read_b128 v[44:47], v25 offset:34816
 v_mfma_f32_16x16x32_bf16 v[216:219], a[132:135], v[60:63], v[216:219]
 ds_read_b128 v[48:51], v24 offset:36864
 v_mfma_f32_16x16x32_bf16 v[220:223], v[240:243], v[56:59], v[220:223]
 ds_read_b128 v[52:55], v25 offset:36864
 v_mfma_f32_16x16x32_bf16 v[220:223], v[244:247], v[60:63], v[220:223]
 s_waitcnt lgkmcnt(4)
 v_mfma_f32_16x16x32_bf16 v[96:99], a[64:67], v[32:35], v[96:99]
 ds_read_b128 v[56:59], v24 offset:38912
 v_mfma_f32_16x16x32_bf16 v[96:99], a[68:71], v[36:39], v[96:99]
 buffer_load_dwordx4 v18, s[8:11], s30 offen  lds
 v_mfma_f32_16x16x32_bf16 v[100:103], a[208:211], v[32:35], v[100:103]
 v_mfma_f32_16x16x32_bf16 v[100:103], a[212:215], v[36:39], v[100:103]
 v_mfma_f32_16x16x32_bf16 v[104:107], a[136:139], v[32:35], v[104:107]
 ds_read_b128 v[60:63], v25 offset:38912
 v_mfma_f32_16x16x32_bf16 v[104:107], a[140:143], v[36:39], v[104:107]
 buffer_load_dwordx4 v18, s[8:11], s31 offen offset:1024  lds
 v_mfma_f32_16x16x32_bf16 v[108:111], v[248:251], v[32:35], v[108:111]
 v_mfma_f32_16x16x32_bf16 v[108:111], v[252:255], v[36:39], v[108:111]
 s_waitcnt lgkmcnt(2)
 v_mfma_f32_16x16x32_bf16 v[112:115], a[64:67], v[40:43], v[112:115]
 ds_read_b128 v[32:35], v24 offset:40960
 v_mfma_f32_16x16x32_bf16 v[112:115], a[68:71], v[44:47], v[112:115]
 buffer_load_dwordx4 v18, s[8:11], s32 offen offset:2048  lds
 v_mfma_f32_16x16x32_bf16 v[116:119], a[208:211], v[40:43], v[116:119]
 v_mfma_f32_16x16x32_bf16 v[116:119], a[212:215], v[44:47], v[116:119]
 v_mfma_f32_16x16x32_bf16 v[120:123], a[136:139], v[40:43], v[120:123]
 ds_read_b128 v[36:39], v25 offset:40960
 v_mfma_f32_16x16x32_bf16 v[120:123], a[140:143], v[44:47], v[120:123]
 buffer_load_dwordx4 v18, s[8:11], s33 offen offset:3072  lds
 v_mul_f32 v100, v96, v100
 v_mfma_f32_16x16x32_bf16 v[124:127], v[248:251], v[40:43], v[124:127]
 v_mul_f32 v96, s54, v96
 v_mul_f32 v101, v97, v101
 v_mfma_f32_16x16x32_bf16 v[124:127], v[252:255], v[44:47], v[124:127]
 v_exp_f32 v96, v96
 v_mfma_f32_16x16x32_bf16 v[128:131], a[64:67], v[48:51], v[128:131]
 ds_read_b128 v[40:43], v24 offset:43008
 s_add_u32 m0, s56, 53248
 v_mfma_f32_16x16x32_bf16 v[128:131], a[68:71], v[52:55], v[128:131]
 buffer_load_dwordx4 v18, s[8:11], s34 offen  lds
 v_add_f32 v96, 1.0, v96
 v_mfma_f32_16x16x32_bf16 v[132:135], a[208:211], v[48:51], v[132:135]
 v_rcp_f32 v96, v96
 v_mfma_f32_16x16x32_bf16 v[132:135], a[212:215], v[52:55], v[132:135]
 v_mul_f32 v100, v96, v100
 v_mul_f32 v97, s54, v97
 v_mfma_f32_16x16x32_bf16 v[136:139], a[136:139], v[48:51], v[136:139]
 ds_read_b128 v[44:47], v25 offset:43008
 v_mul_f32 v102, v98, v102
 v_mfma_f32_16x16x32_bf16 v[136:139], a[140:143], v[52:55], v[136:139]
 buffer_load_dwordx4 v18, s[8:11], s35 offen offset:1024  lds
 v_mul_f32 v98, s54, v98
 v_mfma_f32_16x16x32_bf16 v[140:143], v[248:251], v[48:51], v[140:143]
 v_exp_f32 v97, v97
 v_mfma_f32_16x16x32_bf16 v[140:143], v[252:255], v[52:55], v[140:143]
 s_waitcnt lgkmcnt(2)
 v_exp_f32 v98, v98
 v_mfma_f32_16x16x32_bf16 v[144:147], a[64:67], v[56:59], v[144:147]
 ds_read_b128 v[48:51], v24 offset:45056
 v_add_f32 v97, 1.0, v97
 v_mfma_f32_16x16x32_bf16 v[144:147], a[68:71], v[60:63], v[144:147]
 buffer_load_dwordx4 v18, s[8:11], s36 offen offset:2048  lds
 v_add_f32 v98, 1.0, v98
 v_mfma_f32_16x16x32_bf16 v[148:151], a[208:211], v[56:59], v[148:151]
 v_rcp_f32 v97, v97
 v_mfma_f32_16x16x32_bf16 v[148:151], a[212:215], v[60:63], v[148:151]
 v_rcp_f32 v98, v98
 v_mfma_f32_16x16x32_bf16 v[152:155], a[136:139], v[56:59], v[152:155]
 ds_read_b128 v[52:55], v25 offset:45056
 v_mul_f32 v101, v97, v101
 v_mfma_f32_16x16x32_bf16 v[152:155], a[140:143], v[60:63], v[152:155]
 buffer_load_dwordx4 v18, s[8:11], s37 offen offset:3072  lds
 v_mul_f32 v102, v98, v102
 v_mfma_f32_16x16x32_bf16 v[156:159], v[248:251], v[56:59], v[156:159]
 v_mul_f32 v103, v99, v103
 v_mul_f32 v108, v104, v108
 v_mfma_f32_16x16x32_bf16 v[156:159], v[252:255], v[60:63], v[156:159]
 v_mul_f32 v99, s54, v99
 v_mul_f32 v104, s54, v104
 v_mfma_f32_16x16x32_bf16 v[160:163], a[64:67], v[32:35], v[160:163]
 ds_read_b128 v[56:59], v24 offset:47104
 s_add_u32 m0, s56, 57344
 v_mfma_f32_16x16x32_bf16 v[160:163], a[68:71], v[36:39], v[160:163]
 buffer_load_dwordx4 v18, s[8:11], s38 offen  lds
 v_mul_f32 v109, v105, v109
 v_mfma_f32_16x16x32_bf16 v[164:167], a[208:211], v[32:35], v[164:167]
 v_exp_f32 v99, v99
 v_mfma_f32_16x16x32_bf16 v[164:167], a[212:215], v[36:39], v[164:167]
 v_exp_f32 v104, v104
 v_mfma_f32_16x16x32_bf16 v[168:171], a[136:139], v[32:35], v[168:171]
 ds_read_b128 v[60:63], v25 offset:47104
 s_mov_b32 s80, 36864
 v_mfma_f32_16x16x32_bf16 v[168:171], a[140:143], v[36:39], v[168:171]
 s_cmp_eq_u32 s27, 4
 s_cselect_b32 s80, -331776, s80
 v_add_f32 v99, 1.0, v99
 v_mfma_f32_16x16x32_bf16 v[172:175], v[248:251], v[32:35], v[172:175]
 v_add_u32 v18, s80, v18
 v_add_f32 v104, 1.0, v104
 v_mfma_f32_16x16x32_bf16 v[172:175], v[252:255], v[36:39], v[172:175]
 s_waitcnt lgkmcnt(2)
 v_rcp_f32 v99, v99
 v_mfma_f32_16x16x32_bf16 v[176:179], a[64:67], v[40:43], v[176:179]
 v_rcp_f32 v104, v104
 v_mfma_f32_16x16x32_bf16 v[176:179], a[68:71], v[44:47], v[176:179]
 v_mul_f32 v103, v99, v103
 v_mul_f32 v108, v104, v108
 v_mfma_f32_16x16x32_bf16 v[180:183], a[208:211], v[40:43], v[180:183]
 v_mul_f32 v105, s54, v105
 v_mul_f32 v110, v106, v110
 v_mfma_f32_16x16x32_bf16 v[180:183], a[212:215], v[44:47], v[180:183]
 v_exp_f32 v105, v105
 v_mfma_f32_16x16x32_bf16 v[184:187], a[136:139], v[40:43], v[184:187]
 v_add_f32 v105, 1.0, v105
 v_mul_f32 v106, s54, v106
 v_mfma_f32_16x16x32_bf16 v[184:187], a[140:143], v[44:47], v[184:187]
 v_rcp_f32 v105, v105
 v_mfma_f32_16x16x32_bf16 v[188:191], v[248:251], v[40:43], v[188:191]
 s_waitcnt vmcnt(10) lgkmcnt(0)
 s_barrier
 v_mul_f32 v109, v105, v109
 v_mfma_f32_16x16x32_bf16 v[188:191], v[252:255], v[44:47], v[188:191]
 ds_read_b128 v[32:35], v20 offset:0
 v_mul_f32 v111, v107, v111
 v_mfma_f32_16x16x32_bf16 v[192:195], a[64:67], v[48:51], v[192:195]
 ds_read_b128 v[36:39], v21 offset:0
 v_mul_f32 v107, s54, v107
 v_mfma_f32_16x16x32_bf16 v[192:195], a[68:71], v[52:55], v[192:195]
 ds_read_b128 v[40:43], v20 offset:1024
 v_cvt_pk_bf16_f32 v96, v100, v101
 v_mfma_f32_16x16x32_bf16 v[196:199], a[208:211], v[48:51], v[196:199]
 v_exp_f32 v106, v106
 v_mfma_f32_16x16x32_bf16 v[196:199], a[212:215], v[52:55], v[196:199]
 v_exp_f32 v107, v107
 v_mfma_f32_16x16x32_bf16 v[200:203], a[136:139], v[48:51], v[200:203]
 ds_read_b128 v[44:47], v21 offset:1024
 v_add_f32 v106, 1.0, v106
 v_mfma_f32_16x16x32_bf16 v[200:203], a[140:143], v[52:55], v[200:203]
 v_rcp_f32 v106, v106
 v_mfma_f32_16x16x32_bf16 v[204:207], v[248:251], v[48:51], v[204:207]
 v_mul_f32 v110, v106, v110
 v_add_f32 v107, 1.0, v107
 v_mfma_f32_16x16x32_bf16 v[204:207], v[252:255], v[52:55], v[204:207]
 s_waitcnt lgkmcnt(2)
 v_rcp_f32 v107, v107
 v_mfma_f32_16x16x32_bf16 v[208:211], a[64:67], v[56:59], v[208:211]
 ds_read_b128 v[48:51], v20 offset:2048
 v_mul_f32 v111, v107, v111
 v_mfma_f32_16x16x32_bf16 v[208:211], a[68:71], v[60:63], v[208:211]
 v_cvt_pk_bf16_f32 v97, v102, v103
 v_cvt_pk_bf16_f32 v98, v108, v109
 v_mfma_f32_16x16x32_bf16 v[212:215], a[208:211], v[56:59], v[212:215]
 v_add_u32 v24, v5, v24
 v_cvt_pk_bf16_f32 v99, v110, v111
 v_mfma_f32_16x16x32_bf16 v[212:215], a[212:215], v[60:63], v[212:215]
 buffer_store_dwordx4 v[96:99], v19, s[16:19], s53 offen sc1
 v_add_u32 v25, v5, v25
 v_mfma_f32_16x16x32_bf16 v[216:219], a[136:139], v[56:59], v[216:219]
 ds_read_b128 v[52:55], v21 offset:2048
 s_add_u32 s53, s53, s52
 v_mfma_f32_16x16x32_bf16 v[216:219], a[140:143], v[60:63], v[216:219]
 s_add_u32 m0, s56, 98304
 v_mul_f32 v116, v112, v116
 v_mul_f32 v117, v113, v117
 v_mfma_f32_16x16x32_bf16 v[220:223], v[248:251], v[56:59], v[220:223]
 v_mul_f32 v112, s54, v112
 v_mul_f32 v113, s54, v113
 v_mfma_f32_16x16x32_bf16 v[220:223], v[252:255], v[60:63], v[220:223]
 v_exp_f32 v112, v112
 v_mfma_f32_16x16x32_bf16 v[64:67], a[0:3], v[32:35], 0
 ds_read_b128 v[56:59], v20 offset:3072
 v_exp_f32 v113, v113
 v_mfma_f32_16x16x32_bf16 v[64:67], a[4:7], v[36:39], v[64:67]
 v_add_f32 v112, 1.0, v112
 v_add_f32 v113, 1.0, v113
 v_mfma_f32_16x16x32_bf16 v[68:71], a[144:147], v[32:35], 0
 v_rcp_f32 v112, v112
 v_mfma_f32_16x16x32_bf16 v[68:71], a[148:151], v[36:39], v[68:71]
 v_rcp_f32 v113, v113
 v_mfma_f32_16x16x32_bf16 v[72:75], a[72:75], v[32:35], 0
 ds_read_b128 v[60:63], v21 offset:3072
 v_mul_f32 v116, v112, v116
 v_mfma_f32_16x16x32_bf16 v[72:75], a[76:79], v[36:39], v[72:75]
 v_mul_f32 v117, v113, v117
 v_mul_f32 v118, v114, v118
 v_mfma_f32_16x16x32_bf16 v[76:79], a[216:219], v[32:35], 0
 v_mul_f32 v114, s54, v114
 v_mul_f32 v119, v115, v119
 v_mfma_f32_16x16x32_bf16 v[76:79], a[220:223], v[36:39], v[76:79]
 s_waitcnt lgkmcnt(2)
 v_exp_f32 v114, v114
 v_mfma_f32_16x16x32_bf16 v[64:67], a[8:11], v[40:43], v[64:67]
 ds_read_b128 v[32:35], v20 offset:4096
 v_add_f32 v114, 1.0, v114
 v_mfma_f32_16x16x32_bf16 v[64:67], a[12:15], v[44:47], v[64:67]
 v_rcp_f32 v114, v114
 v_mfma_f32_16x16x32_bf16 v[68:71], a[152:155], v[40:43], v[68:71]
 v_mul_f32 v118, v114, v118
 v_mul_f32 v115, s54, v115
 v_mfma_f32_16x16x32_bf16 v[68:71], a[156:159], v[44:47], v[68:71]
 buffer_load_dwordx4 v18, s[8:11], s30 offen  lds
 v_mul_f32 v124, v120, v124
 v_mfma_f32_16x16x32_bf16 v[72:75], a[80:83], v[40:43], v[72:75]
 ds_read_b128 v[36:39], v21 offset:4096
 v_mul_f32 v120, s54, v120
 v_mfma_f32_16x16x32_bf16 v[72:75], a[84:87], v[44:47], v[72:75]
 v_exp_f32 v115, v115
 v_mfma_f32_16x16x32_bf16 v[76:79], a[224:227], v[40:43], v[76:79]
 v_exp_f32 v120, v120
 v_mfma_f32_16x16x32_bf16 v[76:79], a[228:231], v[44:47], v[76:79]
 buffer_load_dwordx4 v18, s[8:11], s31 offen offset:1024  lds
 v_add_f32 v115, 1.0, v115
 v_mfma_f32_16x16x32_bf16 v[64:67], a[16:19], v[48:51], v[64:67]
 ds_read_b128 v[40:43], v20 offset:5120
 v_add_f32 v120, 1.0, v120
 v_mfma_f32_16x16x32_bf16 v[64:67], a[20:23], v[52:55], v[64:67]
 v_rcp_f32 v115, v115
 v_mfma_f32_16x16x32_bf16 v[68:71], a[160:163], v[48:51], v[68:71]
 v_rcp_f32 v120, v120
 v_mfma_f32_16x16x32_bf16 v[68:71], a[164:167], v[52:55], v[68:71]
 buffer_load_dwordx4 v18, s[8:11], s32 offen offset:2048  lds
 v_mul_f32 v119, v115, v119
 v_mfma_f32_16x16x32_bf16 v[72:75], a[88:91], v[48:51], v[72:75]
 ds_read_b128 v[44:47], v21 offset:5120
 v_mul_f32 v124, v120, v124
 v_mfma_f32_16x16x32_bf16 v[72:75], a[92:95], v[52:55], v[72:75]
 v_mul_f32 v125, v121, v125
 v_mul_f32 v126, v122, v126
 v_mfma_f32_16x16x32_bf16 v[76:79], a[232:235], v[48:51], v[76:79]
 v_mul_f32 v121, s54, v121
 v_mul_f32 v122, s54, v122
 v_mfma_f32_16x16x32_bf16 v[76:79], a[236:239], v[52:55], v[76:79]
 s_waitcnt lgkmcnt(2)
 v_exp_f32 v121, v121
 v_mfma_f32_16x16x32_bf16 v[64:67], a[24:27], v[56:59], v[64:67]
 ds_read_b128 v[48:51], v20 offset:6144
 v_add_f32 v121, 1.0, v121
 v_mfma_f32_16x16x32_bf16 v[64:67], a[28:31], v[60:63], v[64:67]
 buffer_load_dwordx4 v18, s[8:11], s33 offen offset:3072  lds
 v_mul_f32 v127, v123, v127
 v_mfma_f32_16x16x32_bf16 v[68:71], a[168:171], v[56:59], v[68:71]
 v_rcp_f32 v121, v121
 v_mfma_f32_16x16x32_bf16 v[68:71], a[172:175], v[60:63], v[68:71]
 v_exp_f32 v122, v122
 v_mfma_f32_16x16x32_bf16 v[72:75], a[96:99], v[56:59], v[72:75]
 ds_read_b128 v[52:55], v21 offset:6144
 v_mul_f32 v125, v121, v125
 v_mfma_f32_16x16x32_bf16 v[72:75], a[100:103], v[60:63], v[72:75]
 s_add_u32 m0, s56, 102400
 v_add_f32 v122, 1.0, v122
 v_mul_f32 v123, s54, v123
 v_mfma_f32_16x16x32_bf16 v[76:79], a[240:243], v[56:59], v[76:79]
 buffer_load_dwordx4 v18, s[8:11], s34 offen  lds
 v_cvt_pk_bf16_f32 v112, v116, v117
 v_mfma_f32_16x16x32_bf16 v[76:79], a[244:247], v[60:63], v[76:79]
 v_rcp_f32 v122, v122
 v_mfma_f32_16x16x32_bf16 v[64:67], a[32:35], v[32:35], v[64:67]
 ds_read_b128 v[56:59], v20 offset:7168
 v_mul_f32 v126, v122, v126
 v_mfma_f32_16x16x32_bf16 v[64:67], a[36:39], v[36:39], v[64:67]
 v_exp_f32 v123, v123
 v_mfma_f32_16x16x32_bf16 v[68:71], a[176:179], v[32:35], v[68:71]
 buffer_load_dwordx4 v18, s[8:11], s35 offen offset:1024  lds
 v_add_f32 v123, 1.0, v123
 v_mfma_f32_16x16x32_bf16 v[68:71], a[180:183], v[36:39], v[68:71]
 v_rcp_f32 v123, v123
 v_mfma_f32_16x16x32_bf16 v[72:75], a[104:107], v[32:35], v[72:75]
 ds_read_b128 v[60:63], v21 offset:7168
 v_mul_f32 v127, v123, v127
 v_mfma_f32_16x16x32_bf16 v[72:75], a[108:111], v[36:39], v[72:75]
 v_cvt_pk_bf16_f32 v113, v118, v119
 v_cvt_pk_bf16_f32 v114, v124, v125
 v_mfma_f32_16x16x32_bf16 v[76:79], a[248:251], v[32:35], v[76:79]
 v_cvt_pk_bf16_f32 v115, v126, v127
 v_mul_f32 v132, v128, v132
 v_mfma_f32_16x16x32_bf16 v[76:79], a[252:255], v[36:39], v[76:79]
 s_waitcnt lgkmcnt(2)
 buffer_store_dwordx4 v[112:115], v19, s[16:19], s53 offen sc1
 v_mfma_f32_16x16x32_bf16 v[64:67], a[40:43], v[40:43], v[64:67]
 ds_read_b128 v[32:35], v20 offset:8192
 s_add_u32 s53, s53, s52
 v_mfma_f32_16x16x32_bf16 v[64:67], a[44:47], v[44:47], v[64:67]
 v_mul_f32 v128, s54, v128
 v_mul_f32 v133, v129, v133
 v_mfma_f32_16x16x32_bf16 v[68:71], a[184:187], v[40:43], v[68:71]
 v_exp_f32 v128, v128
 v_mfma_f32_16x16x32_bf16 v[68:71], a[188:191], v[44:47], v[68:71]
 v_add_f32 v128, 1.0, v128
 v_mul_f32 v129, s54, v129
 v_mfma_f32_16x16x32_bf16 v[72:75], a[112:115], v[40:43], v[72:75]
 ds_read_b128 v[36:39], v21 offset:8192
 v_mul_f32 v134, v130, v134
 v_mfma_f32_16x16x32_bf16 v[72:75], a[116:119], v[44:47], v[72:75]
 v_rcp_f32 v128, v128
 v_mfma_f32_16x16x32_bf16 v[76:79], v[224:227], v[40:43], v[76:79]
 v_exp_f32 v129, v129
 v_mfma_f32_16x16x32_bf16 v[76:79], v[228:231], v[44:47], v[76:79]
 v_mul_f32 v132, v128, v132
 v_add_f32 v129, 1.0, v129
 v_mfma_f32_16x16x32_bf16 v[64:67], a[48:51], v[48:51], v[64:67]
 ds_read_b128 v[40:43], v20 offset:18432
 v_mul_f32 v130, s54, v130
 v_mfma_f32_16x16x32_bf16 v[64:67], a[52:55], v[52:55], v[64:67]
 v_rcp_f32 v129, v129
 v_mfma_f32_16x16x32_bf16 v[68:71], a[192:195], v[48:51], v[68:71]
 v_exp_f32 v130, v130
 v_mfma_f32_16x16x32_bf16 v[68:71], a[196:199], v[52:55], v[68:71]
 v_mul_f32 v133, v129, v133
 v_add_f32 v130, 1.0, v130
 v_mfma_f32_16x16x32_bf16 v[72:75], a[120:123], v[48:51], v[72:75]
 ds_read_b128 v[44:47], v21 offset:18432
 v_mul_f32 v135, v131, v135
 v_mfma_f32_16x16x32_bf16 v[72:75], a[124:127], v[52:55], v[72:75]
 v_rcp_f32 v130, v130
 v_mfma_f32_16x16x32_bf16 v[76:79], v[232:235], v[48:51], v[76:79]
 v_mul_f32 v134, v130, v134
 v_mul_f32 v131, s54, v131
 v_mfma_f32_16x16x32_bf16 v[76:79], v[236:239], v[52:55], v[76:79]
 s_waitcnt lgkmcnt(2)
 v_exp_f32 v131, v131
 v_mfma_f32_16x16x32_bf16 v[64:67], a[56:59], v[56:59], v[64:67]
 ds_read_b128 v[48:51], v20 offset:19456
 v_add_f32 v131, 1.0, v131
 v_mfma_f32_16x16x32_bf16 v[64:67], a[60:63], v[60:63], v[64:67]
 buffer_load_dwordx4 v18, s[8:11], s36 offen offset:2048  lds
 v_mul_f32 v140, v136, v140
 v_mfma_f32_16x16x32_bf16 v[68:71], a[200:203], v[56:59], v[68:71]
 v_rcp_f32 v131, v131
 v_mfma_f32_16x16x32_bf16 v[68:71], a[204:207], v[60:63], v[68:71]
 v_mul_f32 v135, v131, v135
 v_mul_f32 v136, s54, v136
 v_mfma_f32_16x16x32_bf16 v[72:75], a[128:131], v[56:59], v[72:75]
 ds_read_b128 v[52:55], v21 offset:19456
 v_mul_f32 v141, v137, v141
 v_mfma_f32_16x16x32_bf16 v[72:75], a[132:135], v[60:63], v[72:75]
 buffer_load_dwordx4 v18, s[8:11], s37 offen offset:3072  lds
 v_mul_f32 v137, s54, v137
 v_mfma_f32_16x16x32_bf16 v[76:79], v[240:243], v[56:59], v[76:79]
 v_exp_f32 v136, v136
 v_mfma_f32_16x16x32_bf16 v[76:79], v[244:247], v[60:63], v[76:79]
 v_exp_f32 v137, v137
 v_mfma_f32_16x16x32_bf16 v[64:67], a[64:67], v[32:35], v[64:67]
 ds_read_b128 v[56:59], v20 offset:20480
 v_add_f32 v136, 1.0, v136
 v_mfma_f32_16x16x32_bf16 v[64:67], a[68:71], v[36:39], v[64:67]
 s_add_u32 m0, s56, 106496
 v_rcp_f32 v136, v136
 v_mfma_f32_16x16x32_bf16 v[68:71], a[208:211], v[32:35], v[68:71]
 buffer_load_dwordx4 v18, s[8:11], s38 offen  lds
 v_mul_f32 v140, v136, v140
 v_mfma_f32_16x16x32_bf16 v[68:71], a[212:215], v[36:39], v[68:71]
 v_add_f32 v137, 1.0, v137
 v_mul_f32 v142, v138, v142
 v_mfma_f32_16x16x32_bf16 v[72:75], a[136:139], v[32:35], v[72:75]
 ds_read_b128 v[60:63], v21 offset:20480
 v_mul_f32 v138, s54, v138
 v_mfma_f32_16x16x32_bf16 v[72:75], a[140:143], v[36:39], v[72:75]
 v_rcp_f32 v137, v137
 v_mfma_f32_16x16x32_bf16 v[76:79], v[248:251], v[32:35], v[76:79]
 v_add_u32 v18, 36864, v18
 v_mul_f32 v141, v137, v141
 v_mfma_f32_16x16x32_bf16 v[76:79], v[252:255], v[36:39], v[76:79]
 s_waitcnt lgkmcnt(2)
 v_exp_f32 v138, v138
 v_mfma_f32_16x16x32_bf16 v[80:83], a[0:3], v[40:43], 0
 ds_read_b128 v[32:35], v20 offset:21504
 v_add_f32 v138, 1.0, v138
 v_mfma_f32_16x16x32_bf16 v[80:83], a[4:7], v[44:47], v[80:83]
 v_rcp_f32 v138, v138
 v_mfma_f32_16x16x32_bf16 v[84:87], a[144:147], v[40:43], 0
 v_mul_f32 v142, v138, v142
 v_mul_f32 v143, v139, v143
 v_mfma_f32_16x16x32_bf16 v[84:87], a[148:151], v[44:47], v[84:87]
 v_mul_f32 v139, s54, v139
 v_cvt_pk_bf16_f32 v128, v132, v133
 v_mfma_f32_16x16x32_bf16 v[88:91], a[72:75], v[40:43], 0
 ds_read_b128 v[36:39], v21 offset:21504
 v_cvt_pk_bf16_f32 v129, v134, v135
 v_mfma_f32_16x16x32_bf16 v[88:91], a[76:79], v[44:47], v[88:91]
 v_exp_f32 v139, v139
 v_mfma_f32_16x16x32_bf16 v[92:95], a[216:219], v[40:43], 0
 v_add_f32 v139, 1.0, v139
 v_cvt_pk_bf16_f32 v130, v140, v141
 v_mfma_f32_16x16x32_bf16 v[92:95], a[220:223], v[44:47], v[92:95]
 v_rcp_f32 v139, v139
 v_mfma_f32_16x16x32_bf16 v[80:83], a[8:11], v[48:51], v[80:83]
 ds_read_b128 v[40:43], v20 offset:22528
 v_mul_f32 v143, v139, v143
 v_mfma_f32_16x16x32_bf16 v[80:83], a[12:15], v[52:55], v[80:83]
 v_cvt_pk_bf16_f32 v131, v142, v143
 v_mul_f32 v148, v144, v148
 v_mfma_f32_16x16x32_bf16 v[84:87], a[152:155], v[48:51], v[84:87]
 buffer_store_dwordx4 v[128:131], v19, s[16:19], s53 offen sc1
 v_mul_f32 v144, s54, v144
 v_mfma_f32_16x16x32_bf16 v[84:87], a[156:159], v[52:55], v[84:87]
 s_add_u32 s53, s53, s52
 v_exp_f32 v144, v144
 v_mfma_f32_16x16x32_bf16 v[88:91], a[80:83], v[48:51], v[88:91]
 ds_read_b128 v[44:47], v21 offset:22528
 v_add_f32 v144, 1.0, v144
 v_mfma_f32_16x16x32_bf16 v[88:91], a[84:87], v[52:55], v[88:91]
 v_rcp_f32 v144, v144
 v_mfma_f32_16x16x32_bf16 v[92:95], a[224:227], v[48:51], v[92:95]
 v_mul_f32 v148, v144, v148
 v_mul_f32 v149, v145, v149
 v_mfma_f32_16x16x32_bf16 v[92:95], a[228:231], v[52:55], v[92:95]
 s_waitcnt lgkmcnt(2)
 v_mul_f32 v145, s54, v145
 v_mul_f32 v150, v146, v150
 v_mfma_f32_16x16x32_bf16 v[80:83], a[16:19], v[56:59], v[80:83]
 ds_read_b128 v[48:51], v20 offset:23552
 v_mul_f32 v146, s54, v146
 v_mfma_f32_16x16x32_bf16 v[80:83], a[20:23], v[60:63], v[80:83]
 v_exp_f32 v145, v145
 v_mfma_f32_16x16x32_bf16 v[84:87], a[160:163], v[56:59], v[84:87]
 v_exp_f32 v146, v146
 v_mfma_f32_16x16x32_bf16 v[84:87], a[164:167], v[60:63], v[84:87]
 v_add_f32 v145, 1.0, v145
 v_add_f32 v146, 1.0, v146
 v_mfma_f32_16x16x32_bf16 v[88:91], a[88:91], v[56:59], v[88:91]
 ds_read_b128 v[52:55], v21 offset:23552
 v_mul_f32 v151, v147, v151
 v_mfma_f32_16x16x32_bf16 v[88:91], a[92:95], v[60:63], v[88:91]
 v_rcp_f32 v145, v145
 v_mfma_f32_16x16x32_bf16 v[92:95], a[232:235], v[56:59], v[92:95]
 v_rcp_f32 v146, v146
 v_mfma_f32_16x16x32_bf16 v[92:95], a[236:239], v[60:63], v[92:95]
 v_mul_f32 v149, v145, v149
 v_mul_f32 v150, v146, v150
 v_mfma_f32_16x16x32_bf16 v[80:83], a[24:27], v[32:35], v[80:83]
 ds_read_b128 v[56:59], v20 offset:24576
 v_mul_f32 v147, s54, v147
 v_mfma_f32_16x16x32_bf16 v[80:83], a[28:31], v[36:39], v[80:83]
 v_exp_f32 v147, v147
 v_mfma_f32_16x16x32_bf16 v[84:87], a[168:171], v[32:35], v[84:87]
 v_add_f32 v147, 1.0, v147
 v_mul_f32 v156, v152, v156
 v_mfma_f32_16x16x32_bf16 v[84:87], a[172:175], v[36:39], v[84:87]
 v_rcp_f32 v147, v147
 v_mfma_f32_16x16x32_bf16 v[88:91], a[96:99], v[32:35], v[88:91]
 ds_read_b128 v[60:63], v21 offset:24576
 v_mul_f32 v151, v147, v151
 v_mfma_f32_16x16x32_bf16 v[88:91], a[100:103], v[36:39], v[88:91]
 v_mul_f32 v152, s54, v152
 v_mul_f32 v157, v153, v157
 v_mfma_f32_16x16x32_bf16 v[92:95], a[240:243], v[32:35], v[92:95]
 v_exp_f32 v152, v152
 v_mfma_f32_16x16x32_bf16 v[92:95], a[244:247], v[36:39], v[92:95]
 s_waitcnt lgkmcnt(2)
 v_add_f32 v152, 1.0, v152
 v_mul_f32 v153, s54, v153
 v_mfma_f32_16x16x32_bf16 v[80:83], a[32:35], v[40:43], v[80:83]
 ds_read_b128 v[32:35], v20 offset:25600
 v_mul_f32 v158, v154, v158
 v_mfma_f32_16x16x32_bf16 v[80:83], a[36:39], v[44:47], v[80:83]
 v_rcp_f32 v152, v152
 v_mfma_f32_16x16x32_bf16 v[84:87], a[176:179], v[40:43], v[84:87]
 v_exp_f32 v153, v153
 v_mfma_f32_16x16x32_bf16 v[84:87], a[180:183], v[44:47], v[84:87]
 v_mul_f32 v156, v152, v156
 v_add_f32 v153, 1.0, v153
 v_mfma_f32_16x16x32_bf16 v[88:91], a[104:107], v[40:43], v[88:91]
 ds_read_b128 v[36:39], v21 offset:25600
 v_mul_f32 v154, s54, v154
 v_mfma_f32_16x16x32_bf16 v[88:91], a[108:111], v[44:47], v[88:91]
 v_rcp_f32 v153, v153
 v_mfma_f32_16x16x32_bf16 v[92:95], a[248:251], v[40:43], v[92:95]
 v_exp_f32 v154, v154
 v_mfma_f32_16x16x32_bf16 v[92:95], a[252:255], v[44:47], v[92:95]
 v_mul_f32 v157, v153, v157
 v_add_f32 v154, 1.0, v154
 v_mfma_f32_16x16x32_bf16 v[80:83], a[40:43], v[48:51], v[80:83]
 ds_read_b128 v[40:43], v20 offset:26624
 v_mul_f32 v159, v155, v159
 v_mfma_f32_16x16x32_bf16 v[80:83], a[44:47], v[52:55], v[80:83]
 v_rcp_f32 v154, v154
 v_mfma_f32_16x16x32_bf16 v[84:87], a[184:187], v[48:51], v[84:87]
 v_mul_f32 v158, v154, v158
 v_mul_f32 v155, s54, v155
 v_mfma_f32_16x16x32_bf16 v[84:87], a[188:191], v[52:55], v[84:87]
 v_exp_f32 v155, v155
 v_mfma_f32_16x16x32_bf16 v[88:91], a[112:115], v[48:51], v[88:91]
 ds_read_b128 v[44:47], v21 offset:26624
 v_add_f32 v155, 1.0, v155
 v_mfma_f32_16x16x32_bf16 v[88:91], a[116:119], v[52:55], v[88:91]
 v_rcp_f32 v155, v155
 v_mfma_f32_16x16x32_bf16 v[92:95], v[224:227], v[48:51], v[92:95]
 v_mul_f32 v159, v155, v159
 v_cvt_pk_bf16_f32 v144, v148, v149
 v_mfma_f32_16x16x32_bf16 v[92:95], v[228:231], v[52:55], v[92:95]
 s_waitcnt lgkmcnt(2)
 v_cvt_pk_bf16_f32 v145, v150, v151
 v_cvt_pk_bf16_f32 v146, v156, v157
 v_mfma_f32_16x16x32_bf16 v[80:83], a[48:51], v[56:59], v[80:83]
 v_cvt_pk_bf16_f32 v147, v158, v159
 v_mul_f32 v164, v160, v164
 v_mfma_f32_16x16x32_bf16 v[80:83], a[52:55], v[60:63], v[80:83]
 buffer_store_dwordx4 v[144:147], v19, s[16:19], s53 offen sc1
 v_mul_f32 v160, s54, v160
 v_mfma_f32_16x16x32_bf16 v[84:87], a[192:195], v[56:59], v[84:87]
 s_add_u32 s53, s53, s52
 v_exp_f32 v160, v160
 v_mfma_f32_16x16x32_bf16 v[84:87], a[196:199], v[60:63], v[84:87]
 v_add_f32 v160, 1.0, v160
 v_mul_f32 v165, v161, v165
 v_mfma_f32_16x16x32_bf16 v[88:91], a[120:123], v[56:59], v[88:91]
 v_rcp_f32 v160, v160
 v_mfma_f32_16x16x32_bf16 v[88:91], a[124:127], v[60:63], v[88:91]
 v_mul_f32 v164, v160, v164
 v_mul_f32 v161, s54, v161
 v_mfma_f32_16x16x32_bf16 v[92:95], v[232:235], v[56:59], v[92:95]
 s_waitcnt vmcnt(13) lgkmcnt(0)
 s_barrier
 v_mul_f32 v166, v162, v166
 v_mfma_f32_16x16x32_bf16 v[92:95], v[236:239], v[60:63], v[92:95]
 ds_read_b128 v[48:51], v22 offset:0
 v_mul_f32 v162, s54, v162
 v_mfma_f32_16x16x32_bf16 v[80:83], a[56:59], v[32:35], v[80:83]
 ds_read_b128 v[52:55], v23 offset:0
 v_mul_f32 v167, v163, v167
 v_mfma_f32_16x16x32_bf16 v[80:83], a[60:63], v[36:39], v[80:83]
 ds_read_b128 v[56:59], v22 offset:1024
 v_mul_f32 v163, s54, v163
 v_mfma_f32_16x16x32_bf16 v[84:87], a[200:203], v[32:35], v[84:87]
 v_exp_f32 v161, v161
 v_mfma_f32_16x16x32_bf16 v[84:87], a[204:207], v[36:39], v[84:87]
 v_exp_f32 v162, v162
 v_mfma_f32_16x16x32_bf16 v[88:91], a[128:131], v[32:35], v[88:91]
 ds_read_b128 v[60:63], v23 offset:1024
 v_add_f32 v161, 1.0, v161
 v_mfma_f32_16x16x32_bf16 v[88:91], a[132:135], v[36:39], v[88:91]
 s_load_dword s68, s[6:7], 0
 v_rcp_f32 v161, v161
 v_mfma_f32_16x16x32_bf16 v[92:95], v[240:243], v[32:35], v[92:95]
 v_exp_f32 v163, v163
 v_mfma_f32_16x16x32_bf16 v[92:95], v[244:247], v[36:39], v[92:95]
 v_mul_f32 v165, v161, v165
 v_add_f32 v162, 1.0, v162
 v_mfma_f32_16x16x32_bf16 v[80:83], a[64:67], v[40:43], v[80:83]
 ds_read_b128 v[32:35], v22 offset:2048
 v_add_f32 v163, 1.0, v163
 v_mfma_f32_16x16x32_bf16 v[80:83], a[68:71], v[44:47], v[80:83]
 v_rcp_f32 v162, v162
 v_mfma_f32_16x16x32_bf16 v[84:87], a[208:211], v[40:43], v[84:87]
 s_add_u32 m0, s56, 0
 v_rcp_f32 v163, v163
 v_mfma_f32_16x16x32_bf16 v[84:87], a[212:215], v[44:47], v[84:87]
 buffer_load_dwordx4 v18, s[8:11], s30 offen  lds
 v_mul_f32 v166, v162, v166
 v_mfma_f32_16x16x32_bf16 v[88:91], a[136:139], v[40:43], v[88:91]
 ds_read_b128 v[36:39], v23 offset:2048
 v_mul_f32 v167, v163, v167
 v_mfma_f32_16x16x32_bf16 v[88:91], a[140:143], v[44:47], v[88:91]
 v_mul_f32 v172, v168, v172
 v_mul_f32 v173, v169, v173
 v_mfma_f32_16x16x32_bf16 v[92:95], v[248:251], v[40:43], v[92:95]
 v_mul_f32 v168, s54, v168
 v_mul_f32 v169, s54, v169
 v_mfma_f32_16x16x32_bf16 v[92:95], v[252:255], v[44:47], v[92:95]
 s_waitcnt lgkmcnt(4)
 v_exp_f32 v168, v168
 v_mfma_f32_16x16x32_bf16 v[96:99], a[0:3], v[48:51], 0
 ds_read_b128 v[40:43], v22 offset:3072
 v_add_f32 v168, 1.0, v168
 v_mfma_f32_16x16x32_bf16 v[96:99], a[4:7], v[52:55], v[96:99]
 buffer_load_dwordx4 v18, s[8:11], s31 offen offset:1024  lds
 v_mul_f32 v174, v170, v174
 v_mfma_f32_16x16x32_bf16 v[100:103], a[144:147], v[48:51], 0
 v_rcp_f32 v168, v168
 v_mfma_f32_16x16x32_bf16 v[100:103], a[148:151], v[52:55], v[100:103]
 v_exp_f32 v169, v169
 v_mfma_f32_16x16x32_bf16 v[104:107], a[72:75], v[48:51], 0
 ds_read_b128 v[44:47], v23 offset:3072
 v_mul_f32 v172, v168, v172
 v_mfma_f32_16x16x32_bf16 v[104:107], a[76:79], v[52:55], v[104:107]
 buffer_load_dwordx4 v18, s[8:11], s32 offen offset:2048  lds
 v_lshl_add_u32 v3, v0, 7, s57
 v_mfma_f32_16x16x32_bf16 v[108:111], a[216:219], v[48:51], 0
Lpg10:
 s_cbranch_vccnz Lj_Lfin
 v_min_u32 v3, L_text_end-gated_mix__ssm_conv_s4d__swiglu_ffn__prompt_kernel-4, v3
 v_add_f32 v169, 1.0, v169
 v_mfma_f32_16x16x32_bf16 v[108:111], a[220:223], v[52:55], v[108:111]
 s_waitcnt lgkmcnt(4)
 v_rcp_f32 v169, v169
 v_mfma_f32_16x16x32_bf16 v[96:99], a[8:11], v[56:59], v[96:99]
 ds_read_b128 v[48:51], v22 offset:4096
 v_mul_f32 v173, v169, v173
 v_mfma_f32_16x16x32_bf16 v[96:99], a[12:15], v[60:63], v[96:99]
 buffer_load_dwordx4 v18, s[8:11], s33 offen offset:3072  lds
 v_mul_f32 v170, s54, v170
 v_mfma_f32_16x16x32_bf16 v[100:103], a[152:155], v[56:59], v[100:103]
 v_exp_f32 v170, v170
 v_mfma_f32_16x16x32_bf16 v[100:103], a[156:159], v[60:63], v[100:103]
 v_add_f32 v170, 1.0, v170
 v_mul_f32 v175, v171, v175
 v_mfma_f32_16x16x32_bf16 v[104:107], a[80:83], v[56:59], v[104:107]
 ds_read_b128 v[52:55], v23 offset:4096
 v_mul_f32 v171, s54, v171
 v_mfma_f32_16x16x32_bf16 v[104:107], a[84:87], v[60:63], v[104:107]
 s_add_u32 m0, s56, 4096
 v_rcp_f32 v170, v170
 v_mfma_f32_16x16x32_bf16 v[108:111], a[224:227], v[56:59], v[108:111]
 buffer_load_dwordx4 v18, s[8:11], s34 offen  lds
 v_mul_f32 v174, v170, v174
 v_mfma_f32_16x16x32_bf16 v[108:111], a[228:231], v[60:63], v[108:111]
 s_waitcnt lgkmcnt(4)
 v_exp_f32 v171, v171
 v_mfma_f32_16x16x32_bf16 v[96:99], a[16:19], v[32:35], v[96:99]
 ds_read_b128 v[56:59], v22 offset:5120
 v_add_f32 v171, 1.0, v171
 v_mfma_f32_16x16x32_bf16 v[96:99], a[20:23], v[36:39], v[96:99]
 v_rcp_f32 v171, v171
 v_mfma_f32_16x16x32_bf16 v[100:103], a[160:163], v[32:35], v[100:103]
 buffer_load_dwordx4 v18, s[8:11], s35 offen offset:1024  lds
 v_mul_f32 v175, v171, v175
 v_mfma_f32_16x16x32_bf16 v[100:103], a[164:167], v[36:39], v[100:103]
 v_cvt_pk_bf16_f32 v160, v164, v165
 v_cvt_pk_bf16_f32 v161, v166, v167
 v_mfma_f32_16x16x32_bf16 v[104:107], a[88:91], v[32:35], v[104:107]
 ds_read_b128 v[60:63], v23 offset:5120
 v_cvt_pk_bf16_f32 v162, v172, v173
 v_mfma_f32_16x16x32_bf16 v[104:107], a[92:95], v[36:39], v[104:107]
 v_cvt_pk_bf16_f32 v163, v174, v175
 v_mul_f32 v180, v176, v180
 v_mfma_f32_16x16x32_bf16 v[108:111], a[232:235], v[32:35], v[108:111]
 buffer_store_dwordx4 v[160:163], v19, s[16:19], s53 offen sc1
 v_mul_f32 v176, s54, v176
 v_mfma_f32_16x16x32_bf16 v[108:111], a[236:239], v[36:39], v[108:111]
 s_waitcnt lgkmcnt(4)
 s_add_u32 s53, s53, s52
 v_mul_f32 v181, v177, v181
 v_mfma_f32_16x16x32_bf16 v[96:99], a[24:27], v[40:43], v[96:99]
 ds_read_b128 v[32:35], v22 offset:6144
 v_mul_f32 v177, s54, v177
 v_mfma_f32_16x16x32_bf16 v[96:99], a[28:31], v[44:47], v[96:99]
 v_exp_f32 v176, v176
 v_mfma_f32_16x16x32_bf16 v[100:103], a[168:171], v[40:43], v[100:103]
 v_exp_f32 v177, v177
 v_mfma_f32_16x16x32_bf16 v[100:103], a[172:175], v[44:47], v[100:103]
 v_add_f32 v176, 1.0, v176
 v_add_f32 v177, 1.0, v177
 v_mfma_f32_16x16x32_bf16 v[104:107], a[96:99], v[40:43], v[104:107]
 ds_read_b128 v[36:39], v23 offset:6144
 v_mul_f32 v182, v178, v182
 v_mfma_f32_16x16x32_bf16 v[104:107], a[100:103], v[44:47], v[104:107]
 v_rcp_f32 v176, v176
 v_mfma_f32_16x16x32_bf16 v[108:111], a[240:243], v[40:43], v[108:111]
 v_rcp_f32 v177, v177
 v_mfma_f32_16x16x32_bf16 v[108:111], a[244:247], v[44:47], v[108:111]
 s_waitcnt lgkmcnt(4)
 v_mul_f32 v180, v176, v180
 v_mul_f32 v181, v177, v181
 v_mfma_f32_16x16x32_bf16 v[96:99], a[32:35], v[48:51], v[96:99]
 ds_read_b128 v[40:43], v22 offset:7168
 v_mul_f32 v178, s54, v178
 v_mfma_f32_16x16x32_bf16 v[96:99], a[36:39], v[52:55], v[96:99]
 v_exp_f32 v178, v178
 v_mfma_f32_16x16x32_bf16 v[100:103], a[176:179], v[48:51], v[100:103]
 v_add_f32 v178, 1.0, v178
 v_mul_f32 v183, v179, v183
 v_mfma_f32_16x16x32_bf16 v[100:103], a[180:183], v[52:55], v[100:103]
 v_rcp_f32 v178, v178
 v_mfma_f32_16x16x32_bf16 v[104:107], a[104:107], v[48:51], v[104:107]
 ds_read_b128 v[44:47], v23 offset:7168
 v_mul_f32 v182, v178, v182
 v_mfma_f32_16x16x32_bf16 v[104:107], a[108:111], v[52:55], v[104:107]
 v_mul_f32 v179, s54, v179
 v_mul_f32 v188, v184, v188
 v_mfma_f32_16x16x32_bf16 v[108:111], a[248:251], v[48:51], v[108:111]
 buffer_load_dwordx4 v18, s[8:11], s36 offen offset:2048  lds
 v_mul_f32 v184, s54, v184
 v_mfma_f32_16x16x32_bf16 v[108:111], a[252:255], v[52:55], v[108:111]
 s_waitcnt lgkmcnt(4)
 v_exp_f32 v179, v179
 v_mfma_f32_16x16x32_bf16 v[96:99], a[40:43], v[56:59], v[96:99]
 ds_read_b128 v[48:51], v22 offset:8192
 v_add_f32 v179, 1.0, v179
 v_mfma_f32_16x16x32_bf16 v[96:99], a[44:47], v[60:63], v[96:99]
 v_rcp_f32 v179, v179
 v_mfma_f32_16x16x32_bf16 v[100:103], a[184:187], v[56:59], v[100:103]
 buffer_load_dwordx4 v18, s[8:11], s37 offen offset:3072  lds
 v_mul_f32 v183, v179, v183
 v_mfma_f32_16x16x32_bf16 v[100:103], a[188:191], v[60:63], v[100:103]
 v_exp_f32 v184, v184
 v_mfma_f32_16x16x32_bf16 v[104:107], a[112:115], v[56:59], v[104:107]
 ds_read_b128 v[52:55], v23 offset:8192
 v_add_f32 v184, 1.0, v184
 v_mfma_f32_16x16x32_bf16 v[104:107], a[116:119], v[60:63], v[104:107]
 v_rcp_f32 v184, v184
 v_mfma_f32_16x16x32_bf16 v[108:111], v[224:227], v[56:59], v[108:111]
 s_add_u32 m0, s56, 8192
 v_mul_f32 v188, v184, v188
 v_mul_f32 v189, v185, v189
 v_mfma_f32_16x16x32_bf16 v[108:111], v[228:231], v[60:63], v[108:111]
 s_waitcnt lgkmcnt(4)
 v_mul_f32 v185, s54, v185
 v_mul_f32 v190, v186, v190
 v_mfma_f32_16x16x32_bf16 v[96:99], a[48:51], v[32:35], v[96:99]
 ds_read_b128 v[56:59], v22 offset:18432
 v_mul_f32 v186, s54, v186
 v_mfma_f32_16x16x32_bf16 v[96:99], a[52:55], v[36:39], v[96:99]
 buffer_load_dwordx4 v18, s[8:11], s38 offen  lds
 v_mul_f32 v191, v187, v191
 v_mfma_f32_16x16x32_bf16 v[100:103], a[192:195], v[32:35], v[100:103]
 global_load_dword v4, v3, s[20:21]
 v_mul_f32 v187, s54, v187
 v_mfma_f32_16x16x32_bf16 v[100:103], a[196:199], v[36:39], v[100:103]
 v_exp_f32 v185, v185
 v_mfma_f32_16x16x32_bf16 v[104:107], a[120:123], v[32:35], v[104:107]
 ds_read_b128 v[60:63], v23 offset:18432
 v_add_f32 v185, 1.0, v185
 v_mfma_f32_16x16x32_bf16 v[104:107], a[124:127], v[36:39], v[104:107]
 v_add_u32 v18, 36864, v18
 v_cvt_pk_bf16_f32 v176, v180, v181
 v_mfma_f32_16x16x32_bf16 v[108:111], v[232:235], v[32:35], v[108:111]
 v_rcp_f32 v185, v185
 v_mfma_f32_16x16x32_bf16 v[108:111], v[236:239], v[36:39], v[108:111]
 s_waitcnt lgkmcnt(2)
 v_exp_f32 v186, v186
 v_mfma_f32_16x16x32_bf16 v[96:99], a[56:59], v[40:43], v[96:99]
 ds_read_b128 v[32:35], v22 offset:19456
 v_mul_f32 v189, v185, v189
 v_mfma_f32_16x16x32_bf16 v[96:99], a[60:63], v[44:47], v[96:99]
 v_exp_f32 v187, v187
 v_mfma_f32_16x16x32_bf16 v[100:103], a[200:203], v[40:43], v[100:103]
 v_add_f32 v186, 1.0, v186
 v_add_f32 v187, 1.0, v187
 v_mfma_f32_16x16x32_bf16 v[100:103], a[204:207], v[44:47], v[100:103]
 v_rcp_f32 v186, v186
 v_mfma_f32_16x16x32_bf16 v[104:107], a[128:131], v[40:43], v[104:107]
 ds_read_b128 v[36:39], v23 offset:19456
 v_mul_f32 v190, v186, v190
 v_mfma_f32_16x16x32_bf16 v[104:107], a[132:135], v[44:47], v[104:107]
 v_rcp_f32 v187, v187
 v_mfma_f32_16x16x32_bf16 v[108:111], v[240:243], v[40:43], v[108:111]
 v_mul_f32 v191, v187, v191
 v_cvt_pk_bf16_f32 v177, v182, v183
 v_mfma_f32_16x16x32_bf16 v[108:111], v[244:247], v[44:47], v[108:111]
 v_cvt_pk_bf16_f32 v178, v188, v189
 v_cvt_pk_bf16_f32 v179, v190, v191
 v_mfma_f32_16x16x32_bf16 v[96:99], a[64:67], v[48:51], v[96:99]
 ds_read_b128 v[40:43], v22 offset:20480
 v_mul_f32 v196, v192, v196
 v_mfma_f32_16x16x32_bf16 v[96:99], a[68:71], v[52:55], v[96:99]
 buffer_store_dwordx4 v[176:179], v19, s[16:19], s53 offen sc1
 v_mul_f32 v192, s54, v192
 v_mfma_f32_16x16x32_bf16 v[100:103], a[208:211], v[48:51], v[100:103]
 s_add_u32 s53, s53, s52
 v_exp_f32 v192, v192
 v_mfma_f32_16x16x32_bf16 v[100:103], a[212:215], v[52:55], v[100:103]
 v_add_f32 v192, 1.0, v192
 v_mul_f32 v197, v193, v197
 v_mfma_f32_16x16x32_bf16 v[104:107], a[136:139], v[48:51], v[104:107]
 ds_read_b128 v[44:47], v23 offset:20480
 v_mul_f32 v193, s54, v193
 v_mfma_f32_16x16x32_bf16 v[104:107], a[140:143], v[52:55], v[104:107]
 v_rcp_f32 v192, v192
 v_mfma_f32_16x16x32_bf16 v[108:111], v[248:251], v[48:51], v[108:111]
 v_exp_f32 v193, v193
 v_mfma_f32_16x16x32_bf16 v[108:111], v[252:255], v[52:55], v[108:111]
 s_waitcnt lgkmcnt(2)
 v_mul_f32 v196, v192, v196
 v_add_f32 v193, 1.0, v193
 v_mfma_f32_16x16x32_bf16 v[112:115], a[0:3], v[56:59], 0
 ds_read_b128 v[48:51], v22 offset:21504
 v_mul_f32 v198, v194, v198
 v_mfma_f32_16x16x32_bf16 v[112:115], a[4:7], v[60:63], v[112:115]
 v_rcp_f32 v193, v193
 v_mfma_f32_16x16x32_bf16 v[116:119], a[144:147], v[56:59], 0
 v_mul_f32 v197, v193, v197
 v_mul_f32 v194, s54, v194
 v_mfma_f32_16x16x32_bf16 v[116:119], a[148:151], v[60:63], v[116:119]
 v_exp_f32 v194, v194
 v_mfma_f32_16x16x32_bf16 v[120:123], a[72:75], v[56:59], 0
 ds_read_b128 v[52:55], v23 offset:21504
 v_add_f32 v194, 1.0, v194
 v_mfma_f32_16x16x32_bf16 v[120:123], a[76:79], v[60:63], v[120:123]
 v_rcp_f32 v194, v194
 v_mfma_f32_16x16x32_bf16 v[124:127], a[216:219], v[56:59], 0
 v_mul_f32 v198, v194, v198
 v_mul_f32 v199, v195, v199
 v_mfma_f32_16x16x32_bf16 v[124:127], a[220:223], v[60:63], v[124:127]
 v_mul_f32 v195, s54, v195
 v_mul_f32 v204, v200, v204
 v_mfma_f32_16x16x32_bf16 v[112:115], a[8:11], v[32:35], v[112:115]
 ds_read_b128 v[56:59], v22 offset:22528
 v_mul_f32 v200, s54, v200
 v_mfma_f32_16x16x32_bf16 v[112:115], a[12:15], v[36:39], v[112:115]
 v_exp_f32 v195, v195
 v_mfma_f32_16x16x32_bf16 v[116:119], a[152:155], v[32:35], v[116:119]
 v_exp_f32 v200, v200
 v_mfma_f32_16x16x32_bf16 v[116:119], a[156:159], v[36:39], v[116:119]
 v_add_f32 v195, 1.0, v195
 v_add_f32 v200, 1.0, v200
 v_mfma_f32_16x16x32_bf16 v[120:123], a[80:83], v[32:35], v[120:123]
 ds_read_b128 v[60:63], v23 offset:22528
 v_mul_f32 v205, v201, v205
 v_mfma_f32_16x16x32_bf16 v[120:123], a[84:87], v[36:39], v[120:123]
 v_rcp_f32 v195, v195
 v_mfma_f32_16x16x32_bf16 v[124:127], a[224:227], v[32:35], v[124:127]
 v_rcp_f32 v200, v200
 v_mfma_f32_16x16x32_bf16 v[124:127], a[228:231], v[36:39], v[124:127]
 s_waitcnt lgkmcnt(2)
 v_mul_f32 v199, v195, v199
 v_mul_f32 v204, v200, v204
 v_mfma_f32_16x16x32_bf16 v[112:115], a[16:19], v[40:43], v[112:115]
 ds_read_b128 v[32:35], v22 offset:23552
 v_mul_f32 v201, s54, v201
 v_mfma_f32_16x16x32_bf16 v[112:115], a[20:23], v[44:47], v[112:115]
 v_exp_f32 v201, v201
 v_mfma_f32_16x16x32_bf16 v[116:119], a[160:163], v[40:43], v[116:119]
 v_add_f32 v201, 1.0, v201
 v_mul_f32 v206, v202, v206
 v_mfma_f32_16x16x32_bf16 v[116:119], a[164:167], v[44:47], v[116:119]
 v_rcp_f32 v201, v201
 v_mfma_f32_16x16x32_bf16 v[120:123], a[88:91], v[40:43], v[120:123]
 ds_read_b128 v[36:39], v23 offset:23552
 v_mul_f32 v205, v201, v205
 v_mfma_f32_16x16x32_bf16 v[120:123], a[92:95], v[44:47], v[120:123]
 v_mul_f32 v202, s54, v202
 v_mul_f32 v207, v203, v207
 v_mfma_f32_16x16x32_bf16 v[124:127], a[232:235], v[40:43], v[124:127]
 v_exp_f32 v202, v202
 v_mfma_f32_16x16x32_bf16 v[124:127], a[236:239], v[44:47], v[124:127]
 v_add_f32 v202, 1.0, v202
 v_mul_f32 v203, s54, v203
 v_mfma_f32_16x16x32_bf16 v[112:115], a[24:27], v[48:51], v[112:115]
 ds_read_b128 v[40:43], v22 offset:24576
 v_cvt_pk_bf16_f32 v192, v196, v197
 v_mfma_f32_16x16x32_bf16 v[112:115], a[28:31], v[52:55], v[112:115]
 v_rcp_f32 v202, v202
 v_mfma_f32_16x16x32_bf16 v[116:119], a[168:171], v[48:51], v[116:119]
 v_exp_f32 v203, v203
 v_mfma_f32_16x16x32_bf16 v[116:119], a[172:175], v[52:55], v[116:119]
 v_mul_f32 v206, v202, v206
 v_add_f32 v203, 1.0, v203
 v_mfma_f32_16x16x32_bf16 v[120:123], a[96:99], v[48:51], v[120:123]
 ds_read_b128 v[44:47], v23 offset:24576
 v_cvt_pk_bf16_f32 v193, v198, v199
 v_mfma_f32_16x16x32_bf16 v[120:123], a[100:103], v[52:55], v[120:123]
 v_rcp_f32 v203, v203
 v_mfma_f32_16x16x32_bf16 v[124:127], a[240:243], v[48:51], v[124:127]
 v_mul_f32 v207, v203, v207
 v_cvt_pk_bf16_f32 v194, v204, v205
 v_mfma_f32_16x16x32_bf16 v[124:127], a[244:247], v[52:55], v[124:127]
 s_waitcnt lgkmcnt(2)
 v_cvt_pk_bf16_f32 v195, v206, v207
 v_mul_f32 v212, v208, v212
 v_mfma_f32_16x16x32_bf16 v[112:115], a[32:35], v[56:59], v[112:115]
 ds_read_b128 v[48:51], v22 offset:25600
 v_mul_f32 v208, s54, v208
 v_mfma_f32_16x16x32_bf16 v[112:115], a[36:39], v[60:63], v[112:115]
 buffer_store_dwordx4 v[192:195], v19, s[16:19], s53 offen sc1
 v_mul_f32 v213, v209, v213
 v_mfma_f32_16x16x32_bf16 v[116:119], a[176:179], v[56:59], v[116:119]
 s_add_u32 s53, s53, s52
 v_exp_f32 v208, v208
 v_mfma_f32_16x16x32_bf16 v[116:119], a[180:183], v[60:63], v[116:119]
 v_add_f32 v208, 1.0, v208
 v_mul_f32 v209, s54, v209
 v_mfma_f32_16x16x32_bf16 v[120:123], a[104:107], v[56:59], v[120:123]
 ds_read_b128 v[52:55], v23 offset:25600
 v_mul_f32 v214, v210, v214
 v_mfma_f32_16x16x32_bf16 v[120:123], a[108:111], v[60:63], v[120:123]
 v_rcp_f32 v208, v208
 v_mfma_f32_16x16x32_bf16 v[124:127], a[248:251], v[56:59], v[124:127]
 v_exp_f32 v209, v209
 v_mfma_f32_16x16x32_bf16 v[124:127], a[252:255], v[60:63], v[124:127]
 v_mul_f32 v212, v208, v212
 v_add_f32 v209, 1.0, v209
 v_mfma_f32_16x16x32_bf16 v[112:115], a[40:43], v[32:35], v[112:115]
 ds_read_b128 v[56:59], v22 offset:26624
 v_mul_f32 v210, s54, v210
 v_mfma_f32_16x16x32_bf16 v[112:115], a[44:47], v[36:39], v[112:115]
 v_rcp_f32 v209, v209
 v_mfma_f32_16x16x32_bf16 v[116:119], a[184:187], v[32:35], v[116:119]
 v_exp_f32 v210, v210
 v_mfma_f32_16x16x32_bf16 v[116:119], a[188:191], v[36:39], v[116:119]
 v_mul_f32 v213, v209, v213
 v_add_f32 v210, 1.0, v210
 v_mfma_f32_16x16x32_bf16 v[120:123], a[112:115], v[32:35], v[120:123]
 ds_read_b128 v[60:63], v23 offset:26624
 v_mul_f32 v215, v211, v215
 v_mfma_f32_16x16x32_bf16 v[120:123], a[116:119], v[36:39], v[120:123]
 v_rcp_f32 v210, v210
 v_mfma_f32_16x16x32_bf16 v[124:127], v[224:227], v[32:35], v[124:127]
 v_mul_f32 v214, v210, v214
 v_mul_f32 v211, s54, v211
 v_mfma_f32_16x16x32_bf16 v[124:127], v[228:231], v[36:39], v[124:127]
 s_waitcnt lgkmcnt(2)
 v_exp_f32 v211, v211
 v_mfma_f32_16x16x32_bf16 v[112:115], a[48:51], v[40:43], v[112:115]
 v_add_f32 v211, 1.0, v211
 v_mul_f32 v220, v216, v220
 v_mfma_f32_16x16x32_bf16 v[112:115], a[52:55], v[44:47], v[112:115]
 v_rcp_f32 v211, v211
 v_mfma_f32_16x16x32_bf16 v[116:119], a[192:195], v[40:43], v[116:119]
 v_mul_f32 v215, v211, v215
 v_mul_f32 v216, s54, v216
 v_mfma_f32_16x16x32_bf16 v[116:119], a[196:199], v[44:47], v[116:119]
 v_exp_f32 v216, v216
 v_mfma_f32_16x16x32_bf16 v[120:123], a[120:123], v[40:43], v[120:123]
 v_add_f32 v216, 1.0, v216
 v_mul_f32 v221, v217, v221
 v_mfma_f32_16x16x32_bf16 v[120:123], a[124:127], v[44:47], v[120:123]
 v_rcp_f32 v216, v216
 v_mfma_f32_16x16x32_bf16 v[124:127], v[232:235], v[40:43], v[124:127]
 s_waitcnt vmcnt(15) lgkmcnt(0)
 s_barrier
 v_mul_f32 v220, v216, v220
 v_mfma_f32_16x16x32_bf16 v[124:127], v[236:239], v[44:47], v[124:127]
 ds_read_b128 v[32:35], v24 offset:0
 v_mul_f32 v217, s54, v217
 v_mfma_f32_16x16x32_bf16 v[112:115], a[56:59], v[48:51], v[112:115]
 ds_read_b128 v[36:39], v25 offset:0
 v_mul_f32 v222, v218, v222
 v_mfma_f32_16x16x32_bf16 v[112:115], a[60:63], v[52:55], v[112:115]
 ds_read_b128 v[40:43], v24 offset:1024
 v_mul_f32 v218, s54, v218
 v_mfma_f32_16x16x32_bf16 v[116:119], a[200:203], v[48:51], v[116:119]
 v_exp_f32 v217, v217
 v_mfma_f32_16x16x32_bf16 v[116:119], a[204:207], v[52:55], v[116:119]
 v_exp_f32 v218, v218
 v_mfma_f32_16x16x32_bf16 v[120:123], a[128:131], v[48:51], v[120:123]
 ds_read_b128 v[44:47], v25 offset:1024
 v_add_f32 v217, 1.0, v217
 v_mfma_f32_16x16x32_bf16 v[120:123], a[132:135], v[52:55], v[120:123]
 s_cmp_eq_u32 s68, 16843009
 s_cbranch_scc0 Lsp_g10i
Lrt_g10i:
 v_add_f32 v218, 1.0, v218
 v_mfma_f32_16x16x32_bf16 v[124:127], v[240:243], v[48:51], v[124:127]
 v_rcp_f32 v217, v217
 v_mfma_f32_16x16x32_bf16 v[124:127], v[244:247], v[52:55], v[124:127]
 s_waitcnt lgkmcnt(2)
 v_rcp_f32 v218, v218
 v_mfma_f32_16x16x32_bf16 v[112:115], a[64:67], v[56:59], v[112:115]
 ds_read_b128 v[48:51], v24 offset:2048
 v_mul_f32 v221, v217, v221
 v_mfma_f32_16x16x32_bf16 v[112:115], a[68:71], v[60:63], v[112:115]
 v_mul_f32 v222, v218, v222
 v_mul_f32 v223, v219, v223
 v_mfma_f32_16x16x32_bf16 v[116:119], a[208:211], v[56:59], v[116:119]
 s_add_u32 m0, s56, 49152
 v_mul_f32 v219, s54, v219
 v_cvt_pk_bf16_f32 v208, v212, v213
 v_mfma_f32_16x16x32_bf16 v[116:119], a[212:215], v[60:63], v[116:119]
 buffer_load_dwordx4 v18, s[8:11], s30 offen  lds
 v_cvt_pk_bf16_f32 v209, v214, v215
 v_mfma_f32_16x16x32_bf16 v[120:123], a[136:139], v[56:59], v[120:123]
 ds_read_b128 v[52:55], v25 offset:2048
 v_cvt_pk_bf16_f32 v210, v220, v221
 v_mfma_f32_16x16x32_bf16 v[120:123], a[140:143], v[60:63], v[120:123]
 v_exp_f32 v219, v219
 v_mfma_f32_16x16x32_bf16 v[124:127], v[248:251], v[56:59], v[124:127]
 v_add_f32 v219, 1.0, v219
 v_mul_f32 v68, v64, v68
 v_mfma_f32_16x16x32_bf16 v[124:127], v[252:255], v[60:63], v[124:127]
 buffer_load_dwordx4 v18, s[8:11], s31 offen offset:1024  lds
 v_mul_f32 v64, s54, v64
 v_mfma_f32_16x16x32_bf16 v[128:131], a[0:3], v[32:35], 0
 ds_read_b128 v[56:59], v24 offset:3072
 v_mul_f32 v69, v65, v69
 v_mfma_f32_16x16x32_bf16 v[128:131], a[4:7], v[36:39], v[128:131]
 v_rcp_f32 v219, v219
 v_mfma_f32_16x16x32_bf16 v[132:135], a[144:147], v[32:35], 0
 v_exp_f32 v64, v64
 v_mfma_f32_16x16x32_bf16 v[132:135], a[148:151], v[36:39], v[132:135]
 v_mul_f32 v223, v219, v223
 v_add_f32 v64, 1.0, v64
 v_mfma_f32_16x16x32_bf16 v[136:139], a[72:75], v[32:35], 0
 ds_read_b128 v[60:63], v25 offset:3072
 v_cvt_pk_bf16_f32 v211, v222, v223
 v_mfma_f32_16x16x32_bf16 v[136:139], a[76:79], v[36:39], v[136:139]
 buffer_store_dwordx4 v[208:211], v19, s[16:19], s53 offen sc1
 v_mul_f32 v65, s54, v65
 v_mfma_f32_16x16x32_bf16 v[140:143], a[216:219], v[32:35], 0
 s_add_u32 s53, s53, s52
 v_rcp_f32 v64, v64
 v_mfma_f32_16x16x32_bf16 v[140:143], a[220:223], v[36:39], v[140:143]
 s_waitcnt lgkmcnt(2)
 v_exp_f32 v65, v65
 v_mfma_f32_16x16x32_bf16 v[128:131], a[8:11], v[40:43], v[128:131]
 ds_read_b128 v[32:35], v24 offset:4096
 v_mul_f32 v68, v64, v68
 v_mfma_f32_16x16x32_bf16 v[128:131], a[12:15], v[44:47], v[128:131]
 s_cmp_eq_u32 s27, 6
 s_cselect_b32 s3, 2949120, 0
 s_sub_u32 s53, s53, s3
 v_mfma_f32_16x16x32_bf16 v[132:135], a[152:155], v[40:43], v[132:135]
 v_add_f32 v65, 1.0, v65
 v_mul_f32 v70, v66, v70
 v_mfma_f32_16x16x32_bf16 v[132:135], a[156:159], v[44:47], v[132:135]
 v_rcp_f32 v65, v65
 v_mfma_f32_16x16x32_bf16 v[136:139], a[80:83], v[40:43], v[136:139]
 ds_read_b128 v[36:39], v25 offset:4096
 v_mul_f32 v69, v65, v69
 v_mfma_f32_16x16x32_bf16 v[136:139], a[84:87], v[44:47], v[136:139]
 v_mul_f32 v66, s54, v66
 v_mul_f32 v71, v67, v71
 v_mfma_f32_16x16x32_bf16 v[140:143], a[224:227], v[40:43], v[140:143]
 v_exp_f32 v66, v66
 v_mfma_f32_16x16x32_bf16 v[140:143], a[228:231], v[44:47], v[140:143]
 v_add_f32 v66, 1.0, v66
 v_mul_f32 v67, s54, v67
 v_mfma_f32_16x16x32_bf16 v[128:131], a[16:19], v[48:51], v[128:131]
 ds_read_b128 v[40:43], v24 offset:5120
 v_mul_f32 v76, v72, v76
 v_mfma_f32_16x16x32_bf16 v[128:131], a[20:23], v[52:55], v[128:131]
 v_rcp_f32 v66, v66
 v_mfma_f32_16x16x32_bf16 v[132:135], a[160:163], v[48:51], v[132:135]
 v_exp_f32 v67, v67
 v_mfma_f32_16x16x32_bf16 v[132:135], a[164:167], v[52:55], v[132:135]
 v_mul_f32 v70, v66, v70
 v_add_f32 v67, 1.0, v67
 v_mfma_f32_16x16x32_bf16 v[136:139], a[88:91], v[48:51], v[136:139]
 ds_read_b128 v[44:47], v25 offset:5120
 v_mul_f32 v72, s54, v72
 v_mfma_f32_16x16x32_bf16 v[136:139], a[92:95], v[52:55], v[136:139]
 buffer_load_dwordx4 v18, s[8:11], s32 offen offset:2048  lds
 v_mul_f32 v77, v73, v77
 v_mfma_f32_16x16x32_bf16 v[140:143], a[232:235], v[48:51], v[140:143]
 v_rcp_f32 v67, v67
 v_mfma_f32_16x16x32_bf16 v[140:143], a[236:239], v[52:55], v[140:143]
 s_waitcnt lgkmcnt(2)
 v_exp_f32 v72, v72
 v_mfma_f32_16x16x32_bf16 v[128:131], a[24:27], v[56:59], v[128:131]
 ds_read_b128 v[48:51], v24 offset:6144
 v_mul_f32 v71, v67, v71
 v_mfma_f32_16x16x32_bf16 v[128:131], a[28:31], v[60:63], v[128:131]
 buffer_load_dwordx4 v18, s[8:11], s33 offen offset:3072  lds
 v_add_f32 v72, 1.0, v72
 v_mfma_f32_16x16x32_bf16 v[132:135], a[168:171], v[56:59], v[132:135]
 v_rcp_f32 v72, v72
 v_mfma_f32_16x16x32_bf16 v[132:135], a[172:175], v[60:63], v[132:135]
 v_mul_f32 v76, v72, v76
 v_mul_f32 v73, s54, v73
 v_mfma_f32_16x16x32_bf16 v[136:139], a[96:99], v[56:59], v[136:139]
 ds_read_b128 v[52:55], v25 offset:6144
 v_mul_f32 v78, v74, v78
 v_mfma_f32_16x16x32_bf16 v[136:139], a[100:103], v[60:63], v[136:139]
 s_add_u32 m0, s56, 53248
 v_exp_f32 v73, v73
 v_mfma_f32_16x16x32_bf16 v[140:143], a[240:243], v[56:59], v[140:143]
 buffer_load_dwordx4 v18, s[8:11], s34 offen  lds
 v_add_f32 v73, 1.0, v73
 v_mfma_f32_16x16x32_bf16 v[140:143], a[244:247], v[60:63], v[140:143]
 v_rcp_f32 v73, v73
 v_mfma_f32_16x16x32_bf16 v[128:131], a[32:35], v[32:35], v[128:131]
 ds_read_b128 v[56:59], v24 offset:7168
 v_mul_f32 v77, v73, v77
 v_mfma_f32_16x16x32_bf16 v[128:131], a[36:39], v[36:39], v[128:131]
 v_mul_f32 v74, s54, v74
 v_mul_f32 v79, v75, v79
 v_mfma_f32_16x16x32_bf16 v[132:135], a[176:179], v[32:35], v[132:135]
 buffer_load_dwordx4 v18, s[8:11], s35 offen offset:1024  lds
 v_mul_f32 v75, s54, v75
 v_mfma_f32_16x16x32_bf16 v[132:135], a[180:183], v[36:39], v[132:135]
 v_exp_f32 v74, v74
 v_mfma_f32_16x16x32_bf16 v[136:139], a[104:107], v[32:35], v[136:139]
 ds_read_b128 v[60:63], v25 offset:7168
 v_add_f32 v74, 1.0, v74
 v_mfma_f32_16x16x32_bf16 v[136:139], a[108:111], v[36:39], v[136:139]
 v_rcp_f32 v74, v74
 v_mfma_f32_16x16x32_bf16 v[140:143], a[248:251], v[32:35], v[140:143]
 buffer_load_dwordx4 v18, s[8:11], s36 offen offset:2048  lds
 v_mul_f32 v78, v74, v78
 v_mfma_f32_16x16x32_bf16 v[140:143], a[252:255], v[36:39], v[140:143]
 s_waitcnt lgkmcnt(2)
 v_exp_f32 v75, v75
 v_mfma_f32_16x16x32_bf16 v[128:131], a[40:43], v[40:43], v[128:131]
 ds_read_b128 v[32:35], v24 offset:8192
 v_add_f32 v75, 1.0, v75
 v_mfma_f32_16x16x32_bf16 v[128:131], a[44:47], v[44:47], v[128:131]
 v_rcp_f32 v75, v75
 v_mfma_f32_16x16x32_bf16 v[132:135], a[184:187], v[40:43], v[132:135]
 buffer_load_dwordx4 v18, s[8:11], s37 offen offset:3072  lds
 v_mul_f32 v79, v75, v79
 v_mfma_f32_16x16x32_bf16 v[132:135], a[188:191], v[44:47], v[132:135]
 v_cvt_pk_bf16_f32 v64, v68, v69
 v_cvt_pk_bf16_f32 v65, v70, v71
 v_mfma_f32_16x16x32_bf16 v[136:139], a[112:115], v[40:43], v[136:139]
 ds_read_b128 v[36:39], v25 offset:8192
 v_cvt_pk_bf16_f32 v66, v76, v77
 v_mfma_f32_16x16x32_bf16 v[136:139], a[116:119], v[44:47], v[136:139]
 v_cvt_pk_bf16_f32 v67, v78, v79
 v_mul_f32 v84, v80, v84
 v_mfma_f32_16x16x32_bf16 v[140:143], v[224:227], v[40:43], v[140:143]
 s_add_u32 m0, s56, 57344
 buffer_store_dwordx4 v[64:67], v19, s[16:19], s53 offen sc1
 v_mfma_f32_16x16x32_bf16 v[140:143], v[228:231], v[44:47], v[140:143]
 s_add_u32 s53, s53, s52
 v_mul_f32 v80, s54, v80
 v_mul_f32 v85, v81, v85
 v_mfma_f32_16x16x32_bf16 v[128:131], a[48:51], v[48:51], v[128:131]
 ds_read_b128 v[40:43], v24 offset:18432
 v_mul_f32 v81, s54, v81
 v_mfma_f32_16x16x32_bf16 v[128:131], a[52:55], v[52:55], v[128:131]
 v_exp_f32 v80, v80
 v_mfma_f32_16x16x32_bf16 v[132:135], a[192:195], v[48:51], v[132:135]
 v_exp_f32 v81, v81
 v_mfma_f32_16x16x32_bf16 v[132:135], a[196:199], v[52:55], v[132:135]
 v_add_f32 v80, 1.0, v80
 v_add_f32 v81, 1.0, v81
 v_mfma_f32_16x16x32_bf16 v[136:139], a[120:123], v[48:51], v[136:139]
 ds_read_b128 v[44:47], v25 offset:18432
 v_mul_f32 v86, v82, v86
 v_mfma_f32_16x16x32_bf16 v[136:139], a[124:127], v[52:55], v[136:139]
 v_rcp_f32 v80, v80
 v_mfma_f32_16x16x32_bf16 v[140:143], v[232:235], v[48:51], v[140:143]
 v_rcp_f32 v81, v81
 v_mfma_f32_16x16x32_bf16 v[140:143], v[236:239], v[52:55], v[140:143]
 s_waitcnt lgkmcnt(2)
 v_mul_f32 v84, v80, v84
 v_mul_f32 v85, v81, v85
 v_mfma_f32_16x16x32_bf16 v[128:131], a[56:59], v[56:59], v[128:131]
 ds_read_b128 v[48:51], v24 offset:19456
 v_mul_f32 v82, s54, v82
 v_mfma_f32_16x16x32_bf16 v[128:131], a[60:63], v[60:63], v[128:131]
 v_exp_f32 v82, v82
 v_mfma_f32_16x16x32_bf16 v[132:135], a[200:203], v[56:59], v[132:135]
 v_add_f32 v82, 1.0, v82
 v_mul_f32 v87, v83, v87
 v_mfma_f32_16x16x32_bf16 v[132:135], a[204:207], v[60:63], v[132:135]
 v_rcp_f32 v82, v82
 v_mfma_f32_16x16x32_bf16 v[136:139], a[128:131], v[56:59], v[136:139]
 ds_read_b128 v[52:55], v25 offset:19456
 v_mul_f32 v86, v82, v86
 v_mfma_f32_16x16x32_bf16 v[136:139], a[132:135], v[60:63], v[136:139]
 v_mul_f32 v83, s54, v83
 v_mul_f32 v92, v88, v92
 v_mfma_f32_16x16x32_bf16 v[140:143], v[240:243], v[56:59], v[140:143]
 buffer_load_dwordx4 v18, s[8:11], s38 offen  lds
 v_mul_f32 v88, s54, v88
 v_mfma_f32_16x16x32_bf16 v[140:143], v[244:247], v[60:63], v[140:143]
 v_exp_f32 v83, v83
 v_mfma_f32_16x16x32_bf16 v[128:131], a[64:67], v[32:35], v[128:131]
 ds_read_b128 v[56:59], v24 offset:20480
 v_add_f32 v83, 1.0, v83
 v_mfma_f32_16x16x32_bf16 v[128:131], a[68:71], v[36:39], v[128:131]
 v_rcp_f32 v83, v83
 v_mfma_f32_16x16x32_bf16 v[132:135], a[208:211], v[32:35], v[132:135]
 v_add_u32 v18, 36864, v18
 v_mul_f32 v87, v83, v87
 v_mfma_f32_16x16x32_bf16 v[132:135], a[212:215], v[36:39], v[132:135]
 v_exp_f32 v88, v88
 v_mfma_f32_16x16x32_bf16 v[136:139], a[136:139], v[32:35], v[136:139]
 ds_read_b128 v[60:63], v25 offset:20480
 v_add_f32 v88, 1.0, v88
 v_mfma_f32_16x16x32_bf16 v[136:139], a[140:143], v[36:39], v[136:139]
 v_rcp_f32 v88, v88
 v_mfma_f32_16x16x32_bf16 v[140:143], v[248:251], v[32:35], v[140:143]
 v_mul_f32 v92, v88, v92
 v_mul_f32 v93, v89, v93
 v_mfma_f32_16x16x32_bf16 v[140:143], v[252:255], v[36:39], v[140:143]
 s_waitcnt lgkmcnt(2)
 v_mul_f32 v89, s54, v89
 v_mul_f32 v94, v90, v94
 v_mfma_f32_16x16x32_bf16 v[64:67], a[0:3], v[40:43], 0
 ds_read_b128 v[32:35], v24 offset:21504
 v_mul_f32 v90, s54, v90
 v_mfma_f32_16x16x32_bf16 v[64:67], a[4:7], v[44:47], v[64:67]
 v_exp_f32 v89, v89
 v_mfma_f32_16x16x32_bf16 v[68:71], a[144:147], v[40:43], 0
 v_exp_f32 v90, v90
 v_mfma_f32_16x16x32_bf16 v[68:71], a[148:151], v[44:47], v[68:71]
 v_add_f32 v89, 1.0, v89
 v_add_f32 v90, 1.0, v90
 v_mfma_f32_16x16x32_bf16 v[72:75], a[72:75], v[40:43], 0
 ds_read_b128 v[36:39], v25 offset:21504
 v_mul_f32 v95, v91, v95
 v_mfma_f32_16x16x32_bf16 v[72:75], a[76:79], v[44:47], v[72:75]
 v_rcp_f32 v89, v89
 v_mfma_f32_16x16x32_bf16 v[76:79], a[216:219], v[40:43], 0
 v_rcp_f32 v90, v90
 v_mfma_f32_16x16x32_bf16 v[76:79], a[220:223], v[44:47], v[76:79]
 v_mul_f32 v93, v89, v93
 v_mul_f32 v94, v90, v94
 v_mfma_f32_16x16x32_bf16 v[64:67], a[8:11], v[48:51], v[64:67]
 ds_read_b128 v[40:43], v24 offset:22528
 v_mul_f32 v91, s54, v91
 v_mfma_f32_16x16x32_bf16 v[64:67], a[12:15], v[52:55], v[64:67]
 v_exp_f32 v91, v91
 v_mfma_f32_16x16x32_bf16 v[68:71], a[152:155], v[48:51], v[68:71]
 v_add_f32 v91, 1.0, v91
 v_cvt_pk_bf16_f32 v80, v84, v85
 v_mfma_f32_16x16x32_bf16 v[68:71], a[156:159], v[52:55], v[68:71]
 v_rcp_f32 v91, v91
 v_mfma_f32_16x16x32_bf16 v[72:75], a[80:83], v[48:51], v[72:75]
 ds_read_b128 v[44:47], v25 offset:22528
 v_mul_f32 v95, v91, v95
 v_mfma_f32_16x16x32_bf16 v[72:75], a[84:87], v[52:55], v[72:75]
 v_cvt_pk_bf16_f32 v81, v86, v87
 v_cvt_pk_bf16_f32 v82, v92, v93
 v_mfma_f32_16x16x32_bf16 v[76:79], a[224:227], v[48:51], v[76:79]
 v_cvt_pk_bf16_f32 v83, v94, v95
 v_mul_f32 v100, v96, v100
 v_mfma_f32_16x16x32_bf16 v[76:79], a[228:231], v[52:55], v[76:79]
 s_waitcnt lgkmcnt(2)
 buffer_store_dwordx4 v[80:83], v19, s[16:19], s53 offen sc1
 v_mfma_f32_16x16x32_bf16 v[64:67], a[16:19], v[56:59], v[64:67]
 ds_read_b128 v[48:51], v24 offset:23552
 s_add_u32 s53, s53, s52
 v_mfma_f32_16x16x32_bf16 v[64:67], a[20:23], v[60:63], v[64:67]
 v_mul_f32 v96, s54, v96
 v_mul_f32 v101, v97, v101
 v_mfma_f32_16x16x32_bf16 v[68:71], a[160:163], v[56:59], v[68:71]
 v_exp_f32 v96, v96
 v_mfma_f32_16x16x32_bf16 v[68:71], a[164:167], v[60:63], v[68:71]
 v_add_f32 v96, 1.0, v96
 v_mul_f32 v97, s54, v97
 v_mfma_f32_16x16x32_bf16 v[72:75], a[88:91], v[56:59], v[72:75]
 ds_read_b128 v[52:55], v25 offset:23552
 v_mul_f32 v102, v98, v102
 v_mfma_f32_16x16x32_bf16 v[72:75], a[92:95], v[60:63], v[72:75]
 v_rcp_f32 v96, v96
 v_mfma_f32_16x16x32_bf16 v[76:79], a[232:235], v[56:59], v[76:79]
 v_exp_f32 v97, v97
 v_mfma_f32_16x16x32_bf16 v[76:79], a[236:239], v[60:63], v[76:79]
 v_mul_f32 v100, v96, v100
 v_add_f32 v97, 1.0, v97
 v_mfma_f32_16x16x32_bf16 v[64:67], a[24:27], v[32:35], v[64:67]
 ds_read_b128 v[56:59], v24 offset:24576
 v_mul_f32 v98, s54, v98
 v_mfma_f32_16x16x32_bf16 v[64:67], a[28:31], v[36:39], v[64:67]
 v_rcp_f32 v97, v97
 v_mfma_f32_16x16x32_bf16 v[68:71], a[168:171], v[32:35], v[68:71]
 v_exp_f32 v98, v98
 v_mfma_f32_16x16x32_bf16 v[68:71], a[172:175], v[36:39], v[68:71]
 v_mul_f32 v101, v97, v101
 v_add_f32 v98, 1.0, v98
 v_mfma_f32_16x16x32_bf16 v[72:75], a[96:99], v[32:35], v[72:75]
 ds_read_b128 v[60:63], v25 offset:24576
 v_mul_f32 v103, v99, v103
 v_mfma_f32_16x16x32_bf16 v[72:75], a[100:103], v[36:39], v[72:75]
 v_rcp_f32 v98, v98
 v_mfma_f32_16x16x32_bf16 v[76:79], a[240:243], v[32:35], v[76:79]
 v_mul_f32 v102, v98, v102
 v_mul_f32 v99, s54, v99
 v_mfma_f32_16x16x32_bf16 v[76:79], a[244:247], v[36:39], v[76:79]
 s_waitcnt lgkmcnt(2)
 v_exp_f32 v99, v99
 v_mfma_f32_16x16x32_bf16 v[64:67], a[32:35], v[40:43], v[64:67]
Lpg11:
 s_cbranch_vccnz Lj_Lfin
 ds_read_b128 v[32:35], v24 offset:25600
 v_add_f32 v99, 1.0, v99
 v_mfma_f32_16x16x32_bf16 v[64:67], a[36:39], v[44:47], v[64:67]
 v_rcp_f32 v99, v99
 v_mfma_f32_16x16x32_bf16 v[68:71], a[176:179], v[40:43], v[68:71]
 v_mul_f32 v103, v99, v103
 v_mul_f32 v108, v104, v108
 v_mfma_f32_16x16x32_bf16 v[68:71], a[180:183], v[44:47], v[68:71]
 v_mul_f32 v104, s54, v104
 v_mul_f32 v109, v105, v109
 v_mfma_f32_16x16x32_bf16 v[72:75], a[104:107], v[40:43], v[72:75]
 ds_read_b128 v[36:39], v25 offset:25600
 v_mul_f32 v105, s54, v105
 v_mfma_f32_16x16x32_bf16 v[72:75], a[108:111], v[44:47], v[72:75]
 v_exp_f32 v104, v104
 v_mfma_f32_16x16x32_bf16 v[76:79], a[248:251], v[40:43], v[76:79]
 v_exp_f32 v105, v105
 v_mfma_f32_16x16x32_bf16 v[76:79], a[252:255], v[44:47], v[76:79]
 v_add_f32 v104, 1.0, v104
 v_add_f32 v105, 1.0, v105
 v_mfma_f32_16x16x32_bf16 v[64:67], a[40:43], v[48:51], v[64:67]
 ds_read_b128 v[40:43], v24 offset:26624
 v_mul_f32 v110, v106, v110
 v_mfma_f32_16x16x32_bf16 v[64:67], a[44:47], v[52:55], v[64:67]
 v_rcp_f32 v104, v104
 v_mfma_f32_16x16x32_bf16 v[68:71], a[184:187], v[48:51], v[68:71]
 v_rcp_f32 v105, v105
 v_mfma_f32_16x16x32_bf16 v[68:71], a[188:191], v[52:55], v[68:71]
 v_mul_f32 v108, v104, v108
 v_mul_f32 v109, v105, v109
 v_mfma_f32_16x16x32_bf16 v[72:75], a[112:115], v[48:51], v[72:75]
 ds_read_b128 v[44:47], v25 offset:26624
 v_mul_f32 v106, s54, v106
 v_mfma_f32_16x16x32_bf16 v[72:75], a[116:119], v[52:55], v[72:75]
 v_exp_f32 v106, v106
 v_mfma_f32_16x16x32_bf16 v[76:79], v[224:227], v[48:51], v[76:79]
 v_add_f32 v106, 1.0, v106
 v_mul_f32 v111, v107, v111
 v_mfma_f32_16x16x32_bf16 v[76:79], v[228:231], v[52:55], v[76:79]
 s_waitcnt lgkmcnt(2)
 v_rcp_f32 v106, v106
 v_mfma_f32_16x16x32_bf16 v[64:67], a[48:51], v[56:59], v[64:67]
 v_mul_f32 v110, v106, v110
 v_mul_f32 v107, s54, v107
 v_mfma_f32_16x16x32_bf16 v[64:67], a[52:55], v[60:63], v[64:67]
 v_exp_f32 v107, v107
 v_mfma_f32_16x16x32_bf16 v[68:71], a[192:195], v[56:59], v[68:71]
 v_add_f32 v107, 1.0, v107
 v_cvt_pk_bf16_f32 v96, v100, v101
 v_mfma_f32_16x16x32_bf16 v[68:71], a[196:199], v[60:63], v[68:71]
 v_rcp_f32 v107, v107
 v_mfma_f32_16x16x32_bf16 v[72:75], a[120:123], v[56:59], v[72:75]
 v_mul_f32 v111, v107, v111
 v_cvt_pk_bf16_f32 v97, v102, v103
 v_mfma_f32_16x16x32_bf16 v[72:75], a[124:127], v[60:63], v[72:75]
 v_cvt_pk_bf16_f32 v98, v108, v109
 v_cvt_pk_bf16_f32 v99, v110, v111
 v_mfma_f32_16x16x32_bf16 v[76:79], v[232:235], v[56:59], v[76:79]
 s_waitcnt vmcnt(15) lgkmcnt(0)
 s_waitcnt vmcnt(9)
 s_barrier
 v_mfma_f32_16x16x32_bf16 v[76:79], v[236:239], v[60:63], v[76:79]
 ds_read_b128 v[48:51], v20 offset:0
 v_mul_f32 v116, v112, v116
 v_mfma_f32_16x16x32_bf16 v[64:67], a[56:59], v[32:35], v[64:67]
 ds_read_b128 v[52:55], v21 offset:0
 v_mul_f32 v112, s54, v112
 v_mfma_f32_16x16x32_bf16 v[64:67], a[60:63], v[36:39], v[64:67]
 ds_read_b128 v[56:59], v20 offset:1024
 v_mul_f32 v117, v113, v117
 v_mfma_f32_16x16x32_bf16 v[68:71], a[200:203], v[32:35], v[68:71]
 buffer_store_byte v2, v1, s[16:19], s25 offen sc1
 v_mul_f32 v113, s54, v113
 v_mfma_f32_16x16x32_bf16 v[68:71], a[204:207], v[36:39], v[68:71]
 s_add_u32 s25, s25, 18432
 buffer_store_dwordx4 v[96:99], v19, s[16:19], s53 offen sc1
 v_mfma_f32_16x16x32_bf16 v[72:75], a[128:131], v[32:35], v[72:75]
 ds_read_b128 v[60:63], v21 offset:1024
 s_add_u32 s53, s53, s52
 v_mfma_f32_16x16x32_bf16 v[72:75], a[132:135], v[36:39], v[72:75]
 v_exp_f32 v112, v112
 v_mfma_f32_16x16x32_bf16 v[76:79], v[240:243], v[32:35], v[76:79]
 v_exp_f32 v113, v113
 v_mfma_f32_16x16x32_bf16 v[76:79], v[244:247], v[36:39], v[76:79]
 s_waitcnt lgkmcnt(2)
 v_add_f32 v112, 1.0, v112
 v_add_f32 v113, 1.0, v113
 v_mfma_f32_16x16x32_bf16 v[64:67], a[64:67], v[40:43], v[64:67]
 ds_read_b128 v[32:35], v20 offset:2048
 v_mul_f32 v118, v114, v118
 v_mfma_f32_16x16x32_bf16 v[64:67], a[68:71], v[44:47], v[64:67]
 v_rcp_f32 v112, v112
 v_mfma_f32_16x16x32_bf16 v[68:71], a[208:211], v[40:43], v[68:71]
 s_add_u32 m0, s56, 98304
 v_rcp_f32 v113, v113
 v_mfma_f32_16x16x32_bf16 v[68:71], a[212:215], v[44:47], v[68:71]
 v_mul_f32 v116, v112, v116
 v_mul_f32 v117, v113, v117
 v_mfma_f32_16x16x32_bf16 v[72:75], a[136:139], v[40:43], v[72:75]
 ds_read_b128 v[36:39], v21 offset:2048
 v_mul_f32 v114, s54, v114
 v_mfma_f32_16x16x32_bf16 v[72:75], a[140:143], v[44:47], v[72:75]
 v_exp_f32 v114, v114
 v_mfma_f32_16x16x32_bf16 v[76:79], v[248:251], v[40:43], v[76:79]
 v_add_f32 v114, 1.0, v114
 v_mul_f32 v119, v115, v119
 v_mfma_f32_16x16x32_bf16 v[76:79], v[252:255], v[44:47], v[76:79]
 v_rcp_f32 v114, v114
 v_mfma_f32_16x16x32_bf16 v[80:83], a[0:3], v[48:51], 0
 ds_read_b128 v[40:43], v20 offset:3072
 v_add_u32 v5, 4096, v19
 v_mfma_f32_16x16x32_bf16 v[80:83], a[4:7], v[52:55], v[80:83]
 v_add_u32 v6, 8192, v19
 v_mul_f32 v118, v114, v118
 v_mfma_f32_16x16x32_bf16 v[84:87], a[144:147], v[48:51], 0
 v_add_u32 v7, 147456, v19
 v_mul_f32 v115, s54, v115
 v_mfma_f32_16x16x32_bf16 v[84:87], a[148:151], v[52:55], v[84:87]
 buffer_load_dwordx4 v18, s[8:11], s30 offen  lds
 v_add_u32 v8, 36864, v19
 v_mfma_f32_16x16x32_bf16 v[88:91], a[72:75], v[48:51], 0
 ds_read_b128 v[44:47], v21 offset:3072
 v_add_u32 v9, 135168, v19
 v_mfma_f32_16x16x32_bf16 v[88:91], a[76:79], v[52:55], v[88:91]
 v_add_u32 v26, 0, v19
 v_mul_f32 v124, v120, v124
 v_mfma_f32_16x16x32_bf16 v[92:95], a[216:219], v[48:51], 0
 v_add_u32 v27, 49152, v19
 v_mul_f32 v120, s54, v120
 v_mfma_f32_16x16x32_bf16 v[92:95], a[220:223], v[52:55], v[92:95]
 s_waitcnt lgkmcnt(2)
 v_add_u32 v28, 98304, v19
 v_mul_f32 v125, v121, v125
 v_mfma_f32_16x16x32_bf16 v[80:83], a[8:11], v[56:59], v[80:83]
 ds_read_b128 v[48:51], v20 offset:4096
 v_mul_f32 v121, s54, v121
 v_mfma_f32_16x16x32_bf16 v[80:83], a[12:15], v[60:63], v[80:83]
 buffer_load_dwordx4 v18, s[8:11], s31 offen offset:1024  lds
 v_mul_f32 v126, v122, v126
 v_mfma_f32_16x16x32_bf16 v[84:87], a[152:155], v[56:59], v[84:87]
 v_exp_f32 v115, v115
 v_mfma_f32_16x16x32_bf16 v[84:87], a[156:159], v[60:63], v[84:87]
 v_exp_f32 v120, v120
 v_mfma_f32_16x16x32_bf16 v[88:91], a[80:83], v[56:59], v[88:91]
 ds_read_b128 v[52:55], v21 offset:4096
 v_add_f32 v115, 1.0, v115
 v_mfma_f32_16x16x32_bf16 v[88:91], a[84:87], v[60:63], v[88:91]
 buffer_load_dwordx4 v18, s[8:11], s32 offen offset:2048  lds
 v_add_f32 v120, 1.0, v120
 v_mfma_f32_16x16x32_bf16 v[92:95], a[224:227], v[56:59], v[92:95]
 v_rcp_f32 v115, v115
 v_mfma_f32_16x16x32_bf16 v[92:95], a[228:231], v[60:63], v[92:95]
 v_rcp_f32 v120, v120
 v_mfma_f32_16x16x32_bf16 v[80:83], a[16:19], v[32:35], v[80:83]
 ds_read_b128 v[56:59], v20 offset:5120
 v_mul_f32 v119, v115, v119
 v_mfma_f32_16x16x32_bf16 v[80:83], a[20:23], v[36:39], v[80:83]
 buffer_load_dwordx4 v18, s[8:11], s33 offen offset:3072  lds
 v_mul_f32 v124, v120, v124
 v_mfma_f32_16x16x32_bf16 v[84:87], a[160:163], v[32:35], v[84:87]
 v_exp_f32 v121, v121
 v_mfma_f32_16x16x32_bf16 v[84:87], a[164:167], v[36:39], v[84:87]
 v_add_f32 v121, 1.0, v121
 v_mul_f32 v122, s54, v122
 v_mfma_f32_16x16x32_bf16 v[88:91], a[88:91], v[32:35], v[88:91]
 ds_read_b128 v[60:63], v21 offset:5120
 v_mul_f32 v127, v123, v127
 v_mfma_f32_16x16x32_bf16 v[88:91], a[92:95], v[36:39], v[88:91]
 s_add_u32 m0, s56, 102400
 v_rcp_f32 v121, v121
 v_mfma_f32_16x16x32_bf16 v[92:95], a[232:235], v[32:35], v[92:95]
 buffer_load_dwordx4 v18, s[8:11], s34 offen  lds
 v_mul_f32 v125, v121, v125
 v_mfma_f32_16x16x32_bf16 v[92:95], a[236:239], v[36:39], v[92:95]
 s_waitcnt lgkmcnt(2)
 v_exp_f32 v122, v122
 v_mfma_f32_16x16x32_bf16 v[80:83], a[24:27], v[40:43], v[80:83]
 ds_read_b128 v[32:35], v20 offset:6144
 v_add_f32 v122, 1.0, v122
 v_mfma_f32_16x16x32_bf16 v[80:83], a[28:31], v[44:47], v[80:83]
 v_rcp_f32 v122, v122
 v_mfma_f32_16x16x32_bf16 v[84:87], a[168:171], v[40:43], v[84:87]
 buffer_load_dwordx4 v18, s[8:11], s35 offen offset:1024  lds
 v_mul_f32 v126, v122, v126
 v_mfma_f32_16x16x32_bf16 v[84:87], a[172:175], v[44:47], v[84:87]
 v_mul_f32 v123, s54, v123
 v_cvt_pk_bf16_f32 v112, v116, v117
 v_mfma_f32_16x16x32_bf16 v[88:91], a[96:99], v[40:43], v[88:91]
 ds_read_b128 v[36:39], v21 offset:6144
 v_cvt_pk_bf16_f32 v113, v118, v119
 v_mfma_f32_16x16x32_bf16 v[88:91], a[100:103], v[44:47], v[88:91]
 v_exp_f32 v123, v123
 v_mfma_f32_16x16x32_bf16 v[92:95], a[240:243], v[40:43], v[92:95]
 buffer_load_dwordx4 v18, s[8:11], s36 offen offset:2048  lds
 v_add_f32 v123, 1.0, v123
 v_mfma_f32_16x16x32_bf16 v[92:95], a[244:247], v[44:47], v[92:95]
 v_rcp_f32 v123, v123
 v_mfma_f32_16x16x32_bf16 v[80:83], a[32:35], v[48:51], v[80:83]
 ds_read_b128 v[40:43], v20 offset:7168
 v_mul_f32 v127, v123, v127
 v_mfma_f32_16x16x32_bf16 v[80:83], a[36:39], v[52:55], v[80:83]
 v_cvt_pk_bf16_f32 v114, v124, v125
 v_cvt_pk_bf16_f32 v115, v126, v127
 v_mfma_f32_16x16x32_bf16 v[84:87], a[176:179], v[48:51], v[84:87]
 buffer_store_dwordx4 v[112:115], v19, s[16:19], s53 offen sc1
 v_mul_f32 v132, v128, v132
 v_mfma_f32_16x16x32_bf16 v[84:87], a[180:183], v[52:55], v[84:87]
 s_add_u32 s53, s53, s52
 v_mul_f32 v128, s54, v128
 v_mul_f32 v133, v129, v133
 v_mfma_f32_16x16x32_bf16 v[88:91], a[104:107], v[48:51], v[88:91]
 ds_read_b128 v[44:47], v21 offset:7168
 v_mul_f32 v129, s54, v129
 v_mfma_f32_16x16x32_bf16 v[88:91], a[108:111], v[52:55], v[88:91]
 s_cmp_eq_u32 s27, 4
 s_cselect_b32 s3, 2949120, 0
 s_sub_u32 s53, s53, s3
 v_mfma_f32_16x16x32_bf16 v[92:95], a[248:251], v[48:51], v[92:95]
 v_exp_f32 v128, v128
 v_mfma_f32_16x16x32_bf16 v[92:95], a[252:255], v[52:55], v[92:95]
 s_waitcnt lgkmcnt(2)
 v_exp_f32 v129, v129
 v_mfma_f32_16x16x32_bf16 v[80:83], a[40:43], v[56:59], v[80:83]
 ds_read_b128 v[48:51], v20 offset:8192
 v_add_f32 v128, 1.0, v128
 v_mfma_f32_16x16x32_bf16 v[80:83], a[44:47], v[60:63], v[80:83]
 v_rcp_f32 v128, v128
 v_mfma_f32_16x16x32_bf16 v[84:87], a[184:187], v[56:59], v[84:87]
 v_mul_f32 v132, v128, v132
 v_add_f32 v129, 1.0, v129
 v_mfma_f32_16x16x32_bf16 v[84:87], a[188:191], v[60:63], v[84:87]
 v_rcp_f32 v129, v129
 v_mfma_f32_16x16x32_bf16 v[88:91], a[112:115], v[56:59], v[88:91]
 ds_read_b128 v[52:55], v21 offset:8192
 v_mul_f32 v133, v129, v133
 v_mfma_f32_16x16x32_bf16 v[88:91], a[116:119], v[60:63], v[88:91]
 v_mul_f32 v134, v130, v134
 v_mul_f32 v135, v131, v135
 v_mfma_f32_16x16x32_bf16 v[92:95], v[224:227], v[56:59], v[92:95]
 v_mul_f32 v130, s54, v130
 v_mul_f32 v131, s54, v131
 v_mfma_f32_16x16x32_bf16 v[92:95], v[228:231], v[60:63], v[92:95]
 v_exp_f32 v130, v130
 v_mfma_f32_16x16x32_bf16 v[80:83], a[48:51], v[32:35], v[80:83]
 ds_read_b128 v[56:59], v20 offset:18432
 v_add_f32 v130, 1.0, v130
 v_mfma_f32_16x16x32_bf16 v[80:83], a[52:55], v[36:39], v[80:83]
 v_rcp_f32 v130, v130
 v_mfma_f32_16x16x32_bf16 v[84:87], a[192:195], v[32:35], v[84:87]
 buffer_load_dwordx4 v18, s[8:11], s37 offen offset:3072  lds
 v_mul_f32 v134, v130, v134
 v_mfma_f32_16x16x32_bf16 v[84:87], a[196:199], v[36:39], v[84:87]
 v_exp_f32 v131, v131
 v_mfma_f32_16x16x32_bf16 v[88:91], a[120:123], v[32:35], v[88:91]
 ds_read_b128 v[60:63], v21 offset:18432
 v_add_f32 v131, 1.0, v131
 v_mfma_f32_16x16x32_bf16 v[88:91], a[124:127], v[36:39], v[88:91]
 v_rcp_f32 v131, v131
 v_mfma_f32_16x16x32_bf16 v[92:95], v[232:235], v[32:35], v[92:95]
 s_add_u32 m0, s56, 106496
 v_mul_f32 v135, v131, v135
 v_mul_f32 v140, v136, v140
 v_mfma_f32_16x16x32_bf16 v[92:95], v[236:239], v[36:39], v[92:95]
 s_waitcnt lgkmcnt(2)
 v_mul_f32 v136, s54, v136
 v_mul_f32 v141, v137, v141
 v_mfma_f32_16x16x32_bf16 v[80:83], a[56:59], v[40:43], v[80:83]
 ds_read_b128 v[32:35], v20 offset:19456
 v_mul_f32 v137, s54, v137
 v_mfma_f32_16x16x32_bf16 v[80:83], a[60:63], v[44:47], v[80:83]
 buffer_load_dwordx4 v18, s[8:11], s38 offen  lds
 v_mul_f32 v142, v138, v142
 v_mfma_f32_16x16x32_bf16 v[84:87], a[200:203], v[40:43], v[84:87]
 v_exp_f32 v136, v136
 v_mfma_f32_16x16x32_bf16 v[84:87], a[204:207], v[44:47], v[84:87]
 v_exp_f32 v137, v137
 v_mfma_f32_16x16x32_bf16 v[88:91], a[128:131], v[40:43], v[88:91]
 ds_read_b128 v[36:39], v21 offset:19456
 v_add_f32 v136, 1.0, v136
 v_mfma_f32_16x16x32_bf16 v[88:91], a[132:135], v[44:47], v[88:91]
 v_rcp_f32 v136, v136
 v_mfma_f32_16x16x32_bf16 v[92:95], v[240:243], v[40:43], v[92:95]
 v_mul_f32 v140, v136, v140
 v_add_f32 v137, 1.0, v137
 v_mfma_f32_16x16x32_bf16 v[92:95], v[244:247], v[44:47], v[92:95]
 v_rcp_f32 v137, v137
 v_mfma_f32_16x16x32_bf16 v[80:83], a[64:67], v[48:51], v[80:83]
 ds_read_b128 v[40:43], v20 offset:20480
 v_mul_f32 v141, v137, v141
 v_mfma_f32_16x16x32_bf16 v[80:83], a[68:71], v[52:55], v[80:83]
 v_mul_f32 v138, s54, v138
 v_mul_f32 v143, v139, v143
 v_mfma_f32_16x16x32_bf16 v[84:87], a[208:211], v[48:51], v[84:87]
 v_exp_f32 v138, v138
 v_mfma_f32_16x16x32_bf16 v[84:87], a[212:215], v[52:55], v[84:87]
 v_add_f32 v138, 1.0, v138
 v_mul_f32 v139, s54, v139
 v_mfma_f32_16x16x32_bf16 v[88:91], a[136:139], v[48:51], v[88:91]
 ds_read_b128 v[44:47], v21 offset:20480
 v_cvt_pk_bf16_f32 v128, v132, v133
 v_mfma_f32_16x16x32_bf16 v[88:91], a[140:143], v[52:55], v[88:91]
 v_rcp_f32 v138, v138
 v_mfma_f32_16x16x32_bf16 v[92:95], v[248:251], v[48:51], v[92:95]
 v_exp_f32 v139, v139
 v_mfma_f32_16x16x32_bf16 v[92:95], v[252:255], v[52:55], v[92:95]
 s_waitcnt lgkmcnt(2)
 v_mul_f32 v142, v138, v142
 v_add_f32 v139, 1.0, v139
 v_mfma_f32_16x16x32_bf16 v[96:99], a[0:3], v[56:59], 0
 ds_read_b128 v[48:51], v20 offset:21504
 v_cvt_pk_bf16_f32 v129, v134, v135
 v_mfma_f32_16x16x32_bf16 v[96:99], a[4:7], v[60:63], v[96:99]
 v_rcp_f32 v139, v139
 v_mfma_f32_16x16x32_bf16 v[100:103], a[144:147], v[56:59], 0
 v_mul_f32 v143, v139, v143
 v_cvt_pk_bf16_f32 v130, v140, v141
 v_mfma_f32_16x16x32_bf16 v[100:103], a[148:151], v[60:63], v[100:103]
 v_cvt_pk_bf16_f32 v131, v142, v143
 v_mul_f32 v68, v64, v68
 v_mfma_f32_16x16x32_bf16 v[104:107], a[72:75], v[56:59], 0
 ds_read_b128 v[52:55], v21 offset:21504
 v_mul_f32 v64, s54, v64
 v_mfma_f32_16x16x32_bf16 v[104:107], a[76:79], v[60:63], v[104:107]
 buffer_store_dwordx4 v[128:131], v19, s[16:19], s53 offen sc1
 v_mul_f32 v69, v65, v69
 v_mfma_f32_16x16x32_bf16 v[108:111], a[216:219], v[56:59], 0
 s_add_u32 s53, s53, s52
 v_exp_f32 v64, v64
 v_mfma_f32_16x16x32_bf16 v[108:111], a[220:223], v[60:63], v[108:111]
 v_add_f32 v64, 1.0, v64
 v_mul_f32 v65, s54, v65
 v_mfma_f32_16x16x32_bf16 v[96:99], a[8:11], v[32:35], v[96:99]
 ds_read_b128 v[56:59], v20 offset:22528
 v_mul_f32 v70, v66, v70
 v_mfma_f32_16x16x32_bf16 v[96:99], a[12:15], v[36:39], v[96:99]
 v_rcp_f32 v64, v64
 v_mfma_f32_16x16x32_bf16 v[100:103], a[152:155], v[32:35], v[100:103]
 v_exp_f32 v65, v65
 v_mfma_f32_16x16x32_bf16 v[100:103], a[156:159], v[36:39], v[100:103]
 v_mul_f32 v68, v64, v68
 v_add_f32 v65, 1.0, v65
 v_mfma_f32_16x16x32_bf16 v[104:107], a[80:83], v[32:35], v[104:107]
 ds_read_b128 v[60:63], v21 offset:22528
 v_mul_f32 v66, s54, v66
 v_mfma_f32_16x16x32_bf16 v[104:107], a[84:87], v[36:39], v[104:107]
 v_rcp_f32 v65, v65
 v_mfma_f32_16x16x32_bf16 v[108:111], a[224:227], v[32:35], v[108:111]
 v_exp_f32 v66, v66
 v_mfma_f32_16x16x32_bf16 v[108:111], a[228:231], v[36:39], v[108:111]
 s_waitcnt lgkmcnt(2)
 v_mul_f32 v69, v65, v69
 v_add_f32 v66, 1.0, v66
 v_mfma_f32_16x16x32_bf16 v[96:99], a[16:19], v[40:43], v[96:99]
 ds_read_b128 v[32:35], v20 offset:23552
 v_mul_f32 v71, v67, v71
 v_mfma_f32_16x16x32_bf16 v[96:99], a[20:23], v[44:47], v[96:99]
 v_rcp_f32 v66, v66
 v_mfma_f32_16x16x32_bf16 v[100:103], a[160:163], v[40:43], v[100:103]
 v_mul_f32 v70, v66, v70
 v_mul_f32 v67, s54, v67
 v_mfma_f32_16x16x32_bf16 v[100:103], a[164:167], v[44:47], v[100:103]
 v_exp_f32 v67, v67
 v_mfma_f32_16x16x32_bf16 v[104:107], a[88:91], v[40:43], v[104:107]
 ds_read_b128 v[36:39], v21 offset:23552
 v_add_f32 v67, 1.0, v67
 v_mfma_f32_16x16x32_bf16 v[104:107], a[92:95], v[44:47], v[104:107]
 v_rcp_f32 v67, v67
 v_mfma_f32_16x16x32_bf16 v[108:111], a[232:235], v[40:43], v[108:111]
 v_mul_f32 v71, v67, v71
 v_mul_f32 v76, v72, v76
 v_mfma_f32_16x16x32_bf16 v[108:111], a[236:239], v[44:47], v[108:111]
 v_mul_f32 v72, s54, v72
 v_mul_f32 v77, v73, v77
 v_mfma_f32_16x16x32_bf16 v[96:99], a[24:27], v[48:51], v[96:99]
 ds_read_b128 v[40:43], v20 offset:24576
 v_mul_f32 v73, s54, v73
 v_mfma_f32_16x16x32_bf16 v[96:99], a[28:31], v[52:55], v[96:99]
 v_exp_f32 v72, v72
 v_mfma_f32_16x16x32_bf16 v[100:103], a[168:171], v[48:51], v[100:103]
 v_exp_f32 v73, v73
 v_mfma_f32_16x16x32_bf16 v[100:103], a[172:175], v[52:55], v[100:103]
 v_add_f32 v72, 1.0, v72
 v_add_f32 v73, 1.0, v73
 v_mfma_f32_16x16x32_bf16 v[104:107], a[96:99], v[48:51], v[104:107]
 ds_read_b128 v[44:47], v21 offset:24576
 v_mul_f32 v78, v74, v78
 v_mfma_f32_16x16x32_bf16 v[104:107], a[100:103], v[52:55], v[104:107]
 v_rcp_f32 v72, v72
 v_mfma_f32_16x16x32_bf16 v[108:111], a[240:243], v[48:51], v[108:111]
 v_rcp_f32 v73, v73
 v_mfma_f32_16x16x32_bf16 v[108:111], a[244:247], v[52:55], v[108:111]
 s_waitcnt lgkmcnt(2)
 v_mul_f32 v76, v72, v76
 v_mul_f32 v77, v73, v77
 v_mfma_f32_16x16x32_bf16 v[96:99], a[32:35], v[56:59], v[96:99]
 ds_read_b128 v[48:51], v20 offset:25600
 v_mul_f32 v74, s54, v74
 v_mfma_f32_16x16x32_bf16 v[96:99], a[36:39], v[60:63], v[96:99]
 v_exp_f32 v74, v74
 v_mfma_f32_16x16x32_bf16 v[100:103], a[176:179], v[56:59], v[100:103]
 v_add_f32 v74, 1.0, v74
 v_mul_f32 v79, v75, v79
 v_mfma_f32_16x16x32_bf16 v[100:103], a[180:183], v[60:63], v[100:103]
 v_rcp_f32 v74, v74
 v_mfma_f32_16x16x32_bf16 v[104:107], a[104:107], v[56:59], v[104:107]
 ds_read_b128 v[52:55], v21 offset:25600
 v_mul_f32 v78, v74, v78
 v_mfma_f32_16x16x32_bf16 v[104:107], a[108:111], v[60:63], v[104:107]
 v_mul_f32 v75, s54, v75
 v_cvt_pk_bf16_f32 v64, v68, v69
 v_mfma_f32_16x16x32_bf16 v[108:111], a[248:251], v[56:59], v[108:111]
 v_exp_f32 v75, v75
 v_mfma_f32_16x16x32_bf16 v[108:111], a[252:255], v[60:63], v[108:111]
 v_add_f32 v75, 1.0, v75
 v_cvt_pk_bf16_f32 v65, v70, v71
 v_mfma_f32_16x16x32_bf16 v[96:99], a[40:43], v[32:35], v[96:99]
 ds_read_b128 v[56:59], v20 offset:26624
 v_cvt_pk_bf16_f32 v66, v76, v77
 v_mfma_f32_16x16x32_bf16 v[96:99], a[44:47], v[36:39], v[96:99]
 v_rcp_f32 v75, v75
 v_mfma_f32_16x16x32_bf16 v[100:103], a[184:187], v[32:35], v[100:103]
 v_mul_f32 v79, v75, v79
 v_mul_f32 v84, v80, v84
 v_mfma_f32_16x16x32_bf16 v[100:103], a[188:191], v[36:39], v[100:103]
 v_cvt_pk_bf16_f32 v67, v78, v79
 v_mul_f32 v80, s54, v80
 v_mfma_f32_16x16x32_bf16 v[104:107], a[112:115], v[32:35], v[104:107]
 ds_read_b128 v[60:63], v21 offset:26624
 v_mul_f32 v85, v81, v85
 v_mfma_f32_16x16x32_bf16 v[104:107], a[116:119], v[36:39], v[104:107]
 buffer_store_dwordx4 v[64:67], v19, s[16:19], s53 offen sc1
 v_mul_f32 v81, s54, v81
 v_mfma_f32_16x16x32_bf16 v[108:111], v[224:227], v[32:35], v[108:111]
 s_add_u32 s53, s53, s52
 v_exp_f32 v80, v80
 v_mfma_f32_16x16x32_bf16 v[108:111], v[228:231], v[36:39], v[108:111]
 s_waitcnt lgkmcnt(2)
 v_exp_f32 v81, v81
 v_mfma_f32_16x16x32_bf16 v[96:99], a[48:51], v[40:43], v[96:99]
 v_add_f32 v80, 1.0, v80
 v_add_f32 v81, 1.0, v81
 v_mfma_f32_16x16x32_bf16 v[96:99], a[52:55], v[44:47], v[96:99]
 v_rcp_f32 v80, v80
 v_mfma_f32_16x16x32_bf16 v[100:103], a[192:195], v[40:43], v[100:103]
 v_rcp_f32 v81, v81
 v_mfma_f32_16x16x32_bf16 v[100:103], a[196:199], v[44:47], v[100:103]
 v_mul_f32 v84, v80, v84
 v_mul_f32 v85, v81, v85
 v_mfma_f32_16x16x32_bf16 v[104:107], a[120:123], v[40:43], v[104:107]
 v_mul_f32 v86, v82, v86
 v_mul_f32 v87, v83, v87
 v_mfma_f32_16x16x32_bf16 v[104:107], a[124:127], v[44:47], v[104:107]
 v_mul_f32 v82, s54, v82
 v_mul_f32 v83, s54, v83
 v_mfma_f32_16x16x32_bf16 v[108:111], v[232:235], v[40:43], v[108:111]
 s_waitcnt vmcnt(15) lgkmcnt(0)
 s_barrier
 v_mul_f32 v92, v88, v92
 v_mfma_f32_16x16x32_bf16 v[108:111], v[236:239], v[44:47], v[108:111]
 ds_read_b128 v[32:35], v22 offset:0
 v_mul_f32 v88, s54, v88
 v_mfma_f32_16x16x32_bf16 v[96:99], a[56:59], v[48:51], v[96:99]
 ds_read_b128 v[36:39], v23 offset:0
 v_mul_f32 v93, v89, v93
 v_mfma_f32_16x16x32_bf16 v[96:99], a[60:63], v[52:55], v[96:99]
 ds_read_b128 v[40:43], v22 offset:1024
 v_mul_f32 v89, s54, v89
 v_mfma_f32_16x16x32_bf16 v[100:103], a[200:203], v[48:51], v[100:103]
 v_exp_f32 v82, v82
 v_mfma_f32_16x16x32_bf16 v[100:103], a[204:207], v[52:55], v[100:103]
 v_exp_f32 v83, v83
 v_mfma_f32_16x16x32_bf16 v[104:107], a[128:131], v[48:51], v[104:107]
 ds_read_b128 v[44:47], v23 offset:1024
 v_add_f32 v82, 1.0, v82
 v_mfma_f32_16x16x32_bf16 v[104:107], a[132:135], v[52:55], v[104:107]
 v_rcp_f32 v82, v82
 v_mfma_f32_16x16x32_bf16 v[108:111], v[240:243], v[48:51], v[108:111]
 v_exp_f32 v88, v88
 v_mfma_f32_16x16x32_bf16 v[108:111], v[244:247], v[52:55], v[108:111]
 s_waitcnt lgkmcnt(2)
 v_exp_f32 v89, v89
 v_mfma_f32_16x16x32_bf16 v[96:99], a[64:67], v[56:59], v[96:99]
 ds_read_b128 v[48:51], v22 offset:2048
 v_mul_f32 v86, v82, v86
 v_mfma_f32_16x16x32_bf16 v[96:99], a[68:71], v[60:63], v[96:99]
 v_add_f32 v83, 1.0, v83
 v_add_f32 v88, 1.0, v88
 v_mfma_f32_16x16x32_bf16 v[100:103], a[208:211], v[56:59], v[100:103]
 v_rcp_f32 v83, v83
 v_mfma_f32_16x16x32_bf16 v[100:103], a[212:215], v[60:63], v[100:103]
 v_rcp_f32 v88, v88
 v_mfma_f32_16x16x32_bf16 v[104:107], a[136:139], v[56:59], v[104:107]
 ds_read_b128 v[52:55], v23 offset:2048
 v_mul_f32 v87, v83, v87
 v_mfma_f32_16x16x32_bf16 v[104:107], a[140:143], v[60:63], v[104:107]
 v_mul_f32 v92, v88, v92
 v_add_f32 v89, 1.0, v89
 v_mfma_f32_16x16x32_bf16 v[108:111], v[248:251], v[56:59], v[108:111]
 v_rcp_f32 v89, v89
 v_mfma_f32_16x16x32_bf16 v[108:111], v[252:255], v[60:63], v[108:111]
 v_mul_f32 v93, v89, v93
 v_mul_f32 v94, v90, v94
 v_mfma_f32_16x16x32_bf16 v[64:67], a[0:3], v[32:35], 0
 ds_read_b128 v[56:59], v22 offset:3072
 v_mul_f32 v90, s54, v90
 v_mfma_f32_16x16x32_bf16 v[64:67], a[4:7], v[36:39], v[64:67]
 v_exp_f32 v90, v90
 v_mfma_f32_16x16x32_bf16 v[68:71], a[144:147], v[32:35], 0
 v_add_f32 v90, 1.0, v90
 v_mul_f32 v95, v91, v95
 v_mfma_f32_16x16x32_bf16 v[68:71], a[148:151], v[36:39], v[68:71]
 v_rcp_f32 v90, v90
 v_mfma_f32_16x16x32_bf16 v[72:75], a[72:75], v[32:35], 0
 ds_read_b128 v[60:63], v23 offset:3072
 v_mul_f32 v94, v90, v94
 v_mfma_f32_16x16x32_bf16 v[72:75], a[76:79], v[36:39], v[72:75]
 v_lshl_add_u32 v3, v0, 7, s57
 v_mul_f32 v91, s54, v91
 v_mfma_f32_16x16x32_bf16 v[76:79], a[216:219], v[32:35], 0
 v_min_u32 v3, L_text_end-gated_mix__ssm_conv_s4d__swiglu_ffn__prompt_kernel-4, v3
 v_cvt_pk_bf16_f32 v80, v84, v85
 v_mfma_f32_16x16x32_bf16 v[76:79], a[220:223], v[36:39], v[76:79]
 s_waitcnt lgkmcnt(2)
 v_exp_f32 v91, v91
 v_mfma_f32_16x16x32_bf16 v[64:67], a[8:11], v[40:43], v[64:67]
 ds_read_b128 v[32:35], v22 offset:4096
 v_add_f32 v91, 1.0, v91
 v_mfma_f32_16x16x32_bf16 v[64:67], a[12:15], v[44:47], v[64:67]
 global_load_dword v4, v3, s[20:21]
 v_cvt_pk_bf16_f32 v81, v86, v87
 v_mfma_f32_16x16x32_bf16 v[68:71], a[152:155], v[40:43], v[68:71]
 v_rcp_f32 v91, v91
 v_mfma_f32_16x16x32_bf16 v[68:71], a[156:159], v[44:47], v[68:71]
 v_mul_f32 v95, v91, v95
 v_cvt_pk_bf16_f32 v82, v92, v93
 v_mfma_f32_16x16x32_bf16 v[72:75], a[80:83], v[40:43], v[72:75]
 ds_read_b128 v[36:39], v23 offset:4096
 v_cvt_pk_bf16_f32 v83, v94, v95
 v_mfma_f32_16x16x32_bf16 v[72:75], a[84:87], v[44:47], v[72:75]
 buffer_store_dwordx4 v[80:83], v19, s[16:19], s53 offen sc1
 v_mul_f32 v100, v96, v100
 v_mfma_f32_16x16x32_bf16 v[76:79], a[224:227], v[40:43], v[76:79]
 s_add_u32 s53, s53, s52
 v_mul_f32 v96, s54, v96
 v_mul_f32 v101, v97, v101
 v_mfma_f32_16x16x32_bf16 v[76:79], a[228:231], v[44:47], v[76:79]
 v_exp_f32 v96, v96
 v_mfma_f32_16x16x32_bf16 v[64:67], a[16:19], v[48:51], v[64:67]
 ds_read_b128 v[40:43], v22 offset:5120
 v_add_f32 v96, 1.0, v96
 v_mfma_f32_16x16x32_bf16 v[64:67], a[20:23], v[52:55], v[64:67]
 v_rcp_f32 v96, v96
 v_mfma_f32_16x16x32_bf16 v[68:71], a[160:163], v[48:51], v[68:71]
 v_mul_f32 v100, v96, v100
 v_mul_f32 v97, s54, v97
 v_mfma_f32_16x16x32_bf16 v[68:71], a[164:167], v[52:55], v[68:71]
 v_exp_f32 v97, v97
 v_mfma_f32_16x16x32_bf16 v[72:75], a[88:91], v[48:51], v[72:75]
 ds_read_b128 v[44:47], v23 offset:5120
 v_add_f32 v97, 1.0, v97
 v_mfma_f32_16x16x32_bf16 v[72:75], a[92:95], v[52:55], v[72:75]
 v_rcp_f32 v97, v97
 v_mfma_f32_16x16x32_bf16 v[76:79], a[232:235], v[48:51], v[76:79]
 v_mul_f32 v101, v97, v101
 v_mul_f32 v102, v98, v102
 v_mfma_f32_16x16x32_bf16 v[76:79], a[236:239], v[52:55], v[76:79]
 s_waitcnt lgkmcnt(2)
 v_mul_f32 v98, s54, v98
 v_mul_f32 v103, v99, v103
 v_mfma_f32_16x16x32_bf16 v[64:67], a[24:27], v[56:59], v[64:67]
 ds_read_b128 v[48:51], v22 offset:6144
 v_mul_f32 v99, s54, v99
 v_mfma_f32_16x16x32_bf16 v[64:67], a[28:31], v[60:63], v[64:67]
 v_exp_f32 v98, v98
 v_mfma_f32_16x16x32_bf16 v[68:71], a[168:171], v[56:59], v[68:71]
 v_exp_f32 v99, v99
 v_mfma_f32_16x16x32_bf16 v[68:71], a[172:175], v[60:63], v[68:71]
 v_add_f32 v98, 1.0, v98
 v_add_f32 v99, 1.0, v99
 v_mfma_f32_16x16x32_bf16 v[72:75], a[96:99], v[56:59], v[72:75]
 ds_read_b128 v[52:55], v23 offset:6144
 v_mul_f32 v108, v104, v108
 v_mfma_f32_16x16x32_bf16 v[72:75], a[100:103], v[60:63], v[72:75]
 v_rcp_f32 v98, v98
 v_mfma_f32_16x16x32_bf16 v[76:79], a[240:243], v[56:59], v[76:79]
 v_rcp_f32 v99, v99
 v_mfma_f32_16x16x32_bf16 v[76:79], a[244:247], v[60:63], v[76:79]
 v_mul_f32 v102, v98, v102
 v_mul_f32 v103, v99, v103
 v_mfma_f32_16x16x32_bf16 v[64:67], a[32:35], v[32:35], v[64:67]
 ds_read_b128 v[56:59], v22 offset:7168
 v_mul_f32 v104, s54, v104
 v_mfma_f32_16x16x32_bf16 v[64:67], a[36:39], v[36:39], v[64:67]
 v_exp_f32 v104, v104
 v_mfma_f32_16x16x32_bf16 v[68:71], a[176:179], v[32:35], v[68:71]
 v_add_f32 v104, 1.0, v104
 v_mul_f32 v109, v105, v109
 v_mfma_f32_16x16x32_bf16 v[68:71], a[180:183], v[36:39], v[68:71]
 v_rcp_f32 v104, v104
 v_mfma_f32_16x16x32_bf16 v[72:75], a[104:107], v[32:35], v[72:75]
 ds_read_b128 v[60:63], v23 offset:7168
 v_mul_f32 v108, v104, v108
 v_mfma_f32_16x16x32_bf16 v[72:75], a[108:111], v[36:39], v[72:75]
 v_mul_f32 v105, s54, v105
 v_mul_f32 v110, v106, v110
 v_mfma_f32_16x16x32_bf16 v[76:79], a[248:251], v[32:35], v[76:79]
 v_exp_f32 v105, v105
 v_mfma_f32_16x16x32_bf16 v[76:79], a[252:255], v[36:39], v[76:79]
 s_waitcnt lgkmcnt(2)
 v_add_f32 v105, 1.0, v105
 v_mul_f32 v106, s54, v106
 v_mfma_f32_16x16x32_bf16 v[64:67], a[40:43], v[40:43], v[64:67]
 ds_read_b128 v[32:35], v22 offset:8192
 v_mul_f32 v111, v107, v111
 v_mfma_f32_16x16x32_bf16 v[64:67], a[44:47], v[44:47], v[64:67]
 v_rcp_f32 v105, v105
 v_mfma_f32_16x16x32_bf16 v[68:71], a[184:187], v[40:43], v[68:71]
 v_exp_f32 v106, v106
 v_mfma_f32_16x16x32_bf16 v[68:71], a[188:191], v[44:47], v[68:71]
 v_mul_f32 v109, v105, v109
 v_add_f32 v106, 1.0, v106
 v_mfma_f32_16x16x32_bf16 v[72:75], a[112:115], v[40:43], v[72:75]
 ds_read_b128 v[36:39], v23 offset:8192
 v_mul_f32 v107, s54, v107
 v_mfma_f32_16x16x32_bf16 v[72:75], a[116:119], v[44:47], v[72:75]
 v_rcp_f32 v106, v106
 v_mfma_f32_16x16x32_bf16 v[76:79], v[224:227], v[40:43], v[76:79]
 v_exp_f32 v107, v107
 v_mfma_f32_16x16x32_bf16 v[76:79], v[228:231], v[44:47], v[76:79]
 v_mul_f32 v110, v106, v110
 v_add_f32 v107, 1.0, v107
 v_mfma_f32_16x16x32_bf16 v[64:67], a[48:51], v[48:51], v[64:67]
 ds_read_b128 v[40:43], v22 offset:18432
 v_cvt_pk_bf16_f32 v96, v100, v101
 v_mfma_f32_16x16x32_bf16 v[64:67], a[52:55], v[52:55], v[64:67]
 v_rcp_f32 v107, v107
 v_mfma_f32_16x16x32_bf16 v[68:71], a[192:195], v[48:51], v[68:71]
 s_load_dword s64, s[88:89], s28 offset:8320
 v_mul_f32 v111, v107, v111
 v_cvt_pk_bf16_f32 v97, v102, v103
 v_mfma_f32_16x16x32_bf16 v[68:71], a[196:199], v[52:55], v[68:71]
 v_cvt_pk_bf16_f32 v98, v108, v109
 v_cvt_pk_bf16_f32 v99, v110, v111
 v_mfma_f32_16x16x32_bf16 v[72:75], a[120:123], v[48:51], v[72:75]
 ds_read_b128 v[44:47], v23 offset:18432
 v_mfma_f32_16x16x32_bf16 v[72:75], a[124:127], v[52:55], v[72:75]
 buffer_store_dwordx4 v[96:99], v19, s[16:19], s53 offen sc1
 v_mfma_f32_16x16x32_bf16 v[76:79], v[232:235], v[48:51], v[76:79]
 s_add_u32 s53, s53, s52
 v_mfma_f32_16x16x32_bf16 v[76:79], v[236:239], v[52:55], v[76:79]
 s_waitcnt lgkmcnt(4)
 v_mfma_f32_16x16x32_bf16 v[64:67], a[56:59], v[56:59], v[64:67]
 ds_read_b128 v[48:51], v22 offset:19456
 v_mfma_f32_16x16x32_bf16 v[64:67], a[60:63], v[60:63], v[64:67]
 v_mfma_f32_16x16x32_bf16 v[68:71], a[200:203], v[56:59], v[68:71]
 v_mfma_f32_16x16x32_bf16 v[68:71], a[204:207], v[60:63], v[68:71]
 v_mfma_f32_16x16x32_bf16 v[72:75], a[128:131], v[56:59], v[72:75]
 ds_read_b128 v[52:55], v23 offset:19456
 v_mfma_f32_16x16x32_bf16 v[72:75], a[132:135], v[60:63], v[72:75]
Lpg12:
 s_cbranch_vccnz Lj_Lfin
 v_mfma_f32_16x16x32_bf16 v[76:79], v[240:243], v[56:59], v[76:79]
 v_mfma_f32_16x16x32_bf16 v[76:79], v[244:247], v[60:63], v[76:79]
 s_waitcnt lgkmcnt(4)
 v_mfma_f32_16x16x32_bf16 v[64:67], a[64:67], v[32:35], v[64:67]
 ds_read_b128 v[56:59], v22 offset:20480
 v_mfma_f32_16x16x32_bf16 v[64:67], a[68:71], v[36:39], v[64:67]
 v_mfma_f32_16x16x32_bf16 v[68:71], a[208:211], v[32:35], v[68:71]
 v_mfma_f32_16x16x32_bf16 v[68:71], a[212:215], v[36:39], v[68:71]
 v_mfma_f32_16x16x32_bf16 v[72:75], a[136:139], v[32:35], v[72:75]
 ds_read_b128 v[60:63], v23 offset:20480
 v_mfma_f32_16x16x32_bf16 v[72:75], a[140:143], v[36:39], v[72:75]
 v_mfma_f32_16x16x32_bf16 v[76:79], v[248:251], v[32:35], v[76:79]
 s_load_dwordx4 s[40:43], s[88:89], s60 offset:4224
 v_mfma_f32_16x16x32_bf16 v[76:79], v[252:255], v[36:39], v[76:79]
 s_waitcnt lgkmcnt(4)
 v_mfma_f32_16x16x32_bf16 v[80:83], a[0:3], v[40:43], 0
 ds_read_b128 v[32:35], v22 offset:21504
 v_mfma_f32_16x16x32_bf16 v[80:83], a[4:7], v[44:47], v[80:83]
 v_mfma_f32_16x16x32_bf16 v[84:87], a[144:147], v[40:43], 0
 v_mfma_f32_16x16x32_bf16 v[84:87], a[148:151], v[44:47], v[84:87]
 v_mfma_f32_16x16x32_bf16 v[88:91], a[72:75], v[40:43], 0
 ds_read_b128 v[36:39], v23 offset:21504
 v_mfma_f32_16x16x32_bf16 v[88:91], a[76:79], v[44:47], v[88:91]
 v_mul_f32 v68, v64, v68
 v_mul_f32 v69, v65, v69
 v_mfma_f32_16x16x32_bf16 v[92:95], a[216:219], v[40:43], 0
 v_mul_f32 v64, s54, v64
 v_mul_f32 v65, s54, v65
 v_mfma_f32_16x16x32_bf16 v[92:95], a[220:223], v[44:47], v[92:95]
 s_waitcnt lgkmcnt(4)
 v_exp_f32 v64, v64
 v_mfma_f32_16x16x32_bf16 v[80:83], a[8:11], v[48:51], v[80:83]
 ds_read_b128 v[40:43], v22 offset:22528
 v_add_f32 v64, 1.0, v64
 v_mfma_f32_16x16x32_bf16 v[80:83], a[12:15], v[52:55], v[80:83]
 v_rcp_f32 v64, v64
 v_mfma_f32_16x16x32_bf16 v[84:87], a[152:155], v[48:51], v[84:87]
 v_exp_f32 v65, v65
 v_mfma_f32_16x16x32_bf16 v[84:87], a[156:159], v[52:55], v[84:87]
 v_mul_f32 v68, v64, v68
 v_add_f32 v65, 1.0, v65
 v_mfma_f32_16x16x32_bf16 v[88:91], a[80:83], v[48:51], v[88:91]
 ds_read_b128 v[44:47], v23 offset:22528
 v_mul_f32 v70, v66, v70
 v_mfma_f32_16x16x32_bf16 v[88:91], a[84:87], v[52:55], v[88:91]
 v_rcp_f32 v65, v65
 v_mfma_f32_16x16x32_bf16 v[92:95], a[224:227], v[48:51], v[92:95]
 v_mul_f32 v69, v65, v69
 v_mul_f32 v66, s54, v66
 v_mfma_f32_16x16x32_bf16 v[92:95], a[228:231], v[52:55], v[92:95]
 s_waitcnt lgkmcnt(4)
 v_exp_f32 v66, v66
 v_mfma_f32_16x16x32_bf16 v[80:83], a[16:19], v[56:59], v[80:83]
 ds_read_b128 v[48:51], v22 offset:23552
 v_add_f32 v66, 1.0, v66
 v_mfma_f32_16x16x32_bf16 v[80:83], a[20:23], v[60:63], v[80:83]
 v_rcp_f32 v66, v66
 v_mfma_f32_16x16x32_bf16 v[84:87], a[160:163], v[56:59], v[84:87]
 v_mul_f32 v70, v66, v70
 v_mul_f32 v71, v67, v71
 v_mfma_f32_16x16x32_bf16 v[84:87], a[164:167], v[60:63], v[84:87]
 v_mul_f32 v67, s54, v67
 v_mul_f32 v76, v72, v76
 v_mfma_f32_16x16x32_bf16 v[88:91], a[88:91], v[56:59], v[88:91]
 ds_read_b128 v[52:55], v23 offset:23552
 v_mul_f32 v72, s54, v72
 v_mfma_f32_16x16x32_bf16 v[88:91], a[92:95], v[60:63], v[88:91]
 v_exp_f32 v67, v67
 v_mfma_f32_16x16x32_bf16 v[92:95], a[232:235], v[56:59], v[92:95]
 v_exp_f32 v72, v72
 v_mfma_f32_16x16x32_bf16 v[92:95], a[236:239], v[60:63], v[92:95]
 s_waitcnt lgkmcnt(4)
 v_add_f32 v67, 1.0, v67
 v_add_f32 v72, 1.0, v72
 v_mfma_f32_16x16x32_bf16 v[80:83], a[24:27], v[32:35], v[80:83]
 ds_read_b128 v[56:59], v22 offset:24576
 v_mul_f32 v77, v73, v77
 v_mfma_f32_16x16x32_bf16 v[80:83], a[28:31], v[36:39], v[80:83]
 v_rcp_f32 v67, v67
 v_mfma_f32_16x16x32_bf16 v[84:87], a[168:171], v[32:35], v[84:87]
 v_rcp_f32 v72, v72
 v_mfma_f32_16x16x32_bf16 v[84:87], a[172:175], v[36:39], v[84:87]
 v_mul_f32 v71, v67, v71
 v_mul_f32 v76, v72, v76
 v_mfma_f32_16x16x32_bf16 v[88:91], a[96:99], v[32:35], v[88:91]
 ds_read_b128 v[60:63], v23 offset:24576
 v_mul_f32 v73, s54, v73
 v_mfma_f32_16x16x32_bf16 v[88:91], a[100:103], v[36:39], v[88:91]
 v_exp_f32 v73, v73
 v_mfma_f32_16x16x32_bf16 v[92:95], a[240:243], v[32:35], v[92:95]
 v_add_f32 v73, 1.0, v73
 v_mul_f32 v78, v74, v78
 v_mfma_f32_16x16x32_bf16 v[92:95], a[244:247], v[36:39], v[92:95]
 s_waitcnt lgkmcnt(4)
 v_rcp_f32 v73, v73
 v_mfma_f32_16x16x32_bf16 v[80:83], a[32:35], v[40:43], v[80:83]
 ds_read_b128 v[32:35], v22 offset:25600
 v_mul_f32 v77, v73, v77
 v_mfma_f32_16x16x32_bf16 v[80:83], a[36:39], v[44:47], v[80:83]
 v_mul_f32 v74, s54, v74
 v_mul_f32 v79, v75, v79
 v_mfma_f32_16x16x32_bf16 v[84:87], a[176:179], v[40:43], v[84:87]
 v_exp_f32 v74, v74
 v_mfma_f32_16x16x32_bf16 v[84:87], a[180:183], v[44:47], v[84:87]
 v_add_f32 v74, 1.0, v74
 v_mul_f32 v75, s54, v75
 v_mfma_f32_16x16x32_bf16 v[88:91], a[104:107], v[40:43], v[88:91]
 ds_read_b128 v[36:39], v23 offset:25600
 v_cvt_pk_bf16_f32 v64, v68, v69
 v_mfma_f32_16x16x32_bf16 v[88:91], a[108:111], v[44:47], v[88:91]
 v_rcp_f32 v74, v74
 v_mfma_f32_16x16x32_bf16 v[92:95], a[248:251], v[40:43], v[92:95]
 v_exp_f32 v75, v75
 v_mfma_f32_16x16x32_bf16 v[92:95], a[252:255], v[44:47], v[92:95]
 s_waitcnt lgkmcnt(4)
 v_mul_f32 v78, v74, v78
 v_add_f32 v75, 1.0, v75
 v_mfma_f32_16x16x32_bf16 v[80:83], a[40:43], v[48:51], v[80:83]
 ds_read_b128 v[40:43], v22 offset:26624
 v_cvt_pk_bf16_f32 v65, v70, v71
 v_mfma_f32_16x16x32_bf16 v[80:83], a[44:47], v[52:55], v[80:83]
 v_rcp_f32 v75, v75
 v_mfma_f32_16x16x32_bf16 v[84:87], a[184:187], v[48:51], v[84:87]
 v_mul_f32 v79, v75, v79
 v_cvt_pk_bf16_f32 v66, v76, v77
 v_mfma_f32_16x16x32_bf16 v[84:87], a[188:191], v[52:55], v[84:87]
 v_cvt_pk_bf16_f32 v67, v78, v79
 v_mfma_f32_16x16x32_bf16 v[88:91], a[112:115], v[48:51], v[88:91]
 ds_read_b128 v[44:47], v23 offset:26624
 v_mfma_f32_16x16x32_bf16 v[88:91], a[116:119], v[52:55], v[88:91]
 buffer_store_dwordx4 v[64:67], v19, s[16:19], s53 offen sc1
 v_mfma_f32_16x16x32_bf16 v[92:95], v[224:227], v[48:51], v[92:95]
 s_add_u32 s53, s53, s52
 v_mfma_f32_16x16x32_bf16 v[92:95], v[228:231], v[52:55], v[92:95]
 s_waitcnt lgkmcnt(4)
 v_mfma_f32_16x16x32_bf16 v[80:83], a[48:51], v[56:59], v[80:83]
 v_mfma_f32_16x16x32_bf16 v[80:83], a[52:55], v[60:63], v[80:83]
 v_mfma_f32_16x16x32_bf16 v[84:87], a[192:195], v[56:59], v[84:87]
 v_mfma_f32_16x16x32_bf16 v[84:87], a[196:199], v[60:63], v[84:87]
 s_movk_i32 s30, 4096
 v_mfma_f32_16x16x32_bf16 v[88:91], a[120:123], v[56:59], v[88:91]
 s_mov_b32 s31, 147456
 v_mfma_f32_16x16x32_bf16 v[88:91], a[124:127], v[60:63], v[88:91]
 v_mfma_f32_16x16x32_bf16 v[92:95], v[232:235], v[56:59], v[92:95]
 s_waitcnt vmcnt(6) lgkmcnt(0)
 s_waitcnt vmcnt(1)
 s_barrier
 v_mfma_f32_16x16x32_bf16 v[92:95], v[236:239], v[60:63], v[92:95]
 ds_read_b128 v[48:51], v24 offset:0
 v_mfma_f32_16x16x32_bf16 v[80:83], a[56:59], v[32:35], v[80:83]
 ds_read_b128 v[52:55], v25 offset:0
 v_mfma_f32_16x16x32_bf16 v[80:83], a[60:63], v[36:39], v[80:83]
 ds_read_b128 v[56:59], v24 offset:1024
 v_mfma_f32_16x16x32_bf16 v[84:87], a[200:203], v[32:35], v[84:87]
 buffer_store_byte v2, v1, s[16:19], s25 offen sc1
 v_mfma_f32_16x16x32_bf16 v[84:87], a[204:207], v[36:39], v[84:87]
 s_add_u32 s25, s25, 18432
 v_mfma_f32_16x16x32_bf16 v[88:91], a[128:131], v[32:35], v[88:91]
 ds_read_b128 v[60:63], v25 offset:1024
 v_mfma_f32_16x16x32_bf16 v[88:91], a[132:135], v[36:39], v[88:91]
 s_mul_i32 s42, s42, 16843009
 v_mfma_f32_16x16x32_bf16 v[92:95], v[240:243], v[32:35], v[92:95]
 s_and_b32 s40, s40, s41
 v_mfma_f32_16x16x32_bf16 v[92:95], v[244:247], v[36:39], v[92:95]
 v_mfma_f32_16x16x32_bf16 v[80:83], a[64:67], v[40:43], v[80:83]
 ds_read_b128 v[32:35], v24 offset:2048
 v_mfma_f32_16x16x32_bf16 v[80:83], a[68:71], v[44:47], v[80:83]
 s_and_b32 s40, s40, s42
 v_mfma_f32_16x16x32_bf16 v[84:87], a[208:211], v[40:43], v[84:87]
 s_cmp_eq_u32 s40, 16843009
 s_cbranch_scc0 Lsp_g10w
Lrt_g10w:
 s_mul_i32 s84, s62, 442368
 v_mfma_f32_16x16x32_bf16 v[84:87], a[212:215], v[44:47], v[84:87]
 s_cmp_eq_u32 s64, 0x10101
 s_cbranch_scc0 Lsp_g10p0
Lrt_g10p0:
 s_add_u32 s84, s84, s86
 v_mfma_f32_16x16x32_bf16 v[88:91], a[136:139], v[40:43], v[88:91]
 ds_read_b128 v[36:39], v25 offset:2048
 s_add_u32 m0, s55, 0
 v_mfma_f32_16x16x32_bf16 v[88:91], a[140:143], v[44:47], v[88:91]
 buffer_load_dwordx4 v19, s[16:19], s84 offen sc1 lds
 v_mfma_f32_16x16x32_bf16 v[92:95], v[248:251], v[40:43], v[92:95]
 buffer_load_dwordx4 v19, s[16:19], s84 offen offset:1024 sc1 lds
 v_mfma_f32_16x16x32_bf16 v[92:95], v[252:255], v[44:47], v[92:95]
 s_waitcnt lgkmcnt(4)
 v_mfma_f32_16x16x32_bf16 v[64:67], a[0:3], v[48:51], 0
 ds_read_b128 v[40:43], v24 offset:3072
 v_mfma_f32_16x16x32_bf16 v[64:67], a[4:7], v[52:55], v[64:67]
 buffer_load_dwordx4 v19, s[16:19], s84 offen offset:2048 sc1 lds
 v_mfma_f32_16x16x32_bf16 v[68:71], a[144:147], v[48:51], 0
 v_mfma_f32_16x16x32_bf16 v[68:71], a[148:151], v[52:55], v[68:71]
 v_mfma_f32_16x16x32_bf16 v[72:75], a[72:75], v[48:51], 0
 ds_read_b128 v[44:47], v25 offset:3072
 v_mfma_f32_16x16x32_bf16 v[72:75], a[76:79], v[52:55], v[72:75]
 buffer_load_dwordx4 v19, s[16:19], s84 offen offset:3072 sc1 lds
 s_add_u32 m0, m0, s30
 v_mfma_f32_16x16x32_bf16 v[76:79], a[216:219], v[48:51], 0
 v_mul_f32 v84, v80, v84
 v_mul_f32 v85, v81, v85
 v_mul_f32 v86, v82, v86
 v_mfma_f32_16x16x32_bf16 v[76:79], a[220:223], v[52:55], v[76:79]
 s_waitcnt lgkmcnt(4)
 v_mul_f32 v80, s54, v80
 v_mul_f32 v81, s54, v81
 v_mfma_f32_16x16x32_bf16 v[64:67], a[8:11], v[56:59], v[64:67]
 ds_read_b128 v[48:51], v24 offset:4096
 v_exp_f32 v80, v80
 v_mfma_f32_16x16x32_bf16 v[64:67], a[12:15], v[60:63], v[64:67]
 buffer_load_dwordx4 v5, s[16:19], s84 offen sc1 lds
 v_add_f32 v80, 1.0, v80
 v_mfma_f32_16x16x32_bf16 v[68:71], a[152:155], v[56:59], v[68:71]
 v_rcp_f32 v80, v80
 v_mul_f32 v82, s54, v82
 v_mfma_f32_16x16x32_bf16 v[68:71], a[156:159], v[60:63], v[68:71]
 buffer_load_dwordx4 v5, s[16:19], s84 offen offset:1024 sc1 lds
 v_mul_f32 v84, v80, v84
 v_mfma_f32_16x16x32_bf16 v[72:75], a[80:83], v[56:59], v[72:75]
 ds_read_b128 v[52:55], v25 offset:4096
 v_exp_f32 v81, v81
 v_mfma_f32_16x16x32_bf16 v[72:75], a[84:87], v[60:63], v[72:75]
 v_exp_f32 v82, v82
 v_mfma_f32_16x16x32_bf16 v[76:79], a[224:227], v[56:59], v[76:79]
 v_add_f32 v81, 1.0, v81
 v_add_f32 v82, 1.0, v82
 v_mul_f32 v87, v83, v87
 v_mfma_f32_16x16x32_bf16 v[76:79], a[228:231], v[60:63], v[76:79]
 s_waitcnt lgkmcnt(4)
 v_rcp_f32 v81, v81
 v_mfma_f32_16x16x32_bf16 v[64:67], a[16:19], v[32:35], v[64:67]
 ds_read_b128 v[56:59], v24 offset:5120
 v_rcp_f32 v82, v82
 v_mfma_f32_16x16x32_bf16 v[64:67], a[20:23], v[36:39], v[64:67]
 buffer_load_dwordx4 v5, s[16:19], s84 offen offset:2048 sc1 lds
 v_mul_f32 v85, v81, v85
 v_mfma_f32_16x16x32_bf16 v[68:71], a[160:163], v[32:35], v[68:71]
 v_mul_f32 v86, v82, v86
 v_mul_f32 v83, s54, v83
 v_mul_f32 v92, v88, v92
 v_mfma_f32_16x16x32_bf16 v[68:71], a[164:167], v[36:39], v[68:71]
 buffer_load_dwordx4 v5, s[16:19], s84 offen offset:3072 sc1 lds
 s_add_u32 m0, m0, s30
 v_mfma_f32_16x16x32_bf16 v[72:75], a[88:91], v[32:35], v[72:75]
 ds_read_b128 v[60:63], v25 offset:5120
 v_exp_f32 v83, v83
 v_mfma_f32_16x16x32_bf16 v[72:75], a[92:95], v[36:39], v[72:75]
 v_add_f32 v83, 1.0, v83
 v_mul_f32 v88, s54, v88
 v_mfma_f32_16x16x32_bf16 v[76:79], a[232:235], v[32:35], v[76:79]
 buffer_load_dwordx4 v6, s[16:19], s84 offen sc1 lds
 s_mul_i32 s85, s62, 12288
 v_mul_f32 v93, v89, v93
 v_mfma_f32_16x16x32_bf16 v[76:79], a[236:239], v[36:39], v[76:79]
 s_waitcnt lgkmcnt(4)
 s_add_u32 s85, s85, s87
 v_mul_f32 v89, s54, v89
 v_mfma_f32_16x16x32_bf16 v[64:67], a[24:27], v[40:43], v[64:67]
 ds_read_b128 v[32:35], v24 offset:6144
 v_rcp_f32 v83, v83
 v_mfma_f32_16x16x32_bf16 v[64:67], a[28:31], v[44:47], v[64:67]
 v_exp_f32 v88, v88
 v_mfma_f32_16x16x32_bf16 v[68:71], a[168:171], v[40:43], v[68:71]
 buffer_load_dwordx4 v[160:163], v19, s[16:19], s85 offen sc1
 v_exp_f32 v89, v89
 v_mfma_f32_16x16x32_bf16 v[68:71], a[172:175], v[44:47], v[68:71]
 v_mul_f32 v87, v83, v87
 v_add_f32 v88, 1.0, v88
 v_mfma_f32_16x16x32_bf16 v[72:75], a[96:99], v[40:43], v[72:75]
 ds_read_b128 v[36:39], v25 offset:6144
 v_rcp_f32 v88, v88
 v_mfma_f32_16x16x32_bf16 v[72:75], a[100:103], v[44:47], v[72:75]
 buffer_load_dwordx4 v[164:167], v7, s[16:19], s85 offen sc1
 v_mul_f32 v92, v88, v92
 v_mfma_f32_16x16x32_bf16 v[76:79], a[240:243], v[40:43], v[76:79]
 v_add_f32 v89, 1.0, v89
 v_mul_f32 v94, v90, v94
 v_mul_f32 v95, v91, v95
 v_mfma_f32_16x16x32_bf16 v[76:79], a[244:247], v[44:47], v[76:79]
 s_waitcnt lgkmcnt(4)
 v_rcp_f32 v89, v89
 v_mfma_f32_16x16x32_bf16 v[64:67], a[32:35], v[48:51], v[64:67]
 ds_read_b128 v[40:43], v24 offset:7168
 v_mul_f32 v93, v89, v93
 v_mul_f32 v90, s54, v90
 v_mfma_f32_16x16x32_bf16 v[64:67], a[36:39], v[52:55], v[64:67]
 buffer_load_dwordx4 v[168:171], v19, s[16:19], s85 offen offset:1024 sc1
 v_mul_f32 v91, s54, v91
 v_mfma_f32_16x16x32_bf16 v[68:71], a[176:179], v[48:51], v[68:71]
 v_exp_f32 v90, v90
 v_cvt_pk_bf16_f32 v80, v84, v85
 v_mfma_f32_16x16x32_bf16 v[68:71], a[180:183], v[52:55], v[68:71]
 v_exp_f32 v91, v91
 v_mfma_f32_16x16x32_bf16 v[72:75], a[104:107], v[48:51], v[72:75]
 ds_read_b128 v[44:47], v25 offset:7168
 v_add_f32 v90, 1.0, v90
 v_add_f32 v91, 1.0, v91
 v_mfma_f32_16x16x32_bf16 v[72:75], a[108:111], v[52:55], v[72:75]
 buffer_load_dwordx4 v[172:175], v7, s[16:19], s85 offen offset:1024 sc1
 v_cvt_pk_bf16_f32 v81, v86, v87
 v_mfma_f32_16x16x32_bf16 v[76:79], a[248:251], v[48:51], v[76:79]
 v_rcp_f32 v90, v90
 v_cvt_pk_bf16_f32 v82, v92, v93
 v_mfma_f32_16x16x32_bf16 v[76:79], a[252:255], v[52:55], v[76:79]
 s_waitcnt lgkmcnt(4)
 v_rcp_f32 v91, v91
 v_mfma_f32_16x16x32_bf16 v[64:67], a[40:43], v[56:59], v[64:67]
 ds_read_b128 v[48:51], v24 offset:8192
 v_mul_f32 v94, v90, v94
 v_mul_f32 v95, v91, v95
 v_mfma_f32_16x16x32_bf16 v[64:67], a[44:47], v[60:63], v[64:67]
 buffer_load_dwordx4 v[176:179], v19, s[16:19], s85 offen offset:2048 sc1
 v_cvt_pk_bf16_f32 v83, v94, v95
 v_mfma_f32_16x16x32_bf16 v[68:71], a[184:187], v[56:59], v[68:71]
 buffer_store_dwordx4 v[80:83], v19, s[16:19], s53 offen sc1
 v_mfma_f32_16x16x32_bf16 v[68:71], a[188:191], v[60:63], v[68:71]
 s_add_u32 s53, s53, s52
 v_mfma_f32_16x16x32_bf16 v[72:75], a[112:115], v[56:59], v[72:75]
 ds_read_b128 v[52:55], v25 offset:8192
 v_mfma_f32_16x16x32_bf16 v[72:75], a[116:119], v[60:63], v[72:75]
 buffer_load_dwordx4 v[180:183], v7, s[16:19], s85 offen offset:2048 sc1
 v_mfma_f32_16x16x32_bf16 v[76:79], v[224:227], v[56:59], v[76:79]
 v_mfma_f32_16x16x32_bf16 v[76:79], v[228:231], v[60:63], v[76:79]
 s_waitcnt lgkmcnt(4)
 v_mfma_f32_16x16x32_bf16 v[64:67], a[48:51], v[32:35], v[64:67]
 ds_read_b128 v[56:59], v24 offset:18432
 v_mfma_f32_16x16x32_bf16 v[64:67], a[52:55], v[36:39], v[64:67]
 buffer_load_dwordx4 v[184:187], v19, s[16:19], s85 offen offset:3072 sc1
 v_mfma_f32_16x16x32_bf16 v[68:71], a[192:195], v[32:35], v[68:71]
 v_mfma_f32_16x16x32_bf16 v[68:71], a[196:199], v[36:39], v[68:71]
 buffer_load_dwordx4 v[188:191], v7, s[16:19], s85 offen offset:3072 sc1
 s_add_u32 s84, s84, s31
 v_mfma_f32_16x16x32_bf16 v[72:75], a[120:123], v[32:35], v[72:75]
 ds_read_b128 v[60:63], v25 offset:18432
 s_add_u32 m0, s56, 0
 v_mfma_f32_16x16x32_bf16 v[72:75], a[124:127], v[36:39], v[72:75]
 v_mfma_f32_16x16x32_bf16 v[76:79], v[232:235], v[32:35], v[76:79]
 v_mfma_f32_16x16x32_bf16 v[76:79], v[236:239], v[36:39], v[76:79]
 s_waitcnt lgkmcnt(2)
 v_mfma_f32_16x16x32_bf16 v[64:67], a[56:59], v[40:43], v[64:67]
 ds_read_b128 v[32:35], v24 offset:19456
 v_mfma_f32_16x16x32_bf16 v[64:67], a[60:63], v[44:47], v[64:67]
 buffer_load_dwordx4 v19, s[16:19], s84 offen sc1 lds
 v_mfma_f32_16x16x32_bf16 v[68:71], a[200:203], v[40:43], v[68:71]
 buffer_load_dwordx4 v19, s[16:19], s84 offen offset:1024 sc1 lds
 v_mfma_f32_16x16x32_bf16 v[68:71], a[204:207], v[44:47], v[68:71]
 v_mfma_f32_16x16x32_bf16 v[72:75], a[128:131], v[40:43], v[72:75]
 ds_read_b128 v[36:39], v25 offset:19456
 v_mfma_f32_16x16x32_bf16 v[72:75], a[132:135], v[44:47], v[72:75]
 v_mfma_f32_16x16x32_bf16 v[76:79], v[240:243], v[40:43], v[76:79]
 buffer_load_dwordx4 v19, s[16:19], s84 offen offset:2048 sc1 lds
 v_mfma_f32_16x16x32_bf16 v[76:79], v[244:247], v[44:47], v[76:79]
 v_mfma_f32_16x16x32_bf16 v[64:67], a[64:67], v[48:51], v[64:67]
 ds_read_b128 v[40:43], v24 offset:20480
 v_mfma_f32_16x16x32_bf16 v[64:67], a[68:71], v[52:55], v[64:67]
 buffer_load_dwordx4 v19, s[16:19], s84 offen offset:3072 sc1 lds
 s_add_u32 m0, m0, s30
 v_mfma_f32_16x16x32_bf16 v[68:71], a[208:211], v[48:51], v[68:71]
 v_mfma_f32_16x16x32_bf16 v[68:71], a[212:215], v[52:55], v[68:71]
 v_mfma_f32_16x16x32_bf16 v[72:75], a[136:139], v[48:51], v[72:75]
 ds_read_b128 v[44:47], v25 offset:20480
 v_mfma_f32_16x16x32_bf16 v[72:75], a[140:143], v[52:55], v[72:75]
 buffer_load_dwordx4 v5, s[16:19], s84 offen sc1 lds
 v_mfma_f32_16x16x32_bf16 v[76:79], v[248:251], v[48:51], v[76:79]
 v_mfma_f32_16x16x32_bf16 v[76:79], v[252:255], v[52:55], v[76:79]
 s_waitcnt lgkmcnt(4)
 v_mfma_f32_16x16x32_bf16 v[80:83], a[0:3], v[56:59], 0
 ds_read_b128 v[48:51], v24 offset:21504
 v_mfma_f32_16x16x32_bf16 v[80:83], a[4:7], v[60:63], v[80:83]
 buffer_load_dwordx4 v5, s[16:19], s84 offen offset:1024 sc1 lds
 v_mfma_f32_16x16x32_bf16 v[84:87], a[144:147], v[56:59], 0
 v_mfma_f32_16x16x32_bf16 v[84:87], a[148:151], v[60:63], v[84:87]
 v_mfma_f32_16x16x32_bf16 v[88:91], a[72:75], v[56:59], 0
 ds_read_b128 v[52:55], v25 offset:21504
 v_mfma_f32_16x16x32_bf16 v[88:91], a[76:79], v[60:63], v[88:91]
 buffer_load_dwordx4 v5, s[16:19], s84 offen offset:2048 sc1 lds
 v_mul_f32 v68, v64, v68
 v_mfma_f32_16x16x32_bf16 v[92:95], a[216:219], v[56:59], 0
 v_mul_f32 v64, s54, v64
 v_mul_f32 v69, v65, v69
 v_mul_f32 v70, v66, v70
 v_mfma_f32_16x16x32_bf16 v[92:95], a[220:223], v[60:63], v[92:95]
 s_waitcnt lgkmcnt(4)
 v_exp_f32 v64, v64
 v_mfma_f32_16x16x32_bf16 v[80:83], a[8:11], v[32:35], v[80:83]
 ds_read_b128 v[56:59], v24 offset:22528
 v_add_f32 v64, 1.0, v64
 v_mul_f32 v65, s54, v65
 v_mfma_f32_16x16x32_bf16 v[80:83], a[12:15], v[36:39], v[80:83]
 buffer_load_dwordx4 v5, s[16:19], s84 offen offset:3072 sc1 lds
 s_add_u32 m0, m0, s30
 v_mfma_f32_16x16x32_bf16 v[84:87], a[152:155], v[32:35], v[84:87]
 v_rcp_f32 v64, v64
 v_mul_f32 v66, s54, v66
 v_mfma_f32_16x16x32_bf16 v[84:87], a[156:159], v[36:39], v[84:87]
 buffer_load_dwordx4 v6, s[16:19], s84 offen sc1 lds
 s_add_u32 s85, s85, s30
 v_mfma_f32_16x16x32_bf16 v[88:91], a[80:83], v[32:35], v[88:91]
 ds_read_b128 v[60:63], v25 offset:22528
 v_exp_f32 v65, v65
 v_mfma_f32_16x16x32_bf16 v[88:91], a[84:87], v[36:39], v[88:91]
 v_exp_f32 v66, v66
 v_mfma_f32_16x16x32_bf16 v[92:95], a[224:227], v[32:35], v[92:95]
 v_mul_f32 v68, v64, v68
 v_add_f32 v65, 1.0, v65
 v_add_f32 v66, 1.0, v66
 v_mfma_f32_16x16x32_bf16 v[92:95], a[228:231], v[36:39], v[92:95]
 s_waitcnt lgkmcnt(4)
 v_rcp_f32 v65, v65
 v_mfma_f32_16x16x32_bf16 v[80:83], a[16:19], v[40:43], v[80:83]
 ds_read_b128 v[32:35], v24 offset:23552
 v_rcp_f32 v66, v66
 v_mfma_f32_16x16x32_bf16 v[80:83], a[20:23], v[44:47], v[80:83]
 buffer_load_dwordx4 v[192:195], v19, s[16:19], s85 offen sc1
 v_mul_f32 v69, v65, v69
 v_mfma_f32_16x16x32_bf16 v[84:87], a[160:163], v[40:43], v[84:87]
 v_mul_f32 v70, v66, v70
 v_mul_f32 v71, v67, v71
 v_mul_f32 v76, v72, v76
 v_mfma_f32_16x16x32_bf16 v[84:87], a[164:167], v[44:47], v[84:87]
 buffer_load_dwordx4 v[196:199], v7, s[16:19], s85 offen sc1
 v_mul_f32 v67, s54, v67
 v_mfma_f32_16x16x32_bf16 v[88:91], a[88:91], v[40:43], v[88:91]
 ds_read_b128 v[36:39], v25 offset:23552
 v_exp_f32 v67, v67
 v_mfma_f32_16x16x32_bf16 v[88:91], a[92:95], v[44:47], v[88:91]
 v_add_f32 v67, 1.0, v67
 v_mul_f32 v72, s54, v72
 v_mfma_f32_16x16x32_bf16 v[92:95], a[232:235], v[40:43], v[92:95]
 buffer_load_dwordx4 v[200:203], v19, s[16:19], s85 offen offset:1024 sc1
 v_rcp_f32 v67, v67
 v_mfma_f32_16x16x32_bf16 v[92:95], a[236:239], v[44:47], v[92:95]
 s_waitcnt lgkmcnt(4)
 v_exp_f32 v72, v72
 v_mfma_f32_16x16x32_bf16 v[80:83], a[24:27], v[48:51], v[80:83]
 ds_read_b128 v[40:43], v24 offset:24576
 v_mul_f32 v71, v67, v71
 v_add_f32 v72, 1.0, v72
 v_mfma_f32_16x16x32_bf16 v[80:83], a[28:31], v[52:55], v[80:83]
 v_rcp_f32 v72, v72
 v_mfma_f32_16x16x32_bf16 v[84:87], a[168:171], v[48:51], v[84:87]
 buffer_load_dwordx4 v[204:207], v7, s[16:19], s85 offen offset:1024 sc1
 v_mul_f32 v76, v72, v76
 v_mul_f32 v77, v73, v77
 v_mfma_f32_16x16x32_bf16 v[84:87], a[172:175], v[52:55], v[84:87]
 v_mul_f32 v73, s54, v73
 v_mul_f32 v78, v74, v78
 v_mfma_f32_16x16x32_bf16 v[88:91], a[96:99], v[48:51], v[88:91]
 ds_read_b128 v[44:47], v25 offset:24576
 v_exp_f32 v73, v73
 v_mfma_f32_16x16x32_bf16 v[88:91], a[100:103], v[52:55], v[88:91]
 buffer_load_dwordx4 v[208:211], v19, s[16:19], s85 offen offset:2048 sc1
 v_add_f32 v73, 1.0, v73
 v_mfma_f32_16x16x32_bf16 v[92:95], a[240:243], v[48:51], v[92:95]
 v_rcp_f32 v73, v73
 v_mul_f32 v74, s54, v74
 v_mfma_f32_16x16x32_bf16 v[92:95], a[244:247], v[52:55], v[92:95]
 s_waitcnt lgkmcnt(4)
 v_exp_f32 v74, v74
 v_mfma_f32_16x16x32_bf16 v[80:83], a[32:35], v[56:59], v[80:83]
 ds_read_b128 v[48:51], v24 offset:25600
 v_mul_f32 v77, v73, v77
 v_add_f32 v74, 1.0, v74
 v_mfma_f32_16x16x32_bf16 v[80:83], a[36:39], v[60:63], v[80:83]
 buffer_load_dwordx4 v[212:215], v7, s[16:19], s85 offen offset:2048 sc1
 v_mul_f32 v79, v75, v79
 v_mfma_f32_16x16x32_bf16 v[84:87], a[176:179], v[56:59], v[84:87]
 v_rcp_f32 v74, v74
 v_mul_f32 v75, s54, v75
 v_mfma_f32_16x16x32_bf16 v[84:87], a[180:183], v[60:63], v[84:87]
 v_exp_f32 v75, v75
 v_mfma_f32_16x16x32_bf16 v[88:91], a[104:107], v[56:59], v[88:91]
 ds_read_b128 v[52:55], v25 offset:25600
 v_mul_f32 v78, v74, v78
 v_add_f32 v75, 1.0, v75
 v_mfma_f32_16x16x32_bf16 v[88:91], a[108:111], v[60:63], v[88:91]
 buffer_load_dwordx4 v[216:219], v19, s[16:19], s85 offen offset:3072 sc1
 v_cvt_pk_bf16_f32 v64, v68, v69
 v_mfma_f32_16x16x32_bf16 v[92:95], a[248:251], v[56:59], v[92:95]
 v_rcp_f32 v75, v75
 v_cvt_pk_bf16_f32 v65, v70, v71
 v_mfma_f32_16x16x32_bf16 v[92:95], a[252:255], v[60:63], v[92:95]
 s_waitcnt lgkmcnt(4)
 v_mul_f32 v79, v75, v79
 v_cvt_pk_bf16_f32 v66, v76, v77
 v_mfma_f32_16x16x32_bf16 v[80:83], a[40:43], v[32:35], v[80:83]
 ds_read_b128 v[56:59], v24 offset:26624
 v_cvt_pk_bf16_f32 v67, v78, v79
 v_mfma_f32_16x16x32_bf16 v[80:83], a[44:47], v[36:39], v[80:83]
 buffer_load_dwordx4 v[220:223], v7, s[16:19], s85 offen offset:3072 sc1
 s_add_u32 s84, s84, s31
 v_mfma_f32_16x16x32_bf16 v[84:87], a[184:187], v[32:35], v[84:87]
 s_add_u32 m0, s56, 49152
 buffer_store_dwordx4 v[64:67], v19, s[16:19], s53 offen sc1
 v_mfma_f32_16x16x32_bf16 v[84:87], a[188:191], v[36:39], v[84:87]
 s_add_u32 s53, s53, s52
 v_mfma_f32_16x16x32_bf16 v[88:91], a[112:115], v[32:35], v[88:91]
 ds_read_b128 v[60:63], v25 offset:26624
 v_mfma_f32_16x16x32_bf16 v[88:91], a[116:119], v[36:39], v[88:91]
 buffer_load_dwordx4 v19, s[16:19], s84 offen sc1 lds
 v_mfma_f32_16x16x32_bf16 v[92:95], v[224:227], v[32:35], v[92:95]
 v_mfma_f32_16x16x32_bf16 v[92:95], v[228:231], v[36:39], v[92:95]
 s_waitcnt lgkmcnt(4)
 v_mfma_f32_16x16x32_bf16 v[80:83], a[48:51], v[40:43], v[80:83]
 buffer_load_dwordx4 v19, s[16:19], s84 offen offset:1024 sc1 lds
 v_mfma_f32_16x16x32_bf16 v[80:83], a[52:55], v[44:47], v[80:83]
 v_mfma_f32_16x16x32_bf16 v[84:87], a[192:195], v[40:43], v[84:87]
 v_mfma_f32_16x16x32_bf16 v[84:87], a[196:199], v[44:47], v[84:87]
 buffer_load_dwordx4 v19, s[16:19], s84 offen offset:2048 sc1 lds
 v_mfma_f32_16x16x32_bf16 v[88:91], a[120:123], v[40:43], v[88:91]
 v_mfma_f32_16x16x32_bf16 v[88:91], a[124:127], v[44:47], v[88:91]
 v_mfma_f32_16x16x32_bf16 v[92:95], v[232:235], v[40:43], v[92:95]
 v_mfma_f32_16x16x32_bf16 v[92:95], v[236:239], v[44:47], v[92:95]
 s_waitcnt lgkmcnt(2)
 v_mfma_f32_16x16x32_bf16 v[80:83], a[56:59], v[48:51], v[80:83]
 s_waitcnt vmcnt(21) lgkmcnt(0)
 s_barrier
 v_mfma_f32_16x16x32_bf16 v[80:83], a[60:63], v[52:55], v[80:83]
 ds_read_b128 v[96:99], v8 offset:0
 s_load_dword s64, s[88:89], s29 offset:26752
 v_mfma_f32_16x16x32_bf16 v[84:87], a[200:203], v[48:51], v[84:87]
 ds_read_b128 v[100:103], v8 offset:49152
 v_mfma_f32_16x16x32_bf16 v[84:87], a[204:207], v[52:55], v[84:87]
 ds_read_b128 v[104:107], v8 offset:1024
 v_mfma_f32_16x16x32_bf16 v[88:91], a[128:131], v[48:51], v[88:91]
 ds_read_b128 v[108:111], v8 offset:50176
 v_mfma_f32_16x16x32_bf16 v[88:91], a[132:135], v[52:55], v[88:91]
 ds_read_b128 v[112:115], v8 offset:2048
 v_mfma_f32_16x16x32_bf16 v[92:95], v[240:243], v[48:51], v[92:95]
 ds_read_b128 v[116:119], v8 offset:51200
 v_mfma_f32_16x16x32_bf16 v[92:95], v[244:247], v[52:55], v[92:95]
 v_mfma_f32_16x16x32_bf16 v[80:83], a[64:67], v[56:59], v[80:83]
 ds_read_b128 v[120:123], v8 offset:3072
 v_mfma_f32_16x16x32_bf16 v[80:83], a[68:71], v[60:63], v[80:83]
 ds_read_b128 v[124:127], v8 offset:52224
 v_mfma_f32_16x16x32_bf16 v[84:87], a[208:211], v[56:59], v[84:87]
 ds_read_b128 v[128:131], v8 offset:4096
 v_mfma_f32_16x16x32_bf16 v[84:87], a[212:215], v[60:63], v[84:87]
 ds_read_b128 v[132:135], v8 offset:53248
 v_mfma_f32_16x16x32_bf16 v[88:91], a[136:139], v[56:59], v[88:91]
 ds_read_b128 v[136:139], v8 offset:5120
 v_mfma_f32_16x16x32_bf16 v[88:91], a[140:143], v[60:63], v[88:91]
 buffer_load_dwordx4 v19, s[16:19], s84 offen offset:3072 sc1 lds
 s_add_u32 m0, m0, s30
 v_mfma_f32_16x16x32_bf16 v[92:95], v[248:251], v[56:59], v[92:95]
 ds_read_b128 v[140:143], v8 offset:54272
 s_waitcnt lgkmcnt(8)
 v_mfma_f32_16x16x32_bf16 v[92:95], v[252:255], v[60:63], v[92:95]
 buffer_load_dwordx4 v5, s[16:19], s84 offen sc1 lds
 v_mfma_f32_16x16x32_bf16 v[224:227], v[96:99], v[160:163], 0
 ds_read_b128 v[144:147], v8 offset:6144
 v_mfma_f32_16x16x32_bf16 v[224:227], v[100:103], v[168:171], v[224:227]
 buffer_load_dwordx4 v5, s[16:19], s84 offen offset:1024 sc1 lds
 v_mfma_f32_16x16x32_bf16 v[228:231], v[96:99], v[164:167], 0
 ds_read_b128 v[148:151], v8 offset:55296
 v_mfma_f32_16x16x32_bf16 v[228:231], v[100:103], v[172:175], v[228:231]
 buffer_load_dwordx4 v5, s[16:19], s84 offen offset:2048 sc1 lds
 v_mfma_f32_16x16x32_bf16 v[232:235], v[104:107], v[160:163], 0
 ds_read_b128 v[152:155], v8 offset:7168
 v_mfma_f32_16x16x32_bf16 v[232:235], v[108:111], v[168:171], v[232:235]
 buffer_load_dwordx4 v5, s[16:19], s84 offen offset:3072 sc1 lds
 s_add_u32 m0, m0, s30
 v_mfma_f32_16x16x32_bf16 v[236:239], v[104:107], v[164:167], 0
 ds_read_b128 v[156:159], v8 offset:56320
 s_waitcnt lgkmcnt(8)
 v_mul_f32 v84, v80, v84
 v_mfma_f32_16x16x32_bf16 v[236:239], v[108:111], v[172:175], v[236:239]
 v_mul_f32 v80, s54, v80
 v_mul_f32 v85, v81, v85
 v_mfma_f32_16x16x32_bf16 v[240:243], v[112:115], v[160:163], 0
 ds_read_b128 v[96:99], v8 offset:8192
 v_exp_f32 v80, v80
 v_mfma_f32_16x16x32_bf16 v[240:243], v[116:119], v[168:171], v[240:243]
 buffer_load_dwordx4 v6, s[16:19], s84 offen sc1 lds
 s_add_u32 s85, s85, s30
 v_mfma_f32_16x16x32_bf16 v[244:247], v[112:115], v[164:167], 0
 ds_read_b128 v[100:103], v8 offset:57344
 v_add_f32 v80, 1.0, v80
 v_mul_f32 v81, s54, v81
 v_mfma_f32_16x16x32_bf16 v[244:247], v[116:119], v[172:175], v[244:247]
 v_rcp_f32 v80, v80
 v_mfma_f32_16x16x32_bf16 v[248:251], v[120:123], v[160:163], 0
 ds_read_b128 v[104:107], v9 offset:0
 v_exp_f32 v81, v81
 v_mfma_f32_16x16x32_bf16 v[248:251], v[124:127], v[168:171], v[248:251]
 buffer_load_dwordx4 a[0:3], v19, s[16:19], s85 offen sc1
 v_mul_f32 v84, v80, v84
 v_mfma_f32_16x16x32_bf16 v[252:255], v[120:123], v[164:167], 0
 ds_read_b128 v[108:111], v9 offset:9216
 s_waitcnt lgkmcnt(8)
 v_add_f32 v81, 1.0, v81
 v_mfma_f32_16x16x32_bf16 v[252:255], v[124:127], v[172:175], v[252:255]
 v_rcp_f32 v81, v81
 v_mfma_f32_16x16x32_bf16 v[32:35], v[128:131], v[160:163], 0
 ds_read_b128 v[112:115], v9 offset:1024
 v_mul_f32 v85, v81, v85
 v_mul_f32 v86, v82, v86
 v_mfma_f32_16x16x32_bf16 v[32:35], v[132:135], v[168:171], v[32:35]
 buffer_load_dwordx4 a[4:7], v7, s[16:19], s85 offen sc1
 v_mul_f32 v82, s54, v82
 v_mfma_f32_16x16x32_bf16 v[36:39], v[128:131], v[164:167], 0
 ds_read_b128 v[116:119], v9 offset:10240
 v_exp_f32 v82, v82
 v_mfma_f32_16x16x32_bf16 v[36:39], v[132:135], v[172:175], v[36:39]
 v_add_f32 v82, 1.0, v82
 v_mul_f32 v87, v83, v87
 v_mfma_f32_16x16x32_bf16 v[40:43], v[136:139], v[160:163], 0
 ds_read_b128 v[120:123], v9 offset:2048
 v_rcp_f32 v82, v82
 v_mfma_f32_16x16x32_bf16 v[40:43], v[140:143], v[168:171], v[40:43]
 buffer_load_dwordx4 a[72:75], v19, s[16:19], s85 offen offset:1024 sc1
 v_mul_f32 v86, v82, v86
 v_mfma_f32_16x16x32_bf16 v[44:47], v[136:139], v[164:167], 0
 ds_read_b128 v[124:127], v9 offset:11264
 s_waitcnt lgkmcnt(8)
 v_mul_f32 v83, s54, v83
 v_mfma_f32_16x16x32_bf16 v[44:47], v[140:143], v[172:175], v[44:47]
 buffer_load_dwordx4 a[76:79], v7, s[16:19], s85 offen offset:1024 sc1
 v_mul_f32 v92, v88, v92
 v_mfma_f32_16x16x32_bf16 v[48:51], v[144:147], v[160:163], 0
 ds_read_b128 v[128:131], v9 offset:3072
 v_exp_f32 v83, v83
 v_mfma_f32_16x16x32_bf16 v[48:51], v[148:151], v[168:171], v[48:51]
 v_add_f32 v83, 1.0, v83
 v_mul_f32 v88, s54, v88
 v_mfma_f32_16x16x32_bf16 v[52:55], v[144:147], v[164:167], 0
Lpg13:
 s_cbranch_vccnz Lj_Lfin
 ds_read_b128 v[132:135], v9 offset:12288
 v_rcp_f32 v83, v83
 v_mfma_f32_16x16x32_bf16 v[52:55], v[148:151], v[172:175], v[52:55]
 buffer_load_dwordx4 a[144:147], v19, s[16:19], s85 offen offset:2048 sc1
 v_mul_f32 v87, v83, v87
 v_mfma_f32_16x16x32_bf16 v[56:59], v[152:155], v[160:163], 0
 ds_read_b128 v[136:139], v9 offset:4096
 v_exp_f32 v88, v88
 v_mfma_f32_16x16x32_bf16 v[56:59], v[156:159], v[168:171], v[56:59]
 v_add_f32 v88, 1.0, v88
 v_mul_f32 v93, v89, v93
 v_mfma_f32_16x16x32_bf16 v[60:63], v[152:155], v[164:167], 0
 ds_read_b128 v[140:143], v9 offset:13312
 s_waitcnt lgkmcnt(8)
 v_mul_f32 v89, s54, v89
 v_mfma_f32_16x16x32_bf16 v[60:63], v[156:159], v[172:175], v[60:63]
 buffer_load_dwordx4 a[148:151], v7, s[16:19], s85 offen offset:2048 sc1
 v_mul_f32 v94, v90, v94
 v_mfma_f32_16x16x32_bf16 v[64:67], v[96:99], v[160:163], 0
 ds_read_b128 v[144:147], v9 offset:5120
 v_rcp_f32 v88, v88
 v_mfma_f32_16x16x32_bf16 v[64:67], v[100:103], v[168:171], v[64:67]
 v_exp_f32 v89, v89
 v_mfma_f32_16x16x32_bf16 v[68:71], v[96:99], v[164:167], 0
 ds_read_b128 v[148:151], v9 offset:14336
 v_mul_f32 v92, v88, v92
 v_add_f32 v89, 1.0, v89
 v_mfma_f32_16x16x32_bf16 v[68:71], v[100:103], v[172:175], v[68:71]
 buffer_load_dwordx4 a[216:219], v19, s[16:19], s85 offen offset:3072 sc1
 v_mul_f32 v90, s54, v90
 v_mfma_f32_16x16x32_bf16 v[224:227], v[104:107], v[176:179], v[224:227]
 ds_read_b128 v[152:155], v9 offset:6144
 v_rcp_f32 v89, v89
 v_mfma_f32_16x16x32_bf16 v[224:227], v[108:111], v[184:187], v[224:227]
 v_exp_f32 v90, v90
 v_mfma_f32_16x16x32_bf16 v[228:231], v[104:107], v[180:183], v[228:231]
 ds_read_b128 v[156:159], v9 offset:15360
 s_waitcnt lgkmcnt(8)
 v_mul_f32 v93, v89, v93
 v_mfma_f32_16x16x32_bf16 v[228:231], v[108:111], v[188:191], v[228:231]
 buffer_load_dwordx4 a[220:223], v7, s[16:19], s85 offen offset:3072 sc1
 s_mul_i32 s84, s63, 442368
 v_mfma_f32_16x16x32_bf16 v[232:235], v[112:115], v[176:179], v[232:235]
 ds_read_b128 v[96:99], v9 offset:7168
 s_add_u32 s84, s84, s86
 v_add_f32 v90, 1.0, v90
 v_mfma_f32_16x16x32_bf16 v[232:235], v[116:119], v[184:187], v[232:235]
 s_add_u32 m0, s56, 98304
 v_rcp_f32 v90, v90
 v_mfma_f32_16x16x32_bf16 v[236:239], v[112:115], v[180:183], v[236:239]
 ds_read_b128 v[100:103], v9 offset:16384
 v_mul_f32 v94, v90, v94
 v_mul_f32 v95, v91, v95
 v_mfma_f32_16x16x32_bf16 v[236:239], v[116:119], v[188:191], v[236:239]
 buffer_load_dwordx4 v19, s[16:19], s84 offen sc1 lds
 v_mul_f32 v91, s54, v91
 v_mfma_f32_16x16x32_bf16 v[240:243], v[120:123], v[176:179], v[240:243]
 ds_read_b128 v[104:107], v9 offset:8192
 v_exp_f32 v91, v91
 v_mfma_f32_16x16x32_bf16 v[240:243], v[124:127], v[184:187], v[240:243]
 v_add_f32 v91, 1.0, v91
 v_cvt_pk_bf16_f32 v80, v84, v85
 v_mfma_f32_16x16x32_bf16 v[244:247], v[120:123], v[180:183], v[244:247]
 ds_read_b128 v[108:111], v9 offset:17408
 s_waitcnt lgkmcnt(8)
 v_cvt_pk_bf16_f32 v81, v86, v87
 v_mfma_f32_16x16x32_bf16 v[244:247], v[124:127], v[188:191], v[244:247]
 buffer_load_dwordx4 v19, s[16:19], s84 offen offset:1024 sc1 lds
 v_cvt_pk_bf16_f32 v82, v92, v93
 v_mfma_f32_16x16x32_bf16 v[248:251], v[128:131], v[176:179], v[248:251]
 v_rcp_f32 v91, v91
 v_mfma_f32_16x16x32_bf16 v[248:251], v[132:135], v[184:187], v[248:251]
 v_mul_f32 v95, v91, v95
 v_mfma_f32_16x16x32_bf16 v[252:255], v[128:131], v[180:183], v[252:255]
 buffer_load_dwordx4 v19, s[16:19], s84 offen offset:2048 sc1 lds
 v_cvt_pk_bf16_f32 v83, v94, v95
 v_mfma_f32_16x16x32_bf16 v[252:255], v[132:135], v[188:191], v[252:255]
 buffer_store_dwordx4 v[80:83], v19, s[16:19], s53 offen sc1
 v_mfma_f32_16x16x32_bf16 v[32:35], v[136:139], v[176:179], v[32:35]
 s_add_u32 s53, s53, s52
 v_mfma_f32_16x16x32_bf16 v[32:35], v[140:143], v[184:187], v[32:35]
 v_mfma_f32_16x16x32_bf16 v[36:39], v[136:139], v[180:183], v[36:39]
 buffer_load_dwordx4 v19, s[16:19], s84 offen offset:3072 sc1 lds
 s_add_u32 m0, m0, s30
 v_mfma_f32_16x16x32_bf16 v[36:39], v[140:143], v[188:191], v[36:39]
 s_waitcnt lgkmcnt(4)
 v_mfma_f32_16x16x32_bf16 v[40:43], v[144:147], v[176:179], v[40:43]
 s_waitcnt vmcnt(23) lgkmcnt(0)
 s_barrier
 v_mfma_f32_16x16x32_bf16 v[40:43], v[148:151], v[184:187], v[40:43]
 ds_read_b128 v[112:115], v26 offset:0
 v_mfma_f32_16x16x32_bf16 v[44:47], v[144:147], v[180:183], v[44:47]
 ds_read_b128 v[116:119], v26 offset:9216
 v_mfma_f32_16x16x32_bf16 v[44:47], v[148:151], v[188:191], v[44:47]
 ds_read_b128 v[120:123], v26 offset:1024
 v_mfma_f32_16x16x32_bf16 v[48:51], v[152:155], v[176:179], v[48:51]
 ds_read_b128 v[124:127], v26 offset:10240
 v_mfma_f32_16x16x32_bf16 v[48:51], v[156:159], v[184:187], v[48:51]
 ds_read_b128 v[128:131], v26 offset:2048
 v_mfma_f32_16x16x32_bf16 v[52:55], v[152:155], v[180:183], v[52:55]
 ds_read_b128 v[132:135], v26 offset:11264
 v_mfma_f32_16x16x32_bf16 v[52:55], v[156:159], v[188:191], v[52:55]
 ds_read_b128 v[136:139], v26 offset:3072
 v_mfma_f32_16x16x32_bf16 v[56:59], v[96:99], v[176:179], v[56:59]
 ds_read_b128 v[140:143], v26 offset:12288
 v_mfma_f32_16x16x32_bf16 v[56:59], v[100:103], v[184:187], v[56:59]
 ds_read_b128 v[144:147], v26 offset:4096
 v_mfma_f32_16x16x32_bf16 v[60:63], v[96:99], v[180:183], v[60:63]
 ds_read_b128 v[148:151], v26 offset:13312
 v_mfma_f32_16x16x32_bf16 v[60:63], v[100:103], v[188:191], v[60:63]
 s_cmp_eq_u32 s64, 0x10101
 s_cbranch_scc0 Lsp_g10p1
Lrt_g10p1:
 v_mfma_f32_16x16x32_bf16 v[64:67], v[104:107], v[176:179], v[64:67]
 ds_read_b128 v[152:155], v26 offset:5120
 v_mfma_f32_16x16x32_bf16 v[64:67], v[108:111], v[184:187], v[64:67]
 buffer_load_dwordx4 v5, s[16:19], s84 offen sc1 lds
 v_mfma_f32_16x16x32_bf16 v[68:71], v[104:107], v[180:183], v[68:71]
 ds_read_b128 v[156:159], v26 offset:14336
 s_waitcnt lgkmcnt(6)
 v_mfma_f32_16x16x32_bf16 v[68:71], v[108:111], v[188:191], v[68:71]
 buffer_load_dwordx4 v5, s[16:19], s84 offen offset:1024 sc1 lds
 v_mfma_f32_16x16x32_bf16 v[224:227], v[112:115], v[192:195], v[224:227]
 ds_read_b128 v[96:99], v26 offset:6144
 v_mfma_f32_16x16x32_bf16 v[224:227], v[116:119], v[200:203], v[224:227]
 buffer_load_dwordx4 v5, s[16:19], s84 offen offset:2048 sc1 lds
 v_mfma_f32_16x16x32_bf16 v[228:231], v[112:115], v[196:199], v[228:231]
 ds_read_b128 v[100:103], v26 offset:15360
 v_mfma_f32_16x16x32_bf16 v[228:231], v[116:119], v[204:207], v[228:231]
 buffer_load_dwordx4 v5, s[16:19], s84 offen offset:3072 sc1 lds
 s_add_u32 m0, m0, s30
 v_mfma_f32_16x16x32_bf16 v[232:235], v[120:123], v[192:195], v[232:235]
 ds_read_b128 v[104:107], v26 offset:7168
 v_mfma_f32_16x16x32_bf16 v[232:235], v[124:127], v[200:203], v[232:235]
 v_mfma_f32_16x16x32_bf16 v[236:239], v[120:123], v[196:199], v[236:239]
 ds_read_b128 v[108:111], v26 offset:16384
 v_mfma_f32_16x16x32_bf16 v[236:239], v[124:127], v[204:207], v[236:239]
 buffer_load_dwordx4 v6, s[16:19], s84 offen sc1 lds
 s_mul_i32 s85, s63, 12288
 v_mfma_f32_16x16x32_bf16 v[240:243], v[128:131], v[192:195], v[240:243]
 ds_read_b128 v[112:115], v26 offset:8192
 s_add_u32 s85, s85, s87
 v_mfma_f32_16x16x32_bf16 v[240:243], v[132:135], v[200:203], v[240:243]
 v_mfma_f32_16x16x32_bf16 v[244:247], v[128:131], v[196:199], v[244:247]
 ds_read_b128 v[116:119], v26 offset:17408
 s_waitcnt lgkmcnt(4)
 v_mfma_f32_16x16x32_bf16 v[244:247], v[132:135], v[204:207], v[244:247]
 buffer_load_dwordx4 a[8:11], v19, s[16:19], s85 offen sc1
 v_mfma_f32_16x16x32_bf16 v[248:251], v[136:139], v[192:195], v[248:251]
 ds_read_b128 v[120:123], v26 offset:18432
 v_mfma_f32_16x16x32_bf16 v[248:251], v[140:143], v[200:203], v[248:251]
 v_mfma_f32_16x16x32_bf16 v[252:255], v[136:139], v[196:199], v[252:255]
 ds_read_b128 v[124:127], v26 offset:27648
 v_mfma_f32_16x16x32_bf16 v[252:255], v[140:143], v[204:207], v[252:255]
 buffer_load_dwordx4 a[12:15], v7, s[16:19], s85 offen sc1
 v_mfma_f32_16x16x32_bf16 v[32:35], v[144:147], v[192:195], v[32:35]
 ds_read_b128 v[128:131], v26 offset:19456
 v_mfma_f32_16x16x32_bf16 v[32:35], v[148:151], v[200:203], v[32:35]
 v_mfma_f32_16x16x32_bf16 v[36:39], v[144:147], v[196:199], v[36:39]
 ds_read_b128 v[132:135], v26 offset:28672
 v_mfma_f32_16x16x32_bf16 v[36:39], v[148:151], v[204:207], v[36:39]
 buffer_load_dwordx4 a[80:83], v19, s[16:19], s85 offen offset:1024 sc1
 v_mfma_f32_16x16x32_bf16 v[40:43], v[152:155], v[192:195], v[40:43]
 ds_read_b128 v[136:139], v26 offset:20480
 v_mfma_f32_16x16x32_bf16 v[40:43], v[156:159], v[200:203], v[40:43]
 v_mfma_f32_16x16x32_bf16 v[44:47], v[152:155], v[196:199], v[44:47]
 ds_read_b128 v[140:143], v26 offset:29696
 v_mfma_f32_16x16x32_bf16 v[44:47], v[156:159], v[204:207], v[44:47]
 buffer_load_dwordx4 a[84:87], v7, s[16:19], s85 offen offset:1024 sc1
 v_mfma_f32_16x16x32_bf16 v[48:51], v[96:99], v[192:195], v[48:51]
 ds_read_b128 v[144:147], v26 offset:21504
 v_mfma_f32_16x16x32_bf16 v[48:51], v[100:103], v[200:203], v[48:51]
 v_mfma_f32_16x16x32_bf16 v[52:55], v[96:99], v[196:199], v[52:55]
 ds_read_b128 v[148:151], v26 offset:30720
 s_waitcnt lgkmcnt(4)
 v_mfma_f32_16x16x32_bf16 v[52:55], v[100:103], v[204:207], v[52:55]
 buffer_load_dwordx4 a[152:155], v19, s[16:19], s85 offen offset:2048 sc1
 v_mfma_f32_16x16x32_bf16 v[56:59], v[104:107], v[192:195], v[56:59]
 ds_read_b128 v[152:155], v26 offset:22528
 v_mfma_f32_16x16x32_bf16 v[56:59], v[108:111], v[200:203], v[56:59]
 v_mfma_f32_16x16x32_bf16 v[60:63], v[104:107], v[196:199], v[60:63]
 ds_read_b128 v[156:159], v26 offset:31744
 v_mfma_f32_16x16x32_bf16 v[60:63], v[108:111], v[204:207], v[60:63]
 s_waitcnt vmcnt(11)
 s_barrier
 v_mfma_f32_16x16x32_bf16 v[64:67], v[112:115], v[192:195], v[64:67]
 ds_read_b128 v[96:99], v26 offset:23552
 v_mfma_f32_16x16x32_bf16 v[64:67], v[116:119], v[200:203], v[64:67]
 buffer_store_byte v2, v1, s[16:19], s25 offen sc1
 v_mfma_f32_16x16x32_bf16 v[68:71], v[112:115], v[196:199], v[68:71]
 ds_read_b128 v[100:103], v26 offset:32768
 v_mfma_f32_16x16x32_bf16 v[68:71], v[116:119], v[204:207], v[68:71]
 buffer_load_dwordx4 a[156:159], v7, s[16:19], s85 offen offset:2048 sc1
 v_mfma_f32_16x16x32_bf16 v[224:227], v[120:123], v[208:211], v[224:227]
 ds_read_b128 v[104:107], v26 offset:24576
 v_mfma_f32_16x16x32_bf16 v[224:227], v[124:127], v[216:219], v[224:227]
 buffer_load_dwordx4 a[224:227], v19, s[16:19], s85 offen offset:3072 sc1
 v_mfma_f32_16x16x32_bf16 v[228:231], v[120:123], v[212:215], v[228:231]
 ds_read_b128 v[108:111], v26 offset:33792
 v_mfma_f32_16x16x32_bf16 v[228:231], v[124:127], v[220:223], v[228:231]
 buffer_load_dwordx4 a[228:231], v7, s[16:19], s85 offen offset:3072 sc1
 s_add_u32 s84, s84, s31
 v_mfma_f32_16x16x32_bf16 v[232:235], v[128:131], v[208:211], v[232:235]
 ds_read_b128 v[112:115], v26 offset:25600
 s_add_u32 m0, s55, 0
 v_mfma_f32_16x16x32_bf16 v[232:235], v[132:135], v[216:219], v[232:235]
 v_mfma_f32_16x16x32_bf16 v[236:239], v[128:131], v[212:215], v[236:239]
 ds_read_b128 v[116:119], v26 offset:34816
 s_waitcnt lgkmcnt(4)
 v_mfma_f32_16x16x32_bf16 v[236:239], v[132:135], v[220:223], v[236:239]
 buffer_load_dwordx4 v19, s[16:19], s84 offen sc1 lds
 v_mfma_f32_16x16x32_bf16 v[240:243], v[136:139], v[208:211], v[240:243]
 ds_read_b128 v[120:123], v26 offset:26624
 v_mfma_f32_16x16x32_bf16 v[240:243], v[140:143], v[216:219], v[240:243]
 v_mfma_f32_16x16x32_bf16 v[244:247], v[136:139], v[212:215], v[244:247]
 ds_read_b128 v[124:127], v26 offset:35840
 v_mfma_f32_16x16x32_bf16 v[244:247], v[140:143], v[220:223], v[244:247]
 buffer_load_dwordx4 v19, s[16:19], s84 offen offset:1024 sc1 lds
 v_mfma_f32_16x16x32_bf16 v[248:251], v[144:147], v[208:211], v[248:251]
 v_mfma_f32_16x16x32_bf16 v[248:251], v[148:151], v[216:219], v[248:251]
 v_mfma_f32_16x16x32_bf16 v[252:255], v[144:147], v[212:215], v[252:255]
 v_mfma_f32_16x16x32_bf16 v[252:255], v[148:151], v[220:223], v[252:255]
 buffer_load_dwordx4 v19, s[16:19], s84 offen offset:2048 sc1 lds
 v_mfma_f32_16x16x32_bf16 v[32:35], v[152:155], v[208:211], v[32:35]
 v_mfma_f32_16x16x32_bf16 v[32:35], v[156:159], v[216:219], v[32:35]
 v_mfma_f32_16x16x32_bf16 v[36:39], v[152:155], v[212:215], v[36:39]
 v_mfma_f32_16x16x32_bf16 v[36:39], v[156:159], v[220:223], v[36:39]
 buffer_load_dwordx4 v19, s[16:19], s84 offen offset:3072 sc1 lds
 s_add_u32 m0, m0, s30
 v_mfma_f32_16x16x32_bf16 v[40:43], v[96:99], v[208:211], v[40:43]
 s_waitcnt lgkmcnt(0)
 s_barrier
 v_mfma_f32_16x16x32_bf16 v[40:43], v[100:103], v[216:219], v[40:43]
 ds_read_b128 v[128:131], v27 offset:0
 v_mfma_f32_16x16x32_bf16 v[44:47], v[96:99], v[212:215], v[44:47]
 ds_read_b128 v[132:135], v27 offset:9216
 v_mfma_f32_16x16x32_bf16 v[44:47], v[100:103], v[220:223], v[44:47]
 ds_read_b128 v[136:139], v27 offset:1024
 v_mfma_f32_16x16x32_bf16 v[48:51], v[104:107], v[208:211], v[48:51]
 ds_read_b128 v[140:143], v27 offset:10240
 v_mfma_f32_16x16x32_bf16 v[48:51], v[108:111], v[216:219], v[48:51]
 ds_read_b128 v[144:147], v27 offset:2048
 v_mfma_f32_16x16x32_bf16 v[52:55], v[104:107], v[212:215], v[52:55]
 ds_read_b128 v[148:151], v27 offset:11264
 v_mfma_f32_16x16x32_bf16 v[52:55], v[108:111], v[220:223], v[52:55]
 ds_read_b128 v[152:155], v27 offset:3072
 v_mfma_f32_16x16x32_bf16 v[56:59], v[112:115], v[208:211], v[56:59]
 ds_read_b128 v[156:159], v27 offset:12288
 v_mfma_f32_16x16x32_bf16 v[56:59], v[116:119], v[216:219], v[56:59]
 ds_read_b128 v[96:99], v27 offset:4096
 v_mfma_f32_16x16x32_bf16 v[60:63], v[112:115], v[212:215], v[60:63]
 ds_read_b128 v[100:103], v27 offset:13312
 v_mfma_f32_16x16x32_bf16 v[60:63], v[116:119], v[220:223], v[60:63]
 buffer_load_dwordx4 v5, s[16:19], s84 offen sc1 lds
 v_mfma_f32_16x16x32_bf16 v[64:67], v[120:123], v[208:211], v[64:67]
 ds_read_b128 v[104:107], v27 offset:5120
 v_mfma_f32_16x16x32_bf16 v[64:67], v[124:127], v[216:219], v[64:67]
 buffer_load_dwordx4 v5, s[16:19], s84 offen offset:1024 sc1 lds
 v_mfma_f32_16x16x32_bf16 v[68:71], v[120:123], v[212:215], v[68:71]
 ds_read_b128 v[108:111], v27 offset:14336
 s_waitcnt lgkmcnt(6)
 v_mfma_f32_16x16x32_bf16 v[68:71], v[124:127], v[220:223], v[68:71]
 buffer_load_dwordx4 v5, s[16:19], s84 offen offset:2048 sc1 lds
 v_mfma_f32_16x16x32_bf16 v[224:227], v[128:131], a[0:3], v[224:227]
 ds_read_b128 v[112:115], v27 offset:6144
 v_mfma_f32_16x16x32_bf16 v[224:227], v[132:135], a[72:75], v[224:227]
 buffer_load_dwordx4 v5, s[16:19], s84 offen offset:3072 sc1 lds
 s_add_u32 m0, m0, s30
 v_mfma_f32_16x16x32_bf16 v[228:231], v[128:131], a[4:7], v[228:231]
 ds_read_b128 v[116:119], v27 offset:15360
 v_mfma_f32_16x16x32_bf16 v[228:231], v[132:135], a[76:79], v[228:231]
 v_mfma_f32_16x16x32_bf16 v[232:235], v[136:139], a[0:3], v[232:235]
 ds_read_b128 v[120:123], v27 offset:7168
 v_mfma_f32_16x16x32_bf16 v[232:235], v[140:143], a[72:75], v[232:235]
 buffer_load_dwordx4 v6, s[16:19], s84 offen sc1 lds
 s_add_u32 s85, s85, s30
 v_mfma_f32_16x16x32_bf16 v[236:239], v[136:139], a[4:7], v[236:239]
 ds_read_b128 v[124:127], v27 offset:16384
 v_mfma_f32_16x16x32_bf16 v[236:239], v[140:143], a[76:79], v[236:239]
 v_mfma_f32_16x16x32_bf16 v[240:243], v[144:147], a[0:3], v[240:243]
 ds_read_b128 v[128:131], v27 offset:8192
 v_mfma_f32_16x16x32_bf16 v[240:243], v[148:151], a[72:75], v[240:243]
 buffer_load_dwordx4 v[160:163], v19, s[16:19], s85 offen sc1
 v_mfma_f32_16x16x32_bf16 v[244:247], v[144:147], a[4:7], v[244:247]
 ds_read_b128 v[132:135], v27 offset:17408
 s_waitcnt lgkmcnt(4)
 v_mfma_f32_16x16x32_bf16 v[244:247], v[148:151], a[76:79], v[244:247]
 v_mfma_f32_16x16x32_bf16 v[248:251], v[152:155], a[0:3], v[248:251]
 ds_read_b128 v[136:139], v27 offset:18432
 v_mfma_f32_16x16x32_bf16 v[248:251], v[156:159], a[72:75], v[248:251]
 buffer_load_dwordx4 v[164:167], v7, s[16:19], s85 offen sc1
 v_mfma_f32_16x16x32_bf16 v[252:255], v[152:155], a[4:7], v[252:255]
 ds_read_b128 v[140:143], v27 offset:27648
 v_mfma_f32_16x16x32_bf16 v[252:255], v[156:159], a[76:79], v[252:255]
 v_mfma_f32_16x16x32_bf16 v[32:35], v[96:99], a[0:3], v[32:35]
 ds_read_b128 v[144:147], v27 offset:19456
 v_mfma_f32_16x16x32_bf16 v[32:35], v[100:103], a[72:75], v[32:35]
 buffer_load_dwordx4 v[168:171], v19, s[16:19], s85 offen offset:1024 sc1
 v_mfma_f32_16x16x32_bf16 v[36:39], v[96:99], a[4:7], v[36:39]
 ds_read_b128 v[148:151], v27 offset:28672
 v_mfma_f32_16x16x32_bf16 v[36:39], v[100:103], a[76:79], v[36:39]
 v_mfma_f32_16x16x32_bf16 v[40:43], v[104:107], a[0:3], v[40:43]
 ds_read_b128 v[152:155], v27 offset:20480
 v_mfma_f32_16x16x32_bf16 v[40:43], v[108:111], a[72:75], v[40:43]
 buffer_load_dwordx4 v[172:175], v7, s[16:19], s85 offen offset:1024 sc1
 v_mfma_f32_16x16x32_bf16 v[44:47], v[104:107], a[4:7], v[44:47]
 ds_read_b128 v[156:159], v27 offset:29696
 v_mfma_f32_16x16x32_bf16 v[44:47], v[108:111], a[76:79], v[44:47]
 v_mfma_f32_16x16x32_bf16 v[48:51], v[112:115], a[0:3], v[48:51]
 ds_read_b128 v[96:99], v27 offset:21504
 v_mfma_f32_16x16x32_bf16 v[48:51], v[116:119], a[72:75], v[48:51]
 buffer_load_dwordx4 v[176:179], v19, s[16:19], s85 offen offset:2048 sc1
 v_mfma_f32_16x16x32_bf16 v[52:55], v[112:115], a[4:7], v[52:55]
 ds_read_b128 v[100:103], v27 offset:30720
 s_waitcnt lgkmcnt(4)
 v_mfma_f32_16x16x32_bf16 v[52:55], v[116:119], a[76:79], v[52:55]
 v_mfma_f32_16x16x32_bf16 v[56:59], v[120:123], a[0:3], v[56:59]
 ds_read_b128 v[104:107], v27 offset:22528
 v_mfma_f32_16x16x32_bf16 v[56:59], v[124:127], a[72:75], v[56:59]
 buffer_load_dwordx4 v[180:183], v7, s[16:19], s85 offen offset:2048 sc1
 v_mfma_f32_16x16x32_bf16 v[60:63], v[120:123], a[4:7], v[60:63]
 ds_read_b128 v[108:111], v27 offset:31744
 v_mfma_f32_16x16x32_bf16 v[60:63], v[124:127], a[76:79], v[60:63]
 v_mfma_f32_16x16x32_bf16 v[64:67], v[128:131], a[0:3], v[64:67]
 ds_read_b128 v[112:115], v27 offset:23552
 v_mfma_f32_16x16x32_bf16 v[64:67], v[132:135], a[72:75], v[64:67]
 buffer_load_dwordx4 v[184:187], v19, s[16:19], s85 offen offset:3072 sc1
 v_mfma_f32_16x16x32_bf16 v[68:71], v[128:131], a[4:7], v[68:71]
 ds_read_b128 v[116:119], v27 offset:32768
 v_mfma_f32_16x16x32_bf16 v[68:71], v[132:135], a[76:79], v[68:71]
 v_mfma_f32_16x16x32_bf16 v[224:227], v[136:139], a[144:147], v[224:227]
 ds_read_b128 v[120:123], v27 offset:24576
 v_mfma_f32_16x16x32_bf16 v[224:227], v[140:143], a[216:219], v[224:227]
 buffer_load_dwordx4 v[188:191], v7, s[16:19], s85 offen offset:3072 sc1
 s_add_u32 s84, s84, s31
 v_mfma_f32_16x16x32_bf16 v[228:231], v[136:139], a[148:151], v[228:231]
 ds_read_b128 v[124:127], v27 offset:33792
 s_add_u32 m0, s56, 0
 v_mfma_f32_16x16x32_bf16 v[228:231], v[140:143], a[220:223], v[228:231]
 v_mfma_f32_16x16x32_bf16 v[232:235], v[144:147], a[144:147], v[232:235]
 ds_read_b128 v[128:131], v27 offset:25600
 v_mfma_f32_16x16x32_bf16 v[232:235], v[148:151], a[216:219], v[232:235]
 buffer_load_dwordx4 v19, s[16:19], s84 offen sc1 lds
 v_mfma_f32_16x16x32_bf16 v[236:239], v[144:147], a[148:151], v[236:239]
 ds_read_b128 v[132:135], v27 offset:34816
 s_waitcnt lgkmcnt(4)
 v_mfma_f32_16x16x32_bf16 v[236:239], v[148:151], a[220:223], v[236:239]
 v_mfma_f32_16x16x32_bf16 v[240:243], v[152:155], a[144:147], v[240:243]
 ds_read_b128 v[136:139], v27 offset:26624
 v_mfma_f32_16x16x32_bf16 v[240:243], v[156:159], a[216:219], v[240:243]
 buffer_load_dwordx4 v19, s[16:19], s84 offen offset:1024 sc1 lds
 v_mfma_f32_16x16x32_bf16 v[244:247], v[152:155], a[148:151], v[244:247]
 ds_read_b128 v[140:143], v27 offset:35840
 v_mfma_f32_16x16x32_bf16 v[244:247], v[156:159], a[220:223], v[244:247]
 v_mfma_f32_16x16x32_bf16 v[248:251], v[96:99], a[144:147], v[248:251]
 v_mfma_f32_16x16x32_bf16 v[248:251], v[100:103], a[216:219], v[248:251]
 buffer_load_dwordx4 v19, s[16:19], s84 offen offset:2048 sc1 lds
 v_mfma_f32_16x16x32_bf16 v[252:255], v[96:99], a[148:151], v[252:255]
 v_mfma_f32_16x16x32_bf16 v[252:255], v[100:103], a[220:223], v[252:255]
 v_mfma_f32_16x16x32_bf16 v[32:35], v[104:107], a[144:147], v[32:35]
 v_mfma_f32_16x16x32_bf16 v[32:35], v[108:111], a[216:219], v[32:35]
 buffer_load_dwordx4 v19, s[16:19], s84 offen offset:3072 sc1 lds
 s_add_u32 m0, m0, s30
 v_mfma_f32_16x16x32_bf16 v[36:39], v[104:107], a[148:151], v[36:39]
 v_mfma_f32_16x16x32_bf16 v[36:39], v[108:111], a[220:223], v[36:39]
 v_mfma_f32_16x16x32_bf16 v[40:43], v[112:115], a[144:147], v[40:43]
 s_waitcnt vmcnt(21) lgkmcnt(0)
 s_barrier
 v_mfma_f32_16x16x32_bf16 v[40:43], v[116:119], a[216:219], v[40:43]
 ds_read_b128 v[144:147], v28 offset:0
 v_mfma_f32_16x16x32_bf16 v[44:47], v[112:115], a[148:151], v[44:47]
 ds_read_b128 v[148:151], v28 offset:9216
 v_mfma_f32_16x16x32_bf16 v[44:47], v[116:119], a[220:223], v[44:47]
 ds_read_b128 v[152:155], v28 offset:1024
 v_mfma_f32_16x16x32_bf16 v[48:51], v[120:123], a[144:147], v[48:51]
 ds_read_b128 v[156:159], v28 offset:10240
 v_mfma_f32_16x16x32_bf16 v[48:51], v[124:127], a[216:219], v[48:51]
 ds_read_b128 v[96:99], v28 offset:2048
 v_mfma_f32_16x16x32_bf16 v[52:55], v[120:123], a[148:151], v[52:55]
 ds_read_b128 v[100:103], v28 offset:11264
 v_mfma_f32_16x16x32_bf16 v[52:55], v[124:127], a[220:223], v[52:55]
 ds_read_b128 v[104:107], v28 offset:3072
 v_mfma_f32_16x16x32_bf16 v[56:59], v[128:131], a[144:147], v[56:59]
 ds_read_b128 v[108:111], v28 offset:12288
 v_mfma_f32_16x16x32_bf16 v[56:59], v[132:135], a[216:219], v[56:59]
 ds_read_b128 v[112:115], v28 offset:4096
 v_mfma_f32_16x16x32_bf16 v[60:63], v[128:131], a[148:151], v[60:63]
 ds_read_b128 v[116:119], v28 offset:13312
 v_mfma_f32_16x16x32_bf16 v[60:63], v[132:135], a[220:223], v[60:63]
 buffer_load_dwordx4 v5, s[16:19], s84 offen sc1 lds
 v_mfma_f32_16x16x32_bf16 v[64:67], v[136:139], a[144:147], v[64:67]
 ds_read_b128 v[120:123], v28 offset:5120
 v_mfma_f32_16x16x32_bf16 v[64:67], v[140:143], a[216:219], v[64:67]
 buffer_load_dwordx4 v5, s[16:19], s84 offen offset:1024 sc1 lds
 v_mfma_f32_16x16x32_bf16 v[68:71], v[136:139], a[148:151], v[68:71]
 ds_read_b128 v[124:127], v28 offset:14336
 s_waitcnt lgkmcnt(8)
 v_mfma_f32_16x16x32_bf16 v[68:71], v[140:143], a[220:223], v[68:71]
 buffer_load_dwordx4 v5, s[16:19], s84 offen offset:2048 sc1 lds
 v_mfma_f32_16x16x32_bf16 v[224:227], v[144:147], a[8:11], v[224:227]
 ds_read_b128 v[128:131], v28 offset:6144
 v_mfma_f32_16x16x32_bf16 v[224:227], v[148:151], a[80:83], v[224:227]
 buffer_load_dwordx4 v5, s[16:19], s84 offen offset:3072 sc1 lds
 s_add_u32 m0, m0, s30
 v_mfma_f32_16x16x32_bf16 v[228:231], v[144:147], a[12:15], v[228:231]
 ds_read_b128 v[132:135], v28 offset:15360
 v_mfma_f32_16x16x32_bf16 v[228:231], v[148:151], a[84:87], v[228:231]
 v_mfma_f32_16x16x32_bf16 v[232:235], v[152:155], a[8:11], v[232:235]
 ds_read_b128 v[136:139], v28 offset:7168
 v_mfma_f32_16x16x32_bf16 v[232:235], v[156:159], a[80:83], v[232:235]
 buffer_load_dwordx4 v6, s[16:19], s84 offen sc1 lds
 s_add_u32 s85, s85, s30
 v_mfma_f32_16x16x32_bf16 v[236:239], v[152:155], a[12:15], v[236:239]
 ds_read_b128 v[140:143], v28 offset:16384
 s_waitcnt lgkmcnt(8)
 v_mfma_f32_16x16x32_bf16 v[236:239], v[156:159], a[84:87], v[236:239]
 v_mfma_f32_16x16x32_bf16 v[240:243], v[96:99], a[8:11], v[240:243]
 ds_read_b128 v[144:147], v28 offset:8192
 v_mfma_f32_16x16x32_bf16 v[240:243], v[100:103], a[80:83], v[240:243]
 buffer_load_dwordx4 v[192:195], v19, s[16:19], s85 offen sc1
 v_mfma_f32_16x16x32_bf16 v[244:247], v[96:99], a[12:15], v[244:247]
 ds_read_b128 v[148:151], v28 offset:17408
 v_mfma_f32_16x16x32_bf16 v[244:247], v[100:103], a[84:87], v[244:247]
 v_mfma_f32_16x16x32_bf16 v[248:251], v[104:107], a[8:11], v[248:251]
 ds_read_b128 v[152:155], v28 offset:18432
 v_mfma_f32_16x16x32_bf16 v[248:251], v[108:111], a[80:83], v[248:251]
 buffer_load_dwordx4 v[196:199], v7, s[16:19], s85 offen sc1
 v_mfma_f32_16x16x32_bf16 v[252:255], v[104:107], a[12:15], v[252:255]
 ds_read_b128 v[156:159], v28 offset:27648
 s_waitcnt lgkmcnt(8)
 v_mfma_f32_16x16x32_bf16 v[252:255], v[108:111], a[84:87], v[252:255]
 s_load_dword s64, s[88:89], s39 offset:45184
 v_mfma_f32_16x16x32_bf16 v[32:35], v[112:115], a[8:11], v[32:35]
 ds_read_b128 v[96:99], v28 offset:19456
 v_mfma_f32_16x16x32_bf16 v[32:35], v[116:119], a[80:83], v[32:35]
 buffer_load_dwordx4 v[200:203], v19, s[16:19], s85 offen offset:1024 sc1
 v_mfma_f32_16x16x32_bf16 v[36:39], v[112:115], a[12:15], v[36:39]
 ds_read_b128 v[100:103], v28 offset:28672
 v_mfma_f32_16x16x32_bf16 v[36:39], v[116:119], a[84:87], v[36:39]
 v_mfma_f32_16x16x32_bf16 v[40:43], v[120:123], a[8:11], v[40:43]
 ds_read_b128 v[104:107], v28 offset:20480
 v_mfma_f32_16x16x32_bf16 v[40:43], v[124:127], a[80:83], v[40:43]
 buffer_load_dwordx4 v[204:207], v7, s[16:19], s85 offen offset:1024 sc1
 v_mfma_f32_16x16x32_bf16 v[44:47], v[120:123], a[12:15], v[44:47]
 ds_read_b128 v[108:111], v28 offset:29696
 s_waitcnt lgkmcnt(8)
 v_mfma_f32_16x16x32_bf16 v[44:47], v[124:127], a[84:87], v[44:47]
 v_mfma_f32_16x16x32_bf16 v[48:51], v[128:131], a[8:11], v[48:51]
 ds_read_b128 v[112:115], v28 offset:21504
 v_mfma_f32_16x16x32_bf16 v[48:51], v[132:135], a[80:83], v[48:51]
 buffer_load_dwordx4 v[208:211], v19, s[16:19], s85 offen offset:2048 sc1
 v_mfma_f32_16x16x32_bf16 v[52:55], v[128:131], a[12:15], v[52:55]
 ds_read_b128 v[116:119], v28 offset:30720
 v_mfma_f32_16x16x32_bf16 v[52:55], v[132:135], a[84:87], v[52:55]
 v_mfma_f32_16x16x32_bf16 v[56:59], v[136:139], a[8:11], v[56:59]
 ds_read_b128 v[120:123], v28 offset:22528
 v_mfma_f32_16x16x32_bf16 v[56:59], v[140:143], a[80:83], v[56:59]
 buffer_load_dwordx4 v[212:215], v7, s[16:19], s85 offen offset:2048 sc1
 v_mfma_f32_16x16x32_bf16 v[60:63], v[136:139], a[12:15], v[60:63]
 ds_read_b128 v[124:127], v28 offset:31744
 s_waitcnt lgkmcnt(8)
 v_mfma_f32_16x16x32_bf16 v[60:63], v[140:143], a[84:87], v[60:63]
 v_mfma_f32_16x16x32_bf16 v[64:67], v[144:147], a[8:11], v[64:67]
 ds_read_b128 v[128:131], v28 offset:23552
 v_mfma_f32_16x16x32_bf16 v[64:67], v[148:151], a[80:83], v[64:67]
 buffer_load_dwordx4 v[216:219], v19, s[16:19], s85 offen offset:3072 sc1
 v_mfma_f32_16x16x32_bf16 v[68:71], v[144:147], a[12:15], v[68:71]
 ds_read_b128 v[132:135], v28 offset:32768
 v_mfma_f32_16x16x32_bf16 v[68:71], v[148:151], a[84:87], v[68:71]
 v_mfma_f32_16x16x32_bf16 v[224:227], v[152:155], a[152:155], v[224:227]
 ds_read_b128 v[136:139], v28 offset:24576
 v_mfma_f32_16x16x32_bf16 v[224:227], v[156:159], a[224:227], v[224:227]
 buffer_load_dwordx4 v[220:223], v7, s[16:19], s85 offen offset:3072 sc1
 s_mul_i32 s84, s83, 442368
 v_mfma_f32_16x16x32_bf16 v[228:231], v[152:155], a[156:159], v[228:231]
 ds_read_b128 v[140:143], v28 offset:33792
 s_waitcnt lgkmcnt(8)
 v_mfma_f32_16x16x32_bf16 v[228:231], v[156:159], a[228:231], v[228:231]
 s_add_u32 s84, s84, s86
 s_add_u32 m0, s56, 49152
 v_mfma_f32_16x16x32_bf16 v[232:235], v[96:99], a[152:155], v[232:235]
 ds_read_b128 v[144:147], v28 offset:25600
 v_mfma_f32_16x16x32_bf16 v[232:235], v[100:103], a[224:227], v[232:235]
 buffer_load_dwordx4 v19, s[16:19], s84 offen sc1 lds
 v_mfma_f32_16x16x32_bf16 v[236:239], v[96:99], a[156:159], v[236:239]
 ds_read_b128 v[148:151], v28 offset:34816
 v_mfma_f32_16x16x32_bf16 v[236:239], v[100:103], a[228:231], v[236:239]
 v_mfma_f32_16x16x32_bf16 v[240:243], v[104:107], a[152:155], v[240:243]
 ds_read_b128 v[152:155], v28 offset:26624
 v_mfma_f32_16x16x32_bf16 v[240:243], v[108:111], a[224:227], v[240:243]
 buffer_load_dwordx4 v19, s[16:19], s84 offen offset:1024 sc1 lds
 v_mfma_f32_16x16x32_bf16 v[244:247], v[104:107], a[156:159], v[244:247]
 ds_read_b128 v[156:159], v28 offset:35840
 s_waitcnt lgkmcnt(8)
 v_mfma_f32_16x16x32_bf16 v[244:247], v[108:111], a[228:231], v[244:247]
 v_mfma_f32_16x16x32_bf16 v[248:251], v[112:115], a[152:155], v[248:251]
 v_mfma_f32_16x16x32_bf16 v[248:251], v[116:119], a[224:227], v[248:251]
 buffer_load_dwordx4 v19, s[16:19], s84 offen offset:2048 sc1 lds
 v_mfma_f32_16x16x32_bf16 v[252:255], v[112:115], a[156:159], v[252:255]
 v_mfma_f32_16x16x32_bf16 v[252:255], v[116:119], a[228:231], v[252:255]
 v_mfma_f32_16x16x32_bf16 v[32:35], v[120:123], a[152:155], v[32:35]
 v_mfma_f32_16x16x32_bf16 v[32:35], v[124:127], a[224:227], v[32:35]
 buffer_load_dwordx4 v19, s[16:19], s84 offen offset:3072 sc1 lds
 s_add_u32 m0, m0, s30
 v_mfma_f32_16x16x32_bf16 v[36:39], v[120:123], a[156:159], v[36:39]
 v_mfma_f32_16x16x32_bf16 v[36:39], v[124:127], a[228:231], v[36:39]
 s_waitcnt lgkmcnt(4)
 v_mfma_f32_16x16x32_bf16 v[40:43], v[128:131], a[152:155], v[40:43]
 s_waitcnt vmcnt(21) lgkmcnt(0)
 s_barrier
 v_mfma_f32_16x16x32_bf16 v[40:43], v[132:135], a[224:227], v[40:43]
 ds_read_b128 v[96:99], v8 offset:0
 v_mfma_f32_16x16x32_bf16 v[44:47], v[128:131], a[156:159], v[44:47]
 ds_read_b128 v[100:103], v8 offset:49152
 v_mfma_f32_16x16x32_bf16 v[44:47], v[132:135], a[228:231], v[44:47]
 ds_read_b128 v[104:107], v8 offset:1024
 v_mfma_f32_16x16x32_bf16 v[48:51], v[136:139], a[152:155], v[48:51]
 ds_read_b128 v[108:111], v8 offset:50176
 v_mfma_f32_16x16x32_bf16 v[48:51], v[140:143], a[224:227], v[48:51]
 ds_read_b128 v[112:115], v8 offset:2048
 v_mfma_f32_16x16x32_bf16 v[52:55], v[136:139], a[156:159], v[52:55]
 ds_read_b128 v[116:119], v8 offset:51200
 v_mfma_f32_16x16x32_bf16 v[52:55], v[140:143], a[228:231], v[52:55]
 ds_read_b128 v[120:123], v8 offset:3072
 v_mfma_f32_16x16x32_bf16 v[56:59], v[144:147], a[152:155], v[56:59]
 ds_read_b128 v[124:127], v8 offset:52224
 v_mfma_f32_16x16x32_bf16 v[56:59], v[148:151], a[224:227], v[56:59]
 ds_read_b128 v[128:131], v8 offset:4096
 v_mfma_f32_16x16x32_bf16 v[60:63], v[144:147], a[156:159], v[60:63]
 ds_read_b128 v[132:135], v8 offset:53248
 v_mfma_f32_16x16x32_bf16 v[60:63], v[148:151], a[228:231], v[60:63]
 s_cmp_eq_u32 s64, 0x10101
 s_cbranch_scc0 Lsp_g10p2
Lrt_g10p2:
 v_mfma_f32_16x16x32_bf16 v[64:67], v[152:155], a[152:155], v[64:67]
 ds_read_b128 v[136:139], v8 offset:5120
 v_mfma_f32_16x16x32_bf16 v[64:67], v[156:159], a[224:227], v[64:67]
 buffer_load_dwordx4 v5, s[16:19], s84 offen sc1 lds
 v_mfma_f32_16x16x32_bf16 v[68:71], v[152:155], a[156:159], v[68:71]
 ds_read_b128 v[140:143], v8 offset:54272
 s_waitcnt lgkmcnt(6)
 v_mfma_f32_16x16x32_bf16 v[68:71], v[156:159], a[228:231], v[68:71]
 buffer_load_dwordx4 v5, s[16:19], s84 offen offset:1024 sc1 lds
 v_mfma_f32_16x16x32_bf16 v[224:227], v[96:99], v[160:163], v[224:227]
 ds_read_b128 v[144:147], v8 offset:6144
 v_mfma_f32_16x16x32_bf16 v[224:227], v[100:103], v[168:171], v[224:227]
 buffer_load_dwordx4 v5, s[16:19], s84 offen offset:2048 sc1 lds
 v_mfma_f32_16x16x32_bf16 v[228:231], v[96:99], v[164:167], v[228:231]
 ds_read_b128 v[148:151], v8 offset:55296
 v_mfma_f32_16x16x32_bf16 v[228:231], v[100:103], v[172:175], v[228:231]
Lpg14:
 s_cbranch_vccnz Lj_Lfin
 buffer_load_dwordx4 v5, s[16:19], s84 offen offset:3072 sc1 lds
 s_add_u32 m0, m0, s30
 v_mfma_f32_16x16x32_bf16 v[232:235], v[104:107], v[160:163], v[232:235]
 ds_read_b128 v[152:155], v8 offset:7168
 v_mfma_f32_16x16x32_bf16 v[232:235], v[108:111], v[168:171], v[232:235]
 v_mfma_f32_16x16x32_bf16 v[236:239], v[104:107], v[164:167], v[236:239]
 ds_read_b128 v[156:159], v8 offset:56320
 v_mfma_f32_16x16x32_bf16 v[236:239], v[108:111], v[172:175], v[236:239]
 buffer_load_dwordx4 v6, s[16:19], s84 offen sc1 lds
 s_mul_i32 s85, s83, 12288
 v_mfma_f32_16x16x32_bf16 v[240:243], v[112:115], v[160:163], v[240:243]
 ds_read_b128 v[96:99], v8 offset:8192
 s_add_u32 s85, s85, s87
 v_mfma_f32_16x16x32_bf16 v[240:243], v[116:119], v[168:171], v[240:243]
 v_mfma_f32_16x16x32_bf16 v[244:247], v[112:115], v[164:167], v[244:247]
 ds_read_b128 v[100:103], v8 offset:57344
 s_waitcnt lgkmcnt(4)
 v_mfma_f32_16x16x32_bf16 v[244:247], v[116:119], v[172:175], v[244:247]
 buffer_load_dwordx4 a[0:3], v19, s[16:19], s85 offen sc1
 v_mfma_f32_16x16x32_bf16 v[248:251], v[120:123], v[160:163], v[248:251]
 ds_read_b128 v[104:107], v9 offset:0
 v_mfma_f32_16x16x32_bf16 v[248:251], v[124:127], v[168:171], v[248:251]
 v_mfma_f32_16x16x32_bf16 v[252:255], v[120:123], v[164:167], v[252:255]
 ds_read_b128 v[108:111], v9 offset:9216
 v_mfma_f32_16x16x32_bf16 v[252:255], v[124:127], v[172:175], v[252:255]
 buffer_load_dwordx4 a[4:7], v7, s[16:19], s85 offen sc1
 v_mfma_f32_16x16x32_bf16 v[32:35], v[128:131], v[160:163], v[32:35]
 ds_read_b128 v[112:115], v9 offset:1024
 v_mfma_f32_16x16x32_bf16 v[32:35], v[132:135], v[168:171], v[32:35]
 v_mfma_f32_16x16x32_bf16 v[36:39], v[128:131], v[164:167], v[36:39]
 ds_read_b128 v[116:119], v9 offset:10240
 v_mfma_f32_16x16x32_bf16 v[36:39], v[132:135], v[172:175], v[36:39]
 buffer_load_dwordx4 a[72:75], v19, s[16:19], s85 offen offset:1024 sc1
 v_mfma_f32_16x16x32_bf16 v[40:43], v[136:139], v[160:163], v[40:43]
 ds_read_b128 v[120:123], v9 offset:2048
 v_mfma_f32_16x16x32_bf16 v[40:43], v[140:143], v[168:171], v[40:43]
 v_mfma_f32_16x16x32_bf16 v[44:47], v[136:139], v[164:167], v[44:47]
 ds_read_b128 v[124:127], v9 offset:11264
 v_mfma_f32_16x16x32_bf16 v[44:47], v[140:143], v[172:175], v[44:47]
 buffer_load_dwordx4 a[76:79], v7, s[16:19], s85 offen offset:1024 sc1
 v_mfma_f32_16x16x32_bf16 v[48:51], v[144:147], v[160:163], v[48:51]
 ds_read_b128 v[128:131], v9 offset:3072
 v_mfma_f32_16x16x32_bf16 v[48:51], v[148:151], v[168:171], v[48:51]
 v_mfma_f32_16x16x32_bf16 v[52:55], v[144:147], v[164:167], v[52:55]
 ds_read_b128 v[132:135], v9 offset:12288
 s_waitcnt lgkmcnt(4)
 v_mfma_f32_16x16x32_bf16 v[52:55], v[148:151], v[172:175], v[52:55]
 buffer_load_dwordx4 a[144:147], v19, s[16:19], s85 offen offset:2048 sc1
 v_mfma_f32_16x16x32_bf16 v[56:59], v[152:155], v[160:163], v[56:59]
 ds_read_b128 v[136:139], v9 offset:4096
 v_mfma_f32_16x16x32_bf16 v[56:59], v[156:159], v[168:171], v[56:59]
 v_mfma_f32_16x16x32_bf16 v[60:63], v[152:155], v[164:167], v[60:63]
 ds_read_b128 v[140:143], v9 offset:13312
 v_mfma_f32_16x16x32_bf16 v[60:63], v[156:159], v[172:175], v[60:63]
 buffer_load_dwordx4 a[148:151], v7, s[16:19], s85 offen offset:2048 sc1
 v_mfma_f32_16x16x32_bf16 v[64:67], v[96:99], v[160:163], v[64:67]
 ds_read_b128 v[144:147], v9 offset:5120
 v_mfma_f32_16x16x32_bf16 v[64:67], v[100:103], v[168:171], v[64:67]
 v_mfma_f32_16x16x32_bf16 v[68:71], v[96:99], v[164:167], v[68:71]
 ds_read_b128 v[148:151], v9 offset:14336
 v_mfma_f32_16x16x32_bf16 v[68:71], v[100:103], v[172:175], v[68:71]
 buffer_load_dwordx4 a[216:219], v19, s[16:19], s85 offen offset:3072 sc1
 v_mfma_f32_16x16x32_bf16 v[224:227], v[104:107], v[176:179], v[224:227]
 ds_read_b128 v[152:155], v9 offset:6144
 v_mfma_f32_16x16x32_bf16 v[224:227], v[108:111], v[184:187], v[224:227]
 v_mfma_f32_16x16x32_bf16 v[228:231], v[104:107], v[180:183], v[228:231]
 ds_read_b128 v[156:159], v9 offset:15360
 v_mfma_f32_16x16x32_bf16 v[228:231], v[108:111], v[188:191], v[228:231]
 buffer_load_dwordx4 a[220:223], v7, s[16:19], s85 offen offset:3072 sc1
 s_add_u32 s84, s84, s31
 v_mfma_f32_16x16x32_bf16 v[232:235], v[112:115], v[176:179], v[232:235]
 ds_read_b128 v[96:99], v9 offset:7168
 s_add_u32 m0, s56, 98304
 v_mfma_f32_16x16x32_bf16 v[232:235], v[116:119], v[184:187], v[232:235]
 v_mfma_f32_16x16x32_bf16 v[236:239], v[112:115], v[180:183], v[236:239]
 ds_read_b128 v[100:103], v9 offset:16384
 s_waitcnt lgkmcnt(4)
 v_mfma_f32_16x16x32_bf16 v[236:239], v[116:119], v[188:191], v[236:239]
 buffer_load_dwordx4 v19, s[16:19], s84 offen sc1 lds
 v_mfma_f32_16x16x32_bf16 v[240:243], v[120:123], v[176:179], v[240:243]
 ds_read_b128 v[104:107], v9 offset:8192
 v_mfma_f32_16x16x32_bf16 v[240:243], v[124:127], v[184:187], v[240:243]
 v_mfma_f32_16x16x32_bf16 v[244:247], v[120:123], v[180:183], v[244:247]
 ds_read_b128 v[108:111], v9 offset:17408
 v_mfma_f32_16x16x32_bf16 v[244:247], v[124:127], v[188:191], v[244:247]
 buffer_load_dwordx4 v19, s[16:19], s84 offen offset:1024 sc1 lds
 v_mfma_f32_16x16x32_bf16 v[248:251], v[128:131], v[176:179], v[248:251]
 v_mfma_f32_16x16x32_bf16 v[248:251], v[132:135], v[184:187], v[248:251]
 v_mfma_f32_16x16x32_bf16 v[252:255], v[128:131], v[180:183], v[252:255]
 v_mfma_f32_16x16x32_bf16 v[252:255], v[132:135], v[188:191], v[252:255]
 buffer_load_dwordx4 v19, s[16:19], s84 offen offset:2048 sc1 lds
 v_mfma_f32_16x16x32_bf16 v[32:35], v[136:139], v[176:179], v[32:35]
 v_mfma_f32_16x16x32_bf16 v[32:35], v[140:143], v[184:187], v[32:35]
 v_mfma_f32_16x16x32_bf16 v[36:39], v[136:139], v[180:183], v[36:39]
 v_mfma_f32_16x16x32_bf16 v[36:39], v[140:143], v[188:191], v[36:39]
 buffer_load_dwordx4 v19, s[16:19], s84 offen offset:3072 sc1 lds
 s_add_u32 m0, m0, s30
 v_mfma_f32_16x16x32_bf16 v[40:43], v[144:147], v[176:179], v[40:43]
 s_waitcnt vmcnt(21) lgkmcnt(0)
 s_barrier
 v_mfma_f32_16x16x32_bf16 v[40:43], v[148:151], v[184:187], v[40:43]
 ds_read_b128 v[112:115], v26 offset:0
 v_mfma_f32_16x16x32_bf16 v[44:47], v[144:147], v[180:183], v[44:47]
 ds_read_b128 v[116:119], v26 offset:9216
 v_mfma_f32_16x16x32_bf16 v[44:47], v[148:151], v[188:191], v[44:47]
 ds_read_b128 v[120:123], v26 offset:1024
 v_mfma_f32_16x16x32_bf16 v[48:51], v[152:155], v[176:179], v[48:51]
 ds_read_b128 v[124:127], v26 offset:10240
 v_mfma_f32_16x16x32_bf16 v[48:51], v[156:159], v[184:187], v[48:51]
 ds_read_b128 v[128:131], v26 offset:2048
 v_mfma_f32_16x16x32_bf16 v[52:55], v[152:155], v[180:183], v[52:55]
 ds_read_b128 v[132:135], v26 offset:11264
 v_mfma_f32_16x16x32_bf16 v[52:55], v[156:159], v[188:191], v[52:55]
 ds_read_b128 v[136:139], v26 offset:3072
 v_mfma_f32_16x16x32_bf16 v[56:59], v[96:99], v[176:179], v[56:59]
 ds_read_b128 v[140:143], v26 offset:12288
 v_mfma_f32_16x16x32_bf16 v[56:59], v[100:103], v[184:187], v[56:59]
 ds_read_b128 v[144:147], v26 offset:4096
 v_mfma_f32_16x16x32_bf16 v[60:63], v[96:99], v[180:183], v[60:63]
 ds_read_b128 v[148:151], v26 offset:13312
 v_mfma_f32_16x16x32_bf16 v[60:63], v[100:103], v[188:191], v[60:63]
 buffer_load_dwordx4 v5, s[16:19], s84 offen sc1 lds
 v_mfma_f32_16x16x32_bf16 v[64:67], v[104:107], v[176:179], v[64:67]
 ds_read_b128 v[152:155], v26 offset:5120
 v_mfma_f32_16x16x32_bf16 v[64:67], v[108:111], v[184:187], v[64:67]
 buffer_load_dwordx4 v5, s[16:19], s84 offen offset:1024 sc1 lds
 v_mfma_f32_16x16x32_bf16 v[68:71], v[104:107], v[180:183], v[68:71]
 ds_read_b128 v[156:159], v26 offset:14336
 s_waitcnt lgkmcnt(6)
 v_mfma_f32_16x16x32_bf16 v[68:71], v[108:111], v[188:191], v[68:71]
 buffer_load_dwordx4 v5, s[16:19], s84 offen offset:2048 sc1 lds
 v_mfma_f32_16x16x32_bf16 v[224:227], v[112:115], v[192:195], v[224:227]
 ds_read_b128 v[96:99], v26 offset:6144
 v_mfma_f32_16x16x32_bf16 v[224:227], v[116:119], v[200:203], v[224:227]
 buffer_load_dwordx4 v5, s[16:19], s84 offen offset:3072 sc1 lds
 s_add_u32 m0, m0, s30
 v_mfma_f32_16x16x32_bf16 v[228:231], v[112:115], v[196:199], v[228:231]
 ds_read_b128 v[100:103], v26 offset:15360
 v_mfma_f32_16x16x32_bf16 v[228:231], v[116:119], v[204:207], v[228:231]
 v_mfma_f32_16x16x32_bf16 v[232:235], v[120:123], v[192:195], v[232:235]
 ds_read_b128 v[104:107], v26 offset:7168
 v_mfma_f32_16x16x32_bf16 v[232:235], v[124:127], v[200:203], v[232:235]
 buffer_load_dwordx4 v6, s[16:19], s84 offen sc1 lds
 s_add_u32 s85, s85, s30
 v_mfma_f32_16x16x32_bf16 v[236:239], v[120:123], v[196:199], v[236:239]
 ds_read_b128 v[108:111], v26 offset:16384
 v_mfma_f32_16x16x32_bf16 v[236:239], v[124:127], v[204:207], v[236:239]
 v_mfma_f32_16x16x32_bf16 v[240:243], v[128:131], v[192:195], v[240:243]
 ds_read_b128 v[112:115], v26 offset:8192
 v_mfma_f32_16x16x32_bf16 v[240:243], v[132:135], v[200:203], v[240:243]
 buffer_load_dwordx4 a[8:11], v19, s[16:19], s85 offen sc1
 v_mfma_f32_16x16x32_bf16 v[244:247], v[128:131], v[196:199], v[244:247]
 ds_read_b128 v[116:119], v26 offset:17408
 s_waitcnt lgkmcnt(4)
 v_mfma_f32_16x16x32_bf16 v[244:247], v[132:135], v[204:207], v[244:247]
 v_mfma_f32_16x16x32_bf16 v[248:251], v[136:139], v[192:195], v[248:251]
 ds_read_b128 v[120:123], v26 offset:18432
 v_mfma_f32_16x16x32_bf16 v[248:251], v[140:143], v[200:203], v[248:251]
 buffer_load_dwordx4 a[12:15], v7, s[16:19], s85 offen sc1
 v_mfma_f32_16x16x32_bf16 v[252:255], v[136:139], v[196:199], v[252:255]
 ds_read_b128 v[124:127], v26 offset:27648
 v_mfma_f32_16x16x32_bf16 v[252:255], v[140:143], v[204:207], v[252:255]
 v_mfma_f32_16x16x32_bf16 v[32:35], v[144:147], v[192:195], v[32:35]
 ds_read_b128 v[128:131], v26 offset:19456
 v_mfma_f32_16x16x32_bf16 v[32:35], v[148:151], v[200:203], v[32:35]
 buffer_load_dwordx4 a[80:83], v19, s[16:19], s85 offen offset:1024 sc1
 v_mfma_f32_16x16x32_bf16 v[36:39], v[144:147], v[196:199], v[36:39]
 ds_read_b128 v[132:135], v26 offset:28672
 v_mfma_f32_16x16x32_bf16 v[36:39], v[148:151], v[204:207], v[36:39]
 v_mfma_f32_16x16x32_bf16 v[40:43], v[152:155], v[192:195], v[40:43]
 ds_read_b128 v[136:139], v26 offset:20480
 v_mfma_f32_16x16x32_bf16 v[40:43], v[156:159], v[200:203], v[40:43]
 buffer_load_dwordx4 a[84:87], v7, s[16:19], s85 offen offset:1024 sc1
 v_mfma_f32_16x16x32_bf16 v[44:47], v[152:155], v[196:199], v[44:47]
 ds_read_b128 v[140:143], v26 offset:29696
 v_mfma_f32_16x16x32_bf16 v[44:47], v[156:159], v[204:207], v[44:47]
 v_mfma_f32_16x16x32_bf16 v[48:51], v[96:99], v[192:195], v[48:51]
 ds_read_b128 v[144:147], v26 offset:21504
 v_mfma_f32_16x16x32_bf16 v[48:51], v[100:103], v[200:203], v[48:51]
 buffer_load_dwordx4 a[152:155], v19, s[16:19], s85 offen offset:2048 sc1
 v_mfma_f32_16x16x32_bf16 v[52:55], v[96:99], v[196:199], v[52:55]
 ds_read_b128 v[148:151], v26 offset:30720
 s_waitcnt lgkmcnt(4)
 v_mfma_f32_16x16x32_bf16 v[52:55], v[100:103], v[204:207], v[52:55]
 v_mfma_f32_16x16x32_bf16 v[56:59], v[104:107], v[192:195], v[56:59]
 ds_read_b128 v[152:155], v26 offset:22528
 v_mfma_f32_16x16x32_bf16 v[56:59], v[108:111], v[200:203], v[56:59]
 buffer_load_dwordx4 a[156:159], v7, s[16:19], s85 offen offset:2048 sc1
 v_mfma_f32_16x16x32_bf16 v[60:63], v[104:107], v[196:199], v[60:63]
 ds_read_b128 v[156:159], v26 offset:31744
 v_mfma_f32_16x16x32_bf16 v[60:63], v[108:111], v[204:207], v[60:63]
 v_mfma_f32_16x16x32_bf16 v[64:67], v[112:115], v[192:195], v[64:67]
 ds_read_b128 v[96:99], v26 offset:23552
 v_mfma_f32_16x16x32_bf16 v[64:67], v[116:119], v[200:203], v[64:67]
 buffer_load_dwordx4 a[224:227], v19, s[16:19], s85 offen offset:3072 sc1
 v_mfma_f32_16x16x32_bf16 v[68:71], v[112:115], v[196:199], v[68:71]
 ds_read_b128 v[100:103], v26 offset:32768
 v_mfma_f32_16x16x32_bf16 v[68:71], v[116:119], v[204:207], v[68:71]
 v_mfma_f32_16x16x32_bf16 v[224:227], v[120:123], v[208:211], v[224:227]
 ds_read_b128 v[104:107], v26 offset:24576
 v_mfma_f32_16x16x32_bf16 v[224:227], v[124:127], v[216:219], v[224:227]
 buffer_load_dwordx4 a[228:231], v7, s[16:19], s85 offen offset:3072 sc1
 s_add_u32 s84, s84, s31
 v_mfma_f32_16x16x32_bf16 v[228:231], v[120:123], v[212:215], v[228:231]
 ds_read_b128 v[108:111], v26 offset:33792
 s_add_u32 m0, s55, 0
 v_mfma_f32_16x16x32_bf16 v[228:231], v[124:127], v[220:223], v[228:231]
 v_mfma_f32_16x16x32_bf16 v[232:235], v[128:131], v[208:211], v[232:235]
 ds_read_b128 v[112:115], v26 offset:25600
 v_mfma_f32_16x16x32_bf16 v[232:235], v[132:135], v[216:219], v[232:235]
 buffer_load_dwordx4 v19, s[16:19], s84 offen sc1 lds
 v_mfma_f32_16x16x32_bf16 v[236:239], v[128:131], v[212:215], v[236:239]
 ds_read_b128 v[116:119], v26 offset:34816
 s_waitcnt lgkmcnt(4)
 v_mfma_f32_16x16x32_bf16 v[236:239], v[132:135], v[220:223], v[236:239]
 v_mfma_f32_16x16x32_bf16 v[240:243], v[136:139], v[208:211], v[240:243]
 ds_read_b128 v[120:123], v26 offset:26624
 v_mfma_f32_16x16x32_bf16 v[240:243], v[140:143], v[216:219], v[240:243]
 buffer_load_dwordx4 v19, s[16:19], s84 offen offset:1024 sc1 lds
 v_mfma_f32_16x16x32_bf16 v[244:247], v[136:139], v[212:215], v[244:247]
 ds_read_b128 v[124:127], v26 offset:35840
 v_mfma_f32_16x16x32_bf16 v[244:247], v[140:143], v[220:223], v[244:247]
 v_mfma_f32_16x16x32_bf16 v[248:251], v[144:147], v[208:211], v[248:251]
 v_mfma_f32_16x16x32_bf16 v[248:251], v[148:151], v[216:219], v[248:251]
 buffer_load_dwordx4 v19, s[16:19], s84 offen offset:2048 sc1 lds
 v_mfma_f32_16x16x32_bf16 v[252:255], v[144:147], v[212:215], v[252:255]
 v_mfma_f32_16x16x32_bf16 v[252:255], v[148:151], v[220:223], v[252:255]
 v_mfma_f32_16x16x32_bf16 v[32:35], v[152:155], v[208:211], v[32:35]
 v_mfma_f32_16x16x32_bf16 v[32:35], v[156:159], v[216:219], v[32:35]
 buffer_load_dwordx4 v19, s[16:19], s84 offen offset:3072 sc1 lds
 s_add_u32 m0, m0, s30
 v_mfma_f32_16x16x32_bf16 v[36:39], v[152:155], v[212:215], v[36:39]
 v_mfma_f32_16x16x32_bf16 v[36:39], v[156:159], v[220:223], v[36:39]
 v_mfma_f32_16x16x32_bf16 v[40:43], v[96:99], v[208:211], v[40:43]
 s_waitcnt vmcnt(21) lgkmcnt(0)
 s_barrier
 v_mfma_f32_16x16x32_bf16 v[40:43], v[100:103], v[216:219], v[40:43]
 ds_read_b128 v[128:131], v27 offset:0
 v_mfma_f32_16x16x32_bf16 v[44:47], v[96:99], v[212:215], v[44:47]
 ds_read_b128 v[132:135], v27 offset:9216
 v_mfma_f32_16x16x32_bf16 v[44:47], v[100:103], v[220:223], v[44:47]
 ds_read_b128 v[136:139], v27 offset:1024
 v_mfma_f32_16x16x32_bf16 v[48:51], v[104:107], v[208:211], v[48:51]
 ds_read_b128 v[140:143], v27 offset:10240
 v_mfma_f32_16x16x32_bf16 v[48:51], v[108:111], v[216:219], v[48:51]
 ds_read_b128 v[144:147], v27 offset:2048
 v_mfma_f32_16x16x32_bf16 v[52:55], v[104:107], v[212:215], v[52:55]
 ds_read_b128 v[148:151], v27 offset:11264
 v_mfma_f32_16x16x32_bf16 v[52:55], v[108:111], v[220:223], v[52:55]
 ds_read_b128 v[152:155], v27 offset:3072
 v_mfma_f32_16x16x32_bf16 v[56:59], v[112:115], v[208:211], v[56:59]
 ds_read_b128 v[156:159], v27 offset:12288
 v_mfma_f32_16x16x32_bf16 v[56:59], v[116:119], v[216:219], v[56:59]
 ds_read_b128 v[96:99], v27 offset:4096
 v_mfma_f32_16x16x32_bf16 v[60:63], v[112:115], v[212:215], v[60:63]
 ds_read_b128 v[100:103], v27 offset:13312
 v_mfma_f32_16x16x32_bf16 v[60:63], v[116:119], v[220:223], v[60:63]
 buffer_load_dwordx4 v5, s[16:19], s84 offen sc1 lds
 v_mfma_f32_16x16x32_bf16 v[64:67], v[120:123], v[208:211], v[64:67]
 ds_read_b128 v[104:107], v27 offset:5120
 v_mfma_f32_16x16x32_bf16 v[64:67], v[124:127], v[216:219], v[64:67]
 buffer_load_dwordx4 v5, s[16:19], s84 offen offset:1024 sc1 lds
 v_mfma_f32_16x16x32_bf16 v[68:71], v[120:123], v[212:215], v[68:71]
 ds_read_b128 v[108:111], v27 offset:14336
 s_waitcnt lgkmcnt(6)
 v_mfma_f32_16x16x32_bf16 v[68:71], v[124:127], v[220:223], v[68:71]
 buffer_load_dwordx4 v5, s[16:19], s84 offen offset:2048 sc1 lds
 v_mfma_f32_16x16x32_bf16 v[224:227], v[128:131], a[0:3], v[224:227]
 ds_read_b128 v[112:115], v27 offset:6144
 v_mfma_f32_16x16x32_bf16 v[224:227], v[132:135], a[72:75], v[224:227]
 buffer_load_dwordx4 v5, s[16:19], s84 offen offset:3072 sc1 lds
 s_add_u32 m0, m0, s30
 v_mfma_f32_16x16x32_bf16 v[228:231], v[128:131], a[4:7], v[228:231]
 ds_read_b128 v[116:119], v27 offset:15360
 v_mfma_f32_16x16x32_bf16 v[228:231], v[132:135], a[76:79], v[228:231]
 v_mfma_f32_16x16x32_bf16 v[232:235], v[136:139], a[0:3], v[232:235]
 ds_read_b128 v[120:123], v27 offset:7168
 v_mfma_f32_16x16x32_bf16 v[232:235], v[140:143], a[72:75], v[232:235]
 buffer_load_dwordx4 v6, s[16:19], s84 offen sc1 lds
 s_add_u32 s85, s85, s30
 v_mfma_f32_16x16x32_bf16 v[236:239], v[136:139], a[4:7], v[236:239]
 ds_read_b128 v[124:127], v27 offset:16384
 v_mfma_f32_16x16x32_bf16 v[236:239], v[140:143], a[76:79], v[236:239]
 v_mfma_f32_16x16x32_bf16 v[240:243], v[144:147], a[0:3], v[240:243]
 ds_read_b128 v[128:131], v27 offset:8192
 v_mfma_f32_16x16x32_bf16 v[240:243], v[148:151], a[72:75], v[240:243]
 buffer_load_dwordx4 v[160:163], v19, s[16:19], s85 offen sc1
 v_mfma_f32_16x16x32_bf16 v[244:247], v[144:147], a[4:7], v[244:247]
 ds_read_b128 v[132:135], v27 offset:17408
 s_waitcnt lgkmcnt(4)
 v_mfma_f32_16x16x32_bf16 v[244:247], v[148:151], a[76:79], v[244:247]
 v_mfma_f32_16x16x32_bf16 v[248:251], v[152:155], a[0:3], v[248:251]
 ds_read_b128 v[136:139], v27 offset:18432
 v_mfma_f32_16x16x32_bf16 v[248:251], v[156:159], a[72:75], v[248:251]
 buffer_load_dwordx4 v[164:167], v7, s[16:19], s85 offen sc1
 v_mfma_f32_16x16x32_bf16 v[252:255], v[152:155], a[4:7], v[252:255]
 ds_read_b128 v[140:143], v27 offset:27648
 v_mov_b32 v20, -1
 v_mfma_f32_16x16x32_bf16 v[252:255], v[156:159], a[76:79], v[252:255]
 v_mov_b32 v21, -1
 v_mfma_f32_16x16x32_bf16 v[32:35], v[96:99], a[0:3], v[32:35]
 ds_read_b128 v[144:147], v27 offset:19456
 v_mov_b32 v22, -1
 v_mfma_f32_16x16x32_bf16 v[32:35], v[100:103], a[72:75], v[32:35]
 buffer_load_dwordx4 v[168:171], v19, s[16:19], s85 offen offset:1024 sc1
 v_mov_b32 v23, -1
 v_mfma_f32_16x16x32_bf16 v[36:39], v[96:99], a[4:7], v[36:39]
 ds_read_b128 v[148:151], v27 offset:28672
 v_mfma_f32_16x16x32_bf16 v[36:39], v[100:103], a[76:79], v[36:39]
 v_mfma_f32_16x16x32_bf16 v[40:43], v[104:107], a[0:3], v[40:43]
 ds_read_b128 v[152:155], v27 offset:20480
 v_mfma_f32_16x16x32_bf16 v[40:43], v[108:111], a[72:75], v[40:43]
 buffer_load_dwordx4 v[172:175], v7, s[16:19], s85 offen offset:1024 sc1
 v_mfma_f32_16x16x32_bf16 v[44:47], v[104:107], a[4:7], v[44:47]
 ds_read_b128 v[156:159], v27 offset:29696
 v_mfma_f32_16x16x32_bf16 v[44:47], v[108:111], a[76:79], v[44:47]
 v_mfma_f32_16x16x32_bf16 v[48:51], v[112:115], a[0:3], v[48:51]
 ds_read_b128 v[96:99], v27 offset:21504
 v_mfma_f32_16x16x32_bf16 v[48:51], v[116:119], a[72:75], v[48:51]
 buffer_load_dwordx4 v[176:179], v19, s[16:19], s85 offen offset:2048 sc1
 v_mfma_f32_16x16x32_bf16 v[52:55], v[112:115], a[4:7], v[52:55]
 ds_read_b128 v[100:103], v27 offset:30720
 s_waitcnt lgkmcnt(4)
 v_mfma_f32_16x16x32_bf16 v[52:55], v[116:119], a[76:79], v[52:55]
 v_mfma_f32_16x16x32_bf16 v[56:59], v[120:123], a[0:3], v[56:59]
 ds_read_b128 v[104:107], v27 offset:22528
 v_mfma_f32_16x16x32_bf16 v[56:59], v[124:127], a[72:75], v[56:59]
 buffer_load_dwordx4 v[180:183], v7, s[16:19], s85 offen offset:2048 sc1
 v_mfma_f32_16x16x32_bf16 v[60:63], v[120:123], a[4:7], v[60:63]
 ds_read_b128 v[108:111], v27 offset:31744
 v_mfma_f32_16x16x32_bf16 v[60:63], v[124:127], a[76:79], v[60:63]
 v_mfma_f32_16x16x32_bf16 v[64:67], v[128:131], a[0:3], v[64:67]
 ds_read_b128 v[112:115], v27 offset:23552
 v_mfma_f32_16x16x32_bf16 v[64:67], v[132:135], a[72:75], v[64:67]
 buffer_load_dwordx4 v[184:187], v19, s[16:19], s85 offen offset:3072 sc1
 v_mfma_f32_16x16x32_bf16 v[68:71], v[128:131], a[4:7], v[68:71]
 ds_read_b128 v[116:119], v27 offset:32768
 v_mfma_f32_16x16x32_bf16 v[68:71], v[132:135], a[76:79], v[68:71]
 v_mfma_f32_16x16x32_bf16 v[224:227], v[136:139], a[144:147], v[224:227]
 ds_read_b128 v[120:123], v27 offset:24576
 v_mfma_f32_16x16x32_bf16 v[224:227], v[140:143], a[216:219], v[224:227]
 buffer_load_dwordx4 v[188:191], v7, s[16:19], s85 offen offset:3072 sc1
 v_mfma_f32_16x16x32_bf16 v[228:231], v[136:139], a[148:151], v[228:231]
 ds_read_b128 v[124:127], v27 offset:33792
 v_mfma_f32_16x16x32_bf16 v[228:231], v[140:143], a[220:223], v[228:231]
 v_mfma_f32_16x16x32_bf16 v[232:235], v[144:147], a[144:147], v[232:235]
 ds_read_b128 v[128:131], v27 offset:25600
 v_mfma_f32_16x16x32_bf16 v[232:235], v[148:151], a[216:219], v[232:235]
 buffer_store_dwordx4 v[20:23], v19, s[16:19], s77 offen offset:2048 sc1
 v_mfma_f32_16x16x32_bf16 v[236:239], v[144:147], a[148:151], v[236:239]
 ds_read_b128 v[132:135], v27 offset:34816
 s_waitcnt lgkmcnt(4)
 v_mfma_f32_16x16x32_bf16 v[236:239], v[148:151], a[220:223], v[236:239]
 v_mfma_f32_16x16x32_bf16 v[240:243], v[152:155], a[144:147], v[240:243]
 ds_read_b128 v[136:139], v27 offset:26624
 v_mfma_f32_16x16x32_bf16 v[240:243], v[156:159], a[216:219], v[240:243]
 buffer_store_dwordx4 v[20:23], v19, s[16:19], s77 offen offset:3072 sc1
 v_mfma_f32_16x16x32_bf16 v[244:247], v[152:155], a[148:151], v[244:247]
 ds_read_b128 v[140:143], v27 offset:35840
 s_mov_b32 s35, 0xffff0000
 v_mfma_f32_16x16x32_bf16 v[244:247], v[156:159], a[220:223], v[244:247]
 v_mfma_f32_16x16x32_bf16 v[248:251], v[96:99], a[144:147], v[248:251]
 s_mov_b64 s[12:13], s[4:5]
 v_mfma_f32_16x16x32_bf16 v[248:251], v[100:103], a[216:219], v[248:251]
 buffer_store_dwordx4 v[20:23], v5, s[16:19], s77 offen sc1
 v_mfma_f32_16x16x32_bf16 v[252:255], v[96:99], a[148:151], v[252:255]
 s_mov_b32 s14, 2359296
 v_mfma_f32_16x16x32_bf16 v[252:255], v[100:103], a[220:223], v[252:255]
 v_mfma_f32_16x16x32_bf16 v[32:35], v[104:107], a[144:147], v[32:35]
 s_mov_b32 s15, 0x20000
 v_mfma_f32_16x16x32_bf16 v[32:35], v[108:111], a[216:219], v[32:35]
 buffer_store_dwordx4 v[20:23], v5, s[16:19], s77 offen offset:1024 sc1
 v_mfma_f32_16x16x32_bf16 v[36:39], v[104:107], a[148:151], v[36:39]
 v_mfma_f32_16x16x32_bf16 v[36:39], v[108:111], a[220:223], v[36:39]
 s_lshl_b32 s32, s24, 11
 v_mfma_f32_16x16x32_bf16 v[40:43], v[112:115], a[144:147], v[40:43]
 s_waitcnt vmcnt(21) lgkmcnt(0)
 s_barrier
 v_mfma_f32_16x16x32_bf16 v[40:43], v[116:119], a[216:219], v[40:43]
 ds_read_b128 v[144:147], v28 offset:0
 s_lshl_b32 s33, s24, 8
 v_mfma_f32_16x16x32_bf16 v[44:47], v[112:115], a[148:151], v[44:47]
 ds_read_b128 v[148:151], v28 offset:9216
 v_mfma_f32_16x16x32_bf16 v[44:47], v[116:119], a[220:223], v[44:47]
 ds_read_b128 v[152:155], v28 offset:1024
 s_add_u32 s33, s33, 8192
 v_mfma_f32_16x16x32_bf16 v[48:51], v[120:123], a[144:147], v[48:51]
 ds_read_b128 v[156:159], v28 offset:10240
 v_mfma_f32_16x16x32_bf16 v[48:51], v[124:127], a[216:219], v[48:51]
 ds_read_b128 v[96:99], v28 offset:2048
 s_lshl_b32 s36, s24, 3
 v_mfma_f32_16x16x32_bf16 v[52:55], v[120:123], a[148:151], v[52:55]
 ds_read_b128 v[100:103], v28 offset:11264
 v_mfma_f32_16x16x32_bf16 v[52:55], v[124:127], a[220:223], v[52:55]
 ds_read_b128 v[104:107], v28 offset:3072
 v_mfma_f32_16x16x32_bf16 v[56:59], v[128:131], a[144:147], v[56:59]
 ds_read_b128 v[108:111], v28 offset:12288
 s_lshl_b32 s37, s24, 6
 v_mfma_f32_16x16x32_bf16 v[56:59], v[132:135], a[216:219], v[56:59]
 ds_read_b128 v[112:115], v28 offset:4096
 v_mfma_f32_16x16x32_bf16 v[60:63], v[128:131], a[148:151], v[60:63]
 ds_read_b128 v[116:119], v28 offset:13312
 v_lshlrev_b32 v19, 4, v0
 v_mfma_f32_16x16x32_bf16 v[60:63], v[132:135], a[220:223], v[60:63]
 buffer_store_dwordx4 v[20:23], v5, s[16:19], s77 offen offset:2048 sc1
 v_mfma_f32_16x16x32_bf16 v[64:67], v[136:139], a[144:147], v[64:67]
 ds_read_b128 v[120:123], v28 offset:5120
 s_load_dwordx4 s[40:43], s[88:89], s61 offset:0
 v_mfma_f32_16x16x32_bf16 v[64:67], v[140:143], a[216:219], v[64:67]
 v_mov_b32 v29, 0
 v_mfma_f32_16x16x32_bf16 v[68:71], v[136:139], a[148:151], v[68:71]
 ds_read_b128 v[124:127], v28 offset:14336
 s_waitcnt lgkmcnt(8)
 v_mfma_f32_16x16x32_bf16 v[68:71], v[140:143], a[220:223], v[68:71]
 v_mov_b32 v30, 1
 v_mfma_f32_16x16x32_bf16 v[224:227], v[144:147], a[8:11], v[224:227]
 ds_read_b128 v[128:131], v28 offset:6144
 v_mfma_f32_16x16x32_bf16 v[224:227], v[148:151], a[80:83], v[224:227]
 v_min_u32 v31, 2, v0
 v_mfma_f32_16x16x32_bf16 v[228:231], v[144:147], a[12:15], v[228:231]
 ds_read_b128 v[132:135], v28 offset:15360
 v_mfma_f32_16x16x32_bf16 v[228:231], v[148:151], a[84:87], v[228:231]
 v_add3_u32 v31, v31, 1, s49
 v_mfma_f32_16x16x32_bf16 v[232:235], v[152:155], a[8:11], v[232:235]
 ds_read_b128 v[136:139], v28 offset:7168
 v_mfma_f32_16x16x32_bf16 v[232:235], v[156:159], a[80:83], v[232:235]
 v_and_b32 v31, 3, v31
 v_mfma_f32_16x16x32_bf16 v[236:239], v[152:155], a[12:15], v[236:239]
 ds_read_b128 v[140:143], v28 offset:16384
 s_waitcnt lgkmcnt(8)
 v_mfma_f32_16x16x32_bf16 v[236:239], v[156:159], a[84:87], v[236:239]
 v_lshlrev_b32 v31, 7, v31
 v_mfma_f32_16x16x32_bf16 v[240:243], v[96:99], a[8:11], v[240:243]
 ds_read_b128 v[144:147], v28 offset:8192
 v_mfma_f32_16x16x32_bf16 v[240:243], v[100:103], a[80:83], v[240:243]
 buffer_store_dwordx4 v[20:23], v5, s[16:19], s77 offen offset:3072 sc1
 v_mfma_f32_16x16x32_bf16 v[244:247], v[96:99], a[12:15], v[244:247]
 ds_read_b128 v[148:151], v28 offset:17408
 v_and_b32 v10, 15, v0
 v_mfma_f32_16x16x32_bf16 v[244:247], v[100:103], a[84:87], v[244:247]
 v_mfma_f32_16x16x32_bf16 v[248:251], v[104:107], a[8:11], v[248:251]
 ds_read_b128 v[152:155], v28 offset:18432
 v_lshrrev_b32 v12, 4, v0
 v_mfma_f32_16x16x32_bf16 v[248:251], v[108:111], a[80:83], v[248:251]
 buffer_store_dwordx4 v[20:23], v6, s[16:19], s77 offen sc1
 v_mfma_f32_16x16x32_bf16 v[252:255], v[104:107], a[12:15], v[252:255]
 ds_read_b128 v[156:159], v28 offset:27648
 s_waitcnt lgkmcnt(8)
 v_mfma_f32_16x16x32_bf16 v[252:255], v[108:111], a[84:87], v[252:255]
 v_mul_u32_u24 v11, 1152, v10
 v_mfma_f32_16x16x32_bf16 v[32:35], v[112:115], a[8:11], v[32:35]
 ds_read_b128 v[96:99], v28 offset:19456
 v_lshl_add_u32 v11, v12, 3, v11
 v_mfma_f32_16x16x32_bf16 v[32:35], v[116:119], a[80:83], v[32:35]
 v_mfma_f32_16x16x32_bf16 v[36:39], v[112:115], a[12:15], v[36:39]
 ds_read_b128 v[100:103], v28 offset:28672
 v_mfma_f32_16x16x32_bf16 v[36:39], v[116:119], a[84:87], v[36:39]
 v_add_u32 v11, s37, v11
 v_mfma_f32_16x16x32_bf16 v[40:43], v[120:123], a[8:11], v[40:43]
 ds_read_b128 v[104:107], v28 offset:20480
 v_mfma_f32_16x16x32_bf16 v[40:43], v[124:127], a[80:83], v[40:43]
 v_add_u32 v12, 18432, v11
 v_mfma_f32_16x16x32_bf16 v[44:47], v[120:123], a[12:15], v[44:47]
 ds_read_b128 v[108:111], v28 offset:29696
 s_waitcnt lgkmcnt(8)
 v_mfma_f32_16x16x32_bf16 v[44:47], v[124:127], a[84:87], v[44:47]
 v_lshlrev_b32 v10, 2, v10
 v_mfma_f32_16x16x32_bf16 v[48:51], v[128:131], a[8:11], v[48:51]
 ds_read_b128 v[112:115], v28 offset:21504
 v_mfma_f32_16x16x32_bf16 v[48:51], v[132:135], a[80:83], v[48:51]
 v_and_b32 v16, 2, v0
 v_mfma_f32_16x16x32_bf16 v[52:55], v[128:131], a[12:15], v[52:55]
 ds_read_b128 v[116:119], v28 offset:30720
 v_mfma_f32_16x16x32_bf16 v[52:55], v[132:135], a[84:87], v[52:55]
 v_mfma_f32_16x16x32_bf16 v[56:59], v[136:139], a[8:11], v[56:59]
 ds_read_b128 v[120:123], v28 offset:22528
 v_lshrrev_b32 v17, 2, v0
 v_mfma_f32_16x16x32_bf16 v[56:59], v[140:143], a[80:83], v[56:59]
 v_mfma_f32_16x16x32_bf16 v[60:63], v[136:139], a[12:15], v[60:63]
 ds_read_b128 v[124:127], v28 offset:31744
 s_waitcnt lgkmcnt(8)
 v_mfma_f32_16x16x32_bf16 v[60:63], v[140:143], a[84:87], v[60:63]
 v_lshl_add_u32 v17, v16, 3, v17
 v_mfma_f32_16x16x32_bf16 v[64:67], v[144:147], a[8:11], v[64:67]
 ds_read_b128 v[128:131], v28 offset:23552
 v_and_b32 v15, 1, v0
 v_mfma_f32_16x16x32_bf16 v[64:67], v[148:151], a[80:83], v[64:67]
 v_mfma_f32_16x16x32_bf16 v[68:71], v[144:147], a[12:15], v[68:71]
 ds_read_b128 v[132:135], v28 offset:32768
 v_lshl_add_u32 v15, v15, 2, s36
 v_mfma_f32_16x16x32_bf16 v[68:71], v[148:151], a[84:87], v[68:71]
 v_mfma_f32_16x16x32_bf16 v[224:227], v[152:155], a[152:155], v[224:227]
 ds_read_b128 v[136:139], v28 offset:24576
 v_mfma_f32_16x16x32_bf16 v[224:227], v[156:159], a[224:227], v[224:227]
 v_mul_u32_u24 v16, 1152, v17
 v_mfma_f32_16x16x32_bf16 v[228:231], v[152:155], a[156:159], v[228:231]
 ds_read_b128 v[140:143], v28 offset:33792
 s_waitcnt lgkmcnt(8)
 v_mfma_f32_16x16x32_bf16 v[228:231], v[156:159], a[228:231], v[228:231]
 v_add_u32 v16, v16, v15
 v_mfma_f32_16x16x32_bf16 v[232:235], v[96:99], a[152:155], v[232:235]
 ds_read_b128 v[144:147], v28 offset:25600
 v_mfma_f32_16x16x32_bf16 v[232:235], v[100:103], a[224:227], v[232:235]
 v_lshlrev_b32 v17, 2, v17
 v_mfma_f32_16x16x32_bf16 v[236:239], v[96:99], a[156:159], v[236:239]
 ds_read_b128 v[148:151], v28 offset:34816
 v_mfma_f32_16x16x32_bf16 v[236:239], v[100:103], a[228:231], v[236:239]
 v_add_u32 v14, s32, v19
 v_mfma_f32_16x16x32_bf16 v[240:243], v[104:107], a[152:155], v[240:243]
 ds_read_b128 v[152:155], v28 offset:26624
 v_mfma_f32_16x16x32_bf16 v[240:243], v[108:111], a[224:227], v[240:243]
 v_mfma_f32_16x16x32_bf16 v[244:247], v[104:107], a[156:159], v[244:247]
 ds_read_b128 v[156:159], v28 offset:35840
 s_waitcnt lgkmcnt(8)
 v_mfma_f32_16x16x32_bf16 v[244:247], v[108:111], a[228:231], v[244:247]
 v_lshl_add_u32 v15, v0, 2, s33
 v_mfma_f32_16x16x32_bf16 v[248:251], v[112:115], a[152:155], v[248:251]
 v_mfma_f32_16x16x32_bf16 v[248:251], v[116:119], a[224:227], v[248:251]
 v_mfma_f32_16x16x32_bf16 v[252:255], v[112:115], a[156:159], v[252:255]
 v_mfma_f32_16x16x32_bf16 v[252:255], v[116:119], a[228:231], v[252:255]
 v_mfma_f32_16x16x32_bf16 v[32:35], v[120:123], a[152:155], v[32:35]
 v_mfma_f32_16x16x32_bf16 v[32:35], v[124:127], a[224:227], v[32:35]
 v_mfma_f32_16x16x32_bf16 v[36:39], v[120:123], a[156:159], v[36:39]
 v_mfma_f32_16x16x32_bf16 v[36:39], v[124:127], a[228:231], v[36:39]
 s_waitcnt lgkmcnt(4)
 v_mfma_f32_16x16x32_bf16 v[40:43], v[128:131], a[152:155], v[40:43]
 s_waitcnt vmcnt(7) lgkmcnt(0)
 s_waitcnt vmcnt(0)
 s_barrier
 v_mfma_f32_16x16x32_bf16 v[40:43], v[132:135], a[224:227], v[40:43]
 ds_read_b128 v[96:99], v8 offset:0
 s_mul_i32 s42, s42, 16843009
 v_mfma_f32_16x16x32_bf16 v[44:47], v[128:131], a[156:159], v[44:47]
 ds_read_b128 v[100:103], v8 offset:49152
 s_and_b32 s40, s40, s41
 v_mfma_f32_16x16x32_bf16 v[44:47], v[132:135], a[228:231], v[44:47]
 ds_read_b128 v[104:107], v9 offset:0
 s_and_b32 s40, s40, s42
 v_mfma_f32_16x16x32_bf16 v[48:51], v[136:139], a[152:155], v[48:51]
 ds_read_b128 v[108:111], v9 offset:9216
 s_and_b32 s40, s40, s43
 v_mfma_f32_16x16x32_bf16 v[48:51], v[140:143], a[224:227], v[48:51]
 ds_read_b128 v[112:115], v8 offset:1024
 v_mfma_f32_16x16x32_bf16 v[52:55], v[136:139], a[156:159], v[52:55]
Lpg15:
 s_cbranch_vccnz Lj_Lfin
 ds_read_b128 v[116:119], v8 offset:50176
 v_mfma_f32_16x16x32_bf16 v[52:55], v[140:143], a[228:231], v[52:55]
 ds_read_b128 v[120:123], v9 offset:1024
 v_mfma_f32_16x16x32_bf16 v[56:59], v[144:147], a[152:155], v[56:59]
 ds_read_b128 v[124:127], v9 offset:10240
 v_mfma_f32_16x16x32_bf16 v[56:59], v[148:151], a[224:227], v[56:59]
 ds_read_b128 v[128:131], v8 offset:2048
 v_mfma_f32_16x16x32_bf16 v[60:63], v[144:147], a[156:159], v[60:63]
 ds_read_b128 v[132:135], v8 offset:51200
 v_mfma_f32_16x16x32_bf16 v[60:63], v[148:151], a[228:231], v[60:63]
 s_cmp_eq_u32 s40, 16843009
 s_cbranch_scc0 Lsp_g10a
Lrt_g10a:
 v_mfma_f32_16x16x32_bf16 v[64:67], v[152:155], a[152:155], v[64:67]
 ds_read_b128 v[136:139], v9 offset:2048
 v_mfma_f32_16x16x32_bf16 v[64:67], v[156:159], a[224:227], v[64:67]
 buffer_load_dwordx4 v[200:203], v14, s[16:19], s72 offen sc1
 v_mfma_f32_16x16x32_bf16 v[68:71], v[152:155], a[156:159], v[68:71]
 ds_read_b128 v[140:143], v9 offset:11264
 s_waitcnt lgkmcnt(6)
 v_mfma_f32_16x16x32_bf16 v[68:71], v[156:159], a[228:231], v[68:71]
 buffer_load_dwordx4 v[204:207], v14, s[16:19], s72 offen offset:1024 sc1
 v_mfma_f32_16x16x32_bf16 v[224:227], v[96:99], v[160:163], v[224:227]
 ds_read_b128 v[144:147], v8 offset:3072
 v_mfma_f32_16x16x32_bf16 v[224:227], v[100:103], v[168:171], v[224:227]
 buffer_load_dword v208, v15, s[16:19], s72 offen sc1
 v_mfma_f32_16x16x32_bf16 v[228:231], v[96:99], v[164:167], v[228:231]
 ds_read_b128 v[148:151], v8 offset:52224
 v_mfma_f32_16x16x32_bf16 v[228:231], v[100:103], v[172:175], v[228:231]
 buffer_load_dword v212, v10, s[16:19], s73 offen sc1
 v_mfma_f32_16x16x32_bf16 v[224:227], v[104:107], v[176:179], v[224:227]
 ds_read_b128 v[152:155], v9 offset:3072
 v_mfma_f32_16x16x32_bf16 v[224:227], v[108:111], v[184:187], v[224:227]
 buffer_load_dword v213, v10, s[16:19], s73 offen offset:64 sc1
 v_mfma_f32_16x16x32_bf16 v[228:231], v[104:107], v[180:183], v[228:231]
 ds_read_b128 v[156:159], v9 offset:12288
 v_mfma_f32_16x16x32_bf16 v[228:231], v[108:111], v[188:191], v[228:231]
 buffer_load_dword v214, v17, s[16:19], s73 offen sc1
 v_mfma_f32_16x16x32_bf16 v[232:235], v[112:115], v[160:163], v[232:235]
 ds_read_b128 v[96:99], v8 offset:4096
 v_mfma_f32_16x16x32_bf16 v[232:235], v[116:119], v[168:171], v[232:235]
 v_mfma_f32_16x16x32_bf16 v[236:239], v[112:115], v[164:167], v[236:239]
 ds_read_b128 v[100:103], v8 offset:53248
 s_waitcnt lgkmcnt(4)
 v_mfma_f32_16x16x32_bf16 v[236:239], v[116:119], v[172:175], v[236:239]
 v_mfma_f32_16x16x32_bf16 v[232:235], v[120:123], v[176:179], v[232:235]
 ds_read_b128 v[104:107], v9 offset:4096
 v_mfma_f32_16x16x32_bf16 v[232:235], v[124:127], v[184:187], v[232:235]
 v_cvt_pk_bf16_f32 v224, v224, v225
 v_mfma_f32_16x16x32_bf16 v[236:239], v[120:123], v[180:183], v[236:239]
 ds_read_b128 v[108:111], v9 offset:13312
 v_cvt_pk_bf16_f32 v225, v226, v227
 v_mfma_f32_16x16x32_bf16 v[236:239], v[124:127], v[188:191], v[236:239]
 v_cvt_pk_bf16_f32 v226, v228, v229
 v_cvt_pk_bf16_f32 v227, v230, v231
 v_mfma_f32_16x16x32_bf16 v[240:243], v[128:131], v[160:163], v[240:243]
 ds_read_b128 v[112:115], v8 offset:5120
 v_mfma_f32_16x16x32_bf16 v[240:243], v[132:135], v[168:171], v[240:243]
 buffer_store_dwordx4 v[224:227], v19, s[16:19], s77 offen sc1
 v_mfma_f32_16x16x32_bf16 v[244:247], v[128:131], v[164:167], v[244:247]
 ds_read_b128 v[116:119], v8 offset:54272
 v_mfma_f32_16x16x32_bf16 v[244:247], v[132:135], v[172:175], v[244:247]
 v_mfma_f32_16x16x32_bf16 v[240:243], v[136:139], v[176:179], v[240:243]
 ds_read_b128 v[120:123], v9 offset:5120
 v_mfma_f32_16x16x32_bf16 v[240:243], v[140:143], v[184:187], v[240:243]
 v_cvt_pk_bf16_f32 v232, v232, v233
 v_mfma_f32_16x16x32_bf16 v[244:247], v[136:139], v[180:183], v[244:247]
 ds_read_b128 v[124:127], v9 offset:14336
 v_cvt_pk_bf16_f32 v233, v234, v235
 v_mfma_f32_16x16x32_bf16 v[244:247], v[140:143], v[188:191], v[244:247]
 v_cvt_pk_bf16_f32 v234, v236, v237
 v_cvt_pk_bf16_f32 v235, v238, v239
 v_mfma_f32_16x16x32_bf16 v[248:251], v[144:147], v[160:163], v[248:251]
 ds_read_b128 v[128:131], v8 offset:6144
 v_mfma_f32_16x16x32_bf16 v[248:251], v[148:151], v[168:171], v[248:251]
 buffer_store_dwordx4 v[232:235], v19, s[16:19], s77 offen offset:1024 sc1
 v_mfma_f32_16x16x32_bf16 v[252:255], v[144:147], v[164:167], v[252:255]
 ds_read_b128 v[132:135], v8 offset:55296
 s_waitcnt lgkmcnt(4)
 v_mfma_f32_16x16x32_bf16 v[252:255], v[148:151], v[172:175], v[252:255]
 v_mfma_f32_16x16x32_bf16 v[248:251], v[152:155], v[176:179], v[248:251]
 ds_read_b128 v[136:139], v9 offset:6144
 v_mfma_f32_16x16x32_bf16 v[248:251], v[156:159], v[184:187], v[248:251]
 v_cvt_pk_bf16_f32 v240, v240, v241
 v_mfma_f32_16x16x32_bf16 v[252:255], v[152:155], v[180:183], v[252:255]
 ds_read_b128 v[140:143], v9 offset:15360
 v_cvt_pk_bf16_f32 v241, v242, v243
 v_mfma_f32_16x16x32_bf16 v[252:255], v[156:159], v[188:191], v[252:255]
 v_cvt_pk_bf16_f32 v242, v244, v245
 v_cvt_pk_bf16_f32 v243, v246, v247
 v_mfma_f32_16x16x32_bf16 v[32:35], v[96:99], v[160:163], v[32:35]
 ds_read_b128 v[144:147], v8 offset:7168
 v_mfma_f32_16x16x32_bf16 v[32:35], v[100:103], v[168:171], v[32:35]
 buffer_store_dwordx4 v[240:243], v19, s[16:19], s77 offen offset:2048 sc1
 v_mfma_f32_16x16x32_bf16 v[36:39], v[96:99], v[164:167], v[36:39]
 ds_read_b128 v[148:151], v8 offset:56320
 v_mfma_f32_16x16x32_bf16 v[36:39], v[100:103], v[172:175], v[36:39]
 v_mfma_f32_16x16x32_bf16 v[32:35], v[104:107], v[176:179], v[32:35]
 ds_read_b128 v[152:155], v9 offset:7168
 v_mfma_f32_16x16x32_bf16 v[32:35], v[108:111], v[184:187], v[32:35]
 v_cvt_pk_bf16_f32 v248, v248, v249
 v_mfma_f32_16x16x32_bf16 v[36:39], v[104:107], v[180:183], v[36:39]
 ds_read_b128 v[156:159], v9 offset:16384
 v_cvt_pk_bf16_f32 v249, v250, v251
 v_mfma_f32_16x16x32_bf16 v[36:39], v[108:111], v[188:191], v[36:39]
 v_cvt_pk_bf16_f32 v250, v252, v253
 v_cvt_pk_bf16_f32 v251, v254, v255
 v_mfma_f32_16x16x32_bf16 v[40:43], v[112:115], v[160:163], v[40:43]
 ds_read_b128 v[96:99], v8 offset:8192
 v_mfma_f32_16x16x32_bf16 v[40:43], v[116:119], v[168:171], v[40:43]
 buffer_store_dwordx4 v[248:251], v19, s[16:19], s77 offen offset:3072 sc1
 v_mfma_f32_16x16x32_bf16 v[44:47], v[112:115], v[164:167], v[44:47]
 ds_read_b128 v[100:103], v8 offset:57344
 s_waitcnt lgkmcnt(4)
 v_mfma_f32_16x16x32_bf16 v[44:47], v[116:119], v[172:175], v[44:47]
 v_mfma_f32_16x16x32_bf16 v[40:43], v[120:123], v[176:179], v[40:43]
 ds_read_b128 v[104:107], v9 offset:8192
 v_mfma_f32_16x16x32_bf16 v[40:43], v[124:127], v[184:187], v[40:43]
 v_cvt_pk_bf16_f32 v32, v32, v33
 v_mfma_f32_16x16x32_bf16 v[44:47], v[120:123], v[180:183], v[44:47]
 ds_read_b128 v[108:111], v9 offset:17408
 v_cvt_pk_bf16_f32 v33, v34, v35
 v_mfma_f32_16x16x32_bf16 v[44:47], v[124:127], v[188:191], v[44:47]
 v_cvt_pk_bf16_f32 v34, v36, v37
 v_cvt_pk_bf16_f32 v35, v38, v39
 v_mfma_f32_16x16x32_bf16 v[48:51], v[128:131], v[160:163], v[48:51]
 buffer_store_dwordx4 v[32:35], v5, s[16:19], s77 offen sc1
 v_mfma_f32_16x16x32_bf16 v[48:51], v[132:135], v[168:171], v[48:51]
 s_waitcnt vmcnt(3)
 v_mfma_f32_16x16x32_bf16 v[52:55], v[128:131], v[164:167], v[52:55]
 buffer_store_dword v30, v29, s[16:19], s74 offen sc1
 v_mfma_f32_16x16x32_bf16 v[52:55], v[132:135], v[172:175], v[52:55]
 v_mfma_f32_16x16x32_bf16 v[48:51], v[136:139], v[176:179], v[48:51]
 v_mfma_f32_16x16x32_bf16 v[48:51], v[140:143], v[184:187], v[48:51]
 v_cvt_pk_bf16_f32 v40, v40, v41
 v_mfma_f32_16x16x32_bf16 v[52:55], v[136:139], v[180:183], v[52:55]
 v_cvt_pk_bf16_f32 v41, v42, v43
 v_mfma_f32_16x16x32_bf16 v[52:55], v[140:143], v[188:191], v[52:55]
 v_cvt_pk_bf16_f32 v42, v44, v45
 v_cvt_pk_bf16_f32 v43, v46, v47
 v_mfma_f32_16x16x32_bf16 v[56:59], v[144:147], v[160:163], v[56:59]
 buffer_store_dwordx4 v[40:43], v5, s[16:19], s77 offen offset:1024 sc1
 v_mfma_f32_16x16x32_bf16 v[56:59], v[148:151], v[168:171], v[56:59]
 buffer_load_dword v20, v31, s[16:19], s75 offen sc1
 v_mfma_f32_16x16x32_bf16 v[60:63], v[144:147], v[164:167], v[60:63]
 v_mfma_f32_16x16x32_bf16 v[60:63], v[148:151], v[172:175], v[60:63]
 s_waitcnt lgkmcnt(0)
 v_mfma_f32_16x16x32_bf16 v[56:59], v[152:155], v[176:179], v[56:59]
 v_mfma_f32_16x16x32_bf16 v[56:59], v[156:159], v[184:187], v[56:59]
 v_cvt_pk_bf16_f32 v48, v48, v49
 v_mfma_f32_16x16x32_bf16 v[60:63], v[152:155], v[180:183], v[60:63]
 v_cvt_pk_bf16_f32 v49, v50, v51
 v_mfma_f32_16x16x32_bf16 v[60:63], v[156:159], v[188:191], v[60:63]
 v_cvt_pk_bf16_f32 v50, v52, v53
 v_cvt_pk_bf16_f32 v51, v54, v55
 v_mfma_f32_16x16x32_bf16 v[64:67], v[96:99], v[160:163], v[64:67]
 buffer_store_dwordx4 v[48:51], v5, s[16:19], s77 offen offset:2048 sc1
 v_mfma_f32_16x16x32_bf16 v[64:67], v[100:103], v[168:171], v[64:67]
 v_mfma_f32_16x16x32_bf16 v[68:71], v[96:99], v[164:167], v[68:71]
 v_mfma_f32_16x16x32_bf16 v[68:71], v[100:103], v[172:175], v[68:71]
 v_mfma_f32_16x16x32_bf16 v[64:67], v[104:107], v[176:179], v[64:67]
 v_mfma_f32_16x16x32_bf16 v[64:67], v[108:111], v[184:187], v[64:67]
 v_cvt_pk_bf16_f32 v56, v56, v57
 v_mfma_f32_16x16x32_bf16 v[68:71], v[104:107], v[180:183], v[68:71]
 v_cvt_pk_bf16_f32 v57, v58, v59
 v_mfma_f32_16x16x32_bf16 v[68:71], v[108:111], v[188:191], v[68:71]
 v_cvt_pk_bf16_f32 v58, v60, v61
 v_cvt_pk_bf16_f32 v59, v62, v63
 buffer_store_dwordx4 v[56:59], v5, s[16:19], s77 offen offset:3072 sc1
 s_nop 0
 v_cvt_pk_bf16_f32 v64, v64, v65
 v_cvt_pk_bf16_f32 v65, v66, v67
 s_nop 1
 v_cvt_pk_bf16_f32 v66, v68, v69
 v_cvt_pk_bf16_f32 v67, v70, v71
 buffer_store_dwordx4 v[64:67], v6, s[16:19], s77 offen sc1
 s_waitcnt vmcnt(3)
 v_cmp_eq_u32 vcc, 0, v20
 s_nop 1
 s_and_b32 s43, vcc_lo, -1
 s_cbranch_scc1 Lnl_g10
 buffer_load_dwordx4 v[96:99], v14, s[16:19], s78 offen sc1
 buffer_load_dwordx4 v[100:103], v14, s[16:19], s79 offen sc1
 buffer_load_dwordx4 v[104:107], v14, s[16:19], s0 offen sc1
 buffer_load_dwordx4 v[108:111], v14, s[16:19], s78 offen offset:1024 sc1
 buffer_load_dwordx4 v[112:115], v14, s[16:19], s79 offen offset:1024 sc1
 buffer_load_dwordx4 v[116:119], v14, s[16:19], s0 offen offset:1024 sc1
 buffer_load_dword v120, v15, s[16:19], s78 offen sc1
 buffer_load_dword v121, v15, s[16:19], s79 offen sc1
 buffer_load_dword v122, v15, s[16:19], s0 offen sc1
Lnl_g10:
 s_cmp_lg_u32 s24, s49
 s_cbranch_scc1 Lfin
 ds_write_b128 v19, v[224:227] offset:0
 ds_write_b128 v19, v[232:235] offset:1024
 ds_write_b128 v19, v[240:243] offset:2048
 ds_write_b128 v19, v[248:251] offset:3072
 ds_write_b128 v19, v[32:35] offset:4096
 ds_write_b128 v19, v[40:43] offset:5120
 ds_write_b128 v19, v[48:51] offset:6144
 ds_write_b128 v19, v[56:59] offset:7168
 ds_write_b128 v19, v[64:67] offset:8192
 s_branch Lfin
L1_helper:
 s_sub_u32 s14, s2, 216
 s_cmp_ge_u32 s14, 36
 s_cbranch_scc1 L1_gate
 s_lshr_b32 s15, s14, 3
 s_lshl_b32 s25, s12, 2
 s_add_u32 s25, s25, s15
 s_cmp_ge_u32 s14, 32
 s_cselect_b32 s25, s14, s25
 s_mov_b32 s51, s25
 v_lshlrev_b32 v3, 2, v0
 s_lshl_b32 s26, s25, 4
 s_add_u32 s26, s26, s24
 s_lshl_b32 s27, s26, 8
 v_add_u32 v6, s27, v3
 s_lshr_b32 s26, s26, 1
 s_lshl_b32 s26, s26, 2
 s_waitcnt lgkmcnt(0)
 global_load_dword v44, v6, s[66:67] offset:3072
 global_load_dword v45, v6, s[68:69] offset:3072
 global_load_dword v46, v6, s[70:71] offset:3072
 global_load_dword v47, v6, s[72:73] offset:3072
 s_add_u32 s74, s74, s26
 s_addc_u32 s75, s75, 0
 s_add_u32 s76, s76, s26
 s_addc_u32 s77, s77, 0
 s_load_dword s56, s[74:75], 0
 s_load_dword s32, s[76:77], 0
 s_load_dword s57, s[74:75], 8
 s_load_dword s33, s[76:77], 8
 s_load_dword s58, s[74:75], 16
 s_load_dword s34, s[76:77], 16
 s_load_dword s59, s[74:75], 24
 s_load_dword s35, s[76:77], 24
 global_load_dword v40, v6, s[66:67] offset:2048
 global_load_dword v41, v6, s[68:69] offset:2048
 global_load_dword v42, v6, s[70:71] offset:2048
 global_load_dword v43, v6, s[72:73] offset:2048
 global_load_dword v36, v6, s[66:67] offset:1024
 global_load_dword v37, v6, s[68:69] offset:1024
 global_load_dword v38, v6, s[70:71] offset:1024
 global_load_dword v39, v6, s[72:73] offset:1024
 global_load_dword v32, v6, s[66:67] offset:0
 global_load_dword v33, v6, s[68:69] offset:0
 global_load_dword v34, v6, s[70:71] offset:0
 global_load_dword v35, v6, s[72:73] offset:0
 s_mov_b32 s8, s64
 s_mov_b32 s9, s65
 s_mov_b32 s10, 2359296
 s_mov_b32 s11, 0x20000
 s_mov_b32 s16, s88
 s_mov_b32 s17, s89
 s_mov_b32 s18, 268435456
 s_mov_b32 s19, 0x20000
 v_lshrrev_b32 v4, 1, v0
 v_and_b32 v4, 19, v4
 v_and_b32 v5, 8, v0
 v_or_b32 v4, v4, v5
 v_bfe_u32 v5, v0, 4, 1
 v_lshl_or_b32 v4, v5, 2, v4
 v_mul_u32_u24 v4, 1152, v4
 v_and_b32 v5, 1, v0
 v_lshl_add_u32 v4, v5, 4, v4
 s_mul_i32 s28, s24, 589824
 s_lshl_b32 s29, s25, 5
 s_add_u32 s28, s28, s29
 s_lshl_b32 s29, s24, 14
 s_add_u32 s29, s29, 87744
 s_mul_i32 s30, s24, 8976
 s_getpc_b64 s[46:47]
L_pct:
 s_add_u32 s46, s46, L_table-L_pct
 s_addc_u32 s47, s47, 0
 s_lshl_b32 s44, s14, 2
 s_add_u32 s44, s44, s24
 s_mul_i32 s44, s44, 96
 v_min_u32 v94, 23, v0
 v_lshl_add_u32 v94, v94, 2, s44
 global_load_dword v94, v94, s[46:47]
 v_lshrrev_b32 v48, 4, v0
 v_and_b32 v49, 15, v0
 v_lshl_add_u32 v48, v48, 3, v49
 v_min_u32 v48, 31, v48
 s_mov_b32 s44, 0x10001
 v_mov_b32 v49, 267911168
 v_lshrrev_b32 v49, v48, v49
 v_bfe_u32 v50, v49, 0, 2
 v_lshl_or_b32 v50, v50, 15, v50
 v_and_b32 v50, s44, v50
 v_mul_u32_u24 v50, 0x3f80, v50
 v_accvgpr_write_b32 a228, v50
 v_bfe_u32 v50, v49, 2, 2
 v_lshl_or_b32 v50, v50, 15, v50
 v_and_b32 v50, s44, v50
 v_mul_u32_u24 v50, 0x3f80, v50
 v_accvgpr_write_b32 a229, v50
 v_bfe_u32 v50, v49, 4, 2
 v_lshl_or_b32 v50, v50, 15, v50
 v_and_b32 v50, s44, v50
 v_mul_u32_u24 v50, 0x3f80, v50
 v_accvgpr_write_b32 a230, v50
 v_bfe_u32 v50, v49, 6, 2
 v_lshl_or_b32 v50, v50, 15, v50
 v_and_b32 v50, s44, v50
 v_mul_u32_u24 v50, 0x3f80, v50
 v_accvgpr_write_b32 a231, v50
 v_accvgpr_write_b32 a200, 0
 v_accvgpr_write_b32 a201, 0
 v_mov_b32 v49, 133169152
 v_lshrrev_b32 v49, v48, v49
 v_bfe_u32 v50, v49, 0, 2
 v_lshl_or_b32 v50, v50, 15, v50
 v_and_b32 v50, s44, v50
 v_mul_u32_u24 v50, 0x3f80, v50
 v_accvgpr_write_b32 a232, v50
 v_bfe_u32 v50, v49, 2, 2
 v_lshl_or_b32 v50, v50, 15, v50
 v_and_b32 v50, s44, v50
 v_mul_u32_u24 v50, 0x3f80, v50
 v_accvgpr_write_b32 a233, v50
 v_bfe_u32 v50, v49, 4, 2
 v_lshl_or_b32 v50, v50, 15, v50
 v_and_b32 v50, s44, v50
 v_mul_u32_u24 v50, 0x3f80, v50
 v_accvgpr_write_b32 a234, v50
 v_bfe_u32 v50, v49, 6, 2
 v_lshl_or_b32 v50, v50, 15, v50
 v_and_b32 v50, s44, v50
 v_mul_u32_u24 v50, 0x3f80, v50
 v_accvgpr_write_b32 a235, v50
 v_accvgpr_write_b32 a210, 0
 v_accvgpr_write_b32 a211, 0
 s_and_b32 s3, s24, 1
 s_xor_b32 s3, s3, 1
 s_lshl_b32 s3, s3, 4
 v_lshrrev_b32 v1, 4, v0
 v_and_b32 v2, 15, v0
 s_mul_i32 s31, s24, 8320
 s_add_u32 s31, s31, 54464
 v_and_b32 v5, 31, v0
 v_lshrrev_b32 v7, 5, v0
 v_mul_u32_u24 v8, 272, v5
 v_lshl_add_u32 v8, v7, 4, v8
 v_add_u32 v8, s30, v8
 v_lshlrev_b32 v9, 4, v5
 v_add_u32 v9, s31, v9
 v_lshl_add_u32 v9, v7, 9, v9
 v_and_b32 v10, 30, v0
 v_lshl_add_u32 v10, v7, 6, v10
 v_sub_u32 v10, 3678, v10
 v_and_b32 v11, 1, v0
 v_mul_u32_u24 v11, 384, v11
 v_sub_u32 v10, v10, v11
 v_add_u32 v10, s31, v10
 v_add_u32 v11, s31, v3
 v_mov_b32 v28, 0
 ds_write_b32 v11, v28 offset:3200
 ds_write_b32 v11, v28 offset:3456
 ds_write_b32 v11, v28 offset:3712
 v_and_b32 v11, 28, v3
 v_bfe_u32 v13, v0, 3, 1
 v_mul_u32_u24 v13, 4160, v13
 v_add3_u32 v11, v11, v13, s31
 v_mov_b32 v28, 0
 ds_write_b32 v11, v28
 v_mov_b32 v11, 8316
 v_mov_b32 v13, 4188
 v_cmp_eq_u32 vcc, 0, v0
 s_nop 1
 v_cndmask_b32 v11, v11, v13, vcc
 v_cndmask_b32 v12, 0, -1, vcc
 v_add_u32 v11, s31, v11
 v_and_b32 v13, 1, v0
 v_cmp_eq_u32 s[12:13], 1, v13
 v_add_u32 v13, 1, v2
 v_and_b32 v14, 1, v13
 v_mul_u32_u24 v14, 4160, v14
 v_lshrrev_b32 v13, 1, v13
 v_lshl_add_u32 v13, v1, 2, v13
 v_lshl_add_u32 v14, v13, 2, v14
 v_add_u32 v14, s31, v14
 v_add_u32 v15, 1024, v14
 v_add_u32 v16, 2048, v14
 v_sub_u32 v13, 15, v2
 v_and_b32 v17, 1, v13
 v_mul_u32_u24 v17, 192, v17
 v_lshrrev_b32 v13, 1, v13
 v_lshl_add_u32 v13, v1, 1, v13
 v_lshl_add_u32 v17, v13, 2, v17
 s_add_u32 s14, s31, 3200
 v_add_u32 v17, s14, v17
 s_mul_i32 s31, s24, 4640
 s_add_u32 s31, s31, 35904
 v_lshlrev_b32 v19, 3, v2
 v_lshl_add_u32 v19, v1, 7, v19
 v_add_u32 v19, s31, v19
 v_add_u32 v19, -35904, v19
 v_lshlrev_b32 v13, 5, v2
 v_lshlrev_b32 v18, 4, v1
 v_sub_u32 v18, v18, v13
 v_add_u32 v18, 480, v18
 v_add_u32 v18, s31, v18
 v_add_u32 v27, -35904, v18
 v_lshrrev_b32 v25, 2, v2
 v_and_b32 v26, 3, v0
 v_lshl_add_u32 v24, v1, 2, v25
 v_and_b32 v22, 1, v0
 v_and_b32 v23, 2, v0
 v_lshl_add_u32 v22, v23, 1, v22
 v_lshl_add_u32 v22, v1, 3, v22
 v_lshlrev_b32 v22, 2, v22
 v_sub_u32 v22, v22, v25
 v_add_u32 v22, 3, v22
 v_lshlrev_b32 v22, 5, v22
 v_add_u32 v22, s29, v22
 v_lshlrev_b32 v24, 4, v24
 v_mul_u32_u24 v23, 4640, v26
 v_sub_u32 v24, v23, v24
 s_lshl_b32 s14, s24, 10
 s_sub_u32 s15, 39216, s14
 v_add_u32 v24, s15, v24
 v_mul_u32_u24 v23, 4640, v25
 v_lshl_add_u32 v23, v26, 7, v23
 v_lshl_add_u32 v23, v1, 4, v23
 s_sub_u32 s14, 3072, s14
 v_add_u32 v23, s14, v23
 v_mul_u32_u24 v26, 36864, v1
 v_lshl_add_u32 v26, v2, 4, v26
 v_min_u32 v25, 30, v5
 v_lshlrev_b32 v25, 4, v25
 v_mul_i32_i24 v29, -35904, v7
 v_add3_u32 v25, v25, v29, s31
 v_mov_b32 v29, 0
 v_mov_b32 v30, 0
 v_mov_b32 v31, 0
 s_mul_i32 s26, s24, 589824
 s_lshl_b32 s15, s25, 10
 s_add_u32 s26, s26, s15
 s_add_u32 s26, s26, 27262976
 s_mov_b32 s27, 0x20000000
 s_mov_b32 s54, -35904
 s_mov_b32 s52, 0x3fb8aa3b
 s_mov_b32 s53, 0xffff0000
 s_mov_b32 s50, 0
 s_mov_b32 s62, 1107296256
 s_mov_b32 s63, s62
 s_mov_b32 s48, 0x43800000
 s_mov_b32 s49, 0x43800000
 s_mov_b32 m0, s30
 v_mov_b32 v13, 0x3c00
 ds_write_addtid_b32 v13 offset:8704
 v_mov_b32 v13, v5
 v_writelane_b32 v13, 4, 5
 v_writelane_b32 v13, 4, 37
 v_writelane_b32 v13, 7, 12
 v_writelane_b32 v13, 7, 44
 v_writelane_b32 v13, 7, 13
 v_writelane_b32 v13, 7, 45
 v_writelane_b32 v13, 15, 20
 v_writelane_b32 v13, 15, 52
 v_writelane_b32 v13, 32, 0
 v_writelane_b32 v13, 32, 32
 v_mul_u32_u24 v13, 272, v13
 v_lshl_add_u32 v13, v7, 4, v13
 v_add_u32 v13, s30, v13
 v_cmp_gt_u32 vcc, 2, v0
 s_nop 1
 v_cndmask_b32 v5, 0, -1, vcc
Lswarm:
 s_mov_b64 vcc, -1
 s_cmp_lg_u32 s24, 0
 s_cbranch_scc1 Lhs0
 s_call_b64 s[22:23], Lpg18
 s_branch Lhse
Lhs0:
 s_cmp_lg_u32 s24, 1
 s_cbranch_scc1 Lhs1
 s_call_b64 s[22:23], Lpg19
 s_branch Lhse
Lhs1:
 s_cmp_lg_u32 s24, 2
 s_cbranch_scc1 Lhs2
 s_call_b64 s[22:23], Lpg16
 s_call_b64 s[22:23], Lpg20
 s_branch Lhse
Lhs2:
 s_call_b64 s[22:23], Lpg17
 s_call_b64 s[22:23], Lpg21
Lhse:
 s_mov_b64 vcc, 0
 s_nop 0
 s_waitcnt vmcnt(13) lgkmcnt(0)
 s_lshl_b32 s14, s59, s3
 s_lshl_b32 s15, s35, s3
 s_and_b32 s14, s14, s53
 s_and_b32 s15, s15, s53
 v_mov_b32 v254, s14
 v_lshlrev_b32 v48, 16, v44
 v_and_b32 v49, s53, v44
 v_mul_f32 v254, s52, v254
 v_mul_f32 v48, s52, v48
 v_mul_f32 v49, s52, v49
 v_exp_f32 v254, v254
 v_exp_f32 v48, v48
 v_exp_f32 v49, v49
 v_and_b32 v255, s15, v12
 v_lshlrev_b32 v52, 16, v46
 v_and_b32 v53, s53, v46
 v_lshlrev_b32 v54, 16, v47
 v_and_b32 v55, s53, v47
 v_max_f32 v92, |v52|, |v53|
 v_max3_f32 v92, |v54|, |v55|, v92
 v_cvt_pk_bf16_f32 v254, v254, v254
 v_cvt_pk_bf16_f32 v49, v48, v49
 v_max_f32 v92, v92, v92 row_shr:1 row_mask:0xf bank_mask:0xf
 v_and_b32 v254, s53, v254
 v_lshlrev_b32 v50, 16, v45
 v_max_f32 v92, v92, v92 row_shr:2 row_mask:0xf bank_mask:0xf
 v_and_b32 v51, s53, v45
 v_lshlrev_b32 v48, 16, v49
 v_max_f32 v92, v92, v92 row_shr:4 row_mask:0xf bank_mask:0xf
 v_and_b32 v49, s53, v49
 v_mul_f32 v50, v50, v254
 v_max_f32 v92, v92, v92 row_shr:8 row_mask:0xf bank_mask:0xf
 v_mul_f32 v51, v51, v254
 v_mul_f32 v48, v48, v254
 v_max_f32 v92, v92, v92 row_bcast:15 row_mask:0xa bank_mask:0xf
 v_mul_f32 v49, v49, v254
 v_mul_f32 v50, 0.15915494, v50
 v_max_f32 v92, v92, v92 row_bcast:31 row_mask:0xc bank_mask:0xf
 v_mul_f32 v51, 0.15915494, v51
 v_mul_f32 v48, s52, v48
 v_readlane_b32 s14, v92, 63
 v_mul_f32 v49, s52, v49
 s_lshr_b32 s14, s14, 23
 s_min_u32 s14, s14, 250
 s_sub_u32 s15, 253, s14
 s_lshl_b32 s15, s15, 23
 s_add_u32 s14, s14, 2
 s_lshl_b32 s14, s14, 23
 v_mul_f32 v52, s15, v52
 v_mul_f32 v53, s15, v53
 v_mul_f32 v54, s15, v54
 v_mul_f32 v55, s15, v55
 v_mul_f32 v254, s14, v254
 v_cvt_pk_f16_f32 v152, v52, v54
 v_cvt_pk_f16_f32 v184, v53, v55
Lk_loop:
 s_and_b32 s51, s51, 3
 s_lshl_b32 s44, s51, 12
 s_add_u32 s44, s44, s29
 s_mov_b32 m0, s44
 s_mul_i32 s55, s51, 147456
 s_add_u32 s55, s55, s28
 s_add_u32 s51, s51, 1
 buffer_load_dwordx4 v4, s[8:11], s55 offen lds
 s_add_u32 s55, s55, 35840
 v_exp_f32 v56, -v48
 v_pk_mul_f32 v[64:65], v[48:49], s[62:63]
 v_exp_f32 v57, -v49
 v_pk_mul_f32 v[66:67], v[50:51], s[62:63]
 v_rndne_f32 v60, v50
 v_exp_f32 v64, -v64
 v_rndne_f32 v61, v51
 v_exp_f32 v65, -v65
 v_pk_add_f32 v[58:59], v[50:51], v[60:61] neg_lo:[0,1] neg_hi:[0,1]
 v_rndne_f32 v68, v66
 v_cos_f32 v60, v58
 v_rndne_f32 v69, v67
 v_cos_f32 v61, v59
 v_pk_add_f32 v[66:67], v[66:67], v[68:69] neg_lo:[0,1] neg_hi:[0,1]
 v_sin_f32 v58, v58
 v_cos_f32 v68, v66
 v_sin_f32 v59, v59
 v_cos_f32 v69, v67
 v_pk_mul_f32 v[60:61], v[56:57], v[60:61]
 v_sin_f32 v66, v66
 v_pk_mul_f32 v[58:59], v[56:57], v[58:59]
 v_sin_f32 v67, v67
 v_cvt_pk_f16_f32 v98, v60, -v58
 v_pk_mul_f32 v[68:69], v[64:65], v[68:69]
 v_cvt_pk_f16_f32 v99, v61, -v59
 v_pk_mul_f32 v[66:67], v[64:65], v[66:67]
 v_pk_mul_f32 v[56:57], v[58:59], v[58:59]
 v_cvt_pk_f16_f32 v84, v68, v66
 v_pk_add_f32 v[62:63], v[60:61], v[60:61]
 v_cvt_pk_f16_f32 v85, v69, v67
 v_pk_fma_f32 v[60:61], v[60:61], v[60:61], v[56:57] neg_lo:[0,0,1] neg_hi:[0,0,1]
 v_pk_mul_f32 v[64:65], v[66:67], v[66:67]
 v_pk_mul_f32 v[58:59], v[62:63], v[58:59]
 v_pk_add_f32 v[70:71], v[68:69], v[68:69]
 v_cvt_pk_f16_f32 v100, v60, -v58
 v_pk_fma_f32 v[68:69], v[68:69], v[68:69], v[64:65] neg_lo:[0,0,1] neg_hi:[0,0,1]
 v_cvt_pk_f16_f32 v101, v61, -v59
 v_pk_mul_f32 v[66:67], v[70:71], v[66:67]
 v_pk_mul_f32 v[56:57], v[58:59], v[58:59]
 v_cvt_pk_f16_f32 v86, v68, v66
 v_pk_add_f32 v[62:63], v[60:61], v[60:61]
 v_cvt_pk_f16_f32 v87, v69, v67
 v_pk_fma_f32 v[60:61], v[60:61], v[60:61], v[56:57] neg_lo:[0,0,1] neg_hi:[0,0,1]
 v_pk_mul_f32 v[64:65], v[66:67], v[66:67]
 v_pk_mul_f32 v[58:59], v[62:63], v[58:59]
 v_pk_add_f32 v[70:71], v[68:69], v[68:69]
 v_cvt_pk_f16_f32 v104, v60, -v58
 v_pk_fma_f32 v[68:69], v[68:69], v[68:69], v[64:65] neg_lo:[0,0,1] neg_hi:[0,0,1]
 v_cvt_pk_f16_f32 v105, v61, -v59
 v_pk_mul_f32 v[66:67], v[70:71], v[66:67]
 v_pk_mul_f32 v[56:57], v[58:59], v[58:59]
 v_cvt_pk_f16_f32 v88, v68, v66
 v_pk_add_f32 v[62:63], v[60:61], v[60:61]
 v_cvt_pk_f16_f32 v89, v69, v67
 v_pk_fma_f32 v[60:61], v[60:61], v[60:61], v[56:57] neg_lo:[0,0,1] neg_hi:[0,0,1]
 v_pk_mul_f32 v[64:65], v[66:67], v[66:67]
 v_pk_mul_f32 v[58:59], v[62:63], v[58:59]
 v_pk_add_f32 v[70:71], v[68:69], v[68:69]
 v_cvt_pk_f16_f32 v80, v60, v58
 v_pk_fma_f32 v[68:69], v[68:69], v[68:69], v[64:65] neg_lo:[0,0,1] neg_hi:[0,0,1]
 buffer_load_dwordx4 v4, s[8:11], s55 offen offset:1024 lds
 s_add_u32 s55, s55, 35840
 s_mov_b32 m0, s30
 v_cvt_pk_f16_f32 v81, v61, v59
 v_pk_mul_f32 v[66:67], v[70:71], v[66:67]
 v_cvt_pk_f16_f32 v112, v60, -v58
 v_cvt_pk_f16_f32 v114, v68, -v66
 v_cvt_pk_f16_f32 v113, v61, -v59
 v_cvt_pk_f16_f32 v115, v69, -v67
 v_pk_mul_f32 v[56:57], v[58:59], v[58:59]
 v_pk_mul_f32 v[64:65], v[66:67], v[66:67]
Lpg16:
 s_cbranch_vccnz Lj_Lfin
 v_pk_add_f32 v[62:63], v[60:61], v[60:61]
 v_pk_add_f32 v[70:71], v[68:69], v[68:69]
 v_pk_fma_f32 v[60:61], v[60:61], v[60:61], v[56:57] neg_lo:[0,0,1] neg_hi:[0,0,1]
 v_pk_fma_f32 v[68:69], v[68:69], v[68:69], v[64:65] neg_lo:[0,0,1] neg_hi:[0,0,1]
 v_pk_mul_f32 v[58:59], v[62:63], v[58:59]
 v_pk_mul_f32 v[66:67], v[70:71], v[66:67]
 v_cvt_pk_f16_f32 v82, v60, v58
 v_cvt_pk_f16_f32 v124, v68, -v66
 v_cvt_pk_f16_f32 v83, v61, v59
 v_cvt_pk_f16_f32 v125, v69, -v67
 v_pk_mul_f32 v[64:65], v[66:67], v[66:67]
 v_pk_add_f32 v[70:71], v[68:69], v[68:69]
 v_pk_fma_f32 v[68:69], v[68:69], v[68:69], v[64:65] neg_lo:[0,0,1] neg_hi:[0,0,1]
 v_pk_mul_f32 v[66:67], v[70:71], v[66:67]
 v_cvt_pk_f16_f32 v136, v68, -v66
 v_cvt_pk_f16_f32 v137, v69, -v67
 v_pk_mul_f16 v102, v98, v100 op_sel:[0,0] op_sel_hi:[1,0]
 v_pk_mul_f16 v106, v98, v104 op_sel:[0,0] op_sel_hi:[1,0]
 v_pk_mul_f16 v108, v100, v104 op_sel:[0,0] op_sel_hi:[1,0]
 v_pk_mul_f16 v130, v114, v124 op_sel:[0,0] op_sel_hi:[1,0]
 v_pk_mul_f16 v138, v136, v112 op_sel:[0,0] op_sel_hi:[1,0]
 v_pk_mul_f16 v116, v114, v100 op_sel:[0,0] op_sel_hi:[1,0]
 v_pk_mul_f16 v118, v114, v104 op_sel:[0,0] op_sel_hi:[1,0]
 v_pk_mul_f16 v126, v124, v104 op_sel:[0,0] op_sel_hi:[1,0]
 v_pk_fma_f16 v102, v98, v100, v102 op_sel:[1,1,0] op_sel_hi:[0,1,1] neg_lo:[1,0,0]
 v_pk_fma_f16 v106, v98, v104, v106 op_sel:[1,1,0] op_sel_hi:[0,1,1] neg_lo:[1,0,0]
 v_pk_fma_f16 v108, v100, v104, v108 op_sel:[1,1,0] op_sel_hi:[0,1,1] neg_lo:[1,0,0]
 v_pk_fma_f16 v130, v114, v124, v130 op_sel:[1,1,0] op_sel_hi:[0,1,1] neg_lo:[1,0,0]
 v_pk_fma_f16 v138, v136, v112, v138 op_sel:[1,1,0] op_sel_hi:[0,1,1] neg_lo:[1,0,0]
 v_pk_fma_f16 v116, v114, v100, v116 op_sel:[1,1,0] op_sel_hi:[0,1,1] neg_lo:[1,0,0]
 v_pk_fma_f16 v118, v114, v104, v118 op_sel:[1,1,0] op_sel_hi:[0,1,1] neg_lo:[1,0,0]
 v_pk_fma_f16 v126, v124, v104, v126 op_sel:[1,1,0] op_sel_hi:[0,1,1] neg_lo:[1,0,0]
 v_pk_mul_f16 v110, v102, v104 op_sel:[0,0] op_sel_hi:[1,0]
 v_pk_mul_f16 v120, v114, v108 op_sel:[0,0] op_sel_hi:[1,0]
 v_pk_mul_f16 v132, v130, v104 op_sel:[0,0] op_sel_hi:[1,0]
 v_pk_mul_f16 v142, v138, v114 op_sel:[0,0] op_sel_hi:[1,0]
 v_pk_mul_f16 v146, v138, v124 op_sel:[0,0] op_sel_hi:[1,0]
 v_pk_mul_f16 v150, v138, v130 op_sel:[0,0] op_sel_hi:[1,0]
 v_pk_fma_f16 v110, v102, v104, v110 op_sel:[1,1,0] op_sel_hi:[0,1,1] neg_lo:[1,0,0]
 v_pk_fma_f16 v120, v114, v108, v120 op_sel:[1,1,0] op_sel_hi:[0,1,1] neg_lo:[1,0,0]
 v_pk_fma_f16 v132, v130, v104, v132 op_sel:[1,1,0] op_sel_hi:[0,1,1] neg_lo:[1,0,0]
 v_pk_fma_f16 v142, v138, v114, v142 op_sel:[1,1,0] op_sel_hi:[0,1,1] neg_lo:[1,0,0]
 v_pk_fma_f16 v146, v138, v124, v146 op_sel:[1,1,0] op_sel_hi:[0,1,1] neg_lo:[1,0,0]
 v_pk_fma_f16 v150, v138, v130, v150 op_sel:[1,1,0] op_sel_hi:[0,1,1] neg_lo:[1,0,0]
 ds_write_addtid_b32 v98 offset:272
 ds_write_addtid_b32 v100 offset:544
 ds_write_addtid_b32 v102 offset:816
 ds_write_addtid_b32 v114 offset:1088
 ds_write_addtid_b32 v116 offset:1632
 ds_write_addtid_b32 v118 offset:1904
 ds_write_addtid_b32 v104 offset:2176
 ds_write_addtid_b32 v106 offset:2448
 ds_write_addtid_b32 v108 offset:2720
 ds_write_addtid_b32 v110 offset:2992
 ds_write_addtid_b32 v120 offset:3808
 ds_write_addtid_b32 v124 offset:4624
 ds_write_addtid_b32 v126 offset:4896
 ds_write_addtid_b32 v130 offset:5712
 ds_write_addtid_b32 v132 offset:5984
 ds_write_addtid_b32 v136 offset:6528
 ds_write_addtid_b32 v138 offset:6800
 ds_write_addtid_b32 v142 offset:7344
 ds_write_addtid_b32 v146 offset:7888
 ds_write_addtid_b32 v150 offset:8432
 ds_read_b128 a[0:3], v13 offset:0
 ds_read_b128 a[4:7], v13 offset:32
 ds_read_b128 a[8:11], v13 offset:64
 ds_read_b128 a[12:15], v13 offset:96
 ds_read_b128 a[16:19], v13 offset:128
 ds_read_b128 a[20:23], v13 offset:160
 ds_read_b128 a[24:27], v13 offset:192
 ds_read_b128 a[28:31], v13 offset:224
 s_mov_b32 m0, s44
 s_nop 0
 buffer_load_dwordx4 v4, s[8:11], s55 offen offset:2048 lds
 s_add_u32 s55, s55, 35840
 s_mov_b32 m0, s30
 v_pk_mul_f16 v153, v152, v80 op_sel:[0,0] op_sel_hi:[1,0]
 v_pk_fma_f16 v153, v152, v80, v153 op_sel:[1,1,0] op_sel_hi:[0,1,1] neg_lo:[1,0,0]
 v_pk_mul_f16 v154, v152, v82 op_sel:[0,0] op_sel_hi:[1,0]
 v_pk_mul_f16 v155, v153, v82 op_sel:[0,0] op_sel_hi:[1,0]
 v_pk_fma_f16 v154, v152, v82, v154 op_sel:[1,1,0] op_sel_hi:[0,1,1] neg_lo:[1,0,0]
 v_pk_fma_f16 v155, v153, v82, v155 op_sel:[1,1,0] op_sel_hi:[0,1,1] neg_lo:[1,0,0]
 v_pk_mul_f16 v156, v152, v84 op_sel:[0,0] op_sel_hi:[1,0]
 v_pk_mul_f16 v157, v153, v84 op_sel:[0,0] op_sel_hi:[1,0]
 v_pk_mul_f16 v158, v154, v84 op_sel:[0,0] op_sel_hi:[1,0]
 v_pk_mul_f16 v159, v155, v84 op_sel:[0,0] op_sel_hi:[1,0]
 v_pk_fma_f16 v156, v152, v84, v156 op_sel:[1,1,0] op_sel_hi:[0,1,1] neg_lo:[1,0,0]
 v_pk_fma_f16 v157, v153, v84, v157 op_sel:[1,1,0] op_sel_hi:[0,1,1] neg_lo:[1,0,0]
 v_pk_fma_f16 v158, v154, v84, v158 op_sel:[1,1,0] op_sel_hi:[0,1,1] neg_lo:[1,0,0]
 v_pk_fma_f16 v159, v155, v84, v159 op_sel:[1,1,0] op_sel_hi:[0,1,1] neg_lo:[1,0,0]
 v_pk_mul_f16 v160, v152, v86 op_sel:[0,0] op_sel_hi:[1,0]
 v_pk_mul_f16 v161, v153, v86 op_sel:[0,0] op_sel_hi:[1,0]
 v_pk_mul_f16 v162, v154, v86 op_sel:[0,0] op_sel_hi:[1,0]
 v_pk_mul_f16 v163, v155, v86 op_sel:[0,0] op_sel_hi:[1,0]
 v_pk_mul_f16 v164, v156, v86 op_sel:[0,0] op_sel_hi:[1,0]
 v_pk_mul_f16 v165, v157, v86 op_sel:[0,0] op_sel_hi:[1,0]
 v_pk_mul_f16 v166, v158, v86 op_sel:[0,0] op_sel_hi:[1,0]
 v_pk_mul_f16 v167, v159, v86 op_sel:[0,0] op_sel_hi:[1,0]
 v_pk_fma_f16 v160, v152, v86, v160 op_sel:[1,1,0] op_sel_hi:[0,1,1] neg_lo:[1,0,0]
 v_pk_fma_f16 v161, v153, v86, v161 op_sel:[1,1,0] op_sel_hi:[0,1,1] neg_lo:[1,0,0]
 v_pk_fma_f16 v162, v154, v86, v162 op_sel:[1,1,0] op_sel_hi:[0,1,1] neg_lo:[1,0,0]
 v_pk_fma_f16 v163, v155, v86, v163 op_sel:[1,1,0] op_sel_hi:[0,1,1] neg_lo:[1,0,0]
 v_pk_fma_f16 v164, v156, v86, v164 op_sel:[1,1,0] op_sel_hi:[0,1,1] neg_lo:[1,0,0]
 v_pk_fma_f16 v165, v157, v86, v165 op_sel:[1,1,0] op_sel_hi:[0,1,1] neg_lo:[1,0,0]
 v_pk_fma_f16 v166, v158, v86, v166 op_sel:[1,1,0] op_sel_hi:[0,1,1] neg_lo:[1,0,0]
 v_pk_fma_f16 v167, v159, v86, v167 op_sel:[1,1,0] op_sel_hi:[0,1,1] neg_lo:[1,0,0]
 v_pk_mul_f16 v168, v152, v88 op_sel:[0,0] op_sel_hi:[1,0]
 v_pk_mul_f16 v169, v153, v88 op_sel:[0,0] op_sel_hi:[1,0]
 v_pk_mul_f16 v170, v154, v88 op_sel:[0,0] op_sel_hi:[1,0]
 v_pk_mul_f16 v171, v155, v88 op_sel:[0,0] op_sel_hi:[1,0]
 v_pk_mul_f16 v172, v156, v88 op_sel:[0,0] op_sel_hi:[1,0]
 v_pk_mul_f16 v173, v157, v88 op_sel:[0,0] op_sel_hi:[1,0]
 v_pk_mul_f16 v174, v158, v88 op_sel:[0,0] op_sel_hi:[1,0]
 v_pk_mul_f16 v175, v159, v88 op_sel:[0,0] op_sel_hi:[1,0]
 v_pk_mul_f16 v176, v160, v88 op_sel:[0,0] op_sel_hi:[1,0]
 v_pk_mul_f16 v177, v161, v88 op_sel:[0,0] op_sel_hi:[1,0]
 v_pk_mul_f16 v178, v162, v88 op_sel:[0,0] op_sel_hi:[1,0]
 v_pk_mul_f16 v179, v163, v88 op_sel:[0,0] op_sel_hi:[1,0]
 v_pk_mul_f16 v180, v164, v88 op_sel:[0,0] op_sel_hi:[1,0]
 v_pk_mul_f16 v181, v165, v88 op_sel:[0,0] op_sel_hi:[1,0]
 v_pk_mul_f16 v182, v166, v88 op_sel:[0,0] op_sel_hi:[1,0]
 v_pk_mul_f16 v183, v167, v88 op_sel:[0,0] op_sel_hi:[1,0]
 v_pk_fma_f16 v168, v152, v88, v168 op_sel:[1,1,0] op_sel_hi:[0,1,1] neg_lo:[1,0,0]
 v_pk_fma_f16 v169, v153, v88, v169 op_sel:[1,1,0] op_sel_hi:[0,1,1] neg_lo:[1,0,0]
 v_pk_fma_f16 v170, v154, v88, v170 op_sel:[1,1,0] op_sel_hi:[0,1,1] neg_lo:[1,0,0]
 v_pk_fma_f16 v171, v155, v88, v171 op_sel:[1,1,0] op_sel_hi:[0,1,1] neg_lo:[1,0,0]
 v_pk_fma_f16 v172, v156, v88, v172 op_sel:[1,1,0] op_sel_hi:[0,1,1] neg_lo:[1,0,0]
 v_pk_fma_f16 v173, v157, v88, v173 op_sel:[1,1,0] op_sel_hi:[0,1,1] neg_lo:[1,0,0]
 v_pk_fma_f16 v174, v158, v88, v174 op_sel:[1,1,0] op_sel_hi:[0,1,1] neg_lo:[1,0,0]
 v_pk_fma_f16 v175, v159, v88, v175 op_sel:[1,1,0] op_sel_hi:[0,1,1] neg_lo:[1,0,0]
 v_pk_fma_f16 v176, v160, v88, v176 op_sel:[1,1,0] op_sel_hi:[0,1,1] neg_lo:[1,0,0]
 v_pk_fma_f16 v177, v161, v88, v177 op_sel:[1,1,0] op_sel_hi:[0,1,1] neg_lo:[1,0,0]
 v_pk_fma_f16 v178, v162, v88, v178 op_sel:[1,1,0] op_sel_hi:[0,1,1] neg_lo:[1,0,0]
 v_pk_fma_f16 v179, v163, v88, v179 op_sel:[1,1,0] op_sel_hi:[0,1,1] neg_lo:[1,0,0]
 v_pk_fma_f16 v180, v164, v88, v180 op_sel:[1,1,0] op_sel_hi:[0,1,1] neg_lo:[1,0,0]
 v_pk_fma_f16 v181, v165, v88, v181 op_sel:[1,1,0] op_sel_hi:[0,1,1] neg_lo:[1,0,0]
 v_pk_fma_f16 v182, v166, v88, v182 op_sel:[1,1,0] op_sel_hi:[0,1,1] neg_lo:[1,0,0]
 v_pk_fma_f16 v183, v167, v88, v183 op_sel:[1,1,0] op_sel_hi:[0,1,1] neg_lo:[1,0,0]
 ds_write_addtid_b32 v152 offset:0
 ds_write_addtid_b32 v153 offset:272
 ds_write_addtid_b32 v154 offset:544
 ds_write_addtid_b32 v155 offset:816
 ds_write_addtid_b32 v156 offset:1088
 ds_write_addtid_b32 v157 offset:1360
 ds_write_addtid_b32 v158 offset:1632
 ds_write_addtid_b32 v159 offset:1904
 ds_write_addtid_b32 v160 offset:2176
 ds_write_addtid_b32 v161 offset:2448
 ds_write_addtid_b32 v162 offset:2720
 ds_write_addtid_b32 v163 offset:2992
 ds_write_addtid_b32 v164 offset:3264
 ds_write_addtid_b32 v165 offset:3536
 ds_write_addtid_b32 v166 offset:3808
 ds_write_addtid_b32 v167 offset:4080
 ds_write_addtid_b32 v168 offset:4352
 ds_write_addtid_b32 v169 offset:4624
 ds_write_addtid_b32 v170 offset:4896
 ds_write_addtid_b32 v171 offset:5168
 ds_write_addtid_b32 v172 offset:5440
 ds_write_addtid_b32 v173 offset:5712
 ds_write_addtid_b32 v174 offset:5984
 ds_write_addtid_b32 v175 offset:6256
 ds_write_addtid_b32 v176 offset:6528
 ds_write_addtid_b32 v177 offset:6800
 ds_write_addtid_b32 v178 offset:7072
 ds_write_addtid_b32 v179 offset:7344
 ds_write_addtid_b32 v180 offset:7616
 ds_write_addtid_b32 v181 offset:7888
 ds_write_addtid_b32 v182 offset:8160
 ds_write_addtid_b32 v183 offset:8432
 ds_read_b128 a[32:35], v8 offset:0
 ds_read_b128 a[36:39], v8 offset:32
 ds_read_b128 a[40:43], v8 offset:64
 ds_read_b128 a[44:47], v8 offset:96
 ds_read_b128 a[48:51], v8 offset:128
 ds_read_b128 a[52:55], v8 offset:160
 ds_read_b128 a[56:59], v8 offset:192
 ds_read_b128 a[60:63], v8 offset:224
 s_mov_b32 m0, s44
 s_nop 0
 buffer_load_dwordx4 v4, s[8:11], s55 offen offset:3072 lds
 s_mov_b32 m0, s30
 v_pk_mul_f16 v103, v99, v101 op_sel:[0,0] op_sel_hi:[1,0]
 v_pk_mul_f16 v107, v99, v105 op_sel:[0,0] op_sel_hi:[1,0]
 v_pk_mul_f16 v109, v101, v105 op_sel:[0,0] op_sel_hi:[1,0]
 v_pk_mul_f16 v131, v115, v125 op_sel:[0,0] op_sel_hi:[1,0]
 v_pk_mul_f16 v139, v137, v113 op_sel:[0,0] op_sel_hi:[1,0]
 v_pk_mul_f16 v117, v115, v101 op_sel:[0,0] op_sel_hi:[1,0]
 v_pk_mul_f16 v119, v115, v105 op_sel:[0,0] op_sel_hi:[1,0]
 v_pk_mul_f16 v127, v125, v105 op_sel:[0,0] op_sel_hi:[1,0]
 v_pk_fma_f16 v103, v99, v101, v103 op_sel:[1,1,0] op_sel_hi:[0,1,1] neg_lo:[1,0,0]
 v_pk_fma_f16 v107, v99, v105, v107 op_sel:[1,1,0] op_sel_hi:[0,1,1] neg_lo:[1,0,0]
 v_pk_fma_f16 v109, v101, v105, v109 op_sel:[1,1,0] op_sel_hi:[0,1,1] neg_lo:[1,0,0]
 v_pk_fma_f16 v131, v115, v125, v131 op_sel:[1,1,0] op_sel_hi:[0,1,1] neg_lo:[1,0,0]
 v_pk_fma_f16 v139, v137, v113, v139 op_sel:[1,1,0] op_sel_hi:[0,1,1] neg_lo:[1,0,0]
 v_pk_fma_f16 v117, v115, v101, v117 op_sel:[1,1,0] op_sel_hi:[0,1,1] neg_lo:[1,0,0]
 v_pk_fma_f16 v119, v115, v105, v119 op_sel:[1,1,0] op_sel_hi:[0,1,1] neg_lo:[1,0,0]
 v_pk_fma_f16 v127, v125, v105, v127 op_sel:[1,1,0] op_sel_hi:[0,1,1] neg_lo:[1,0,0]
 v_pk_mul_f16 v111, v103, v105 op_sel:[0,0] op_sel_hi:[1,0]
 v_pk_mul_f16 v121, v115, v109 op_sel:[0,0] op_sel_hi:[1,0]
 v_pk_mul_f16 v133, v131, v105 op_sel:[0,0] op_sel_hi:[1,0]
 v_pk_mul_f16 v143, v139, v115 op_sel:[0,0] op_sel_hi:[1,0]
 v_pk_mul_f16 v147, v139, v125 op_sel:[0,0] op_sel_hi:[1,0]
 v_pk_mul_f16 v151, v139, v131 op_sel:[0,0] op_sel_hi:[1,0]
 v_pk_fma_f16 v111, v103, v105, v111 op_sel:[1,1,0] op_sel_hi:[0,1,1] neg_lo:[1,0,0]
 v_pk_fma_f16 v121, v115, v109, v121 op_sel:[1,1,0] op_sel_hi:[0,1,1] neg_lo:[1,0,0]
 v_pk_fma_f16 v133, v131, v105, v133 op_sel:[1,1,0] op_sel_hi:[0,1,1] neg_lo:[1,0,0]
 v_pk_fma_f16 v143, v139, v115, v143 op_sel:[1,1,0] op_sel_hi:[0,1,1] neg_lo:[1,0,0]
 v_pk_fma_f16 v147, v139, v125, v147 op_sel:[1,1,0] op_sel_hi:[0,1,1] neg_lo:[1,0,0]
 v_pk_fma_f16 v151, v139, v131, v151 op_sel:[1,1,0] op_sel_hi:[0,1,1] neg_lo:[1,0,0]
 ds_write_addtid_b32 v99 offset:272
 ds_write_addtid_b32 v101 offset:544
 ds_write_addtid_b32 v103 offset:816
 ds_write_addtid_b32 v115 offset:1088
 ds_write_addtid_b32 v117 offset:1632
 ds_write_addtid_b32 v119 offset:1904
 ds_write_addtid_b32 v105 offset:2176
 ds_write_addtid_b32 v107 offset:2448
 ds_write_addtid_b32 v109 offset:2720
 ds_write_addtid_b32 v111 offset:2992
 ds_write_addtid_b32 v121 offset:3808
 ds_write_addtid_b32 v125 offset:4624
 ds_write_addtid_b32 v127 offset:4896
 ds_write_addtid_b32 v131 offset:5712
 ds_write_addtid_b32 v133 offset:5984
 ds_write_addtid_b32 v137 offset:6528
 ds_write_addtid_b32 v139 offset:6800
 ds_write_addtid_b32 v143 offset:7344
 ds_write_addtid_b32 v147 offset:7888
 ds_write_addtid_b32 v151 offset:8432
 ds_read_b128 a[64:67], v13 offset:0
 ds_read_b128 a[68:71], v13 offset:32
 ds_read_b128 a[72:75], v13 offset:64
 ds_read_b128 a[76:79], v13 offset:96
 ds_read_b128 a[80:83], v13 offset:128
 ds_read_b128 a[84:87], v13 offset:160
 ds_read_b128 a[88:91], v13 offset:192
 ds_read_b128 a[92:95], v13 offset:224
 s_waitcnt lgkmcnt(15)
 v_mfma_f32_32x32x16_f16 a[176:191], a[0:3], a[32:35], 0
 v_pk_mul_f16 v185, v184, v81 op_sel:[0,0] op_sel_hi:[1,0]
 v_pk_fma_f16 v185, v184, v81, v185 op_sel:[1,1,0] op_sel_hi:[0,1,1] neg_lo:[1,0,0]
 v_pk_mul_f16 v186, v184, v83 op_sel:[0,0] op_sel_hi:[1,0]
 v_pk_mul_f16 v187, v185, v83 op_sel:[0,0] op_sel_hi:[1,0]
 v_pk_fma_f16 v186, v184, v83, v186 op_sel:[1,1,0] op_sel_hi:[0,1,1] neg_lo:[1,0,0]
 v_pk_fma_f16 v187, v185, v83, v187 op_sel:[1,1,0] op_sel_hi:[0,1,1] neg_lo:[1,0,0]
 v_mfma_f32_32x32x16_f16 a[176:191], a[4:7], a[36:39], a[176:191]
 v_pk_mul_f16 v188, v184, v85 op_sel:[0,0] op_sel_hi:[1,0]
 v_pk_mul_f16 v189, v185, v85 op_sel:[0,0] op_sel_hi:[1,0]
 v_pk_mul_f16 v190, v186, v85 op_sel:[0,0] op_sel_hi:[1,0]
 v_pk_mul_f16 v191, v187, v85 op_sel:[0,0] op_sel_hi:[1,0]
 v_pk_fma_f16 v188, v184, v85, v188 op_sel:[1,1,0] op_sel_hi:[0,1,1] neg_lo:[1,0,0]
 v_pk_fma_f16 v189, v185, v85, v189 op_sel:[1,1,0] op_sel_hi:[0,1,1] neg_lo:[1,0,0]
 v_mfma_f32_32x32x16_f16 a[176:191], a[8:11], a[40:43], a[176:191]
 v_pk_fma_f16 v190, v186, v85, v190 op_sel:[1,1,0] op_sel_hi:[0,1,1] neg_lo:[1,0,0]
 v_pk_fma_f16 v191, v187, v85, v191 op_sel:[1,1,0] op_sel_hi:[0,1,1] neg_lo:[1,0,0]
 v_pk_mul_f16 v192, v184, v87 op_sel:[0,0] op_sel_hi:[1,0]
 v_pk_mul_f16 v193, v185, v87 op_sel:[0,0] op_sel_hi:[1,0]
 v_pk_mul_f16 v194, v186, v87 op_sel:[0,0] op_sel_hi:[1,0]
 v_pk_mul_f16 v195, v187, v87 op_sel:[0,0] op_sel_hi:[1,0]
 v_mfma_f32_32x32x16_f16 a[176:191], a[12:15], a[44:47], a[176:191]
 v_pk_mul_f16 v196, v188, v87 op_sel:[0,0] op_sel_hi:[1,0]
 v_pk_mul_f16 v197, v189, v87 op_sel:[0,0] op_sel_hi:[1,0]
 v_pk_mul_f16 v198, v190, v87 op_sel:[0,0] op_sel_hi:[1,0]
 v_pk_mul_f16 v199, v191, v87 op_sel:[0,0] op_sel_hi:[1,0]
 v_pk_fma_f16 v192, v184, v87, v192 op_sel:[1,1,0] op_sel_hi:[0,1,1] neg_lo:[1,0,0]
 v_pk_fma_f16 v193, v185, v87, v193 op_sel:[1,1,0] op_sel_hi:[0,1,1] neg_lo:[1,0,0]
 v_mfma_f32_32x32x16_f16 a[176:191], a[16:19], a[48:51], a[176:191]
 v_pk_fma_f16 v194, v186, v87, v194 op_sel:[1,1,0] op_sel_hi:[0,1,1] neg_lo:[1,0,0]
 v_pk_fma_f16 v195, v187, v87, v195 op_sel:[1,1,0] op_sel_hi:[0,1,1] neg_lo:[1,0,0]
 v_pk_fma_f16 v196, v188, v87, v196 op_sel:[1,1,0] op_sel_hi:[0,1,1] neg_lo:[1,0,0]
 v_pk_fma_f16 v197, v189, v87, v197 op_sel:[1,1,0] op_sel_hi:[0,1,1] neg_lo:[1,0,0]
 v_pk_fma_f16 v198, v190, v87, v198 op_sel:[1,1,0] op_sel_hi:[0,1,1] neg_lo:[1,0,0]
 v_pk_fma_f16 v199, v191, v87, v199 op_sel:[1,1,0] op_sel_hi:[0,1,1] neg_lo:[1,0,0]
 v_mfma_f32_32x32x16_f16 a[176:191], a[20:23], a[52:55], a[176:191]
 v_pk_mul_f16 v200, v184, v89 op_sel:[0,0] op_sel_hi:[1,0]
 v_pk_mul_f16 v201, v185, v89 op_sel:[0,0] op_sel_hi:[1,0]
 v_pk_mul_f16 v202, v186, v89 op_sel:[0,0] op_sel_hi:[1,0]
 v_pk_mul_f16 v203, v187, v89 op_sel:[0,0] op_sel_hi:[1,0]
 v_pk_mul_f16 v204, v188, v89 op_sel:[0,0] op_sel_hi:[1,0]
 v_pk_mul_f16 v205, v189, v89 op_sel:[0,0] op_sel_hi:[1,0]
 v_mfma_f32_32x32x16_f16 a[176:191], a[24:27], a[56:59], a[176:191]
 v_pk_mul_f16 v206, v190, v89 op_sel:[0,0] op_sel_hi:[1,0]
 v_pk_mul_f16 v207, v191, v89 op_sel:[0,0] op_sel_hi:[1,0]
 v_pk_mul_f16 v208, v192, v89 op_sel:[0,0] op_sel_hi:[1,0]
 v_pk_mul_f16 v209, v193, v89 op_sel:[0,0] op_sel_hi:[1,0]
 v_pk_mul_f16 v210, v194, v89 op_sel:[0,0] op_sel_hi:[1,0]
 v_pk_mul_f16 v211, v195, v89 op_sel:[0,0] op_sel_hi:[1,0]
 v_mfma_f32_32x32x16_f16 a[176:191], a[28:31], a[60:63], a[176:191]
 v_pk_mul_f16 v212, v196, v89 op_sel:[0,0] op_sel_hi:[1,0]
 v_pk_mul_f16 v213, v197, v89 op_sel:[0,0] op_sel_hi:[1,0]
 v_pk_mul_f16 v214, v198, v89 op_sel:[0,0] op_sel_hi:[1,0]
 v_pk_mul_f16 v215, v199, v89 op_sel:[0,0] op_sel_hi:[1,0]
 v_pk_fma_f16 v200, v184, v89, v200 op_sel:[1,1,0] op_sel_hi:[0,1,1] neg_lo:[1,0,0]
 v_pk_fma_f16 v201, v185, v89, v201 op_sel:[1,1,0] op_sel_hi:[0,1,1] neg_lo:[1,0,0]
 v_pk_fma_f16 v202, v186, v89, v202 op_sel:[1,1,0] op_sel_hi:[0,1,1] neg_lo:[1,0,0]
 v_pk_fma_f16 v203, v187, v89, v203 op_sel:[1,1,0] op_sel_hi:[0,1,1] neg_lo:[1,0,0]
 v_pk_fma_f16 v204, v188, v89, v204 op_sel:[1,1,0] op_sel_hi:[0,1,1] neg_lo:[1,0,0]
 v_pk_fma_f16 v205, v189, v89, v205 op_sel:[1,1,0] op_sel_hi:[0,1,1] neg_lo:[1,0,0]
 v_pk_fma_f16 v206, v190, v89, v206 op_sel:[1,1,0] op_sel_hi:[0,1,1] neg_lo:[1,0,0]
 v_pk_fma_f16 v207, v191, v89, v207 op_sel:[1,1,0] op_sel_hi:[0,1,1] neg_lo:[1,0,0]
 v_pk_fma_f16 v208, v192, v89, v208 op_sel:[1,1,0] op_sel_hi:[0,1,1] neg_lo:[1,0,0]
 v_pk_fma_f16 v209, v193, v89, v209 op_sel:[1,1,0] op_sel_hi:[0,1,1] neg_lo:[1,0,0]
 v_pk_fma_f16 v210, v194, v89, v210 op_sel:[1,1,0] op_sel_hi:[0,1,1] neg_lo:[1,0,0]
 v_pk_fma_f16 v211, v195, v89, v211 op_sel:[1,1,0] op_sel_hi:[0,1,1] neg_lo:[1,0,0]
 v_pk_fma_f16 v212, v196, v89, v212 op_sel:[1,1,0] op_sel_hi:[0,1,1] neg_lo:[1,0,0]
 v_pk_fma_f16 v213, v197, v89, v213 op_sel:[1,1,0] op_sel_hi:[0,1,1] neg_lo:[1,0,0]
 v_pk_fma_f16 v214, v198, v89, v214 op_sel:[1,1,0] op_sel_hi:[0,1,1] neg_lo:[1,0,0]
 v_pk_fma_f16 v215, v199, v89, v215 op_sel:[1,1,0] op_sel_hi:[0,1,1] neg_lo:[1,0,0]
 ds_write_addtid_b32 v184 offset:0
 ds_write_addtid_b32 v185 offset:272
 ds_write_addtid_b32 v186 offset:544
 ds_write_addtid_b32 v187 offset:816
 ds_write_addtid_b32 v188 offset:1088
 ds_write_addtid_b32 v189 offset:1360
 ds_write_addtid_b32 v190 offset:1632
 ds_write_addtid_b32 v191 offset:1904
 ds_write_addtid_b32 v192 offset:2176
 ds_write_addtid_b32 v193 offset:2448
 ds_write_addtid_b32 v194 offset:2720
 ds_write_addtid_b32 v195 offset:2992
 ds_write_addtid_b32 v196 offset:3264
 ds_write_addtid_b32 v197 offset:3536
 ds_write_addtid_b32 v198 offset:3808
 ds_write_addtid_b32 v199 offset:4080
 ds_write_addtid_b32 v200 offset:4352
 ds_write_addtid_b32 v201 offset:4624
 ds_write_addtid_b32 v202 offset:4896
 ds_write_addtid_b32 v203 offset:5168
 ds_write_addtid_b32 v204 offset:5440
 ds_write_addtid_b32 v205 offset:5712
 ds_write_addtid_b32 v206 offset:5984
 ds_write_addtid_b32 v207 offset:6256
 ds_write_addtid_b32 v208 offset:6528
 ds_write_addtid_b32 v209 offset:6800
 ds_write_addtid_b32 v210 offset:7072
 ds_write_addtid_b32 v211 offset:7344
 ds_write_addtid_b32 v212 offset:7616
 ds_write_addtid_b32 v213 offset:7888
 ds_write_addtid_b32 v214 offset:8160
 ds_write_addtid_b32 v215 offset:8432
 ds_read_b128 a[96:99], v8 offset:0
 ds_read_b128 a[100:103], v8 offset:32
 ds_read_b128 a[104:107], v8 offset:64
 ds_read_b128 a[108:111], v8 offset:96
 ds_read_b128 a[112:115], v8 offset:128
 ds_read_b128 a[116:119], v8 offset:160
 ds_read_b128 a[120:123], v8 offset:192
 ds_read_b128 a[124:127], v8 offset:224
 s_cmp_lg_u32 s50, 0
 s_cbranch_scc1 Lk_t1
 s_waitcnt vmcnt(4)
 s_lshl_b32 s14, s58, s3
 s_lshl_b32 s15, s34, s3
 s_and_b32 s14, s14, s53
 s_and_b32 s15, s15, s53
 v_mov_b32 v252, s14
 v_lshlrev_b32 v48, 16, v40
 v_and_b32 v49, s53, v40
 v_mul_f32 v252, s52, v252
 v_mul_f32 v48, s52, v48
 v_mul_f32 v49, s52, v49
 v_exp_f32 v252, v252
 v_exp_f32 v48, v48
 v_exp_f32 v49, v49
 s_waitcnt lgkmcnt(4)
 v_mfma_f32_32x32x16_f16 a[160:175], a[64:67], a[96:99], a[176:191]
 v_and_b32 v253, s15, v12
 v_lshlrev_b32 v52, 16, v42
 v_and_b32 v53, s53, v42
 v_lshlrev_b32 v54, 16, v43
 v_and_b32 v55, s53, v43
 v_mfma_f32_32x32x16_f16 a[160:175], a[68:71], a[100:103], a[160:175]
 v_max_f32 v92, |v52|, |v53|
 v_max3_f32 v92, |v54|, |v55|, v92
 v_cvt_pk_bf16_f32 v252, v252, v252
 v_cvt_pk_bf16_f32 v49, v48, v49
 v_max_f32 v92, v92, v92 row_shr:1 row_mask:0xf bank_mask:0xf
 v_mfma_f32_32x32x16_f16 a[160:175], a[72:75], a[104:107], a[160:175]
 v_and_b32 v252, s53, v252
 v_lshlrev_b32 v50, 16, v41
 v_max_f32 v92, v92, v92 row_shr:2 row_mask:0xf bank_mask:0xf
 v_and_b32 v51, s53, v41
 v_lshlrev_b32 v48, 16, v49
 v_mfma_f32_32x32x16_f16 a[160:175], a[76:79], a[108:111], a[160:175]
 v_max_f32 v92, v92, v92 row_shr:4 row_mask:0xf bank_mask:0xf
 v_and_b32 v49, s53, v49
 v_mul_f32 v50, v50, v252
 v_max_f32 v92, v92, v92 row_shr:8 row_mask:0xf bank_mask:0xf
 v_mul_f32 v51, v51, v252
 s_waitcnt lgkmcnt(0)
 v_mfma_f32_32x32x16_f16 a[160:175], a[80:83], a[112:115], a[160:175]
 v_mul_f32 v48, v48, v252
 v_max_f32 v92, v92, v92 row_bcast:15 row_mask:0xa bank_mask:0xf
 v_mul_f32 v49, v49, v252
 v_mul_f32 v50, 0.15915494, v50
 v_max_f32 v92, v92, v92 row_bcast:31 row_mask:0xc bank_mask:0xf
 v_mfma_f32_32x32x16_f16 a[160:175], a[84:87], a[116:119], a[160:175]
 v_mul_f32 v51, 0.15915494, v51
 v_mul_f32 v48, s52, v48
 v_readlane_b32 s14, v92, 63
 v_mul_f32 v49, s52, v49
 s_lshr_b32 s14, s14, 23
 v_mfma_f32_32x32x16_f16 a[160:175], a[88:91], a[120:123], a[160:175]
 s_min_u32 s14, s14, 250
 s_sub_u32 s15, 253, s14
 s_lshl_b32 s15, s15, 23
 s_add_u32 s14, s14, 2
 s_lshl_b32 s14, s14, 23
 v_mfma_f32_32x32x16_f16 a[160:175], a[92:95], a[124:127], a[160:175]
 v_mul_f32 v52, s15, v52
 v_mul_f32 v53, s15, v53
 v_mul_f32 v54, s15, v54
 v_mul_f32 v55, s15, v55
 v_mul_f32 v252, s14, v252
 v_cvt_pk_f16_f32 v152, v52, v54
 v_cvt_pk_f16_f32 v184, v53, v55
 s_add_u32 s50, s50, 1
 s_branch Lk_loop
Lk_t1:
 s_cmp_lg_u32 s50, 1
 s_cbranch_scc1 Lk_t2
 s_lshl_b32 s14, s56, s3
 s_lshl_b32 s15, s32, s3
 s_and_b32 s14, s14, s53
 s_and_b32 s15, s15, s53
 v_mov_b32 v248, s14
 v_lshlrev_b32 v48, 16, v32
 v_and_b32 v49, s53, v32
 v_mul_f32 v248, s52, v248
 v_mul_f32 v48, s52, v48
 v_mul_f32 v49, s52, v49
 v_exp_f32 v248, v248
 v_exp_f32 v48, v48
 v_exp_f32 v49, v49
 v_and_b32 v249, s15, v12
 s_waitcnt lgkmcnt(4)
 v_mfma_f32_32x32x16_f16 a[144:159], a[64:67], a[96:99], a[176:191]
 v_lshlrev_b32 v52, 16, v34
 v_and_b32 v53, s53, v34
 v_lshlrev_b32 v54, 16, v35
 v_and_b32 v55, s53, v35
 v_max_f32 v92, |v52|, |v53|
 v_mfma_f32_32x32x16_f16 a[144:159], a[68:71], a[100:103], a[144:159]
 v_max3_f32 v92, |v54|, |v55|, v92
 v_cvt_pk_bf16_f32 v248, v248, v248
 v_cvt_pk_bf16_f32 v49, v48, v49
 v_max_f32 v92, v92, v92 row_shr:1 row_mask:0xf bank_mask:0xf
 v_and_b32 v248, s53, v248
 v_mfma_f32_32x32x16_f16 a[144:159], a[72:75], a[104:107], a[144:159]
 v_lshlrev_b32 v50, 16, v33
 v_max_f32 v92, v92, v92 row_shr:2 row_mask:0xf bank_mask:0xf
 v_and_b32 v51, s53, v33
 v_lshlrev_b32 v48, 16, v49
 v_max_f32 v92, v92, v92 row_shr:4 row_mask:0xf bank_mask:0xf
 v_mfma_f32_32x32x16_f16 a[144:159], a[76:79], a[108:111], a[144:159]
 v_and_b32 v49, s53, v49
 v_mul_f32 v50, v50, v248
 v_max_f32 v92, v92, v92 row_shr:8 row_mask:0xf bank_mask:0xf
 v_mul_f32 v51, v51, v248
 v_mul_f32 v48, v48, v248
 s_waitcnt lgkmcnt(0)
 v_mfma_f32_32x32x16_f16 a[144:159], a[80:83], a[112:115], a[144:159]
 v_max_f32 v92, v92, v92 row_bcast:15 row_mask:0xa bank_mask:0xf
 v_mul_f32 v49, v49, v248
 v_mul_f32 v50, 0.15915494, v50
 v_max_f32 v92, v92, v92 row_bcast:31 row_mask:0xc bank_mask:0xf
 v_mul_f32 v51, 0.15915494, v51
 v_mfma_f32_32x32x16_f16 a[144:159], a[84:87], a[116:119], a[144:159]
 v_mul_f32 v48, s52, v48
 v_readlane_b32 s14, v92, 63
 v_mul_f32 v49, s52, v49
 s_lshr_b32 s14, s14, 23
 s_min_u32 s14, s14, 250
 v_mfma_f32_32x32x16_f16 a[144:159], a[88:91], a[120:123], a[144:159]
 s_sub_u32 s15, 253, s14
 s_lshl_b32 s15, s15, 23
 s_add_u32 s14, s14, 2
 s_lshl_b32 s14, s14, 23
 v_mul_f32 v52, s15, v52
 v_mfma_f32_32x32x16_f16 a[144:159], a[92:95], a[124:127], a[144:159]
 v_mul_f32 v53, s15, v53
 v_mul_f32 v54, s15, v54
 v_mul_f32 v55, s15, v55
 v_mul_f32 v248, s14, v248
 v_cvt_pk_f16_f32 v152, v52, v54
 v_cvt_pk_f16_f32 v184, v53, v55
 s_add_u32 s50, s50, 1
 s_branch Lk_loop
Lk_t2:
 s_cmp_lg_u32 s50, 2
 s_cbranch_scc1 Lk_t3
 s_lshl_b32 s14, s57, s3
 s_lshl_b32 s15, s33, s3
 s_and_b32 s14, s14, s53
 s_and_b32 s15, s15, s53
 v_mov_b32 v250, s14
 v_lshlrev_b32 v48, 16, v36
 v_and_b32 v49, s53, v36
 v_mul_f32 v250, s52, v250
 v_mul_f32 v48, s52, v48
 v_mul_f32 v49, s52, v49
 v_exp_f32 v250, v250
 v_exp_f32 v48, v48
 v_exp_f32 v49, v49
 v_and_b32 v251, s15, v12
 s_waitcnt lgkmcnt(4)
 v_mfma_f32_32x32x16_f16 a[236:251], a[64:67], a[96:99], a[176:191]
 v_lshlrev_b32 v52, 16, v38
 v_and_b32 v53, s53, v38
 v_lshlrev_b32 v54, 16, v39
 v_and_b32 v55, s53, v39
 v_max_f32 v92, |v52|, |v53|
 v_mfma_f32_32x32x16_f16 a[236:251], a[68:71], a[100:103], a[236:251]
 v_max3_f32 v92, |v54|, |v55|, v92
 v_cvt_pk_bf16_f32 v250, v250, v250
 v_cvt_pk_bf16_f32 v49, v48, v49
 v_max_f32 v92, v92, v92 row_shr:1 row_mask:0xf bank_mask:0xf
 v_and_b32 v250, s53, v250
 v_mfma_f32_32x32x16_f16 a[236:251], a[72:75], a[104:107], a[236:251]
 v_lshlrev_b32 v50, 16, v37
 v_max_f32 v92, v92, v92 row_shr:2 row_mask:0xf bank_mask:0xf
 v_and_b32 v51, s53, v37
 v_lshlrev_b32 v48, 16, v49
 v_max_f32 v92, v92, v92 row_shr:4 row_mask:0xf bank_mask:0xf
 v_mfma_f32_32x32x16_f16 a[236:251], a[76:79], a[108:111], a[236:251]
 v_and_b32 v49, s53, v49
 v_mul_f32 v50, v50, v250
 v_max_f32 v92, v92, v92 row_shr:8 row_mask:0xf bank_mask:0xf
 v_mul_f32 v51, v51, v250
 v_mul_f32 v48, v48, v250
 s_waitcnt lgkmcnt(0)
 v_mfma_f32_32x32x16_f16 a[236:251], a[80:83], a[112:115], a[236:251]
 v_max_f32 v92, v92, v92 row_bcast:15 row_mask:0xa bank_mask:0xf
 v_mul_f32 v49, v49, v250
 v_mul_f32 v50, 0.15915494, v50
 v_max_f32 v92, v92, v92 row_bcast:31 row_mask:0xc bank_mask:0xf
 v_mul_f32 v51, 0.15915494, v51
 v_mfma_f32_32x32x16_f16 a[236:251], a[84:87], a[116:119], a[236:251]
 v_mul_f32 v48, s52, v48
 v_readlane_b32 s14, v92, 63
 v_mul_f32 v49, s52, v49
 s_lshr_b32 s14, s14, 23
 s_min_u32 s14, s14, 250
 v_mfma_f32_32x32x16_f16 a[236:251], a[88:91], a[120:123], a[236:251]
 s_sub_u32 s15, 253, s14
 s_lshl_b32 s15, s15, 23
 s_add_u32 s14, s14, 2
 s_lshl_b32 s14, s14, 23
 v_mul_f32 v52, s15, v52
 v_mfma_f32_32x32x16_f16 a[236:251], a[92:95], a[124:127], a[236:251]
 v_mul_f32 v53, s15, v53
 v_mul_f32 v54, s15, v54
 v_mul_f32 v55, s15, v55
 v_mul_f32 v250, s14, v250
 v_cvt_pk_f16_f32 v152, v52, v54
 v_cvt_pk_f16_f32 v184, v53, v55
 s_load_dword s68, s[6:7], 0
 s_add_u32 s50, s50, 1
 s_branch Lk_loop
Lk_t3:
 s_waitcnt vmcnt(0)
 ds_read_b64_tr_b16 v[128:129], v22 offset:256
 ds_read_b64_tr_b16 v[130:131], v22 offset:0
 ds_read_b64_tr_b16 v[132:133], v22 offset:4352
 ds_read_b64_tr_b16 v[134:135], v22 offset:4096
 ds_read_b64_tr_b16 v[136:137], v22 offset:8448
 ds_read_b64_tr_b16 v[138:139], v22 offset:8192
 ds_read_b64_tr_b16 v[140:141], v22 offset:12544
 ds_read_b64_tr_b16 v[142:143], v22 offset:12288
 v_accvgpr_read_b32 v48, a236
 v_accvgpr_read_b32 v49, a237
 v_accvgpr_read_b32 v50, a238
 v_accvgpr_read_b32 v51, a239
 v_accvgpr_read_b32 v52, a240
 v_accvgpr_read_b32 v53, a241
 v_accvgpr_read_b32 v54, a242
 v_accvgpr_read_b32 v55, a243
 v_accvgpr_read_b32 v57, a245
 v_accvgpr_read_b32 v58, a246
 v_accvgpr_read_b32 v60, a248
 v_accvgpr_read_b32 v61, a249
 v_accvgpr_read_b32 v63, a251
 v_fma_f32 v48, v48, v248, v249
 v_mul_f32 v49, v49, v248
 v_mul_f32 v50, v50, v248
 v_mul_f32 v51, v51, v248
 v_mul_f32 v52, v52, v248
 v_mul_f32 v53, v53, v248
Lpg17:
 s_cbranch_vccnz Lj_Lfin
 v_mul_f32 v54, v54, v248
 v_mul_f32 v55, v55, v248
 v_mul_f32 v57, v57, v248
 v_mul_f32 v58, v58, v248
 v_mul_f32 v60, v60, v248
 v_mul_f32 v61, v61, v248
 v_mul_f32 v63, v63, v248
 v_mov_b32 v56, v57 wave_rol:1 row_mask:0xf bank_mask:0xf
 v_mov_b32 v59, v60 wave_rol:1 row_mask:0xf bank_mask:0xf
 s_nop 0
 v_mov_b32 v56, v48 wave_shl:1 row_mask:0xf bank_mask:0xf
 v_mov_b32 v59, v57 wave_shl:1 row_mask:0xf bank_mask:0xf
 s_nop 0
 v_mov_b32 v55, v56 quad_perm:[0,1,2,3] row_mask:0xc bank_mask:0xf
 v_and_b32 v60, v60, v5
 v_and_b32 v62, v61, v12
 s_waitcnt lgkmcnt(0)
 v_mfma_f32_32x32x16_f16 a[128:143], a[64:67], a[96:99], a[176:191]
 ds_write_b128 v24, v[128:131] offset:768
 v_xor_b32 v61, v61, v62
 v_cndmask_b32 v20, v60, v62, s[12:13]
 v_cvt_pk_bf16_f32 v21, v61, v63
 v_mfma_f32_32x32x16_f16 a[128:143], a[68:71], a[100:103], a[128:143]
 ds_write_b128 v24, v[132:135] offset:512
 v_cvt_pk_bf16_f32 v6, 0, v48
 v_cvt_pk_bf16_f32 v96, v48, v49
 v_cvt_pk_bf16_f32 v97, v50, v51
 v_mfma_f32_32x32x16_f16 a[128:143], a[72:75], a[104:107], a[128:143]
 ds_write_b128 v24, v[136:139] offset:256
 v_cvt_pk_bf16_f32 v98, v52, v53
 v_cvt_pk_bf16_f32 v99, v54, v55
 v_cvt_pk_bf16_f32 v100, v49, v50
 v_mfma_f32_32x32x16_f16 a[128:143], a[76:79], a[108:111], a[128:143]
 ds_write_b128 v24, v[140:143] offset:0
 v_cvt_pk_bf16_f32 v101, v51, v52
 v_cvt_pk_bf16_f32 v102, v53, v54
 v_cvt_pk_bf16_f32 v103, v55, v56
 v_mfma_f32_32x32x16_f16 a[128:143], a[80:83], a[112:115], a[128:143]
 v_cvt_pk_bf16_f32 v104, v57, v57
 v_cvt_pk_bf16_f32 v105, v57, v58
 v_cvt_pk_bf16_f32 v106, v58, v58
 v_cvt_pk_bf16_f32 v107, v59, v59
 v_cvt_pk_bf16_f32 v108, v57, v57
 v_cvt_pk_bf16_f32 v109, v58, v58
 v_mfma_f32_32x32x16_f16 a[128:143], a[84:87], a[116:119], a[128:143]
 ds_write_b128 v9, v[96:99] offset:32
 v_cvt_pk_bf16_f32 v110, v58, v59
 v_cvt_pk_bf16_f32 v111, v59, v59
 v_cvt_pk_bf16_f32 v112, v60, v60
 v_mfma_f32_32x32x16_f16 a[128:143], a[88:91], a[120:123], a[128:143]
 ds_write_b128 v9, v[100:103] offset:4192
 v_cvt_pk_bf16_f32 v113, v60, v60
 v_cvt_pk_bf16_f32 v114, v20, v62
 v_cvt_pk_bf16_f32 v115, v62, v62
 v_mfma_f32_32x32x16_f16 a[128:143], a[92:95], a[124:127], a[128:143]
 ds_write_b128 v9, v[104:107] offset:1056
 v_cvt_pk_bf16_f32 v116, v60, v60
 v_cvt_pk_bf16_f32 v117, v60, v20
 v_cvt_pk_bf16_f32 v118, v62, v62
 v_cvt_pk_bf16_f32 v119, v62, v62
 ds_write_b32 v11, v6
 ds_write_b16 v10, v21 offset:32
 ds_write_b16_d16_hi v10, v21 offset:0
 ds_write_b16 v10, v21 offset:222
 ds_write_b16_d16_hi v10, v21 offset:190
 s_waitcnt lgkmcnt(8)
 s_barrier
 ds_write_b128 v9, v[108:111] offset:5216
 ds_write_b128 v9, v[112:115] offset:2080
 ds_write_b128 v9, v[116:119] offset:6240
 ds_write_b128 v25, v[28:31] offset:4096
 ds_read2_b32 a[0:1], v14 offset0:0 offset1:1
 ds_read2_b32 a[2:3], v14 offset0:2 offset1:3
 ds_read_b128 a[32:35], v18 offset:3584
 ds_read2_b32 a[4:5], v14 offset0:128 offset1:129
 ds_read2_b32 a[6:7], v14 offset0:130 offset1:131
 ds_read_b128 a[36:39], v18 offset:3072
 ds_read2_b32 a[8:9], v15 offset0:0 offset1:1
 ds_read2_b32 a[10:11], v15 offset0:2 offset1:3
 ds_read_b128 a[40:43], v18 offset:2560
 ds_read2_b32 a[12:13], v15 offset0:128 offset1:129
 ds_read2_b32 a[14:15], v15 offset0:130 offset1:131
 ds_read_b128 a[44:47], v18 offset:2048
 ds_read2_b32 a[16:17], v16 offset0:0 offset1:1
 ds_read2_b32 a[18:19], v16 offset0:2 offset1:3
 ds_read_b128 a[48:51], v18 offset:1536
 ds_read_b128 a[52:55], v18 offset:1024
 ds_read_b128 a[56:59], v18 offset:512
 ds_read_b128 a[60:63], v18 offset:0
 s_add_u32 s88, s88, 40960000
 s_addc_u32 s89, s89, 0
 s_cmp_eq_u32 s68, 16843009
 s_cbranch_scc0 Lsp_hi
Lrt_hi:
 v_add_u32 v22, 8, v22
 v_add_u32 v24, -35904, v24
 s_mov_b32 s50, 0
 s_waitcnt lgkmcnt(0)
Ls_loop:
 v_mfma_f32_16x16x32_bf16 v[216:219], a[0:3], a[32:35], 0
 ds_read_b128 a[212:215], v18 offset:3600
 v_accvgpr_read_b32 v48, a128
 v_mfma_f32_16x16x32_bf16 v[220:223], a[0:3], a[36:39], 0
 ds_read_b128 a[216:219], v18 offset:3088
 v_accvgpr_read_b32 v49, a129
 v_mfma_f32_16x16x32_bf16 v[220:223], a[4:7], a[32:35], v[220:223]
 ds_read_b128 a[220:223], v18 offset:2576
 v_accvgpr_read_b32 v50, a130
 v_mfma_f32_16x16x32_bf16 v[224:227], a[0:3], a[40:43], 0
 ds_read_b128 a[224:227], v18 offset:2064
 v_cvt_pk_bf16_f32 v240, v240, v241
 v_mfma_f32_16x16x32_bf16 v[224:227], a[4:7], a[36:39], v[224:227]
 ds_read_b64_tr_b16 v[128:129], v22 offset:256
 v_cvt_pk_bf16_f32 v241, v242, v243
 v_mfma_f32_16x16x32_bf16 v[224:227], a[8:11], a[32:35], v[224:227]
 ds_write_b64 v19, v[240:241] offset:0
 v_accvgpr_read_b32 v51, a131
 v_mfma_f32_16x16x32_bf16 v[228:231], a[0:3], a[44:47], 0
 ds_read2_b32 a[64:65], v14 offset0:16 offset1:17
 v_accvgpr_read_b32 v52, a132
 v_mfma_f32_16x16x32_bf16 v[228:231], a[4:7], a[40:43], v[228:231]
 ds_read2_b32 a[66:67], v14 offset0:18 offset1:19
 v_accvgpr_read_b32 v53, a133
 v_mfma_f32_16x16x32_bf16 v[228:231], a[8:11], a[36:39], v[228:231]
 ds_read_b128 a[96:99], v18 offset:3648
 v_accvgpr_read_b32 v54, a134
 v_mfma_f32_16x16x32_bf16 v[228:231], a[12:15], a[32:35], v[228:231]
 ds_read2_b32 a[68:69], v14 offset0:144 offset1:145
 v_cvt_pk_bf16_f32 v244, v244, v245
 v_mfma_f32_16x16x32_bf16 v[232:235], a[0:3], a[48:51], 0
 ds_read_b64_tr_b16 v[130:131], v22 offset:0
 v_cvt_pk_bf16_f32 v245, v246, v247
 v_mfma_f32_16x16x32_bf16 v[232:235], a[4:7], a[44:47], v[232:235]
 ds_write_b64 v19, v[244:245] offset:512
 v_accvgpr_read_b32 v55, a135
 v_mfma_f32_16x16x32_bf16 v[232:235], a[8:11], a[40:43], v[232:235]
 ds_read2_b32 a[70:71], v14 offset0:146 offset1:147
 v_subrev_u32 v19, s54, v19
 v_mfma_f32_16x16x32_bf16 v[232:235], a[12:15], a[36:39], v[232:235]
 ds_read_b128 a[100:103], v18 offset:3136
 v_accvgpr_read_b32 v57, a137
 v_mfma_f32_16x16x32_bf16 v[232:235], a[16:19], a[32:35], v[232:235]
 ds_read2_b32 a[72:73], v15 offset0:16 offset1:17
 v_accvgpr_read_b32 v58, a138
 v_mfma_f32_16x16x32_bf16 v[236:239], a[0:3], a[52:55], 0
 ds_read2_b32 a[74:75], v15 offset0:18 offset1:19
 v_accvgpr_read_b32 v60, a140
 v_mfma_f32_16x16x32_bf16 v[236:239], a[4:7], a[48:51], v[236:239]
 ds_read_b64_tr_b16 v[132:133], v22 offset:4352
 v_accvgpr_read_b32 v61, a141
 v_mfma_f32_16x16x32_bf16 v[236:239], a[8:11], a[44:47], v[236:239]
 v_accvgpr_read_b32 v63, a143
 v_fma_f32 v48, v48, v250, v251
 v_mfma_f32_16x16x32_bf16 v[236:239], a[12:15], a[40:43], v[236:239]
 ds_read_b128 a[104:107], v18 offset:2624
 v_mul_f32 v49, v49, v250
 v_mfma_f32_16x16x32_bf16 v[236:239], a[16:19], a[36:39], v[236:239]
 ds_read2_b32 a[76:77], v15 offset0:144 offset1:145
 v_mul_f32 v50, v50, v250
 v_mfma_f32_16x16x32_bf16 v[240:243], a[0:3], a[56:59], 0
 ds_read2_b32 a[78:79], v15 offset0:146 offset1:147
 v_mul_f32 v51, v51, v250
 v_mfma_f32_16x16x32_bf16 v[240:243], a[4:7], a[52:55], v[240:243]
 ds_read_b128 a[108:111], v18 offset:2112
 v_mul_f32 v52, v52, v250
 v_mfma_f32_16x16x32_bf16 v[240:243], a[8:11], a[48:51], v[240:243]
 ds_read_b64_tr_b16 v[134:135], v22 offset:4096
 v_mul_f32 v53, v53, v250
 v_mfma_f32_16x16x32_bf16 v[240:243], a[12:15], a[44:47], v[240:243]
 v_mul_f32 v54, v54, v250
 v_mul_f32 v55, v55, v250
 v_mfma_f32_16x16x32_bf16 v[240:243], a[16:19], a[40:43], v[240:243]
 ds_read_b128 a[112:115], v18 offset:1600
 v_mul_f32 v57, v57, v250
 v_mfma_f32_16x16x32_bf16 v[244:247], a[0:3], a[60:63], 0
 ds_read_b128 a[116:119], v18 offset:1088
 v_mul_f32 v58, v58, v250
 v_mfma_f32_16x16x32_bf16 v[244:247], a[4:7], a[56:59], v[244:247]
 ds_read_b128 a[120:123], v18 offset:576
 v_mul_f32 v60, v60, v250
 v_mfma_f32_16x16x32_bf16 v[244:247], a[8:11], a[52:55], v[244:247]
 ds_read_b128 a[124:127], v18 offset:64
 v_mul_f32 v61, v61, v250
 v_mfma_f32_16x16x32_bf16 v[244:247], a[12:15], a[48:51], v[244:247]
 s_waitcnt lgkmcnt(8)
 s_barrier
 v_mul_f32 v63, v63, v250
 v_mfma_f32_16x16x32_bf16 v[244:247], a[16:19], a[44:47], v[244:247]
 ds_read_b64_tr_b16 v[144:145], v23 offset:0
 v_mov_b32 v56, v57 wave_rol:1 row_mask:0xf bank_mask:0xf
 v_mfma_f32_16x16x32_bf16 v[176:179], a[32:35], a[232:235], 0
 ds_read_b64_tr_b16 v[146:147], v23 offset:8
 v_mov_b32 v59, v60 wave_rol:1 row_mask:0xf bank_mask:0xf
 v_mfma_f32_16x16x32_bf16 v[180:183], a[36:39], a[232:235], 0
 ds_read_b64_tr_b16 v[148:149], v23 offset:64
 v_mov_b32 v56, v48 wave_shl:1 row_mask:0xf bank_mask:0xf
 v_mfma_f32_16x16x32_bf16 v[184:187], a[40:43], a[232:235], 0
 ds_read_b64_tr_b16 v[150:151], v23 offset:72
 v_mov_b32 v59, v57 wave_shl:1 row_mask:0xf bank_mask:0xf
 v_mfma_f32_16x16x32_bf16 v[188:191], a[44:47], a[232:235], 0
 ds_read_b64_tr_b16 v[152:153], v23 offset:512
 v_mov_b32 v55, v56 quad_perm:[0,1,2,3] row_mask:0xc bank_mask:0xf
 v_mfma_f32_16x16x32_bf16 v[160:163], a[212:215], a[228:231], 0
 ds_read_b64_tr_b16 v[154:155], v23 offset:520
 v_and_b32 v60, v60, v5
 v_mfma_f32_16x16x32_bf16 v[164:167], a[216:219], a[228:231], 0
 ds_read_b64_tr_b16 v[156:157], v23 offset:576
 v_and_b32 v62, v61, v12
 v_mfma_f32_16x16x32_bf16 v[168:171], a[220:223], a[228:231], 0
 ds_read_b64_tr_b16 v[158:159], v23 offset:584
 v_xor_b32 v61, v61, v62
 v_mfma_f32_16x16x32_bf16 v[172:175], a[224:227], a[228:231], 0
 s_waitcnt lgkmcnt(8)
 v_cndmask_b32 v20, v60, v62, s[12:13]
 v_cvt_pk_bf16_f32 v21, v61, v63
 v_mfma_f32_16x16x32_bf16 v[216:219], a[64:67], a[96:99], v[216:219]
 ds_read2_b32 a[0:1], v14 offset0:32 offset1:33
 v_cvt_pk_bf16_f32 v6, 0, v48
 v_mfma_f32_16x16x32_bf16 v[220:223], a[64:67], a[100:103], v[220:223]
 ds_read2_b32 a[2:3], v14 offset0:34 offset1:35
 v_cvt_pk_bf16_f32 v96, v48, v49
 v_mfma_f32_16x16x32_bf16 v[220:223], a[68:71], a[96:99], v[220:223]
 ds_read_b128 a[32:35], v18 offset:3712
 v_cvt_pk_bf16_f32 v97, v50, v51
 v_mfma_f32_16x16x32_bf16 v[224:227], a[64:67], a[104:107], v[224:227]
 ds_read2_b32 a[4:5], v14 offset0:160 offset1:161
 v_cvt_pk_bf16_f32 v98, v52, v53
 v_mfma_f32_16x16x32_bf16 v[224:227], a[68:71], a[100:103], v[224:227]
 ds_read_b64_tr_b16 v[136:137], v22 offset:8448
 v_cvt_pk_bf16_f32 v99, v54, v55
 v_mfma_f32_16x16x32_bf16 v[224:227], a[72:75], a[96:99], v[224:227]
 v_cvt_pk_bf16_f32 v100, v49, v50
 v_cvt_pk_bf16_f32 v101, v51, v52
 v_mfma_f32_16x16x32_bf16 v[228:231], a[64:67], a[108:111], v[228:231]
 ds_read2_b32 a[6:7], v14 offset0:162 offset1:163
 v_cvt_pk_bf16_f32 v200, v176, v177
 v_mfma_f32_16x16x32_bf16 v[228:231], a[68:71], a[104:107], v[228:231]
 ds_read_b128 a[36:39], v18 offset:3200
 v_cvt_pk_bf16_f32 v201, v178, v179
 v_mfma_f32_16x16x32_bf16 v[228:231], a[72:75], a[100:103], v[228:231]
 ds_read2_b32 a[8:9], v15 offset0:32 offset1:33
 v_cvt_pk_bf16_f32 v202, v180, v181
 v_mfma_f32_16x16x32_bf16 v[228:231], a[76:79], a[96:99], v[228:231]
 ds_read2_b32 a[10:11], v15 offset0:34 offset1:35
 v_cvt_pk_bf16_f32 v203, v182, v183
 v_mfma_f32_16x16x32_bf16 v[232:235], a[64:67], a[112:115], v[232:235]
 ds_read_b64_tr_b16 v[138:139], v22 offset:8192
 v_cvt_pk_bf16_f32 v204, v184, v185
 v_mfma_f32_16x16x32_bf16 v[232:235], a[68:71], a[108:111], v[232:235]
 v_cvt_pk_bf16_f32 v205, v186, v187
 v_cvt_pk_bf16_f32 v206, v188, v189
 v_mfma_f32_16x16x32_bf16 v[232:235], a[72:75], a[104:107], v[232:235]
 ds_read_b128 a[40:43], v18 offset:2688
 v_cvt_pk_bf16_f32 v207, v190, v191
 v_mfma_f32_16x16x32_bf16 v[232:235], a[76:79], a[100:103], v[232:235]
 ds_read2_b32 a[12:13], v15 offset0:160 offset1:161
 v_cvt_pk_bf16_f32 v192, v160, v161
 v_mfma_f32_16x16x32_bf16 v[236:239], a[64:67], a[116:119], v[236:239]
 ds_read2_b32 a[14:15], v15 offset0:162 offset1:163
 v_cvt_pk_bf16_f32 v193, v162, v163
 v_mfma_f32_16x16x32_bf16 v[236:239], a[68:71], a[112:115], v[236:239]
 ds_read_b128 a[44:47], v18 offset:2176
 v_cvt_pk_bf16_f32 v194, v164, v165
 v_mfma_f32_16x16x32_bf16 v[236:239], a[72:75], a[108:111], v[236:239]
 ds_read_b64_tr_b16 v[140:141], v22 offset:12544
 v_cvt_pk_bf16_f32 v195, v166, v167
 v_mfma_f32_16x16x32_bf16 v[236:239], a[76:79], a[104:107], v[236:239]
 v_cvt_pk_bf16_f32 v196, v168, v169
 v_cvt_pk_bf16_f32 v197, v170, v171
 v_mfma_f32_16x16x32_bf16 v[240:243], a[64:67], a[120:123], v[240:243]
 ds_read_b128 a[48:51], v18 offset:1664
 v_cvt_pk_bf16_f32 v198, v172, v173
 v_mfma_f32_16x16x32_bf16 v[240:243], a[68:71], a[116:119], v[240:243]
 ds_read_b128 a[52:55], v18 offset:1152
 v_cvt_pk_bf16_f32 v199, v174, v175
 v_mfma_f32_16x16x32_bf16 v[240:243], a[72:75], a[112:115], v[240:243]
 ds_read_b128 a[56:59], v18 offset:640
 v_cvt_pk_bf16_f32 v102, v53, v54
 v_mfma_f32_16x16x32_bf16 v[240:243], a[76:79], a[108:111], v[240:243]
 ds_read_b128 a[60:63], v18 offset:128
 v_cvt_pk_bf16_f32 v103, v55, v56
 v_mfma_f32_16x16x32_bf16 v[244:247], a[64:67], a[124:127], v[244:247]
 ds_read_b64_tr_b16 v[142:143], v22 offset:12288
 v_cvt_pk_bf16_f32 v104, v57, v57
 v_mfma_f32_16x16x32_bf16 v[244:247], a[68:71], a[120:123], v[244:247]
 v_cvt_pk_bf16_f32 v105, v57, v58
 v_cvt_pk_bf16_f32 v106, v58, v58
 v_mfma_f32_16x16x32_bf16 v[244:247], a[72:75], a[116:119], v[244:247]
 v_cvt_pk_bf16_f32 v107, v59, v59
 v_cvt_pk_bf16_f32 v108, v57, v57
 v_mfma_f32_16x16x32_bf16 v[244:247], a[76:79], a[112:115], v[244:247]
 s_waitcnt lgkmcnt(1)
 v_cvt_pk_bf16_f32 v109, v58, v58
 v_cvt_pk_bf16_f32 v110, v58, v59
 v_mfma_f32_16x16x32_bf16 v[216:219], a[0:3], a[32:35], v[216:219]
 ds_read2_b32 a[64:65], v14 offset0:48 offset1:49
 v_cvt_pk_bf16_f32 v111, v59, v59
 v_mfma_f32_16x16x32_bf16 v[220:223], a[0:3], a[36:39], v[220:223]
 ds_read2_b32 a[66:67], v14 offset0:50 offset1:51
 v_cvt_pk_bf16_f32 v112, v60, v60
 v_mfma_f32_16x16x32_bf16 v[220:223], a[4:7], a[32:35], v[220:223]
 ds_read_b128 a[96:99], v18 offset:3776
 v_cvt_pk_bf16_f32 v113, v60, v60
 v_mfma_f32_16x16x32_bf16 v[224:227], a[0:3], a[40:43], v[224:227]
 ds_read2_b32 a[68:69], v14 offset0:176 offset1:177
 v_cvt_pk_bf16_f32 v114, v20, v62
 v_mfma_f32_16x16x32_bf16 v[224:227], a[4:7], a[36:39], v[224:227]
 ds_read2_b32 a[70:71], v14 offset0:178 offset1:179
 v_cvt_pk_bf16_f32 v115, v62, v62
 v_mfma_f32_16x16x32_bf16 v[224:227], a[8:11], a[32:35], v[224:227]
 ds_read_b128 a[100:103], v18 offset:3264
 v_cvt_pk_bf16_f32 v116, v60, v60
 v_mfma_f32_16x16x32_bf16 v[228:231], a[0:3], a[44:47], v[228:231]
 ds_read2_b32 a[72:73], v15 offset0:48 offset1:49
 v_cvt_pk_bf16_f32 v117, v60, v20
 v_mfma_f32_16x16x32_bf16 v[228:231], a[4:7], a[40:43], v[228:231]
 ds_read2_b32 a[74:75], v15 offset0:50 offset1:51
 v_cvt_pk_bf16_f32 v118, v62, v62
 v_mfma_f32_16x16x32_bf16 v[228:231], a[8:11], a[36:39], v[228:231]
 ds_read_b128 a[104:107], v18 offset:2752
 v_cvt_pk_bf16_f32 v119, v62, v62
 v_mfma_f32_16x16x32_bf16 v[228:231], a[12:15], a[32:35], v[228:231]
 ds_read2_b32 a[76:77], v15 offset0:176 offset1:177
 v_accvgpr_mov_b32 a128, a144
 v_mfma_f32_16x16x32_bf16 v[232:235], a[0:3], a[48:51], v[232:235]
 ds_read2_b32 a[78:79], v15 offset0:178 offset1:179
 v_accvgpr_mov_b32 a129, a145
 v_mfma_f32_16x16x32_bf16 v[232:235], a[4:7], a[44:47], v[232:235]
 ds_read_b128 a[108:111], v18 offset:2240
 v_accvgpr_mov_b32 a130, a146
 v_mfma_f32_16x16x32_bf16 v[232:235], a[8:11], a[40:43], v[232:235]
 ds_read_b128 a[112:115], v18 offset:1728
 v_accvgpr_mov_b32 a131, a147
 v_mfma_f32_16x16x32_bf16 v[232:235], a[12:15], a[36:39], v[232:235]
 ds_read_b128 a[116:119], v18 offset:1216
 v_accvgpr_mov_b32 a132, a148
 v_mfma_f32_16x16x32_bf16 v[236:239], a[0:3], a[52:55], v[236:239]
 ds_read_b128 a[120:123], v18 offset:704
 v_accvgpr_mov_b32 a133, a149
 v_mfma_f32_16x16x32_bf16 v[236:239], a[4:7], a[48:51], v[236:239]
 ds_read_b128 a[124:127], v18 offset:192
 v_accvgpr_mov_b32 a134, a150
 v_mfma_f32_16x16x32_bf16 v[236:239], a[8:11], a[44:47], v[236:239]
 ds_read2_b32 a[198:199], v17 offset0:24 offset1:25
 v_accvgpr_mov_b32 a135, a151
 v_mfma_f32_16x16x32_bf16 v[236:239], a[12:15], a[40:43], v[236:239]
 ds_read2_b32 a[196:197], v17 offset0:16 offset1:17
 v_accvgpr_mov_b32 a136, a152
 v_mfma_f32_16x16x32_bf16 v[240:243], a[0:3], a[56:59], v[240:243]
 ds_read2_b32 a[194:195], v17 offset0:8 offset1:9
 v_accvgpr_mov_b32 a137, a153
 v_mfma_f32_16x16x32_bf16 v[240:243], a[4:7], a[52:55], v[240:243]
 ds_read2_b32 a[192:193], v17 offset0:0 offset1:1
 v_accvgpr_mov_b32 a138, a154
 v_mfma_f32_16x16x32_bf16 v[240:243], a[8:11], a[48:51], v[240:243]
 ds_read2_b32 a[208:209], v17 offset0:120 offset1:121
 v_accvgpr_mov_b32 a139, a155
 v_mfma_f32_16x16x32_bf16 v[240:243], a[12:15], a[44:47], v[240:243]
 ds_read2_b32 a[206:207], v17 offset0:112 offset1:113
 v_accvgpr_mov_b32 a140, a156
 v_mfma_f32_16x16x32_bf16 v[244:247], a[0:3], a[60:63], v[244:247]
 ds_read2_b32 a[204:205], v17 offset0:104 offset1:105
 v_accvgpr_mov_b32 a141, a157
 v_mfma_f32_16x16x32_bf16 v[244:247], a[4:7], a[56:59], v[244:247]
 ds_read2_b32 a[202:203], v17 offset0:96 offset1:97
 v_accvgpr_mov_b32 a142, a158
 v_mfma_f32_16x16x32_bf16 v[244:247], a[8:11], a[52:55], v[244:247]
 v_accvgpr_mov_b32 a143, a159
 v_accvgpr_mov_b32 a144, a160
 v_mfma_f32_16x16x32_bf16 v[244:247], a[12:15], a[48:51], v[244:247]
 s_waitcnt lgkmcnt(8)
 v_accvgpr_mov_b32 a145, a161
 v_accvgpr_mov_b32 a146, a162
 v_mfma_f32_16x16x32_bf16 v[216:219], a[64:67], a[96:99], v[216:219]
 ds_read2_b32 a[0:1], v14 offset0:64 offset1:65
 v_accvgpr_mov_b32 a147, a163
 v_mfma_f32_16x16x32_bf16 v[220:223], a[64:67], a[100:103], v[220:223]
 ds_read2_b32 a[2:3], v14 offset0:66 offset1:67
 v_accvgpr_mov_b32 a148, a164
 v_mfma_f32_16x16x32_bf16 v[220:223], a[68:71], a[96:99], v[220:223]
 ds_read_b128 a[32:35], v18 offset:3840
 v_accvgpr_mov_b32 a149, a165
 v_mfma_f32_16x16x32_bf16 v[224:227], a[64:67], a[104:107], v[224:227]
 ds_read2_b32 a[4:5], v14 offset0:192 offset1:193
 v_accvgpr_mov_b32 a150, a166
 v_mfma_f32_16x16x32_bf16 v[224:227], a[68:71], a[100:103], v[224:227]
 ds_read2_b32 a[6:7], v14 offset0:194 offset1:195
 v_accvgpr_mov_b32 a151, a167
 v_mfma_f32_16x16x32_bf16 v[224:227], a[72:75], a[96:99], v[224:227]
 ds_read_b128 a[36:39], v18 offset:3328
 v_accvgpr_mov_b32 a152, a168
 v_mfma_f32_16x16x32_bf16 v[228:231], a[64:67], a[108:111], v[228:231]
 ds_read2_b32 a[8:9], v15 offset0:64 offset1:65
 v_accvgpr_mov_b32 a153, a169
 v_mfma_f32_16x16x32_bf16 v[228:231], a[68:71], a[104:107], v[228:231]
 ds_read2_b32 a[10:11], v15 offset0:66 offset1:67
 v_accvgpr_mov_b32 a154, a170
 v_mfma_f32_16x16x32_bf16 v[228:231], a[72:75], a[100:103], v[228:231]
 ds_read_b128 a[40:43], v18 offset:2816
 v_accvgpr_mov_b32 a155, a171
 v_mfma_f32_16x16x32_bf16 v[228:231], a[76:79], a[96:99], v[228:231]
 ds_read2_b32 a[12:13], v15 offset0:192 offset1:193
 v_accvgpr_mov_b32 a156, a172
 v_mfma_f32_16x16x32_bf16 v[232:235], a[64:67], a[112:115], v[232:235]
 buffer_store_dwordx4 v[144:147], v26, s[16:19], s27 offen sc1
 s_add_u32 s27, s27, 147456
 v_mfma_f32_16x16x32_bf16 v[232:235], a[68:71], a[108:111], v[232:235]
 ds_read2_b32 a[14:15], v15 offset0:194 offset1:195
 v_accvgpr_mov_b32 a157, a173
 v_mfma_f32_16x16x32_bf16 v[232:235], a[72:75], a[104:107], v[232:235]
 ds_read_b128 a[44:47], v18 offset:2304
 v_accvgpr_mov_b32 a158, a174
 v_mfma_f32_16x16x32_bf16 v[232:235], a[76:79], a[100:103], v[232:235]
 ds_read_b128 a[48:51], v18 offset:1792
 v_accvgpr_mov_b32 a159, a175
 s_waitcnt lgkmcnt(15)
 v_mfma_f32_16x16x32_bf16 v[232:235], v[192:195], a[198:201], v[232:235]
 ds_read_b128 a[52:55], v18 offset:1280
 v_mov_b32 v250, v252
 v_mfma_f32_16x16x32_bf16 v[232:235], v[200:203], a[208:211], v[232:235]
 ds_read_b128 a[56:59], v18 offset:768
 v_mov_b32 v251, v253
 v_mfma_f32_16x16x32_bf16 v[236:239], a[64:67], a[116:119], v[236:239]
 ds_read_b128 a[60:63], v18 offset:256
 v_mov_b32 v252, v254
 v_mfma_f32_16x16x32_bf16 v[236:239], a[68:71], a[112:115], v[236:239]
 ds_read2_b32 a[16:17], v14 offset0:96 offset1:97
 v_mov_b32 v253, v255
 v_mfma_f32_16x16x32_bf16 v[236:239], a[72:75], a[108:111], v[236:239]
 ds_read2_b32 a[18:19], v14 offset0:98 offset1:99
 v_readlane_b32 s28, v94, 0
 v_mfma_f32_16x16x32_bf16 v[236:239], a[76:79], a[104:107], v[236:239]
 ds_read2_b32 a[20:21], v14 offset0:224 offset1:225
 v_readlane_b32 s29, v94, 1
 v_mfma_f32_16x16x32_bf16 v[236:239], v[192:195], a[196:199], v[236:239]
 ds_read2_b32 a[22:23], v14 offset0:226 offset1:227
 v_readlane_b32 s39, v94, 2
 v_mfma_f32_16x16x32_bf16 v[236:239], v[200:203], a[206:209], v[236:239]
 buffer_store_dwordx4 v[148:151], v26, s[16:19], s27 offen sc1
 s_add_u32 s27, s27, 147456
 v_mfma_f32_16x16x32_bf16 v[240:243], a[64:67], a[120:123], v[240:243]
 ds_read2_b32 a[24:25], v15 offset0:96 offset1:97
 v_readlane_b32 s49, v94, 3
 v_mfma_f32_16x16x32_bf16 v[240:243], a[68:71], a[116:119], v[240:243]
 ds_read2_b32 a[26:27], v15 offset0:98 offset1:99
 v_readlane_b32 s56, v94, 4
 v_mfma_f32_16x16x32_bf16 v[240:243], a[72:75], a[112:115], v[240:243]
 ds_read2_b32 a[28:29], v15 offset0:224 offset1:225
 v_readlane_b32 s59, v94, 5
 v_mfma_f32_16x16x32_bf16 v[240:243], a[76:79], a[108:111], v[240:243]
 ds_read2_b32 a[30:31], v15 offset0:226 offset1:227
 v_readlane_b32 s60, v94, 6
 v_mfma_f32_16x16x32_bf16 v[240:243], v[192:195], a[194:197], v[240:243]
 ds_read2_b32 a[80:81], v14 offset0:112 offset1:113
 v_readlane_b32 s61, v94, 7
 v_mfma_f32_16x16x32_bf16 v[240:243], v[196:199], a[198:201], v[240:243]
 ds_read2_b32 a[82:83], v14 offset0:114 offset1:115
 v_readlane_b32 s86, v94, 8
 s_waitcnt lgkmcnt(15)
 v_mfma_f32_16x16x32_bf16 v[240:243], v[200:203], a[204:207], v[240:243]
 ds_read2_b32 a[84:85], v14 offset0:240 offset1:241
 v_readlane_b32 s87, v94, 9
 v_mfma_f32_16x16x32_bf16 v[240:243], v[204:207], a[208:211], v[240:243]
 ds_read2_b32 a[86:87], v14 offset0:242 offset1:243
 v_readlane_b32 s72, v94, 10
 v_mfma_f32_16x16x32_bf16 v[244:247], a[64:67], a[124:127], v[244:247]
 ds_read2_b32 a[88:89], v15 offset0:112 offset1:113
 v_readlane_b32 s73, v94, 11
 v_mfma_f32_16x16x32_bf16 v[244:247], a[68:71], a[120:123], v[244:247]
 ds_read2_b32 a[90:91], v15 offset0:114 offset1:115
 v_readlane_b32 s74, v94, 12
 v_mfma_f32_16x16x32_bf16 v[244:247], a[72:75], a[116:119], v[244:247]
 ds_read2_b32 a[92:93], v15 offset0:240 offset1:241
 v_readlane_b32 s75, v94, 13
 v_mfma_f32_16x16x32_bf16 v[244:247], a[76:79], a[112:115], v[244:247]
 ds_read2_b32 a[94:95], v15 offset0:242 offset1:243
 v_readlane_b32 s76, v94, 14
 v_mfma_f32_16x16x32_bf16 v[244:247], v[192:195], a[192:195], v[244:247]
 ds_write_b128 v24, v[128:131] offset:768
 v_readlane_b32 s77, v94, 15
 v_mfma_f32_16x16x32_bf16 v[244:247], v[196:199], a[196:199], v[244:247]
 v_readlane_b32 s62, v94, 16
 v_readlane_b32 s63, v94, 17
 v_mfma_f32_16x16x32_bf16 v[244:247], v[200:203], a[202:205], v[244:247]
 v_readlane_b32 s83, v94, 18
 v_readlane_b32 s78, v94, 19
 v_mfma_f32_16x16x32_bf16 v[244:247], v[204:207], a[206:209], v[244:247]
 s_waitcnt lgkmcnt(15)
 v_readlane_b32 s79, v94, 20
 v_readlane_b32 s0, v94, 21
 v_mfma_f32_16x16x32_bf16 v[216:219], a[0:3], a[32:35], v[216:219]
 ds_read2_b32 a[64:65], v14 offset0:80 offset1:81
 v_mfma_f32_16x16x32_bf16 v[220:223], a[0:3], a[36:39], v[220:223]
 ds_read2_b32 a[66:67], v14 offset0:82 offset1:83
 v_mfma_f32_16x16x32_bf16 v[220:223], a[4:7], a[32:35], v[220:223]
 ds_read_b128 a[96:99], v18 offset:3904
 v_mfma_f32_16x16x32_bf16 v[224:227], a[0:3], a[40:43], v[224:227]
 ds_read2_b32 a[68:69], v14 offset0:208 offset1:209
 v_mfma_f32_16x16x32_bf16 v[224:227], a[4:7], a[36:39], v[224:227]
 ds_read2_b32 a[70:71], v14 offset0:210 offset1:211
 v_mfma_f32_16x16x32_bf16 v[224:227], a[8:11], a[32:35], v[224:227]
 ds_write_b128 v24, v[132:135] offset:512
 v_mfma_f32_16x16x32_bf16 v[228:231], a[0:3], a[44:47], v[228:231]
 v_mfma_f32_16x16x32_bf16 v[228:231], a[4:7], a[40:43], v[228:231]
 v_mfma_f32_16x16x32_bf16 v[228:231], a[8:11], a[36:39], v[228:231]
 ds_read_b128 a[100:103], v18 offset:3392
 v_mfma_f32_16x16x32_bf16 v[228:231], a[12:15], a[32:35], v[228:231]
 ds_read2_b32 a[72:73], v15 offset0:80 offset1:81
 v_mfma_f32_16x16x32_bf16 v[232:235], a[0:3], a[48:51], v[232:235]
 ds_read2_b32 a[74:75], v15 offset0:82 offset1:83
 v_mfma_f32_16x16x32_bf16 v[232:235], a[4:7], a[44:47], v[232:235]
 ds_read_b128 a[104:107], v18 offset:2880
 v_mfma_f32_16x16x32_bf16 v[232:235], a[8:11], a[40:43], v[232:235]
 ds_read2_b32 a[76:77], v15 offset0:208 offset1:209
 v_mfma_f32_16x16x32_bf16 v[232:235], a[12:15], a[36:39], v[232:235]
 buffer_store_dwordx4 v[152:155], v26, s[16:19], s27 offen sc1
 s_add_u32 s27, s27, 147456
 v_mfma_f32_16x16x32_bf16 v[236:239], a[0:3], a[52:55], v[236:239]
 v_mfma_f32_16x16x32_bf16 v[236:239], a[4:7], a[48:51], v[236:239]
 ds_read2_b32 a[78:79], v15 offset0:210 offset1:211
 v_mfma_f32_16x16x32_bf16 v[236:239], a[8:11], a[44:47], v[236:239]
 ds_read_b128 a[108:111], v18 offset:2368
 v_mfma_f32_16x16x32_bf16 v[236:239], a[12:15], a[40:43], v[236:239]
 ds_read_b128 a[112:115], v18 offset:1856
 v_mfma_f32_16x16x32_bf16 v[240:243], a[0:3], a[56:59], v[240:243]
 ds_read_b128 a[116:119], v18 offset:1344
 v_mfma_f32_16x16x32_bf16 v[240:243], a[4:7], a[52:55], v[240:243]
 ds_read_b128 a[120:123], v18 offset:832
 v_mfma_f32_16x16x32_bf16 v[240:243], a[8:11], a[48:51], v[240:243]
 ds_read_b128 a[124:127], v18 offset:320
 v_mfma_f32_16x16x32_bf16 v[240:243], a[12:15], a[44:47], v[240:243]
 ds_write_b128 v24, v[136:139] offset:256
 v_mfma_f32_16x16x32_bf16 v[244:247], a[0:3], a[60:63], v[244:247]
 v_mfma_f32_16x16x32_bf16 v[244:247], a[4:7], a[56:59], v[244:247]
 v_mfma_f32_16x16x32_bf16 v[244:247], a[8:11], a[52:55], v[244:247]
 v_mfma_f32_16x16x32_bf16 v[244:247], a[12:15], a[48:51], v[244:247]
 s_waitcnt lgkmcnt(0)
 v_mfma_f32_16x16x32_bf16 v[216:219], a[64:67], a[96:99], v[216:219]
 ds_read_b128 a[32:35], v18 offset:3968
 v_mfma_f32_16x16x32_bf16 v[220:223], a[64:67], a[100:103], v[220:223]
 ds_write_b128 v24, v[140:143] offset:0
 v_mfma_f32_16x16x32_bf16 v[220:223], a[68:71], a[96:99], v[220:223]
 v_mfma_f32_16x16x32_bf16 v[224:227], a[64:67], a[104:107], v[224:227]
 v_mfma_f32_16x16x32_bf16 v[224:227], a[68:71], a[100:103], v[224:227]
 ds_read_b128 a[36:39], v18 offset:3456
 v_mfma_f32_16x16x32_bf16 v[224:227], a[72:75], a[96:99], v[224:227]
 buffer_store_dwordx4 v[156:159], v26, s[16:19], s27 offen sc1
 s_add_u32 s27, s27, 147456
 v_mfma_f32_16x16x32_bf16 v[228:231], a[64:67], a[108:111], v[228:231]
 ds_read_b128 a[40:43], v18 offset:2944
 v_mfma_f32_16x16x32_bf16 v[228:231], a[68:71], a[104:107], v[228:231]
Lpg18:
 s_cbranch_vccnz Lj_Lfin
 ds_write_b32 v11, v6
 v_mfma_f32_16x16x32_bf16 v[228:231], a[72:75], a[100:103], v[228:231]
 v_mfma_f32_16x16x32_bf16 v[228:231], a[76:79], a[96:99], v[228:231]
 ds_read_b128 a[44:47], v18 offset:2432
 v_mfma_f32_16x16x32_bf16 v[232:235], a[64:67], a[112:115], v[232:235]
 ds_write_b16 v10, v21 offset:32
 v_mfma_f32_16x16x32_bf16 v[232:235], a[68:71], a[108:111], v[232:235]
 ds_read_b128 a[48:51], v18 offset:1920
 v_mfma_f32_16x16x32_bf16 v[232:235], a[72:75], a[104:107], v[232:235]
 ds_write_b16_d16_hi v10, v21 offset:0
 v_mfma_f32_16x16x32_bf16 v[232:235], a[76:79], a[100:103], v[232:235]
 ds_read_b128 a[52:55], v18 offset:1408
 v_mfma_f32_16x16x32_bf16 v[236:239], a[64:67], a[116:119], v[236:239]
 ds_read_b128 a[56:59], v18 offset:896
 v_mfma_f32_16x16x32_bf16 v[236:239], a[68:71], a[112:115], v[236:239]
 ds_read_b128 a[60:63], v18 offset:384
 v_mfma_f32_16x16x32_bf16 v[236:239], a[72:75], a[108:111], v[236:239]
 ds_write_b16 v10, v21 offset:222
 v_mfma_f32_16x16x32_bf16 v[236:239], a[76:79], a[104:107], v[236:239]
 ds_write_b16_d16_hi v10, v21 offset:190
 v_mfma_f32_16x16x32_bf16 v[240:243], a[64:67], a[120:123], v[240:243]
 ds_write_b128 v9, v[96:99] offset:32
 v_mfma_f32_16x16x32_bf16 v[240:243], a[68:71], a[116:119], v[240:243]
 v_mfma_f32_16x16x32_bf16 v[240:243], a[72:75], a[112:115], v[240:243]
 v_mfma_f32_16x16x32_bf16 v[240:243], a[76:79], a[108:111], v[240:243]
 ds_write_b128 v9, v[100:103] offset:4192
 v_mfma_f32_16x16x32_bf16 v[244:247], a[64:67], a[124:127], v[244:247]
 v_mfma_f32_16x16x32_bf16 v[244:247], a[68:71], a[120:123], v[244:247]
 v_mfma_f32_16x16x32_bf16 v[244:247], a[72:75], a[116:119], v[244:247]
 v_mfma_f32_16x16x32_bf16 v[244:247], a[76:79], a[112:115], v[244:247]
 s_waitcnt lgkmcnt(4)
 v_mfma_f32_16x16x32_bf16 v[216:219], a[16:19], a[32:35], v[216:219]
 ds_read_b128 a[96:99], v18 offset:4032
 v_mfma_f32_16x16x32_bf16 v[220:223], a[16:19], a[36:39], v[220:223]
 ds_read_b128 a[100:103], v18 offset:3520
 v_mfma_f32_16x16x32_bf16 v[220:223], a[20:23], a[32:35], v[220:223]
 ds_write_b128 v9, v[104:107] offset:1056
 v_mfma_f32_16x16x32_bf16 v[224:227], a[16:19], a[40:43], v[224:227]
 s_cmp_eq_u32 s50, 2
 s_cselect_b32 s36, s60, 59264
 s_cselect_b32 s37, s28, 55424
 v_mfma_f32_16x16x32_bf16 v[224:227], a[20:23], a[36:39], v[224:227]
 s_load_dwordx4 s[40:43], s[88:89], s36 offset:4224
 s_load_dword s64, s[88:89], s37 offset:8320
 v_mfma_f32_16x16x32_bf16 v[224:227], a[24:27], a[32:35], v[224:227]
 ds_read_b128 a[104:107], v18 offset:3008
 v_mfma_f32_16x16x32_bf16 v[228:231], a[16:19], a[44:47], v[228:231]
 ds_read_b128 a[108:111], v18 offset:2496
 v_mfma_f32_16x16x32_bf16 v[228:231], a[20:23], a[40:43], v[228:231]
 ds_write_b128 v9, v[108:111] offset:5216
 v_mfma_f32_16x16x32_bf16 v[228:231], a[24:27], a[36:39], v[228:231]
 v_mfma_f32_16x16x32_bf16 v[228:231], a[28:31], a[32:35], v[228:231]
 v_mfma_f32_16x16x32_bf16 v[232:235], a[16:19], a[48:51], v[232:235]
 ds_read_b128 a[112:115], v18 offset:1984
 v_mfma_f32_16x16x32_bf16 v[232:235], a[20:23], a[44:47], v[232:235]
 ds_read_b128 a[116:119], v18 offset:1472
 v_mfma_f32_16x16x32_bf16 v[232:235], a[24:27], a[40:43], v[232:235]
 ds_write_b128 v9, v[112:115] offset:2080
 v_mfma_f32_16x16x32_bf16 v[232:235], a[28:31], a[36:39], v[232:235]
 v_mfma_f32_16x16x32_bf16 v[236:239], a[16:19], a[52:55], v[236:239]
 v_mfma_f32_16x16x32_bf16 v[236:239], a[20:23], a[48:51], v[236:239]
 ds_read_b128 a[120:123], v18 offset:960
 v_mfma_f32_16x16x32_bf16 v[236:239], a[24:27], a[44:47], v[236:239]
 ds_read_b128 a[124:127], v18 offset:448
 v_mfma_f32_16x16x32_bf16 v[236:239], a[28:31], a[40:43], v[236:239]
 ds_write_b128 v9, v[116:119] offset:6240
 v_mfma_f32_16x16x32_bf16 v[240:243], a[16:19], a[56:59], v[240:243]
 v_mfma_f32_16x16x32_bf16 v[240:243], a[20:23], a[52:55], v[240:243]
 v_mfma_f32_16x16x32_bf16 v[240:243], a[24:27], a[48:51], v[240:243]
 v_mfma_f32_16x16x32_bf16 v[240:243], a[28:31], a[44:47], v[240:243]
 ds_read2_b32 a[0:1], v14 offset0:0 offset1:1
 v_mfma_f32_16x16x32_bf16 v[244:247], a[16:19], a[60:63], v[244:247]
 ds_read2_b32 a[2:3], v14 offset0:2 offset1:3
 v_mfma_f32_16x16x32_bf16 v[244:247], a[20:23], a[56:59], v[244:247]
 ds_read2_b32 a[4:5], v14 offset0:128 offset1:129
 v_mfma_f32_16x16x32_bf16 v[244:247], a[24:27], a[52:55], v[244:247]
 ds_read2_b32 a[6:7], v14 offset0:130 offset1:131
 v_mfma_f32_16x16x32_bf16 v[244:247], a[28:31], a[48:51], v[244:247]
 s_waitcnt lgkmcnt(5)
 s_barrier
 v_mfma_f32_16x16x32_bf16 v[216:219], a[80:83], a[96:99], v[216:219]
 ds_read_b128 a[32:35], v27 offset:3584
 v_subrev_u32 v23, s54, v23
 v_mfma_f32_16x16x32_bf16 v[220:223], a[80:83], a[100:103], v[220:223]
 ds_read_b128 a[36:39], v27 offset:3072
 v_add_u32 v22, 8, v22
 v_mfma_f32_16x16x32_bf16 v[220:223], a[84:87], a[96:99], v[220:223]
 ds_read2_b32 a[8:9], v15 offset0:0 offset1:1
 v_subrev_u32 v24, s54, v24
 v_mfma_f32_16x16x32_bf16 v[224:227], a[80:83], a[104:107], v[224:227]
 ds_read2_b32 a[10:11], v15 offset0:2 offset1:3
 v_add_u32 v18, s54, v18
 v_mfma_f32_16x16x32_bf16 v[224:227], a[84:87], a[100:103], v[224:227]
 ds_read_b128 a[40:43], v27 offset:2560
 v_cvt_pk_bf16_f32 v216, v216, v217
 v_mfma_f32_16x16x32_bf16 v[224:227], a[88:91], a[96:99], v[224:227]
 s_mov_b32 s27, s26
 v_cvt_pk_bf16_f32 v217, v218, v219
 v_mfma_f32_16x16x32_bf16 v[228:231], a[80:83], a[108:111], v[228:231]
 ds_write_b64 v19, v[216:217] offset:3072
 v_cvt_pk_bf16_f32 v220, v220, v221
 v_mfma_f32_16x16x32_bf16 v[228:231], a[84:87], a[104:107], v[228:231]
 ds_read2_b32 a[12:13], v15 offset0:128 offset1:129
 v_cvt_pk_bf16_f32 v221, v222, v223
 v_mfma_f32_16x16x32_bf16 v[228:231], a[88:91], a[100:103], v[228:231]
 ds_read2_b32 a[14:15], v15 offset0:130 offset1:131
 s_add_u32 s26, s26, 256
 v_mfma_f32_16x16x32_bf16 v[228:231], a[92:95], a[96:99], v[228:231]
 ds_write_b64 v19, v[220:221] offset:3584
 v_cvt_pk_bf16_f32 v224, v224, v225
 v_mfma_f32_16x16x32_bf16 v[232:235], a[80:83], a[112:115], v[232:235]
 ds_read_b128 a[44:47], v27 offset:2048
 v_cvt_pk_bf16_f32 v225, v226, v227
 v_mfma_f32_16x16x32_bf16 v[232:235], a[84:87], a[108:111], v[232:235]
 ds_read2_b32 a[16:17], v16 offset0:0 offset1:1
 s_add_u32 s50, s50, 1
 v_mfma_f32_16x16x32_bf16 v[232:235], a[88:91], a[104:107], v[232:235]
 ds_read2_b32 a[18:19], v16 offset0:2 offset1:3
 v_mfma_f32_16x16x32_bf16 v[232:235], a[92:95], a[100:103], v[232:235]
 ds_write_b64 v19, v[224:225] offset:2048
 v_cvt_pk_bf16_f32 v228, v228, v229
 v_mfma_f32_16x16x32_bf16 v[236:239], a[80:83], a[116:119], v[236:239]
 ds_read_b128 a[48:51], v27 offset:1536
 v_cvt_pk_bf16_f32 v229, v230, v231
 v_mfma_f32_16x16x32_bf16 v[236:239], a[84:87], a[112:115], v[236:239]
 ds_read_b128 a[52:55], v27 offset:1024
 v_mfma_f32_16x16x32_bf16 v[236:239], a[88:91], a[108:111], v[236:239]
 ds_write_b64 v19, v[228:229] offset:2560
 v_mfma_f32_16x16x32_bf16 v[236:239], a[92:95], a[104:107], v[236:239]
 ds_read_b128 a[56:59], v27 offset:512
 v_cvt_pk_bf16_f32 v232, v232, v233
 v_mfma_f32_16x16x32_bf16 v[240:243], a[80:83], a[120:123], v[240:243]
 ds_read_b128 a[60:63], v27 offset:0
 v_cvt_pk_bf16_f32 v233, v234, v235
 v_mfma_f32_16x16x32_bf16 v[240:243], a[84:87], a[116:119], v[240:243]
 ds_write_b64 v19, v[232:233] offset:1024
 v_subrev_u32 v27, s54, v27
 v_mfma_f32_16x16x32_bf16 v[240:243], a[88:91], a[112:115], v[240:243]
 s_sub_u32 s54, 0, s54
 v_mfma_f32_16x16x32_bf16 v[240:243], a[92:95], a[108:111], v[240:243]
 v_cvt_pk_bf16_f32 v236, v236, v237
 v_cvt_pk_bf16_f32 v237, v238, v239
 v_mfma_f32_16x16x32_bf16 v[244:247], a[80:83], a[124:127], v[244:247]
 ds_write_b64 v19, v[236:237] offset:1536
 v_mfma_f32_16x16x32_bf16 v[244:247], a[84:87], a[120:123], v[244:247]
 v_mfma_f32_16x16x32_bf16 v[244:247], a[88:91], a[116:119], v[244:247]
 s_waitcnt lgkmcnt(2)
 v_mfma_f32_16x16x32_bf16 v[244:247], a[92:95], a[112:115], v[244:247]
 s_cmp_lt_u32 s50, 3
 s_cbranch_scc1 Ls_loop
 s_waitcnt vmcnt(0) lgkmcnt(0)
 v_mfma_f32_16x16x32_bf16 v[216:219], a[0:3], a[32:35], 0
 ds_read_b128 a[212:215], v18 offset:3600
 s_movk_i32 s30, 4096
 s_mov_b32 s31, 147456
 v_mfma_f32_16x16x32_bf16 v[220:223], a[0:3], a[36:39], 0
 ds_read_b128 a[216:219], v18 offset:3088
 s_mul_i32 s42, s42, 16843009
 s_and_b32 s40, s40, s41
 v_mfma_f32_16x16x32_bf16 v[220:223], a[4:7], a[32:35], v[220:223]
 ds_read_b128 a[220:223], v18 offset:2576
 s_and_b32 s40, s40, s42
 v_mfma_f32_16x16x32_bf16 v[224:227], a[0:3], a[40:43], 0
 ds_read_b128 a[224:227], v18 offset:2064
 s_cmp_eq_u32 s40, 16843009
 s_cbranch_scc0 Lsp_hw
Lrt_hw:
 v_mfma_f32_16x16x32_bf16 v[224:227], a[4:7], a[36:39], v[224:227]
 s_cmp_eq_u32 s64, 0x10101
 s_cbranch_scc0 Lsp_hp0
Lrt_hp0:
 v_lshlrev_b32 v24, 4, v0
 v_mfma_f32_16x16x32_bf16 v[224:227], a[8:11], a[32:35], v[224:227]
 ds_read2_b32 a[64:65], v14 offset0:16 offset1:17
 v_add_u32 v5, 4096, v24
 v_mfma_f32_16x16x32_bf16 v[228:231], a[0:3], a[44:47], 0
 ds_read2_b32 a[66:67], v14 offset0:18 offset1:19
 v_add_u32 v6, 8192, v24
 v_mfma_f32_16x16x32_bf16 v[228:231], a[4:7], a[40:43], v[228:231]
 ds_read_b128 a[96:99], v18 offset:3648
 v_cvt_pk_bf16_f32 v240, v240, v241
 v_mfma_f32_16x16x32_bf16 v[228:231], a[8:11], a[36:39], v[228:231]
 ds_read2_b32 a[68:69], v14 offset0:144 offset1:145
 v_cvt_pk_bf16_f32 v241, v242, v243
 v_mfma_f32_16x16x32_bf16 v[228:231], a[12:15], a[32:35], v[228:231]
 ds_write_b64 v19, v[240:241] offset:0
 v_add_u32 v7, 147456, v24
 v_mfma_f32_16x16x32_bf16 v[232:235], a[0:3], a[48:51], 0
 ds_read2_b32 a[70:71], v14 offset0:146 offset1:147
 v_add_u32 v8, 126976, v24
 v_mfma_f32_16x16x32_bf16 v[232:235], a[4:7], a[44:47], v[232:235]
 ds_read_b128 a[100:103], v18 offset:3136
 v_cvt_pk_bf16_f32 v244, v244, v245
 v_mfma_f32_16x16x32_bf16 v[232:235], a[8:11], a[40:43], v[232:235]
 ds_read2_b32 a[72:73], v15 offset0:16 offset1:17
 v_cvt_pk_bf16_f32 v245, v246, v247
 v_mfma_f32_16x16x32_bf16 v[232:235], a[12:15], a[36:39], v[232:235]
 ds_write_b64 v19, v[244:245] offset:512
 v_add_u32 v9, 90112, v24
 v_mfma_f32_16x16x32_bf16 v[232:235], a[16:19], a[32:35], v[232:235]
 ds_read2_b32 a[74:75], v15 offset0:18 offset1:19
 v_subrev_u32 v19, s54, v19
 v_mfma_f32_16x16x32_bf16 v[236:239], a[0:3], a[52:55], 0
 ds_read_b128 a[104:107], v18 offset:2624
 v_add_u32 v13, 53248, v24
 v_mfma_f32_16x16x32_bf16 v[236:239], a[4:7], a[48:51], v[236:239]
 ds_read2_b32 a[76:77], v15 offset0:144 offset1:145
 v_add_u32 v25, 0, v24
 v_mfma_f32_16x16x32_bf16 v[236:239], a[8:11], a[44:47], v[236:239]
 ds_read2_b32 a[78:79], v15 offset0:146 offset1:147
 v_mov_b32 v1, 0
 v_mfma_f32_16x16x32_bf16 v[236:239], a[12:15], a[40:43], v[236:239]
 v_mov_b32 v2, 1
 v_mfma_f32_16x16x32_bf16 v[236:239], a[16:19], a[36:39], v[236:239]
 ds_read_b128 a[108:111], v18 offset:2112
 s_mul_i32 s84, s62, 442368
 v_mfma_f32_16x16x32_bf16 v[240:243], a[0:3], a[56:59], 0
 ds_read_b128 a[112:115], v18 offset:1600
 s_add_u32 s84, s84, s86
 v_mfma_f32_16x16x32_bf16 v[240:243], a[4:7], a[52:55], v[240:243]
 ds_read_b128 a[116:119], v18 offset:1088
 s_add_u32 m0, s56, 126976
 v_mfma_f32_16x16x32_bf16 v[240:243], a[8:11], a[48:51], v[240:243]
 ds_read_b128 a[120:123], v18 offset:576
 v_mfma_f32_16x16x32_bf16 v[240:243], a[12:15], a[44:47], v[240:243]
 buffer_load_dwordx4 v24, s[16:19], s84 offen sc1 lds
 v_mfma_f32_16x16x32_bf16 v[240:243], a[16:19], a[40:43], v[240:243]
 ds_read_b128 a[124:127], v18 offset:64
 buffer_load_dwordx4 v24, s[16:19], s84 offen offset:1024 sc1 lds
 v_mfma_f32_16x16x32_bf16 v[244:247], a[0:3], a[60:63], 0
 s_waitcnt lgkmcnt(8)
 s_barrier
 v_mfma_f32_16x16x32_bf16 v[244:247], a[4:7], a[56:59], v[244:247]
 ds_read_b64_tr_b16 v[144:145], v23 offset:0
 v_mfma_f32_16x16x32_bf16 v[244:247], a[8:11], a[52:55], v[244:247]
 v_mfma_f32_16x16x32_bf16 v[244:247], a[12:15], a[48:51], v[244:247]
 ds_read_b64_tr_b16 v[146:147], v23 offset:8
 buffer_load_dwordx4 v24, s[16:19], s84 offen offset:2048 sc1 lds
 v_mfma_f32_16x16x32_bf16 v[244:247], a[16:19], a[44:47], v[244:247]
 ds_read_b64_tr_b16 v[148:149], v23 offset:64
 v_mfma_f32_16x16x32_bf16 v[176:179], a[32:35], a[232:235], 0
 ds_read_b64_tr_b16 v[150:151], v23 offset:72
 v_mfma_f32_16x16x32_bf16 v[180:183], a[36:39], a[232:235], 0
 ds_read_b64_tr_b16 v[152:153], v23 offset:512
 v_mfma_f32_16x16x32_bf16 v[184:187], a[40:43], a[232:235], 0
 v_mfma_f32_16x16x32_bf16 v[188:191], a[44:47], a[232:235], 0
 ds_read_b64_tr_b16 v[154:155], v23 offset:520
 buffer_load_dwordx4 v24, s[16:19], s84 offen offset:3072 sc1 lds
 v_mfma_f32_16x16x32_bf16 v[160:163], a[212:215], a[228:231], 0
 ds_read_b64_tr_b16 v[156:157], v23 offset:576
 s_add_u32 m0, m0, s30
 v_mfma_f32_16x16x32_bf16 v[164:167], a[216:219], a[228:231], 0
 ds_read_b64_tr_b16 v[158:159], v23 offset:584
 v_mfma_f32_16x16x32_bf16 v[168:171], a[220:223], a[228:231], 0
 v_mfma_f32_16x16x32_bf16 v[172:175], a[224:227], a[228:231], 0
 s_waitcnt lgkmcnt(8)
 buffer_load_dwordx4 v5, s[16:19], s84 offen sc1 lds
 v_mfma_f32_16x16x32_bf16 v[216:219], a[64:67], a[96:99], v[216:219]
 ds_read2_b32 a[0:1], v14 offset0:32 offset1:33
 v_mfma_f32_16x16x32_bf16 v[220:223], a[64:67], a[100:103], v[220:223]
 ds_read2_b32 a[2:3], v14 offset0:34 offset1:35
 v_mfma_f32_16x16x32_bf16 v[220:223], a[68:71], a[96:99], v[220:223]
 ds_read_b128 a[32:35], v18 offset:3712
 v_mfma_f32_16x16x32_bf16 v[224:227], a[64:67], a[104:107], v[224:227]
 v_mfma_f32_16x16x32_bf16 v[224:227], a[68:71], a[100:103], v[224:227]
 ds_read2_b32 a[4:5], v14 offset0:160 offset1:161
 buffer_load_dwordx4 v5, s[16:19], s84 offen offset:1024 sc1 lds
 v_mfma_f32_16x16x32_bf16 v[224:227], a[72:75], a[96:99], v[224:227]
 ds_read2_b32 a[6:7], v14 offset0:162 offset1:163
 v_mfma_f32_16x16x32_bf16 v[228:231], a[64:67], a[108:111], v[228:231]
 ds_read_b128 a[36:39], v18 offset:3200
 v_cvt_pk_bf16_f32 v200, v176, v177
 v_mfma_f32_16x16x32_bf16 v[228:231], a[68:71], a[104:107], v[228:231]
 v_cvt_pk_bf16_f32 v201, v178, v179
 v_cvt_pk_bf16_f32 v202, v180, v181
 v_mfma_f32_16x16x32_bf16 v[228:231], a[72:75], a[100:103], v[228:231]
 ds_read2_b32 a[8:9], v15 offset0:32 offset1:33
 v_cvt_pk_bf16_f32 v203, v182, v183
 v_mfma_f32_16x16x32_bf16 v[228:231], a[76:79], a[96:99], v[228:231]
 ds_read2_b32 a[10:11], v15 offset0:34 offset1:35
 v_cvt_pk_bf16_f32 v204, v184, v185
 v_mfma_f32_16x16x32_bf16 v[232:235], a[64:67], a[112:115], v[232:235]
 buffer_load_dwordx4 v5, s[16:19], s84 offen offset:2048 sc1 lds
 v_cvt_pk_bf16_f32 v205, v186, v187
 v_cvt_pk_bf16_f32 v206, v188, v189
 v_mfma_f32_16x16x32_bf16 v[232:235], a[68:71], a[108:111], v[232:235]
 ds_read_b128 a[40:43], v18 offset:2688
 v_cvt_pk_bf16_f32 v207, v190, v191
 v_mfma_f32_16x16x32_bf16 v[232:235], a[72:75], a[104:107], v[232:235]
 ds_read2_b32 a[12:13], v15 offset0:160 offset1:161
 v_cvt_pk_bf16_f32 v192, v160, v161
 v_mfma_f32_16x16x32_bf16 v[232:235], a[76:79], a[100:103], v[232:235]
 ds_read2_b32 a[14:15], v15 offset0:162 offset1:163
 v_cvt_pk_bf16_f32 v193, v162, v163
 v_mfma_f32_16x16x32_bf16 v[236:239], a[64:67], a[116:119], v[236:239]
 buffer_load_dwordx4 v5, s[16:19], s84 offen offset:3072 sc1 lds
 v_cvt_pk_bf16_f32 v194, v164, v165
 v_cvt_pk_bf16_f32 v195, v166, v167
 v_mfma_f32_16x16x32_bf16 v[236:239], a[68:71], a[112:115], v[236:239]
 ds_read_b128 a[44:47], v18 offset:2176
 v_cvt_pk_bf16_f32 v196, v168, v169
 v_mfma_f32_16x16x32_bf16 v[236:239], a[72:75], a[108:111], v[236:239]
 ds_read_b128 a[48:51], v18 offset:1664
 v_cvt_pk_bf16_f32 v197, v170, v171
 v_mfma_f32_16x16x32_bf16 v[236:239], a[76:79], a[104:107], v[236:239]
 ds_read_b128 a[52:55], v18 offset:1152
 v_cvt_pk_bf16_f32 v198, v172, v173
 v_mfma_f32_16x16x32_bf16 v[240:243], a[64:67], a[120:123], v[240:243]
 s_add_u32 m0, m0, s30
 v_cvt_pk_bf16_f32 v199, v174, v175
 v_mfma_f32_16x16x32_bf16 v[240:243], a[68:71], a[116:119], v[240:243]
 ds_read_b128 a[56:59], v18 offset:640
 buffer_load_dwordx4 v6, s[16:19], s84 offen sc1 lds
 v_mfma_f32_16x16x32_bf16 v[240:243], a[72:75], a[112:115], v[240:243]
 ds_read_b128 a[60:63], v18 offset:128
 s_add_u32 s84, s84, s31
 v_mfma_f32_16x16x32_bf16 v[240:243], a[76:79], a[108:111], v[240:243]
 s_add_u32 m0, s56, 90112
 v_mfma_f32_16x16x32_bf16 v[244:247], a[64:67], a[124:127], v[244:247]
 v_mfma_f32_16x16x32_bf16 v[244:247], a[68:71], a[120:123], v[244:247]
 buffer_load_dwordx4 v24, s[16:19], s84 offen sc1 lds
 v_mfma_f32_16x16x32_bf16 v[244:247], a[72:75], a[116:119], v[244:247]
 v_mfma_f32_16x16x32_bf16 v[244:247], a[76:79], a[112:115], v[244:247]
 s_waitcnt lgkmcnt(0)
 v_mfma_f32_16x16x32_bf16 v[216:219], a[0:3], a[32:35], v[216:219]
 ds_read2_b32 a[64:65], v14 offset0:48 offset1:49
 v_mfma_f32_16x16x32_bf16 v[220:223], a[0:3], a[36:39], v[220:223]
 ds_read2_b32 a[66:67], v14 offset0:50 offset1:51
 v_mfma_f32_16x16x32_bf16 v[220:223], a[4:7], a[32:35], v[220:223]
 ds_read_b128 a[96:99], v18 offset:3776
 buffer_load_dwordx4 v24, s[16:19], s84 offen offset:1024 sc1 lds
 v_mfma_f32_16x16x32_bf16 v[224:227], a[0:3], a[40:43], v[224:227]
 ds_read2_b32 a[68:69], v14 offset0:176 offset1:177
 v_mfma_f32_16x16x32_bf16 v[224:227], a[4:7], a[36:39], v[224:227]
 ds_read2_b32 a[70:71], v14 offset0:178 offset1:179
 v_mfma_f32_16x16x32_bf16 v[224:227], a[8:11], a[32:35], v[224:227]
 ds_read_b128 a[100:103], v18 offset:3264
 v_mfma_f32_16x16x32_bf16 v[228:231], a[0:3], a[44:47], v[228:231]
 ds_read2_b32 a[72:73], v15 offset0:48 offset1:49
 buffer_load_dwordx4 v24, s[16:19], s84 offen offset:2048 sc1 lds
 v_mfma_f32_16x16x32_bf16 v[228:231], a[4:7], a[40:43], v[228:231]
 ds_read2_b32 a[74:75], v15 offset0:50 offset1:51
 v_mfma_f32_16x16x32_bf16 v[228:231], a[8:11], a[36:39], v[228:231]
 ds_read_b128 a[104:107], v18 offset:2752
 v_mfma_f32_16x16x32_bf16 v[228:231], a[12:15], a[32:35], v[228:231]
 ds_read2_b32 a[76:77], v15 offset0:176 offset1:177
 v_mfma_f32_16x16x32_bf16 v[232:235], a[0:3], a[48:51], v[232:235]
 ds_read2_b32 a[78:79], v15 offset0:178 offset1:179
 v_mfma_f32_16x16x32_bf16 v[232:235], a[4:7], a[44:47], v[232:235]
 ds_read_b128 a[108:111], v18 offset:2240
 buffer_load_dwordx4 v24, s[16:19], s84 offen offset:3072 sc1 lds
 v_mfma_f32_16x16x32_bf16 v[232:235], a[8:11], a[40:43], v[232:235]
 ds_read_b128 a[112:115], v18 offset:1728
 s_add_u32 m0, m0, s30
 v_mfma_f32_16x16x32_bf16 v[232:235], a[12:15], a[36:39], v[232:235]
 ds_read_b128 a[116:119], v18 offset:1216
 v_mfma_f32_16x16x32_bf16 v[236:239], a[0:3], a[52:55], v[236:239]
 ds_read_b128 a[120:123], v18 offset:704
 v_mfma_f32_16x16x32_bf16 v[236:239], a[4:7], a[48:51], v[236:239]
 ds_read_b128 a[124:127], v18 offset:192
 v_mfma_f32_16x16x32_bf16 v[236:239], a[8:11], a[44:47], v[236:239]
 ds_read2_b32 a[198:199], v17 offset0:24 offset1:25
 buffer_load_dwordx4 v5, s[16:19], s84 offen sc1 lds
 v_mfma_f32_16x16x32_bf16 v[236:239], a[12:15], a[40:43], v[236:239]
 ds_read2_b32 a[196:197], v17 offset0:16 offset1:17
 v_mfma_f32_16x16x32_bf16 v[240:243], a[0:3], a[56:59], v[240:243]
 ds_read2_b32 a[194:195], v17 offset0:8 offset1:9
 v_mfma_f32_16x16x32_bf16 v[240:243], a[4:7], a[52:55], v[240:243]
 ds_read2_b32 a[192:193], v17 offset0:0 offset1:1
 v_mfma_f32_16x16x32_bf16 v[240:243], a[8:11], a[48:51], v[240:243]
 ds_read2_b32 a[208:209], v17 offset0:120 offset1:121
 buffer_load_dwordx4 v5, s[16:19], s84 offen offset:1024 sc1 lds
 v_mfma_f32_16x16x32_bf16 v[240:243], a[12:15], a[44:47], v[240:243]
 ds_read2_b32 a[206:207], v17 offset0:112 offset1:113
 v_mfma_f32_16x16x32_bf16 v[244:247], a[0:3], a[60:63], v[244:247]
 ds_read2_b32 a[204:205], v17 offset0:104 offset1:105
 v_mfma_f32_16x16x32_bf16 v[244:247], a[4:7], a[56:59], v[244:247]
 ds_read2_b32 a[202:203], v17 offset0:96 offset1:97
 v_mfma_f32_16x16x32_bf16 v[244:247], a[8:11], a[52:55], v[244:247]
 v_mfma_f32_16x16x32_bf16 v[244:247], a[12:15], a[48:51], v[244:247]
 s_waitcnt lgkmcnt(8)
 buffer_load_dwordx4 v5, s[16:19], s84 offen offset:2048 sc1 lds
 v_mfma_f32_16x16x32_bf16 v[216:219], a[64:67], a[96:99], v[216:219]
 ds_read2_b32 a[0:1], v14 offset0:64 offset1:65
 v_mfma_f32_16x16x32_bf16 v[220:223], a[64:67], a[100:103], v[220:223]
 ds_read2_b32 a[2:3], v14 offset0:66 offset1:67
 v_mfma_f32_16x16x32_bf16 v[220:223], a[68:71], a[96:99], v[220:223]
 ds_read_b128 a[32:35], v18 offset:3840
 v_mfma_f32_16x16x32_bf16 v[224:227], a[64:67], a[104:107], v[224:227]
 ds_read2_b32 a[4:5], v14 offset0:192 offset1:193
 v_mfma_f32_16x16x32_bf16 v[224:227], a[68:71], a[100:103], v[224:227]
 ds_read2_b32 a[6:7], v14 offset0:194 offset1:195
 buffer_load_dwordx4 v5, s[16:19], s84 offen offset:3072 sc1 lds
 v_mfma_f32_16x16x32_bf16 v[224:227], a[72:75], a[96:99], v[224:227]
 ds_read_b128 a[36:39], v18 offset:3328
 s_add_u32 m0, m0, s30
 v_mfma_f32_16x16x32_bf16 v[228:231], a[64:67], a[108:111], v[228:231]
 ds_read2_b32 a[8:9], v15 offset0:64 offset1:65
 v_mfma_f32_16x16x32_bf16 v[228:231], a[68:71], a[104:107], v[228:231]
 ds_read2_b32 a[10:11], v15 offset0:66 offset1:67
 v_mfma_f32_16x16x32_bf16 v[228:231], a[72:75], a[100:103], v[228:231]
 ds_read_b128 a[40:43], v18 offset:2816
 buffer_load_dwordx4 v6, s[16:19], s84 offen sc1 lds
 v_mfma_f32_16x16x32_bf16 v[228:231], a[76:79], a[96:99], v[228:231]
 ds_read2_b32 a[12:13], v15 offset0:192 offset1:193
 s_mul_i32 s85, s62, 12288
 v_mfma_f32_16x16x32_bf16 v[232:235], a[64:67], a[112:115], v[232:235]
 buffer_store_dwordx4 v[144:147], v26, s[16:19], s27 offen sc1
 s_add_u32 s27, s27, 147456
 v_mfma_f32_16x16x32_bf16 v[232:235], a[68:71], a[108:111], v[232:235]
 ds_read2_b32 a[14:15], v15 offset0:194 offset1:195
 s_add_u32 s85, s85, s87
 v_mfma_f32_16x16x32_bf16 v[232:235], a[72:75], a[104:107], v[232:235]
 ds_read_b128 a[44:47], v18 offset:2304
 v_mfma_f32_16x16x32_bf16 v[232:235], a[76:79], a[100:103], v[232:235]
 ds_read_b128 a[48:51], v18 offset:1792
 buffer_load_dwordx4 v[160:163], v24, s[16:19], s85 offen sc1
 s_waitcnt lgkmcnt(15)
 v_mfma_f32_16x16x32_bf16 v[232:235], v[192:195], a[198:201], v[232:235]
 ds_read_b128 a[52:55], v18 offset:1280
 v_mfma_f32_16x16x32_bf16 v[232:235], v[200:203], a[208:211], v[232:235]
 ds_read_b128 a[56:59], v18 offset:768
 v_mfma_f32_16x16x32_bf16 v[236:239], a[64:67], a[116:119], v[236:239]
 ds_read_b128 a[60:63], v18 offset:256
 v_mfma_f32_16x16x32_bf16 v[236:239], a[68:71], a[112:115], v[236:239]
 ds_read2_b32 a[16:17], v14 offset0:96 offset1:97
 v_mfma_f32_16x16x32_bf16 v[236:239], a[72:75], a[108:111], v[236:239]
 ds_read2_b32 a[18:19], v14 offset0:98 offset1:99
 buffer_load_dwordx4 v[164:167], v7, s[16:19], s85 offen sc1
 v_mfma_f32_16x16x32_bf16 v[236:239], a[76:79], a[104:107], v[236:239]
 ds_read2_b32 a[20:21], v14 offset0:224 offset1:225
 v_mfma_f32_16x16x32_bf16 v[236:239], v[192:195], a[196:199], v[236:239]
 ds_read2_b32 a[22:23], v14 offset0:226 offset1:227
 v_mfma_f32_16x16x32_bf16 v[236:239], v[200:203], a[206:209], v[236:239]
 buffer_store_dwordx4 v[148:151], v26, s[16:19], s27 offen sc1
 s_add_u32 s27, s27, 147456
 v_mfma_f32_16x16x32_bf16 v[240:243], a[64:67], a[120:123], v[240:243]
 ds_read2_b32 a[24:25], v15 offset0:96 offset1:97
 v_mfma_f32_16x16x32_bf16 v[240:243], a[68:71], a[116:119], v[240:243]
 ds_read2_b32 a[26:27], v15 offset0:98 offset1:99
 buffer_load_dwordx4 v[168:171], v24, s[16:19], s85 offen offset:1024 sc1
 v_mfma_f32_16x16x32_bf16 v[240:243], a[72:75], a[112:115], v[240:243]
 ds_read2_b32 a[28:29], v15 offset0:224 offset1:225
 v_mfma_f32_16x16x32_bf16 v[240:243], a[76:79], a[108:111], v[240:243]
 ds_read2_b32 a[30:31], v15 offset0:226 offset1:227
 v_mfma_f32_16x16x32_bf16 v[240:243], v[192:195], a[194:197], v[240:243]
 ds_read2_b32 a[80:81], v14 offset0:112 offset1:113
 v_mfma_f32_16x16x32_bf16 v[240:243], v[196:199], a[198:201], v[240:243]
 ds_read2_b32 a[82:83], v14 offset0:114 offset1:115
 buffer_load_dwordx4 v[172:175], v7, s[16:19], s85 offen offset:1024 sc1
 s_waitcnt lgkmcnt(15)
 v_mfma_f32_16x16x32_bf16 v[240:243], v[200:203], a[204:207], v[240:243]
 ds_read2_b32 a[84:85], v14 offset0:240 offset1:241
 v_mfma_f32_16x16x32_bf16 v[240:243], v[204:207], a[208:211], v[240:243]
 ds_read2_b32 a[86:87], v14 offset0:242 offset1:243
 v_mfma_f32_16x16x32_bf16 v[244:247], a[64:67], a[124:127], v[244:247]
 ds_read2_b32 a[88:89], v15 offset0:112 offset1:113
 v_mfma_f32_16x16x32_bf16 v[244:247], a[68:71], a[120:123], v[244:247]
 ds_read2_b32 a[90:91], v15 offset0:114 offset1:115
 v_mfma_f32_16x16x32_bf16 v[244:247], a[72:75], a[116:119], v[244:247]
 ds_read2_b32 a[92:93], v15 offset0:240 offset1:241
 buffer_load_dwordx4 v[176:179], v24, s[16:19], s85 offen offset:2048 sc1
 v_mfma_f32_16x16x32_bf16 v[244:247], a[76:79], a[112:115], v[244:247]
 ds_read2_b32 a[94:95], v15 offset0:242 offset1:243
 v_mfma_f32_16x16x32_bf16 v[244:247], v[192:195], a[192:195], v[244:247]
 v_mfma_f32_16x16x32_bf16 v[244:247], v[196:199], a[196:199], v[244:247]
 v_mfma_f32_16x16x32_bf16 v[244:247], v[200:203], a[202:205], v[244:247]
 v_mfma_f32_16x16x32_bf16 v[244:247], v[204:207], a[206:209], v[244:247]
 s_waitcnt lgkmcnt(15)
 buffer_load_dwordx4 v[180:183], v7, s[16:19], s85 offen offset:2048 sc1
 v_mfma_f32_16x16x32_bf16 v[216:219], a[0:3], a[32:35], v[216:219]
 ds_read2_b32 a[64:65], v14 offset0:80 offset1:81
 v_mfma_f32_16x16x32_bf16 v[220:223], a[0:3], a[36:39], v[220:223]
 ds_read2_b32 a[66:67], v14 offset0:82 offset1:83
 v_mfma_f32_16x16x32_bf16 v[220:223], a[4:7], a[32:35], v[220:223]
 ds_read_b128 a[96:99], v18 offset:3904
 v_mfma_f32_16x16x32_bf16 v[224:227], a[0:3], a[40:43], v[224:227]
 ds_read2_b32 a[68:69], v14 offset0:208 offset1:209
 v_mfma_f32_16x16x32_bf16 v[224:227], a[4:7], a[36:39], v[224:227]
 buffer_load_dwordx4 v[184:187], v24, s[16:19], s85 offen offset:3072 sc1
 v_mfma_f32_16x16x32_bf16 v[224:227], a[8:11], a[32:35], v[224:227]
 ds_read2_b32 a[70:71], v14 offset0:210 offset1:211
 v_mfma_f32_16x16x32_bf16 v[228:231], a[0:3], a[44:47], v[228:231]
 ds_read_b128 a[100:103], v18 offset:3392
 v_mfma_f32_16x16x32_bf16 v[228:231], a[4:7], a[40:43], v[228:231]
 ds_read2_b32 a[72:73], v15 offset0:80 offset1:81
 v_mfma_f32_16x16x32_bf16 v[228:231], a[8:11], a[36:39], v[228:231]
 ds_read2_b32 a[74:75], v15 offset0:82 offset1:83
 v_mfma_f32_16x16x32_bf16 v[228:231], a[12:15], a[32:35], v[228:231]
 buffer_load_dwordx4 v[188:191], v7, s[16:19], s85 offen offset:3072 sc1
 s_add_u32 s85, s85, s30
 v_mfma_f32_16x16x32_bf16 v[232:235], a[0:3], a[48:51], v[232:235]
 buffer_store_dwordx4 v[152:155], v26, s[16:19], s27 offen sc1
 s_add_u32 s27, s27, 147456
 v_mfma_f32_16x16x32_bf16 v[232:235], a[4:7], a[44:47], v[232:235]
 ds_read_b128 a[104:107], v18 offset:2880
 v_mfma_f32_16x16x32_bf16 v[232:235], a[8:11], a[40:43], v[232:235]
 v_mfma_f32_16x16x32_bf16 v[232:235], a[12:15], a[36:39], v[232:235]
 ds_read2_b32 a[76:77], v15 offset0:208 offset1:209
 buffer_load_dwordx4 a[128:131], v24, s[16:19], s85 offen sc1
 v_mfma_f32_16x16x32_bf16 v[236:239], a[0:3], a[52:55], v[236:239]
 ds_read2_b32 a[78:79], v15 offset0:210 offset1:211
 v_mfma_f32_16x16x32_bf16 v[236:239], a[4:7], a[48:51], v[236:239]
 ds_read_b128 a[108:111], v18 offset:2368
 v_mfma_f32_16x16x32_bf16 v[236:239], a[8:11], a[44:47], v[236:239]
 ds_read_b128 a[112:115], v18 offset:1856
 v_mfma_f32_16x16x32_bf16 v[236:239], a[12:15], a[40:43], v[236:239]
 buffer_load_dwordx4 a[132:135], v7, s[16:19], s85 offen sc1
 v_mfma_f32_16x16x32_bf16 v[240:243], a[0:3], a[56:59], v[240:243]
 ds_read_b128 a[116:119], v18 offset:1344
 v_mfma_f32_16x16x32_bf16 v[240:243], a[4:7], a[52:55], v[240:243]
 ds_read_b128 a[120:123], v18 offset:832
 v_mfma_f32_16x16x32_bf16 v[240:243], a[8:11], a[48:51], v[240:243]
 ds_read_b128 a[124:127], v18 offset:320
 v_mfma_f32_16x16x32_bf16 v[240:243], a[12:15], a[44:47], v[240:243]
 v_mfma_f32_16x16x32_bf16 v[244:247], a[0:3], a[60:63], v[244:247]
 buffer_load_dwordx4 a[136:139], v24, s[16:19], s85 offen offset:1024 sc1
 v_mfma_f32_16x16x32_bf16 v[244:247], a[4:7], a[56:59], v[244:247]
 v_mfma_f32_16x16x32_bf16 v[244:247], a[8:11], a[52:55], v[244:247]
 v_mfma_f32_16x16x32_bf16 v[244:247], a[12:15], a[48:51], v[244:247]
 s_waitcnt lgkmcnt(0)
 v_mfma_f32_16x16x32_bf16 v[216:219], a[64:67], a[96:99], v[216:219]
 ds_read_b128 a[32:35], v18 offset:3968
 v_mfma_f32_16x16x32_bf16 v[220:223], a[64:67], a[100:103], v[220:223]
 buffer_load_dwordx4 a[140:143], v7, s[16:19], s85 offen offset:1024 sc1
 v_mfma_f32_16x16x32_bf16 v[220:223], a[68:71], a[96:99], v[220:223]
 ds_read_b128 a[36:39], v18 offset:3456
 s_load_dword s64, s[88:89], s29 offset:26752
 v_mfma_f32_16x16x32_bf16 v[224:227], a[64:67], a[104:107], v[224:227]
 v_mfma_f32_16x16x32_bf16 v[224:227], a[68:71], a[100:103], v[224:227]
 ds_read_b128 a[40:43], v18 offset:2944
 v_mfma_f32_16x16x32_bf16 v[224:227], a[72:75], a[96:99], v[224:227]
 buffer_load_dwordx4 a[144:147], v24, s[16:19], s85 offen offset:2048 sc1
 v_mfma_f32_16x16x32_bf16 v[228:231], a[64:67], a[108:111], v[228:231]
Lpg19:
 s_cbranch_vccnz Lj_Lfin
 ds_read_b128 a[44:47], v18 offset:2432
 v_mfma_f32_16x16x32_bf16 v[228:231], a[68:71], a[104:107], v[228:231]
 v_mfma_f32_16x16x32_bf16 v[228:231], a[72:75], a[100:103], v[228:231]
 v_mfma_f32_16x16x32_bf16 v[228:231], a[76:79], a[96:99], v[228:231]
 buffer_store_dwordx4 v[156:159], v26, s[16:19], s27 offen sc1
 s_add_u32 s27, s27, 147456
 v_mfma_f32_16x16x32_bf16 v[232:235], a[64:67], a[112:115], v[232:235]
 buffer_load_dwordx4 a[148:151], v7, s[16:19], s85 offen offset:2048 sc1
 v_mfma_f32_16x16x32_bf16 v[232:235], a[68:71], a[108:111], v[232:235]
 v_mfma_f32_16x16x32_bf16 v[232:235], a[72:75], a[104:107], v[232:235]
 ds_read_b128 a[48:51], v18 offset:1920
 v_mfma_f32_16x16x32_bf16 v[232:235], a[76:79], a[100:103], v[232:235]
 v_mfma_f32_16x16x32_bf16 v[236:239], a[64:67], a[116:119], v[236:239]
 v_mfma_f32_16x16x32_bf16 v[236:239], a[68:71], a[112:115], v[236:239]
 ds_read_b128 a[52:55], v18 offset:1408
 v_mfma_f32_16x16x32_bf16 v[236:239], a[72:75], a[108:111], v[236:239]
 buffer_load_dwordx4 a[152:155], v24, s[16:19], s85 offen offset:3072 sc1
 v_mfma_f32_16x16x32_bf16 v[236:239], a[76:79], a[104:107], v[236:239]
 ds_read_b128 a[56:59], v18 offset:896
 v_mfma_f32_16x16x32_bf16 v[240:243], a[64:67], a[120:123], v[240:243]
 v_mfma_f32_16x16x32_bf16 v[240:243], a[68:71], a[116:119], v[240:243]
 ds_read_b128 a[60:63], v18 offset:384
 v_mfma_f32_16x16x32_bf16 v[240:243], a[72:75], a[112:115], v[240:243]
 buffer_load_dwordx4 a[156:159], v7, s[16:19], s85 offen offset:3072 sc1
 s_add_u32 s85, s85, s30
 v_mfma_f32_16x16x32_bf16 v[240:243], a[76:79], a[108:111], v[240:243]
 v_mfma_f32_16x16x32_bf16 v[244:247], a[64:67], a[124:127], v[244:247]
 v_mfma_f32_16x16x32_bf16 v[244:247], a[68:71], a[120:123], v[244:247]
 v_mfma_f32_16x16x32_bf16 v[244:247], a[72:75], a[116:119], v[244:247]
 buffer_load_dwordx4 a[160:163], v24, s[16:19], s85 offen sc1
 v_mfma_f32_16x16x32_bf16 v[244:247], a[76:79], a[112:115], v[244:247]
 s_waitcnt lgkmcnt(0)
 v_mfma_f32_16x16x32_bf16 v[216:219], a[16:19], a[32:35], v[216:219]
 ds_read_b128 a[96:99], v18 offset:4032
 v_mfma_f32_16x16x32_bf16 v[220:223], a[16:19], a[36:39], v[220:223]
 v_mfma_f32_16x16x32_bf16 v[220:223], a[20:23], a[32:35], v[220:223]
 ds_read_b128 a[100:103], v18 offset:3520
 v_mfma_f32_16x16x32_bf16 v[224:227], a[16:19], a[40:43], v[224:227]
 buffer_load_dwordx4 a[164:167], v7, s[16:19], s85 offen sc1
 v_mfma_f32_16x16x32_bf16 v[224:227], a[20:23], a[36:39], v[224:227]
 v_mfma_f32_16x16x32_bf16 v[224:227], a[24:27], a[32:35], v[224:227]
 ds_read_b128 a[104:107], v18 offset:3008
 v_mfma_f32_16x16x32_bf16 v[228:231], a[16:19], a[44:47], v[228:231]
 v_mfma_f32_16x16x32_bf16 v[228:231], a[20:23], a[40:43], v[228:231]
 v_mfma_f32_16x16x32_bf16 v[228:231], a[24:27], a[36:39], v[228:231]
 ds_read_b128 a[108:111], v18 offset:2496
 v_mfma_f32_16x16x32_bf16 v[228:231], a[28:31], a[32:35], v[228:231]
 buffer_load_dwordx4 a[168:171], v24, s[16:19], s85 offen offset:1024 sc1
 v_mfma_f32_16x16x32_bf16 v[232:235], a[16:19], a[48:51], v[232:235]
 v_mfma_f32_16x16x32_bf16 v[232:235], a[20:23], a[44:47], v[232:235]
 ds_read_b128 a[112:115], v18 offset:1984
 v_mfma_f32_16x16x32_bf16 v[232:235], a[24:27], a[40:43], v[232:235]
 buffer_load_dwordx4 a[172:175], v7, s[16:19], s85 offen offset:1024 sc1
 v_mfma_f32_16x16x32_bf16 v[232:235], a[28:31], a[36:39], v[232:235]
 ds_read_b128 a[116:119], v18 offset:1472
 v_mfma_f32_16x16x32_bf16 v[236:239], a[16:19], a[52:55], v[236:239]
 v_mfma_f32_16x16x32_bf16 v[236:239], a[20:23], a[48:51], v[236:239]
 v_mfma_f32_16x16x32_bf16 v[236:239], a[24:27], a[44:47], v[236:239]
 ds_read_b128 a[120:123], v18 offset:960
 v_mfma_f32_16x16x32_bf16 v[236:239], a[28:31], a[40:43], v[236:239]
 buffer_load_dwordx4 a[176:179], v24, s[16:19], s85 offen offset:2048 sc1
 v_mfma_f32_16x16x32_bf16 v[240:243], a[16:19], a[56:59], v[240:243]
 v_mfma_f32_16x16x32_bf16 v[240:243], a[20:23], a[52:55], v[240:243]
 ds_read_b128 a[124:127], v18 offset:448
 v_mfma_f32_16x16x32_bf16 v[240:243], a[24:27], a[48:51], v[240:243]
 v_mfma_f32_16x16x32_bf16 v[240:243], a[28:31], a[44:47], v[240:243]
 v_mfma_f32_16x16x32_bf16 v[244:247], a[16:19], a[60:63], v[244:247]
 buffer_load_dwordx4 a[180:183], v7, s[16:19], s85 offen offset:2048 sc1
 v_mfma_f32_16x16x32_bf16 v[244:247], a[20:23], a[56:59], v[244:247]
 v_mfma_f32_16x16x32_bf16 v[244:247], a[24:27], a[52:55], v[244:247]
 v_mfma_f32_16x16x32_bf16 v[244:247], a[28:31], a[48:51], v[244:247]
 s_waitcnt lgkmcnt(0)
 v_mfma_f32_16x16x32_bf16 v[216:219], a[80:83], a[96:99], v[216:219]
 buffer_load_dwordx4 a[184:187], v24, s[16:19], s85 offen offset:3072 sc1
 v_mfma_f32_16x16x32_bf16 v[220:223], a[80:83], a[100:103], v[220:223]
 v_mfma_f32_16x16x32_bf16 v[220:223], a[84:87], a[96:99], v[220:223]
 v_mfma_f32_16x16x32_bf16 v[224:227], a[80:83], a[104:107], v[224:227]
 v_mfma_f32_16x16x32_bf16 v[224:227], a[84:87], a[100:103], v[224:227]
 s_nop 2
 v_cvt_pk_bf16_f32 v216, v216, v217
 v_cvt_pk_bf16_f32 v217, v218, v219
 v_mfma_f32_16x16x32_bf16 v[224:227], a[88:91], a[96:99], v[224:227]
 ds_write_b64 v19, v[216:217] offset:3072
 buffer_load_dwordx4 a[188:191], v7, s[16:19], s85 offen offset:3072 sc1
 v_mfma_f32_16x16x32_bf16 v[228:231], a[80:83], a[108:111], v[228:231]
 v_cvt_pk_bf16_f32 v220, v220, v221
 v_cvt_pk_bf16_f32 v221, v222, v223
 v_mfma_f32_16x16x32_bf16 v[228:231], a[84:87], a[104:107], v[228:231]
 ds_write_b64 v19, v[220:221] offset:3584
 v_mfma_f32_16x16x32_bf16 v[228:231], a[88:91], a[100:103], v[228:231]
 v_mfma_f32_16x16x32_bf16 v[228:231], a[92:95], a[96:99], v[228:231]
 v_cvt_pk_bf16_f32 v224, v224, v225
 v_cvt_pk_bf16_f32 v225, v226, v227
 v_mfma_f32_16x16x32_bf16 v[232:235], a[80:83], a[112:115], v[232:235]
Lhelp2:
 s_waitcnt vmcnt(18) lgkmcnt(0)
 s_barrier
 ds_write_b64 v19, v[224:225] offset:2048
 v_mfma_f32_16x16x32_bf16 v[232:235], a[84:87], a[108:111], v[232:235]
 ds_read_b128 v[96:99], v8 offset:0
 s_add_u32 s84, s84, s31
 v_mfma_f32_16x16x32_bf16 v[232:235], a[88:91], a[104:107], v[232:235]
 ds_read_b128 v[100:103], v8 offset:9216
 s_add_u32 m0, s56, 53248
 v_mfma_f32_16x16x32_bf16 v[232:235], a[92:95], a[100:103], v[232:235]
 buffer_load_dwordx4 v24, s[16:19], s84 offen sc1 lds
 v_cvt_pk_bf16_f32 v228, v228, v229
 v_cvt_pk_bf16_f32 v229, v230, v231
 v_mfma_f32_16x16x32_bf16 v[236:239], a[80:83], a[116:119], v[236:239]
 ds_write_b64 v19, v[228:229] offset:2560
 v_mfma_f32_16x16x32_bf16 v[236:239], a[84:87], a[112:115], v[236:239]
 ds_read_b128 v[104:107], v8 offset:1024
 buffer_load_dwordx4 v24, s[16:19], s84 offen offset:1024 sc1 lds
 v_mfma_f32_16x16x32_bf16 v[236:239], a[88:91], a[108:111], v[236:239]
 ds_read_b128 v[108:111], v8 offset:10240
 v_mfma_f32_16x16x32_bf16 v[236:239], a[92:95], a[104:107], v[236:239]
 v_cvt_pk_bf16_f32 v232, v232, v233
 v_cvt_pk_bf16_f32 v233, v234, v235
 v_mfma_f32_16x16x32_bf16 v[240:243], a[80:83], a[120:123], v[240:243]
 ds_write_b64 v19, v[232:233] offset:1024
 v_mfma_f32_16x16x32_bf16 v[240:243], a[84:87], a[116:119], v[240:243]
 ds_read_b128 v[112:115], v8 offset:2048
 buffer_load_dwordx4 v24, s[16:19], s84 offen offset:2048 sc1 lds
 v_mfma_f32_16x16x32_bf16 v[240:243], a[88:91], a[112:115], v[240:243]
 ds_read_b128 v[116:119], v8 offset:11264
 v_mfma_f32_16x16x32_bf16 v[240:243], a[92:95], a[108:111], v[240:243]
 v_cvt_pk_bf16_f32 v236, v236, v237
 v_cvt_pk_bf16_f32 v237, v238, v239
 v_mfma_f32_16x16x32_bf16 v[244:247], a[80:83], a[124:127], v[244:247]
 ds_write_b64 v19, v[236:237] offset:1536
 v_mfma_f32_16x16x32_bf16 v[244:247], a[84:87], a[120:123], v[244:247]
 ds_read_b128 v[120:123], v8 offset:3072
 v_mfma_f32_16x16x32_bf16 v[244:247], a[88:91], a[116:119], v[244:247]
 ds_read_b128 v[124:127], v8 offset:12288
 s_waitcnt lgkmcnt(6)
 v_mfma_f32_16x16x32_bf16 v[244:247], a[92:95], a[112:115], v[244:247]
 buffer_load_dwordx4 v24, s[16:19], s84 offen offset:3072 sc1 lds
 v_cvt_pk_bf16_f32 v240, v240, v241
 v_cvt_pk_bf16_f32 v241, v242, v243
 v_mfma_f32_16x16x32_bf16 v[32:35], v[96:99], v[160:163], 0
 ds_write_b64 v19, v[240:241] offset:0
 s_add_u32 m0, m0, s30
 v_mfma_f32_16x16x32_bf16 v[32:35], v[100:103], v[168:171], v[32:35]
 ds_read_b128 v[128:131], v8 offset:4096
 v_mfma_f32_16x16x32_bf16 v[36:39], v[96:99], v[164:167], 0
 ds_read_b128 v[132:135], v8 offset:13312
 v_mfma_f32_16x16x32_bf16 v[36:39], v[100:103], v[172:175], v[36:39]
 ds_read_b128 v[136:139], v8 offset:5120
 buffer_load_dwordx4 v5, s[16:19], s84 offen sc1 lds
 v_mfma_f32_16x16x32_bf16 v[40:43], v[104:107], v[160:163], 0
 s_cmp_eq_u32 s64, 0x10101
 s_cbranch_scc0 Lsp_hp1
Lrt_hp1:
 v_cvt_pk_bf16_f32 v244, v244, v245
 v_mfma_f32_16x16x32_bf16 v[40:43], v[108:111], v[168:171], v[40:43]
 v_cvt_pk_bf16_f32 v245, v246, v247
 v_mfma_f32_16x16x32_bf16 v[44:47], v[104:107], v[164:167], 0
 ds_write_b64 v19, v[244:245] offset:512
 s_waitcnt lgkmcnt(5)
 v_mfma_f32_16x16x32_bf16 v[44:47], v[108:111], v[172:175], v[44:47]
 buffer_load_dwordx4 v5, s[16:19], s84 offen offset:1024 sc1 lds
 v_subrev_u32 v23, s54, v23
 v_mfma_f32_16x16x32_bf16 v[48:51], v[112:115], v[160:163], 0
 s_mov_b32 s27, s26
 v_mfma_f32_16x16x32_bf16 v[48:51], v[116:119], v[168:171], v[48:51]
 ds_read_b128 v[140:143], v8 offset:14336
 v_mfma_f32_16x16x32_bf16 v[52:55], v[112:115], v[164:167], 0
 ds_read_b128 v[144:147], v8 offset:6144
 v_mfma_f32_16x16x32_bf16 v[52:55], v[116:119], v[172:175], v[52:55]
 ds_read_b128 v[148:151], v8 offset:15360
 v_mfma_f32_16x16x32_bf16 v[56:59], v[120:123], v[160:163], 0
 ds_read_b128 v[152:155], v8 offset:7168
 buffer_load_dwordx4 v5, s[16:19], s84 offen offset:2048 sc1 lds
 v_mfma_f32_16x16x32_bf16 v[56:59], v[124:127], v[168:171], v[56:59]
 s_waitcnt lgkmcnt(4)
 s_barrier
 v_mfma_f32_16x16x32_bf16 v[60:63], v[120:123], v[164:167], 0
 ds_read_b128 v[156:159], v8 offset:16384
 v_mfma_f32_16x16x32_bf16 v[60:63], v[124:127], v[172:175], v[60:63]
 ds_read_b128 v[96:99], v8 offset:8192
 v_mfma_f32_16x16x32_bf16 v[80:83], v[128:131], v[160:163], 0
 ds_read_b128 v[100:103], v8 offset:17408
 v_mfma_f32_16x16x32_bf16 v[80:83], v[132:135], v[168:171], v[80:83]
 ds_read_b128 v[104:107], v8 offset:18432
 buffer_load_dwordx4 v5, s[16:19], s84 offen offset:3072 sc1 lds
 v_mfma_f32_16x16x32_bf16 v[84:87], v[128:131], v[164:167], 0
 ds_read_b128 v[108:111], v8 offset:27648
 s_waitcnt lgkmcnt(6)
 v_mfma_f32_16x16x32_bf16 v[84:87], v[132:135], v[172:175], v[84:87]
 ds_read_b128 v[112:115], v8 offset:19456
 s_add_u32 m0, m0, s30
 v_mfma_f32_16x16x32_bf16 v[88:91], v[136:139], v[160:163], 0
 ds_read_b128 v[116:119], v8 offset:28672
 v_mfma_f32_16x16x32_bf16 v[88:91], v[140:143], v[168:171], v[88:91]
 ds_read_b128 v[120:123], v8 offset:20480
 buffer_load_dwordx4 v6, s[16:19], s84 offen sc1 lds
 v_mfma_f32_16x16x32_bf16 v[92:95], v[136:139], v[164:167], 0
 ds_read_b128 v[124:127], v8 offset:29696
 s_mul_i32 s85, s63, 12288
 v_mfma_f32_16x16x32_bf16 v[92:95], v[140:143], v[172:175], v[92:95]
 ds_read_b64_tr_b16 v[64:65], v23 offset:0
 s_add_u32 s85, s85, s87
 v_mfma_f32_16x16x32_bf16 v[216:219], v[144:147], v[160:163], 0
 ds_read_b128 v[128:131], v8 offset:21504
 v_mfma_f32_16x16x32_bf16 v[216:219], v[148:151], v[168:171], v[216:219]
 ds_read_b64_tr_b16 v[66:67], v23 offset:8
 v_mfma_f32_16x16x32_bf16 v[220:223], v[144:147], v[164:167], 0
 ds_read_b128 v[132:135], v8 offset:30720
 s_waitcnt lgkmcnt(10)
 v_mfma_f32_16x16x32_bf16 v[220:223], v[148:151], v[172:175], v[220:223]
 ds_read_b64_tr_b16 v[68:69], v23 offset:64
 v_mfma_f32_16x16x32_bf16 v[224:227], v[152:155], v[160:163], 0
 ds_read_b128 v[136:139], v8 offset:22528
 v_mfma_f32_16x16x32_bf16 v[224:227], v[156:159], v[168:171], v[224:227]
 ds_read_b64_tr_b16 v[70:71], v23 offset:72
 v_mfma_f32_16x16x32_bf16 v[228:231], v[152:155], v[164:167], 0
 ds_read_b128 v[140:143], v8 offset:31744
 v_mfma_f32_16x16x32_bf16 v[228:231], v[156:159], v[172:175], v[228:231]
 ds_read_b64_tr_b16 v[72:73], v23 offset:512
 v_mfma_f32_16x16x32_bf16 v[232:235], v[96:99], v[160:163], 0
 ds_read_b128 v[144:147], v8 offset:23552
 v_mfma_f32_16x16x32_bf16 v[232:235], v[100:103], v[168:171], v[232:235]
 ds_read_b64_tr_b16 v[74:75], v23 offset:520
 v_mfma_f32_16x16x32_bf16 v[236:239], v[96:99], v[164:167], 0
 ds_read_b128 v[148:151], v8 offset:32768
 s_waitcnt lgkmcnt(14)
 v_mfma_f32_16x16x32_bf16 v[236:239], v[100:103], v[172:175], v[236:239]
 ds_read_b64_tr_b16 v[76:77], v23 offset:576
 v_mfma_f32_16x16x32_bf16 v[32:35], v[104:107], v[176:179], v[32:35]
 ds_read_b128 v[152:155], v8 offset:24576
 v_mfma_f32_16x16x32_bf16 v[32:35], v[108:111], v[184:187], v[32:35]
 ds_read_b64_tr_b16 v[78:79], v23 offset:584
 v_mfma_f32_16x16x32_bf16 v[36:39], v[104:107], v[180:183], v[36:39]
 ds_read_b128 v[156:159], v8 offset:33792
 v_mfma_f32_16x16x32_bf16 v[36:39], v[108:111], v[188:191], v[36:39]
 buffer_load_dwordx4 a[0:3], v24, s[16:19], s85 offen sc1
 v_mfma_f32_16x16x32_bf16 v[40:43], v[112:115], v[176:179], v[40:43]
 ds_read_b128 v[96:99], v8 offset:25600
 v_mfma_f32_16x16x32_bf16 v[40:43], v[116:119], v[184:187], v[40:43]
 buffer_load_dwordx4 a[4:7], v7, s[16:19], s85 offen sc1
 v_mfma_f32_16x16x32_bf16 v[44:47], v[112:115], v[180:183], v[44:47]
 ds_read_b128 v[100:103], v8 offset:34816
 s_waitcnt lgkmcnt(14)
 v_mfma_f32_16x16x32_bf16 v[44:47], v[116:119], v[188:191], v[44:47]
 s_waitcnt lgkmcnt(3)
 v_mfma_f32_16x16x32_bf16 v[48:51], v[120:123], v[176:179], v[48:51]
 ds_read_b128 v[104:107], v8 offset:26624
 v_mfma_f32_16x16x32_bf16 v[48:51], v[124:127], v[184:187], v[48:51]
 buffer_store_dwordx4 v[64:67], v26, s[16:19], s27 offen sc1
 s_add_u32 s27, s27, 147456
 v_mfma_f32_16x16x32_bf16 v[52:55], v[120:123], v[180:183], v[52:55]
 ds_read_b128 v[108:111], v8 offset:35840
 v_mfma_f32_16x16x32_bf16 v[52:55], v[124:127], v[188:191], v[52:55]
 buffer_store_dwordx4 v[68:71], v26, s[16:19], s27 offen sc1
 s_add_u32 s27, s27, 147456
 v_mfma_f32_16x16x32_bf16 v[56:59], v[128:131], v[176:179], v[56:59]
 buffer_store_dwordx4 v[72:75], v26, s[16:19], s27 offen sc1
 s_add_u32 s27, s27, 147456
 v_mfma_f32_16x16x32_bf16 v[56:59], v[132:135], v[184:187], v[56:59]
 buffer_store_dwordx4 v[76:79], v26, s[16:19], s27 offen sc1
 s_add_u32 s27, s27, 147456
 v_mfma_f32_16x16x32_bf16 v[60:63], v[128:131], v[180:183], v[60:63]
 buffer_load_dwordx4 a[8:11], v24, s[16:19], s85 offen offset:1024 sc1
 v_mfma_f32_16x16x32_bf16 v[60:63], v[132:135], v[188:191], v[60:63]
 v_mfma_f32_16x16x32_bf16 v[80:83], v[136:139], v[176:179], v[80:83]
 buffer_load_dwordx4 a[12:15], v7, s[16:19], s85 offen offset:1024 sc1
 v_mfma_f32_16x16x32_bf16 v[80:83], v[140:143], v[184:187], v[80:83]
 buffer_load_dwordx4 a[16:19], v24, s[16:19], s85 offen offset:2048 sc1
 v_mfma_f32_16x16x32_bf16 v[84:87], v[136:139], v[180:183], v[84:87]
 v_mfma_f32_16x16x32_bf16 v[84:87], v[140:143], v[188:191], v[84:87]
 v_mfma_f32_16x16x32_bf16 v[88:91], v[144:147], v[176:179], v[88:91]
 s_waitcnt vmcnt(26) lgkmcnt(0)
 s_barrier
 v_mfma_f32_16x16x32_bf16 v[88:91], v[148:151], v[184:187], v[88:91]
 ds_read_b128 v[112:115], v9 offset:0
 v_mfma_f32_16x16x32_bf16 v[92:95], v[144:147], v[180:183], v[92:95]
 ds_read_b128 v[116:119], v9 offset:9216
 v_mfma_f32_16x16x32_bf16 v[92:95], v[148:151], v[188:191], v[92:95]
 ds_read_b128 v[120:123], v9 offset:1024
 v_mfma_f32_16x16x32_bf16 v[216:219], v[152:155], v[176:179], v[216:219]
 ds_read_b128 v[124:127], v9 offset:10240
 v_mfma_f32_16x16x32_bf16 v[216:219], v[156:159], v[184:187], v[216:219]
 ds_read_b128 v[128:131], v9 offset:2048
 v_mfma_f32_16x16x32_bf16 v[220:223], v[152:155], v[180:183], v[220:223]
 ds_read_b128 v[132:135], v9 offset:11264
 v_mfma_f32_16x16x32_bf16 v[220:223], v[156:159], v[188:191], v[220:223]
 ds_read_b128 v[136:139], v9 offset:3072
 v_mfma_f32_16x16x32_bf16 v[224:227], v[96:99], v[176:179], v[224:227]
 ds_read_b128 v[140:143], v9 offset:12288
 v_mfma_f32_16x16x32_bf16 v[224:227], v[100:103], v[184:187], v[224:227]
 ds_read_b128 v[144:147], v9 offset:4096
 v_mfma_f32_16x16x32_bf16 v[228:231], v[96:99], v[180:183], v[228:231]
 ds_read_b128 v[148:151], v9 offset:13312
 s_waitcnt lgkmcnt(8)
 v_mfma_f32_16x16x32_bf16 v[228:231], v[100:103], v[188:191], v[228:231]
 buffer_load_dwordx4 a[20:23], v7, s[16:19], s85 offen offset:2048 sc1
 v_mfma_f32_16x16x32_bf16 v[232:235], v[104:107], v[176:179], v[232:235]
 ds_read_b128 v[152:155], v9 offset:5120
 v_mfma_f32_16x16x32_bf16 v[232:235], v[108:111], v[184:187], v[232:235]
 buffer_load_dwordx4 a[24:27], v24, s[16:19], s85 offen offset:3072 sc1
 v_mfma_f32_16x16x32_bf16 v[236:239], v[104:107], v[180:183], v[236:239]
 ds_read_b128 v[156:159], v9 offset:14336
 v_mfma_f32_16x16x32_bf16 v[236:239], v[108:111], v[188:191], v[236:239]
 buffer_load_dwordx4 a[28:31], v7, s[16:19], s85 offen offset:3072 sc1
 s_mul_i32 s84, s63, 442368
 v_mfma_f32_16x16x32_bf16 v[32:35], v[112:115], a[128:131], v[32:35]
 ds_read_b128 v[96:99], v9 offset:6144
 s_add_u32 s84, s84, s86
 v_mfma_f32_16x16x32_bf16 v[32:35], v[116:119], a[136:139], v[32:35]
 s_add_u32 m0, s56, 0
 v_mfma_f32_16x16x32_bf16 v[36:39], v[112:115], a[132:135], v[36:39]
 ds_read_b128 v[100:103], v9 offset:15360
 s_waitcnt lgkmcnt(4)
 v_mfma_f32_16x16x32_bf16 v[36:39], v[116:119], a[140:143], v[36:39]
 buffer_load_dwordx4 v24, s[16:19], s84 offen sc1 lds
 v_mfma_f32_16x16x32_bf16 v[40:43], v[120:123], a[128:131], v[40:43]
 ds_read_b128 v[104:107], v9 offset:7168
 v_mfma_f32_16x16x32_bf16 v[40:43], v[124:127], a[136:139], v[40:43]
 buffer_load_dwordx4 v24, s[16:19], s84 offen offset:1024 sc1 lds
 v_mfma_f32_16x16x32_bf16 v[44:47], v[120:123], a[132:135], v[44:47]
 ds_read_b128 v[108:111], v9 offset:16384
 v_mfma_f32_16x16x32_bf16 v[44:47], v[124:127], a[140:143], v[44:47]
 v_mfma_f32_16x16x32_bf16 v[48:51], v[128:131], a[128:131], v[48:51]
 ds_read_b128 v[112:115], v9 offset:8192
 v_mfma_f32_16x16x32_bf16 v[48:51], v[132:135], a[136:139], v[48:51]
 buffer_load_dwordx4 v24, s[16:19], s84 offen offset:2048 sc1 lds
 v_mfma_f32_16x16x32_bf16 v[52:55], v[128:131], a[132:135], v[52:55]
 ds_read_b128 v[116:119], v9 offset:17408
 v_mfma_f32_16x16x32_bf16 v[52:55], v[132:135], a[140:143], v[52:55]
 v_mfma_f32_16x16x32_bf16 v[56:59], v[136:139], a[128:131], v[56:59]
 ds_read_b128 v[120:123], v9 offset:18432
 v_mfma_f32_16x16x32_bf16 v[56:59], v[140:143], a[136:139], v[56:59]
 buffer_load_dwordx4 v24, s[16:19], s84 offen offset:3072 sc1 lds
 s_add_u32 m0, m0, s30
 v_mfma_f32_16x16x32_bf16 v[60:63], v[136:139], a[132:135], v[60:63]
 ds_read_b128 v[124:127], v9 offset:27648
 v_mfma_f32_16x16x32_bf16 v[60:63], v[140:143], a[140:143], v[60:63]
 v_mfma_f32_16x16x32_bf16 v[80:83], v[144:147], a[128:131], v[80:83]
 ds_read_b128 v[128:131], v9 offset:19456
 v_mfma_f32_16x16x32_bf16 v[80:83], v[148:151], a[136:139], v[80:83]
 buffer_load_dwordx4 v5, s[16:19], s84 offen sc1 lds
 v_mfma_f32_16x16x32_bf16 v[84:87], v[144:147], a[132:135], v[84:87]
 ds_read_b128 v[132:135], v9 offset:28672
 s_waitcnt lgkmcnt(4)
 v_mfma_f32_16x16x32_bf16 v[84:87], v[148:151], a[140:143], v[84:87]
 v_mfma_f32_16x16x32_bf16 v[88:91], v[152:155], a[128:131], v[88:91]
 ds_read_b128 v[136:139], v9 offset:20480
 v_mfma_f32_16x16x32_bf16 v[88:91], v[156:159], a[136:139], v[88:91]
 buffer_load_dwordx4 v5, s[16:19], s84 offen offset:1024 sc1 lds
 v_mfma_f32_16x16x32_bf16 v[92:95], v[152:155], a[132:135], v[92:95]
 ds_read_b128 v[140:143], v9 offset:29696
 v_mfma_f32_16x16x32_bf16 v[92:95], v[156:159], a[140:143], v[92:95]
 v_mfma_f32_16x16x32_bf16 v[216:219], v[96:99], a[128:131], v[216:219]
 ds_read_b128 v[144:147], v9 offset:21504
 v_mfma_f32_16x16x32_bf16 v[216:219], v[100:103], a[136:139], v[216:219]
 buffer_load_dwordx4 v5, s[16:19], s84 offen offset:2048 sc1 lds
 v_mfma_f32_16x16x32_bf16 v[220:223], v[96:99], a[132:135], v[220:223]
 ds_read_b128 v[148:151], v9 offset:30720
 v_mfma_f32_16x16x32_bf16 v[220:223], v[100:103], a[140:143], v[220:223]
 v_mfma_f32_16x16x32_bf16 v[224:227], v[104:107], a[128:131], v[224:227]
 ds_read_b128 v[152:155], v9 offset:22528
 v_mfma_f32_16x16x32_bf16 v[224:227], v[108:111], a[136:139], v[224:227]
 buffer_load_dwordx4 v5, s[16:19], s84 offen offset:3072 sc1 lds
 s_add_u32 m0, m0, s30
 v_mfma_f32_16x16x32_bf16 v[228:231], v[104:107], a[132:135], v[228:231]
 ds_read_b128 v[156:159], v9 offset:31744
 v_mfma_f32_16x16x32_bf16 v[228:231], v[108:111], a[140:143], v[228:231]
 v_mfma_f32_16x16x32_bf16 v[232:235], v[112:115], a[128:131], v[232:235]
 ds_read_b128 v[96:99], v9 offset:23552
 v_mfma_f32_16x16x32_bf16 v[232:235], v[116:119], a[136:139], v[232:235]
 buffer_load_dwordx4 v6, s[16:19], s84 offen sc1 lds
 s_add_u32 s84, s84, s31
 v_mfma_f32_16x16x32_bf16 v[236:239], v[112:115], a[132:135], v[236:239]
 ds_read_b128 v[100:103], v9 offset:32768
 s_waitcnt lgkmcnt(4)
 v_mfma_f32_16x16x32_bf16 v[236:239], v[116:119], a[140:143], v[236:239]
 s_add_u32 m0, s56, 126976
 v_mfma_f32_16x16x32_bf16 v[32:35], v[120:123], a[144:147], v[32:35]
 ds_read_b128 v[104:107], v9 offset:24576
 v_mfma_f32_16x16x32_bf16 v[32:35], v[124:127], a[152:155], v[32:35]
 buffer_load_dwordx4 v24, s[16:19], s84 offen sc1 lds
 v_mfma_f32_16x16x32_bf16 v[36:39], v[120:123], a[148:151], v[36:39]
 ds_read_b128 v[108:111], v9 offset:33792
 v_mfma_f32_16x16x32_bf16 v[36:39], v[124:127], a[156:159], v[36:39]
 v_mfma_f32_16x16x32_bf16 v[40:43], v[128:131], a[144:147], v[40:43]
 ds_read_b128 v[112:115], v9 offset:25600
 v_mfma_f32_16x16x32_bf16 v[40:43], v[132:135], a[152:155], v[40:43]
 buffer_load_dwordx4 v24, s[16:19], s84 offen offset:1024 sc1 lds
 v_mfma_f32_16x16x32_bf16 v[44:47], v[128:131], a[148:151], v[44:47]
 ds_read_b128 v[116:119], v9 offset:34816
 v_mfma_f32_16x16x32_bf16 v[44:47], v[132:135], a[156:159], v[44:47]
 v_mfma_f32_16x16x32_bf16 v[48:51], v[136:139], a[144:147], v[48:51]
 ds_read_b128 v[120:123], v9 offset:26624
 v_mfma_f32_16x16x32_bf16 v[48:51], v[140:143], a[152:155], v[48:51]
 buffer_load_dwordx4 v24, s[16:19], s84 offen offset:2048 sc1 lds
 v_mfma_f32_16x16x32_bf16 v[52:55], v[136:139], a[148:151], v[52:55]
 ds_read_b128 v[124:127], v9 offset:35840
 v_mfma_f32_16x16x32_bf16 v[52:55], v[140:143], a[156:159], v[52:55]
 v_mfma_f32_16x16x32_bf16 v[56:59], v[144:147], a[144:147], v[56:59]
 v_mfma_f32_16x16x32_bf16 v[56:59], v[148:151], a[152:155], v[56:59]
 buffer_load_dwordx4 v24, s[16:19], s84 offen offset:3072 sc1 lds
 s_add_u32 m0, m0, s30
 v_mfma_f32_16x16x32_bf16 v[60:63], v[144:147], a[148:151], v[60:63]
 v_mfma_f32_16x16x32_bf16 v[60:63], v[148:151], a[156:159], v[60:63]
 s_waitcnt lgkmcnt(2)
 v_mfma_f32_16x16x32_bf16 v[80:83], v[152:155], a[144:147], v[80:83]
 v_mfma_f32_16x16x32_bf16 v[80:83], v[156:159], a[152:155], v[80:83]
 buffer_load_dwordx4 v5, s[16:19], s84 offen sc1 lds
 v_mfma_f32_16x16x32_bf16 v[84:87], v[152:155], a[148:151], v[84:87]
 v_mfma_f32_16x16x32_bf16 v[84:87], v[156:159], a[156:159], v[84:87]
 v_mfma_f32_16x16x32_bf16 v[88:91], v[96:99], a[144:147], v[88:91]
 s_waitcnt vmcnt(26) lgkmcnt(0)
 s_barrier
 s_waitcnt vmcnt(20)
 v_mfma_f32_16x16x32_bf16 v[88:91], v[100:103], a[152:155], v[88:91]
 ds_read_b128 v[128:131], v13 offset:0
 v_mfma_f32_16x16x32_bf16 v[92:95], v[96:99], a[148:151], v[92:95]
 ds_read_b128 v[132:135], v13 offset:9216
 v_mfma_f32_16x16x32_bf16 v[92:95], v[100:103], a[156:159], v[92:95]
 ds_read_b128 v[136:139], v13 offset:1024
 v_mfma_f32_16x16x32_bf16 v[216:219], v[104:107], a[144:147], v[216:219]
 ds_read_b128 v[140:143], v13 offset:10240
 v_mfma_f32_16x16x32_bf16 v[216:219], v[108:111], a[152:155], v[216:219]
 ds_read_b128 v[144:147], v13 offset:2048
 v_mfma_f32_16x16x32_bf16 v[220:223], v[104:107], a[148:151], v[220:223]
 ds_read_b128 v[148:151], v13 offset:11264
 v_mfma_f32_16x16x32_bf16 v[220:223], v[108:111], a[156:159], v[220:223]
 ds_read_b128 v[152:155], v13 offset:3072
 v_mfma_f32_16x16x32_bf16 v[224:227], v[112:115], a[144:147], v[224:227]
 ds_read_b128 v[156:159], v13 offset:12288
 v_mfma_f32_16x16x32_bf16 v[224:227], v[116:119], a[152:155], v[224:227]
 ds_read_b128 v[96:99], v13 offset:4096
 v_mfma_f32_16x16x32_bf16 v[228:231], v[112:115], a[148:151], v[228:231]
 ds_read_b128 v[100:103], v13 offset:13312
 s_waitcnt lgkmcnt(8)
 v_mfma_f32_16x16x32_bf16 v[228:231], v[116:119], a[156:159], v[228:231]
 buffer_store_byte v2, v1, s[16:19], s59 offen sc1
 v_mfma_f32_16x16x32_bf16 v[232:235], v[120:123], a[144:147], v[232:235]
 ds_read_b128 v[104:107], v13 offset:5120
 v_mfma_f32_16x16x32_bf16 v[232:235], v[124:127], a[152:155], v[232:235]
 buffer_load_dwordx4 v5, s[16:19], s84 offen offset:1024 sc1 lds
 v_mfma_f32_16x16x32_bf16 v[236:239], v[120:123], a[148:151], v[236:239]
 ds_read_b128 v[108:111], v13 offset:14336
 v_mfma_f32_16x16x32_bf16 v[236:239], v[124:127], a[156:159], v[236:239]
 buffer_load_dwordx4 v5, s[16:19], s84 offen offset:2048 sc1 lds
 v_mfma_f32_16x16x32_bf16 v[32:35], v[128:131], a[160:163], v[32:35]
 ds_read_b128 v[112:115], v13 offset:6144
 v_mfma_f32_16x16x32_bf16 v[32:35], v[132:135], a[168:171], v[32:35]
 buffer_load_dwordx4 v5, s[16:19], s84 offen offset:3072 sc1 lds
 s_add_u32 m0, m0, s30
 v_mfma_f32_16x16x32_bf16 v[36:39], v[128:131], a[164:167], v[36:39]
 ds_read_b128 v[116:119], v13 offset:15360
 s_waitcnt lgkmcnt(4)
 v_mfma_f32_16x16x32_bf16 v[36:39], v[132:135], a[172:175], v[36:39]
 buffer_load_dwordx4 v6, s[16:19], s84 offen sc1 lds
 s_add_u32 s85, s85, s30
 v_mfma_f32_16x16x32_bf16 v[40:43], v[136:139], a[160:163], v[40:43]
 ds_read_b128 v[120:123], v13 offset:7168
 v_mfma_f32_16x16x32_bf16 v[40:43], v[140:143], a[168:171], v[40:43]
 v_mfma_f32_16x16x32_bf16 v[44:47], v[136:139], a[164:167], v[44:47]
 ds_read_b128 v[124:127], v13 offset:16384
 v_mfma_f32_16x16x32_bf16 v[44:47], v[140:143], a[172:175], v[44:47]
 buffer_load_dwordx4 v[160:163], v24, s[16:19], s85 offen sc1
 v_mfma_f32_16x16x32_bf16 v[48:51], v[144:147], a[160:163], v[48:51]
 ds_read_b128 v[128:131], v13 offset:8192
 v_mfma_f32_16x16x32_bf16 v[48:51], v[148:151], a[168:171], v[48:51]
 v_mfma_f32_16x16x32_bf16 v[52:55], v[144:147], a[164:167], v[52:55]
 ds_read_b128 v[132:135], v13 offset:17408
 v_mfma_f32_16x16x32_bf16 v[52:55], v[148:151], a[172:175], v[52:55]
 buffer_load_dwordx4 v[164:167], v7, s[16:19], s85 offen sc1
 v_mfma_f32_16x16x32_bf16 v[56:59], v[152:155], a[160:163], v[56:59]
 ds_read_b128 v[136:139], v13 offset:18432
 v_mfma_f32_16x16x32_bf16 v[56:59], v[156:159], a[168:171], v[56:59]
 v_mfma_f32_16x16x32_bf16 v[60:63], v[152:155], a[164:167], v[60:63]
 ds_read_b128 v[140:143], v13 offset:27648
 v_mfma_f32_16x16x32_bf16 v[60:63], v[156:159], a[172:175], v[60:63]
 buffer_load_dwordx4 v[168:171], v24, s[16:19], s85 offen offset:1024 sc1
 v_mfma_f32_16x16x32_bf16 v[80:83], v[96:99], a[160:163], v[80:83]
 ds_read_b128 v[144:147], v13 offset:19456
 v_mfma_f32_16x16x32_bf16 v[80:83], v[100:103], a[168:171], v[80:83]
 v_mfma_f32_16x16x32_bf16 v[84:87], v[96:99], a[164:167], v[84:87]
 ds_read_b128 v[148:151], v13 offset:28672
 s_waitcnt lgkmcnt(4)
 v_mfma_f32_16x16x32_bf16 v[84:87], v[100:103], a[172:175], v[84:87]
 buffer_load_dwordx4 v[172:175], v7, s[16:19], s85 offen offset:1024 sc1
 v_mfma_f32_16x16x32_bf16 v[88:91], v[104:107], a[160:163], v[88:91]
 ds_read_b128 v[152:155], v13 offset:20480
 v_mfma_f32_16x16x32_bf16 v[88:91], v[108:111], a[168:171], v[88:91]
 v_mfma_f32_16x16x32_bf16 v[92:95], v[104:107], a[164:167], v[92:95]
 ds_read_b128 v[156:159], v13 offset:29696
 v_mfma_f32_16x16x32_bf16 v[92:95], v[108:111], a[172:175], v[92:95]
 buffer_load_dwordx4 v[176:179], v24, s[16:19], s85 offen offset:2048 sc1
 v_mfma_f32_16x16x32_bf16 v[216:219], v[112:115], a[160:163], v[216:219]
 ds_read_b128 v[96:99], v13 offset:21504
 v_mfma_f32_16x16x32_bf16 v[216:219], v[116:119], a[168:171], v[216:219]
 v_mfma_f32_16x16x32_bf16 v[220:223], v[112:115], a[164:167], v[220:223]
 ds_read_b128 v[100:103], v13 offset:30720
 v_mfma_f32_16x16x32_bf16 v[220:223], v[116:119], a[172:175], v[220:223]
 buffer_load_dwordx4 v[180:183], v7, s[16:19], s85 offen offset:2048 sc1
 v_mfma_f32_16x16x32_bf16 v[224:227], v[120:123], a[160:163], v[224:227]
 ds_read_b128 v[104:107], v13 offset:22528
 v_mfma_f32_16x16x32_bf16 v[224:227], v[124:127], a[168:171], v[224:227]
 v_mfma_f32_16x16x32_bf16 v[228:231], v[120:123], a[164:167], v[228:231]
 ds_read_b128 v[108:111], v13 offset:31744
 v_mfma_f32_16x16x32_bf16 v[228:231], v[124:127], a[172:175], v[228:231]
 buffer_load_dwordx4 v[184:187], v24, s[16:19], s85 offen offset:3072 sc1
 v_mfma_f32_16x16x32_bf16 v[232:235], v[128:131], a[160:163], v[232:235]
 ds_read_b128 v[112:115], v13 offset:23552
 v_mfma_f32_16x16x32_bf16 v[232:235], v[132:135], a[168:171], v[232:235]
 v_mfma_f32_16x16x32_bf16 v[236:239], v[128:131], a[164:167], v[236:239]
 ds_read_b128 v[116:119], v13 offset:32768
 s_waitcnt lgkmcnt(4)
 v_mfma_f32_16x16x32_bf16 v[236:239], v[132:135], a[172:175], v[236:239]
 buffer_load_dwordx4 v[188:191], v7, s[16:19], s85 offen offset:3072 sc1
 s_add_u32 s84, s84, s31
 v_mfma_f32_16x16x32_bf16 v[32:35], v[136:139], a[176:179], v[32:35]
 ds_read_b128 v[120:123], v13 offset:24576
 s_add_u32 m0, s56, 90112
 v_mfma_f32_16x16x32_bf16 v[32:35], v[140:143], a[184:187], v[32:35]
 v_mfma_f32_16x16x32_bf16 v[36:39], v[136:139], a[180:183], v[36:39]
 ds_read_b128 v[124:127], v13 offset:33792
 v_mfma_f32_16x16x32_bf16 v[36:39], v[140:143], a[188:191], v[36:39]
 buffer_load_dwordx4 v24, s[16:19], s84 offen sc1 lds
 v_mfma_f32_16x16x32_bf16 v[40:43], v[144:147], a[176:179], v[40:43]
 ds_read_b128 v[128:131], v13 offset:25600
 v_mfma_f32_16x16x32_bf16 v[40:43], v[148:151], a[184:187], v[40:43]
 v_mfma_f32_16x16x32_bf16 v[44:47], v[144:147], a[180:183], v[44:47]
 ds_read_b128 v[132:135], v13 offset:34816
 v_mfma_f32_16x16x32_bf16 v[44:47], v[148:151], a[188:191], v[44:47]
 buffer_load_dwordx4 v24, s[16:19], s84 offen offset:1024 sc1 lds
 v_mfma_f32_16x16x32_bf16 v[48:51], v[152:155], a[176:179], v[48:51]
 ds_read_b128 v[136:139], v13 offset:26624
 v_mfma_f32_16x16x32_bf16 v[48:51], v[156:159], a[184:187], v[48:51]
 v_mfma_f32_16x16x32_bf16 v[52:55], v[152:155], a[180:183], v[52:55]
 ds_read_b128 v[140:143], v13 offset:35840
 v_mfma_f32_16x16x32_bf16 v[52:55], v[156:159], a[188:191], v[52:55]
Lpg20:
 s_cbranch_vccnz Lj_Lfin
 buffer_load_dwordx4 v24, s[16:19], s84 offen offset:2048 sc1 lds
 v_mfma_f32_16x16x32_bf16 v[56:59], v[96:99], a[176:179], v[56:59]
 v_mfma_f32_16x16x32_bf16 v[56:59], v[100:103], a[184:187], v[56:59]
 v_mfma_f32_16x16x32_bf16 v[60:63], v[96:99], a[180:183], v[60:63]
 v_mfma_f32_16x16x32_bf16 v[60:63], v[100:103], a[188:191], v[60:63]
 s_waitcnt lgkmcnt(2)
 v_mfma_f32_16x16x32_bf16 v[80:83], v[104:107], a[176:179], v[80:83]
 buffer_load_dwordx4 v24, s[16:19], s84 offen offset:3072 sc1 lds
 s_add_u32 m0, m0, s30
 v_mfma_f32_16x16x32_bf16 v[80:83], v[108:111], a[184:187], v[80:83]
 v_mfma_f32_16x16x32_bf16 v[84:87], v[104:107], a[180:183], v[84:87]
 v_mfma_f32_16x16x32_bf16 v[84:87], v[108:111], a[188:191], v[84:87]
 buffer_load_dwordx4 v5, s[16:19], s84 offen sc1 lds
 v_mfma_f32_16x16x32_bf16 v[88:91], v[112:115], a[176:179], v[88:91]
 s_waitcnt vmcnt(23) lgkmcnt(0)
 s_barrier
 v_mfma_f32_16x16x32_bf16 v[88:91], v[116:119], a[184:187], v[88:91]
 ds_read_b128 v[144:147], v25 offset:0
 v_mfma_f32_16x16x32_bf16 v[92:95], v[112:115], a[180:183], v[92:95]
 ds_read_b128 v[148:151], v25 offset:9216
 v_mfma_f32_16x16x32_bf16 v[92:95], v[116:119], a[188:191], v[92:95]
 ds_read_b128 v[152:155], v25 offset:1024
 v_mfma_f32_16x16x32_bf16 v[216:219], v[120:123], a[176:179], v[216:219]
 ds_read_b128 v[156:159], v25 offset:10240
 v_mfma_f32_16x16x32_bf16 v[216:219], v[124:127], a[184:187], v[216:219]
 ds_read_b128 v[96:99], v25 offset:2048
 v_mfma_f32_16x16x32_bf16 v[220:223], v[120:123], a[180:183], v[220:223]
 ds_read_b128 v[100:103], v25 offset:11264
 v_mfma_f32_16x16x32_bf16 v[220:223], v[124:127], a[188:191], v[220:223]
 ds_read_b128 v[104:107], v25 offset:3072
 v_mfma_f32_16x16x32_bf16 v[224:227], v[128:131], a[176:179], v[224:227]
 ds_read_b128 v[108:111], v25 offset:12288
 v_mfma_f32_16x16x32_bf16 v[224:227], v[132:135], a[184:187], v[224:227]
 ds_read_b128 v[112:115], v25 offset:4096
 v_mfma_f32_16x16x32_bf16 v[228:231], v[128:131], a[180:183], v[228:231]
 ds_read_b128 v[116:119], v25 offset:13312
 s_waitcnt lgkmcnt(8)
 v_mfma_f32_16x16x32_bf16 v[228:231], v[132:135], a[188:191], v[228:231]
 buffer_load_dwordx4 v5, s[16:19], s84 offen offset:1024 sc1 lds
 v_mfma_f32_16x16x32_bf16 v[232:235], v[136:139], a[176:179], v[232:235]
 ds_read_b128 v[120:123], v25 offset:5120
 v_mfma_f32_16x16x32_bf16 v[232:235], v[140:143], a[184:187], v[232:235]
 buffer_load_dwordx4 v5, s[16:19], s84 offen offset:2048 sc1 lds
 v_mfma_f32_16x16x32_bf16 v[236:239], v[136:139], a[180:183], v[236:239]
 ds_read_b128 v[124:127], v25 offset:14336
 v_mfma_f32_16x16x32_bf16 v[236:239], v[140:143], a[188:191], v[236:239]
 buffer_load_dwordx4 v5, s[16:19], s84 offen offset:3072 sc1 lds
 s_add_u32 m0, m0, s30
 v_mfma_f32_16x16x32_bf16 v[32:35], v[144:147], a[0:3], v[32:35]
 ds_read_b128 v[128:131], v25 offset:6144
 v_mfma_f32_16x16x32_bf16 v[32:35], v[148:151], a[8:11], v[32:35]
 buffer_load_dwordx4 v6, s[16:19], s84 offen sc1 lds
 s_add_u32 s85, s85, s30
 v_mfma_f32_16x16x32_bf16 v[36:39], v[144:147], a[4:7], v[36:39]
 ds_read_b128 v[132:135], v25 offset:15360
 s_waitcnt lgkmcnt(8)
 v_mfma_f32_16x16x32_bf16 v[36:39], v[148:151], a[12:15], v[36:39]
 v_mfma_f32_16x16x32_bf16 v[40:43], v[152:155], a[0:3], v[40:43]
 ds_read_b128 v[136:139], v25 offset:7168
 v_mfma_f32_16x16x32_bf16 v[40:43], v[156:159], a[8:11], v[40:43]
 buffer_load_dwordx4 a[128:131], v24, s[16:19], s85 offen sc1
 v_mfma_f32_16x16x32_bf16 v[44:47], v[152:155], a[4:7], v[44:47]
 ds_read_b128 v[140:143], v25 offset:16384
 v_mfma_f32_16x16x32_bf16 v[44:47], v[156:159], a[12:15], v[44:47]
 v_mfma_f32_16x16x32_bf16 v[48:51], v[96:99], a[0:3], v[48:51]
 ds_read_b128 v[144:147], v25 offset:8192
 v_mfma_f32_16x16x32_bf16 v[48:51], v[100:103], a[8:11], v[48:51]
 buffer_load_dwordx4 a[132:135], v7, s[16:19], s85 offen sc1
 v_mfma_f32_16x16x32_bf16 v[52:55], v[96:99], a[4:7], v[52:55]
 ds_read_b128 v[148:151], v25 offset:17408
 s_waitcnt lgkmcnt(8)
 v_mfma_f32_16x16x32_bf16 v[52:55], v[100:103], a[12:15], v[52:55]
 v_mfma_f32_16x16x32_bf16 v[56:59], v[104:107], a[0:3], v[56:59]
 ds_read_b128 v[152:155], v25 offset:18432
 v_mfma_f32_16x16x32_bf16 v[56:59], v[108:111], a[8:11], v[56:59]
 buffer_load_dwordx4 a[136:139], v24, s[16:19], s85 offen offset:1024 sc1
 v_mfma_f32_16x16x32_bf16 v[60:63], v[104:107], a[4:7], v[60:63]
 ds_read_b128 v[156:159], v25 offset:27648
 s_load_dword s64, s[88:89], s39 offset:45184
 v_mfma_f32_16x16x32_bf16 v[60:63], v[108:111], a[12:15], v[60:63]
 v_mfma_f32_16x16x32_bf16 v[80:83], v[112:115], a[0:3], v[80:83]
 ds_read_b128 v[96:99], v25 offset:19456
 v_mfma_f32_16x16x32_bf16 v[80:83], v[116:119], a[8:11], v[80:83]
 buffer_load_dwordx4 a[140:143], v7, s[16:19], s85 offen offset:1024 sc1
 v_mfma_f32_16x16x32_bf16 v[84:87], v[112:115], a[4:7], v[84:87]
 ds_read_b128 v[100:103], v25 offset:28672
 s_waitcnt lgkmcnt(8)
 v_mfma_f32_16x16x32_bf16 v[84:87], v[116:119], a[12:15], v[84:87]
 v_mfma_f32_16x16x32_bf16 v[88:91], v[120:123], a[0:3], v[88:91]
 ds_read_b128 v[104:107], v25 offset:20480
 v_mfma_f32_16x16x32_bf16 v[88:91], v[124:127], a[8:11], v[88:91]
 buffer_load_dwordx4 a[144:147], v24, s[16:19], s85 offen offset:2048 sc1
 v_mfma_f32_16x16x32_bf16 v[92:95], v[120:123], a[4:7], v[92:95]
 ds_read_b128 v[108:111], v25 offset:29696
 v_mfma_f32_16x16x32_bf16 v[92:95], v[124:127], a[12:15], v[92:95]
 v_mfma_f32_16x16x32_bf16 v[216:219], v[128:131], a[0:3], v[216:219]
 ds_read_b128 v[112:115], v25 offset:21504
 v_mfma_f32_16x16x32_bf16 v[216:219], v[132:135], a[8:11], v[216:219]
 buffer_load_dwordx4 a[148:151], v7, s[16:19], s85 offen offset:2048 sc1
 v_mfma_f32_16x16x32_bf16 v[220:223], v[128:131], a[4:7], v[220:223]
 ds_read_b128 v[116:119], v25 offset:30720
 s_waitcnt lgkmcnt(8)
 v_mfma_f32_16x16x32_bf16 v[220:223], v[132:135], a[12:15], v[220:223]
 v_mfma_f32_16x16x32_bf16 v[224:227], v[136:139], a[0:3], v[224:227]
 ds_read_b128 v[120:123], v25 offset:22528
 v_mfma_f32_16x16x32_bf16 v[224:227], v[140:143], a[8:11], v[224:227]
 buffer_load_dwordx4 a[152:155], v24, s[16:19], s85 offen offset:3072 sc1
 v_mfma_f32_16x16x32_bf16 v[228:231], v[136:139], a[4:7], v[228:231]
 ds_read_b128 v[124:127], v25 offset:31744
 v_mfma_f32_16x16x32_bf16 v[228:231], v[140:143], a[12:15], v[228:231]
 v_mfma_f32_16x16x32_bf16 v[232:235], v[144:147], a[0:3], v[232:235]
 ds_read_b128 v[128:131], v25 offset:23552
 v_mfma_f32_16x16x32_bf16 v[232:235], v[148:151], a[8:11], v[232:235]
 buffer_load_dwordx4 a[156:159], v7, s[16:19], s85 offen offset:3072 sc1
 s_mul_i32 s84, s83, 442368
 v_mfma_f32_16x16x32_bf16 v[236:239], v[144:147], a[4:7], v[236:239]
 ds_read_b128 v[132:135], v25 offset:32768
 s_waitcnt lgkmcnt(8)
 v_mfma_f32_16x16x32_bf16 v[236:239], v[148:151], a[12:15], v[236:239]
 s_add_u32 s84, s84, s86
 s_add_u32 m0, s56, 53248
 v_mfma_f32_16x16x32_bf16 v[32:35], v[152:155], a[16:19], v[32:35]
 ds_read_b128 v[136:139], v25 offset:24576
 v_mfma_f32_16x16x32_bf16 v[32:35], v[156:159], a[24:27], v[32:35]
 buffer_load_dwordx4 v24, s[16:19], s84 offen sc1 lds
 v_mfma_f32_16x16x32_bf16 v[36:39], v[152:155], a[20:23], v[36:39]
 ds_read_b128 v[140:143], v25 offset:33792
 v_mfma_f32_16x16x32_bf16 v[36:39], v[156:159], a[28:31], v[36:39]
 v_mfma_f32_16x16x32_bf16 v[40:43], v[96:99], a[16:19], v[40:43]
 ds_read_b128 v[144:147], v25 offset:25600
 v_mfma_f32_16x16x32_bf16 v[40:43], v[100:103], a[24:27], v[40:43]
 buffer_load_dwordx4 v24, s[16:19], s84 offen offset:1024 sc1 lds
 v_mfma_f32_16x16x32_bf16 v[44:47], v[96:99], a[20:23], v[44:47]
 ds_read_b128 v[148:151], v25 offset:34816
 s_waitcnt lgkmcnt(8)
 v_mfma_f32_16x16x32_bf16 v[44:47], v[100:103], a[28:31], v[44:47]
 v_mfma_f32_16x16x32_bf16 v[48:51], v[104:107], a[16:19], v[48:51]
 ds_read_b128 v[152:155], v25 offset:26624
 v_mfma_f32_16x16x32_bf16 v[48:51], v[108:111], a[24:27], v[48:51]
 buffer_load_dwordx4 v24, s[16:19], s84 offen offset:2048 sc1 lds
 v_mfma_f32_16x16x32_bf16 v[52:55], v[104:107], a[20:23], v[52:55]
 ds_read_b128 v[156:159], v25 offset:35840
 v_mfma_f32_16x16x32_bf16 v[52:55], v[108:111], a[28:31], v[52:55]
 v_mfma_f32_16x16x32_bf16 v[56:59], v[112:115], a[16:19], v[56:59]
 v_mfma_f32_16x16x32_bf16 v[56:59], v[116:119], a[24:27], v[56:59]
 buffer_load_dwordx4 v24, s[16:19], s84 offen offset:3072 sc1 lds
 s_add_u32 m0, m0, s30
 v_mfma_f32_16x16x32_bf16 v[60:63], v[112:115], a[20:23], v[60:63]
 v_mfma_f32_16x16x32_bf16 v[60:63], v[116:119], a[28:31], v[60:63]
 s_waitcnt lgkmcnt(6)
 v_mfma_f32_16x16x32_bf16 v[80:83], v[120:123], a[16:19], v[80:83]
 v_mfma_f32_16x16x32_bf16 v[80:83], v[124:127], a[24:27], v[80:83]
 buffer_load_dwordx4 v5, s[16:19], s84 offen sc1 lds
 v_mfma_f32_16x16x32_bf16 v[84:87], v[120:123], a[20:23], v[84:87]
 v_mfma_f32_16x16x32_bf16 v[84:87], v[124:127], a[28:31], v[84:87]
 v_mfma_f32_16x16x32_bf16 v[88:91], v[128:131], a[16:19], v[88:91]
 s_waitcnt vmcnt(22) lgkmcnt(0)
 s_barrier
 v_mfma_f32_16x16x32_bf16 v[88:91], v[132:135], a[24:27], v[88:91]
 ds_read_b128 v[96:99], v8 offset:0
 v_mfma_f32_16x16x32_bf16 v[92:95], v[128:131], a[20:23], v[92:95]
 ds_read_b128 v[100:103], v8 offset:9216
 v_mfma_f32_16x16x32_bf16 v[92:95], v[132:135], a[28:31], v[92:95]
 ds_read_b128 v[104:107], v8 offset:1024
 v_mfma_f32_16x16x32_bf16 v[216:219], v[136:139], a[16:19], v[216:219]
 ds_read_b128 v[108:111], v8 offset:10240
 v_mfma_f32_16x16x32_bf16 v[216:219], v[140:143], a[24:27], v[216:219]
 ds_read_b128 v[112:115], v8 offset:2048
 v_mfma_f32_16x16x32_bf16 v[220:223], v[136:139], a[20:23], v[220:223]
 ds_read_b128 v[116:119], v8 offset:11264
 v_mfma_f32_16x16x32_bf16 v[220:223], v[140:143], a[28:31], v[220:223]
 ds_read_b128 v[120:123], v8 offset:3072
 v_mfma_f32_16x16x32_bf16 v[224:227], v[144:147], a[16:19], v[224:227]
 ds_read_b128 v[124:127], v8 offset:12288
 v_mfma_f32_16x16x32_bf16 v[224:227], v[148:151], a[24:27], v[224:227]
 ds_read_b128 v[128:131], v8 offset:4096
 v_mfma_f32_16x16x32_bf16 v[228:231], v[144:147], a[20:23], v[228:231]
 ds_read_b128 v[132:135], v8 offset:13312
 s_waitcnt lgkmcnt(8)
 v_mfma_f32_16x16x32_bf16 v[228:231], v[148:151], a[28:31], v[228:231]
 s_cmp_eq_u32 s64, 0x10101
 s_cbranch_scc0 Lsp_hp2
Lrt_hp2:
 v_mfma_f32_16x16x32_bf16 v[232:235], v[152:155], a[16:19], v[232:235]
 ds_read_b128 v[136:139], v8 offset:5120
 v_mfma_f32_16x16x32_bf16 v[232:235], v[156:159], a[24:27], v[232:235]
 buffer_load_dwordx4 v5, s[16:19], s84 offen offset:1024 sc1 lds
 v_mfma_f32_16x16x32_bf16 v[236:239], v[152:155], a[20:23], v[236:239]
 ds_read_b128 v[140:143], v8 offset:14336
 v_mfma_f32_16x16x32_bf16 v[236:239], v[156:159], a[28:31], v[236:239]
 buffer_load_dwordx4 v5, s[16:19], s84 offen offset:2048 sc1 lds
 v_mfma_f32_16x16x32_bf16 v[32:35], v[96:99], v[160:163], v[32:35]
 ds_read_b128 v[144:147], v8 offset:6144
 v_mfma_f32_16x16x32_bf16 v[32:35], v[100:103], v[168:171], v[32:35]
 buffer_load_dwordx4 v5, s[16:19], s84 offen offset:3072 sc1 lds
 s_add_u32 m0, m0, s30
 v_mfma_f32_16x16x32_bf16 v[36:39], v[96:99], v[164:167], v[36:39]
 ds_read_b128 v[148:151], v8 offset:15360
 s_waitcnt lgkmcnt(4)
 v_mfma_f32_16x16x32_bf16 v[36:39], v[100:103], v[172:175], v[36:39]
 buffer_load_dwordx4 v6, s[16:19], s84 offen sc1 lds
 s_mul_i32 s85, s83, 12288
 v_mfma_f32_16x16x32_bf16 v[40:43], v[104:107], v[160:163], v[40:43]
 ds_read_b128 v[152:155], v8 offset:7168
 s_add_u32 s85, s85, s87
 v_mfma_f32_16x16x32_bf16 v[40:43], v[108:111], v[168:171], v[40:43]
 v_mfma_f32_16x16x32_bf16 v[44:47], v[104:107], v[164:167], v[44:47]
 ds_read_b128 v[156:159], v8 offset:16384
 v_mfma_f32_16x16x32_bf16 v[44:47], v[108:111], v[172:175], v[44:47]
 buffer_load_dwordx4 a[160:163], v24, s[16:19], s85 offen sc1
 v_mfma_f32_16x16x32_bf16 v[48:51], v[112:115], v[160:163], v[48:51]
 ds_read_b128 v[96:99], v8 offset:8192
 v_mfma_f32_16x16x32_bf16 v[48:51], v[116:119], v[168:171], v[48:51]
 v_mfma_f32_16x16x32_bf16 v[52:55], v[112:115], v[164:167], v[52:55]
 ds_read_b128 v[100:103], v8 offset:17408
 v_mfma_f32_16x16x32_bf16 v[52:55], v[116:119], v[172:175], v[52:55]
 buffer_load_dwordx4 a[164:167], v7, s[16:19], s85 offen sc1
 v_mfma_f32_16x16x32_bf16 v[56:59], v[120:123], v[160:163], v[56:59]
 ds_read_b128 v[104:107], v8 offset:18432
 v_mfma_f32_16x16x32_bf16 v[56:59], v[124:127], v[168:171], v[56:59]
 v_mfma_f32_16x16x32_bf16 v[60:63], v[120:123], v[164:167], v[60:63]
 ds_read_b128 v[108:111], v8 offset:27648
 v_mfma_f32_16x16x32_bf16 v[60:63], v[124:127], v[172:175], v[60:63]
 buffer_load_dwordx4 a[168:171], v24, s[16:19], s85 offen offset:1024 sc1
 v_mfma_f32_16x16x32_bf16 v[80:83], v[128:131], v[160:163], v[80:83]
 ds_read_b128 v[112:115], v8 offset:19456
 v_mfma_f32_16x16x32_bf16 v[80:83], v[132:135], v[168:171], v[80:83]
 v_mfma_f32_16x16x32_bf16 v[84:87], v[128:131], v[164:167], v[84:87]
 ds_read_b128 v[116:119], v8 offset:28672
 s_waitcnt lgkmcnt(4)
 v_mfma_f32_16x16x32_bf16 v[84:87], v[132:135], v[172:175], v[84:87]
 buffer_load_dwordx4 a[172:175], v7, s[16:19], s85 offen offset:1024 sc1
 v_mfma_f32_16x16x32_bf16 v[88:91], v[136:139], v[160:163], v[88:91]
 ds_read_b128 v[120:123], v8 offset:20480
 v_mfma_f32_16x16x32_bf16 v[88:91], v[140:143], v[168:171], v[88:91]
 v_mfma_f32_16x16x32_bf16 v[92:95], v[136:139], v[164:167], v[92:95]
 ds_read_b128 v[124:127], v8 offset:29696
 v_mfma_f32_16x16x32_bf16 v[92:95], v[140:143], v[172:175], v[92:95]
 buffer_load_dwordx4 a[176:179], v24, s[16:19], s85 offen offset:2048 sc1
 v_mfma_f32_16x16x32_bf16 v[216:219], v[144:147], v[160:163], v[216:219]
 ds_read_b128 v[128:131], v8 offset:21504
 v_mfma_f32_16x16x32_bf16 v[216:219], v[148:151], v[168:171], v[216:219]
 v_mfma_f32_16x16x32_bf16 v[220:223], v[144:147], v[164:167], v[220:223]
 ds_read_b128 v[132:135], v8 offset:30720
 v_mfma_f32_16x16x32_bf16 v[220:223], v[148:151], v[172:175], v[220:223]
 buffer_load_dwordx4 a[180:183], v7, s[16:19], s85 offen offset:2048 sc1
 v_mfma_f32_16x16x32_bf16 v[224:227], v[152:155], v[160:163], v[224:227]
 ds_read_b128 v[136:139], v8 offset:22528
 v_mfma_f32_16x16x32_bf16 v[224:227], v[156:159], v[168:171], v[224:227]
 v_mfma_f32_16x16x32_bf16 v[228:231], v[152:155], v[164:167], v[228:231]
 ds_read_b128 v[140:143], v8 offset:31744
 v_mfma_f32_16x16x32_bf16 v[228:231], v[156:159], v[172:175], v[228:231]
 buffer_load_dwordx4 a[184:187], v24, s[16:19], s85 offen offset:3072 sc1
 v_mfma_f32_16x16x32_bf16 v[232:235], v[96:99], v[160:163], v[232:235]
 ds_read_b128 v[144:147], v8 offset:23552
 v_mfma_f32_16x16x32_bf16 v[232:235], v[100:103], v[168:171], v[232:235]
 v_mfma_f32_16x16x32_bf16 v[236:239], v[96:99], v[164:167], v[236:239]
 ds_read_b128 v[148:151], v8 offset:32768
 s_waitcnt lgkmcnt(4)
 v_mfma_f32_16x16x32_bf16 v[236:239], v[100:103], v[172:175], v[236:239]
 buffer_load_dwordx4 a[188:191], v7, s[16:19], s85 offen offset:3072 sc1
 s_add_u32 s84, s84, s31
 v_mfma_f32_16x16x32_bf16 v[32:35], v[104:107], v[176:179], v[32:35]
 ds_read_b128 v[152:155], v8 offset:24576
 s_add_u32 m0, s56, 0
 v_mfma_f32_16x16x32_bf16 v[32:35], v[108:111], v[184:187], v[32:35]
 v_mfma_f32_16x16x32_bf16 v[36:39], v[104:107], v[180:183], v[36:39]
 ds_read_b128 v[156:159], v8 offset:33792
 v_mfma_f32_16x16x32_bf16 v[36:39], v[108:111], v[188:191], v[36:39]
 buffer_load_dwordx4 v24, s[16:19], s84 offen sc1 lds
 v_mfma_f32_16x16x32_bf16 v[40:43], v[112:115], v[176:179], v[40:43]
 ds_read_b128 v[96:99], v8 offset:25600
 v_mfma_f32_16x16x32_bf16 v[40:43], v[116:119], v[184:187], v[40:43]
 v_mfma_f32_16x16x32_bf16 v[44:47], v[112:115], v[180:183], v[44:47]
 ds_read_b128 v[100:103], v8 offset:34816
 v_mfma_f32_16x16x32_bf16 v[44:47], v[116:119], v[188:191], v[44:47]
 buffer_load_dwordx4 v24, s[16:19], s84 offen offset:1024 sc1 lds
 v_mfma_f32_16x16x32_bf16 v[48:51], v[120:123], v[176:179], v[48:51]
 ds_read_b128 v[104:107], v8 offset:26624
 v_mfma_f32_16x16x32_bf16 v[48:51], v[124:127], v[184:187], v[48:51]
 v_mfma_f32_16x16x32_bf16 v[52:55], v[120:123], v[180:183], v[52:55]
 ds_read_b128 v[108:111], v8 offset:35840
 v_mfma_f32_16x16x32_bf16 v[52:55], v[124:127], v[188:191], v[52:55]
 buffer_load_dwordx4 v24, s[16:19], s84 offen offset:2048 sc1 lds
 v_mfma_f32_16x16x32_bf16 v[56:59], v[128:131], v[176:179], v[56:59]
 v_mfma_f32_16x16x32_bf16 v[56:59], v[132:135], v[184:187], v[56:59]
 v_mfma_f32_16x16x32_bf16 v[60:63], v[128:131], v[180:183], v[60:63]
 v_mfma_f32_16x16x32_bf16 v[60:63], v[132:135], v[188:191], v[60:63]
 s_waitcnt lgkmcnt(2)
 v_mfma_f32_16x16x32_bf16 v[80:83], v[136:139], v[176:179], v[80:83]
 buffer_load_dwordx4 v24, s[16:19], s84 offen offset:3072 sc1 lds
 s_add_u32 m0, m0, s30
 v_mfma_f32_16x16x32_bf16 v[80:83], v[140:143], v[184:187], v[80:83]
 v_mfma_f32_16x16x32_bf16 v[84:87], v[136:139], v[180:183], v[84:87]
 v_mfma_f32_16x16x32_bf16 v[84:87], v[140:143], v[188:191], v[84:87]
 buffer_load_dwordx4 v5, s[16:19], s84 offen sc1 lds
 v_mfma_f32_16x16x32_bf16 v[88:91], v[144:147], v[176:179], v[88:91]
 s_waitcnt vmcnt(22) lgkmcnt(0)
 s_barrier
 v_mfma_f32_16x16x32_bf16 v[88:91], v[148:151], v[184:187], v[88:91]
 ds_read_b128 v[112:115], v9 offset:0
 v_mfma_f32_16x16x32_bf16 v[92:95], v[144:147], v[180:183], v[92:95]
 ds_read_b128 v[116:119], v9 offset:9216
 v_mfma_f32_16x16x32_bf16 v[92:95], v[148:151], v[188:191], v[92:95]
 ds_read_b128 v[120:123], v9 offset:1024
 v_mfma_f32_16x16x32_bf16 v[216:219], v[152:155], v[176:179], v[216:219]
 ds_read_b128 v[124:127], v9 offset:10240
 v_mfma_f32_16x16x32_bf16 v[216:219], v[156:159], v[184:187], v[216:219]
 ds_read_b128 v[128:131], v9 offset:2048
 v_mfma_f32_16x16x32_bf16 v[220:223], v[152:155], v[180:183], v[220:223]
 ds_read_b128 v[132:135], v9 offset:11264
 v_mfma_f32_16x16x32_bf16 v[220:223], v[156:159], v[188:191], v[220:223]
 ds_read_b128 v[136:139], v9 offset:3072
 v_mfma_f32_16x16x32_bf16 v[224:227], v[96:99], v[176:179], v[224:227]
 ds_read_b128 v[140:143], v9 offset:12288
 v_mfma_f32_16x16x32_bf16 v[224:227], v[100:103], v[184:187], v[224:227]
 ds_read_b128 v[144:147], v9 offset:4096
 v_mfma_f32_16x16x32_bf16 v[228:231], v[96:99], v[180:183], v[228:231]
 ds_read_b128 v[148:151], v9 offset:13312
 s_waitcnt lgkmcnt(8)
 v_mfma_f32_16x16x32_bf16 v[228:231], v[100:103], v[188:191], v[228:231]
 buffer_load_dwordx4 v5, s[16:19], s84 offen offset:1024 sc1 lds
 v_mfma_f32_16x16x32_bf16 v[232:235], v[104:107], v[176:179], v[232:235]
 ds_read_b128 v[152:155], v9 offset:5120
 v_mfma_f32_16x16x32_bf16 v[232:235], v[108:111], v[184:187], v[232:235]
 buffer_load_dwordx4 v5, s[16:19], s84 offen offset:2048 sc1 lds
 v_mfma_f32_16x16x32_bf16 v[236:239], v[104:107], v[180:183], v[236:239]
 ds_read_b128 v[156:159], v9 offset:14336
 v_mfma_f32_16x16x32_bf16 v[236:239], v[108:111], v[188:191], v[236:239]
 buffer_load_dwordx4 v5, s[16:19], s84 offen offset:3072 sc1 lds
 s_add_u32 m0, m0, s30
 v_mfma_f32_16x16x32_bf16 v[32:35], v[112:115], a[128:131], v[32:35]
 ds_read_b128 v[96:99], v9 offset:6144
 v_mfma_f32_16x16x32_bf16 v[32:35], v[116:119], a[136:139], v[32:35]
 buffer_load_dwordx4 v6, s[16:19], s84 offen sc1 lds
 s_add_u32 s85, s85, s30
 v_mfma_f32_16x16x32_bf16 v[36:39], v[112:115], a[132:135], v[36:39]
 ds_read_b128 v[100:103], v9 offset:15360
 s_waitcnt lgkmcnt(4)
 v_mfma_f32_16x16x32_bf16 v[36:39], v[116:119], a[140:143], v[36:39]
 v_mfma_f32_16x16x32_bf16 v[40:43], v[120:123], a[128:131], v[40:43]
 ds_read_b128 v[104:107], v9 offset:7168
 v_mfma_f32_16x16x32_bf16 v[40:43], v[124:127], a[136:139], v[40:43]
 buffer_load_dwordx4 a[0:3], v24, s[16:19], s85 offen sc1
 v_mfma_f32_16x16x32_bf16 v[44:47], v[120:123], a[132:135], v[44:47]
 ds_read_b128 v[108:111], v9 offset:16384
 v_mfma_f32_16x16x32_bf16 v[44:47], v[124:127], a[140:143], v[44:47]
 v_mfma_f32_16x16x32_bf16 v[48:51], v[128:131], a[128:131], v[48:51]
 ds_read_b128 v[112:115], v9 offset:8192
 v_mfma_f32_16x16x32_bf16 v[48:51], v[132:135], a[136:139], v[48:51]
 buffer_load_dwordx4 a[4:7], v7, s[16:19], s85 offen sc1
 v_mfma_f32_16x16x32_bf16 v[52:55], v[128:131], a[132:135], v[52:55]
 ds_read_b128 v[116:119], v9 offset:17408
 v_mfma_f32_16x16x32_bf16 v[52:55], v[132:135], a[140:143], v[52:55]
 v_mfma_f32_16x16x32_bf16 v[56:59], v[136:139], a[128:131], v[56:59]
 ds_read_b128 v[120:123], v9 offset:18432
 v_mfma_f32_16x16x32_bf16 v[56:59], v[140:143], a[136:139], v[56:59]
 buffer_load_dwordx4 a[8:11], v24, s[16:19], s85 offen offset:1024 sc1
 v_mfma_f32_16x16x32_bf16 v[60:63], v[136:139], a[132:135], v[60:63]
 ds_read_b128 v[124:127], v9 offset:27648
 v_mfma_f32_16x16x32_bf16 v[60:63], v[140:143], a[140:143], v[60:63]
 v_mfma_f32_16x16x32_bf16 v[80:83], v[144:147], a[128:131], v[80:83]
 ds_read_b128 v[128:131], v9 offset:19456
 v_mfma_f32_16x16x32_bf16 v[80:83], v[148:151], a[136:139], v[80:83]
 buffer_load_dwordx4 a[12:15], v7, s[16:19], s85 offen offset:1024 sc1
 v_mfma_f32_16x16x32_bf16 v[84:87], v[144:147], a[132:135], v[84:87]
 ds_read_b128 v[132:135], v9 offset:28672
 s_waitcnt lgkmcnt(4)
 v_mfma_f32_16x16x32_bf16 v[84:87], v[148:151], a[140:143], v[84:87]
 v_mfma_f32_16x16x32_bf16 v[88:91], v[152:155], a[128:131], v[88:91]
 ds_read_b128 v[136:139], v9 offset:20480
 v_mfma_f32_16x16x32_bf16 v[88:91], v[156:159], a[136:139], v[88:91]
 buffer_load_dwordx4 a[16:19], v24, s[16:19], s85 offen offset:2048 sc1
 v_mfma_f32_16x16x32_bf16 v[92:95], v[152:155], a[132:135], v[92:95]
 ds_read_b128 v[140:143], v9 offset:29696
 v_mfma_f32_16x16x32_bf16 v[92:95], v[156:159], a[140:143], v[92:95]
 v_mfma_f32_16x16x32_bf16 v[216:219], v[96:99], a[128:131], v[216:219]
 ds_read_b128 v[144:147], v9 offset:21504
 v_mfma_f32_16x16x32_bf16 v[216:219], v[100:103], a[136:139], v[216:219]
 buffer_load_dwordx4 a[20:23], v7, s[16:19], s85 offen offset:2048 sc1
 v_mfma_f32_16x16x32_bf16 v[220:223], v[96:99], a[132:135], v[220:223]
 ds_read_b128 v[148:151], v9 offset:30720
 v_mfma_f32_16x16x32_bf16 v[220:223], v[100:103], a[140:143], v[220:223]
 v_mfma_f32_16x16x32_bf16 v[224:227], v[104:107], a[128:131], v[224:227]
 ds_read_b128 v[152:155], v9 offset:22528
 v_mfma_f32_16x16x32_bf16 v[224:227], v[108:111], a[136:139], v[224:227]
 buffer_load_dwordx4 a[24:27], v24, s[16:19], s85 offen offset:3072 sc1
 v_mfma_f32_16x16x32_bf16 v[228:231], v[104:107], a[132:135], v[228:231]
 ds_read_b128 v[156:159], v9 offset:31744
 v_mfma_f32_16x16x32_bf16 v[228:231], v[108:111], a[140:143], v[228:231]
 v_mfma_f32_16x16x32_bf16 v[232:235], v[112:115], a[128:131], v[232:235]
 ds_read_b128 v[96:99], v9 offset:23552
 v_mfma_f32_16x16x32_bf16 v[232:235], v[116:119], a[136:139], v[232:235]
 buffer_load_dwordx4 a[28:31], v7, s[16:19], s85 offen offset:3072 sc1
 s_add_u32 s84, s84, s31
 v_mfma_f32_16x16x32_bf16 v[236:239], v[112:115], a[132:135], v[236:239]
 ds_read_b128 v[100:103], v9 offset:32768
 s_waitcnt lgkmcnt(4)
 v_mfma_f32_16x16x32_bf16 v[236:239], v[116:119], a[140:143], v[236:239]
 s_add_u32 m0, s56, 126976
 v_mfma_f32_16x16x32_bf16 v[32:35], v[120:123], a[144:147], v[32:35]
 ds_read_b128 v[104:107], v9 offset:24576
 v_mfma_f32_16x16x32_bf16 v[32:35], v[124:127], a[152:155], v[32:35]
 buffer_load_dwordx4 v24, s[16:19], s84 offen sc1 lds
 v_mfma_f32_16x16x32_bf16 v[36:39], v[120:123], a[148:151], v[36:39]
 ds_read_b128 v[108:111], v9 offset:33792
 v_mfma_f32_16x16x32_bf16 v[36:39], v[124:127], a[156:159], v[36:39]
 v_mfma_f32_16x16x32_bf16 v[40:43], v[128:131], a[144:147], v[40:43]
 ds_read_b128 v[112:115], v9 offset:25600
 v_mfma_f32_16x16x32_bf16 v[40:43], v[132:135], a[152:155], v[40:43]
 buffer_load_dwordx4 v24, s[16:19], s84 offen offset:1024 sc1 lds
 v_mfma_f32_16x16x32_bf16 v[44:47], v[128:131], a[148:151], v[44:47]
 ds_read_b128 v[116:119], v9 offset:34816
 v_mfma_f32_16x16x32_bf16 v[44:47], v[132:135], a[156:159], v[44:47]
 v_mfma_f32_16x16x32_bf16 v[48:51], v[136:139], a[144:147], v[48:51]
 ds_read_b128 v[120:123], v9 offset:26624
 v_mfma_f32_16x16x32_bf16 v[48:51], v[140:143], a[152:155], v[48:51]
 buffer_load_dwordx4 v24, s[16:19], s84 offen offset:2048 sc1 lds
 v_mfma_f32_16x16x32_bf16 v[52:55], v[136:139], a[148:151], v[52:55]
 ds_read_b128 v[124:127], v9 offset:35840
 v_mfma_f32_16x16x32_bf16 v[52:55], v[140:143], a[156:159], v[52:55]
 v_mfma_f32_16x16x32_bf16 v[56:59], v[144:147], a[144:147], v[56:59]
 v_mfma_f32_16x16x32_bf16 v[56:59], v[148:151], a[152:155], v[56:59]
 buffer_load_dwordx4 v24, s[16:19], s84 offen offset:3072 sc1 lds
 s_add_u32 m0, m0, s30
 v_mfma_f32_16x16x32_bf16 v[60:63], v[144:147], a[148:151], v[60:63]
 v_mfma_f32_16x16x32_bf16 v[60:63], v[148:151], a[156:159], v[60:63]
 s_waitcnt lgkmcnt(2)
 v_mfma_f32_16x16x32_bf16 v[80:83], v[152:155], a[144:147], v[80:83]
 v_mfma_f32_16x16x32_bf16 v[80:83], v[156:159], a[152:155], v[80:83]
 buffer_load_dwordx4 v5, s[16:19], s84 offen sc1 lds
 v_mfma_f32_16x16x32_bf16 v[84:87], v[152:155], a[148:151], v[84:87]
 v_mfma_f32_16x16x32_bf16 v[84:87], v[156:159], a[156:159], v[84:87]
 v_mfma_f32_16x16x32_bf16 v[88:91], v[96:99], a[144:147], v[88:91]
 s_waitcnt vmcnt(22) lgkmcnt(0)
 s_barrier
 v_mfma_f32_16x16x32_bf16 v[88:91], v[100:103], a[152:155], v[88:91]
 ds_read_b128 v[128:131], v13 offset:0
 v_mfma_f32_16x16x32_bf16 v[92:95], v[96:99], a[148:151], v[92:95]
 ds_read_b128 v[132:135], v13 offset:9216
 v_mfma_f32_16x16x32_bf16 v[92:95], v[100:103], a[156:159], v[92:95]
 ds_read_b128 v[136:139], v13 offset:1024
 v_mfma_f32_16x16x32_bf16 v[216:219], v[104:107], a[144:147], v[216:219]
 ds_read_b128 v[140:143], v13 offset:10240
 v_mfma_f32_16x16x32_bf16 v[216:219], v[108:111], a[152:155], v[216:219]
 ds_read_b128 v[144:147], v13 offset:2048
 v_mfma_f32_16x16x32_bf16 v[220:223], v[104:107], a[148:151], v[220:223]
 ds_read_b128 v[148:151], v13 offset:11264
 v_mfma_f32_16x16x32_bf16 v[220:223], v[108:111], a[156:159], v[220:223]
 ds_read_b128 v[152:155], v13 offset:3072
 v_mfma_f32_16x16x32_bf16 v[224:227], v[112:115], a[144:147], v[224:227]
 ds_read_b128 v[156:159], v13 offset:12288
 v_mfma_f32_16x16x32_bf16 v[224:227], v[116:119], a[152:155], v[224:227]
 ds_read_b128 v[96:99], v13 offset:4096
 v_mfma_f32_16x16x32_bf16 v[228:231], v[112:115], a[148:151], v[228:231]
 ds_read_b128 v[100:103], v13 offset:13312
 s_waitcnt lgkmcnt(8)
 v_mfma_f32_16x16x32_bf16 v[228:231], v[116:119], a[156:159], v[228:231]
 buffer_load_dwordx4 v5, s[16:19], s84 offen offset:1024 sc1 lds
 v_mfma_f32_16x16x32_bf16 v[232:235], v[120:123], a[144:147], v[232:235]
 ds_read_b128 v[104:107], v13 offset:5120
 v_mfma_f32_16x16x32_bf16 v[232:235], v[124:127], a[152:155], v[232:235]
 buffer_load_dwordx4 v5, s[16:19], s84 offen offset:2048 sc1 lds
 v_mfma_f32_16x16x32_bf16 v[236:239], v[120:123], a[148:151], v[236:239]
 ds_read_b128 v[108:111], v13 offset:14336
 v_mfma_f32_16x16x32_bf16 v[236:239], v[124:127], a[156:159], v[236:239]
 buffer_load_dwordx4 v5, s[16:19], s84 offen offset:3072 sc1 lds
 s_add_u32 m0, m0, s30
 v_mfma_f32_16x16x32_bf16 v[32:35], v[128:131], a[160:163], v[32:35]
 ds_read_b128 v[112:115], v13 offset:6144
 v_mfma_f32_16x16x32_bf16 v[32:35], v[132:135], a[168:171], v[32:35]
 buffer_load_dwordx4 v6, s[16:19], s84 offen sc1 lds
 s_add_u32 s85, s85, s30
 v_mfma_f32_16x16x32_bf16 v[36:39], v[128:131], a[164:167], v[36:39]
 ds_read_b128 v[116:119], v13 offset:15360
 s_waitcnt lgkmcnt(4)
 v_mfma_f32_16x16x32_bf16 v[36:39], v[132:135], a[172:175], v[36:39]
 v_mfma_f32_16x16x32_bf16 v[40:43], v[136:139], a[160:163], v[40:43]
 ds_read_b128 v[120:123], v13 offset:7168
 v_mfma_f32_16x16x32_bf16 v[40:43], v[140:143], a[168:171], v[40:43]
 buffer_load_dwordx4 v[160:163], v24, s[16:19], s85 offen sc1
 v_mfma_f32_16x16x32_bf16 v[44:47], v[136:139], a[164:167], v[44:47]
 ds_read_b128 v[124:127], v13 offset:16384
 v_mfma_f32_16x16x32_bf16 v[44:47], v[140:143], a[172:175], v[44:47]
 v_mfma_f32_16x16x32_bf16 v[48:51], v[144:147], a[160:163], v[48:51]
 ds_read_b128 v[128:131], v13 offset:8192
 v_mfma_f32_16x16x32_bf16 v[48:51], v[148:151], a[168:171], v[48:51]
 buffer_load_dwordx4 v[164:167], v7, s[16:19], s85 offen sc1
 v_mfma_f32_16x16x32_bf16 v[52:55], v[144:147], a[164:167], v[52:55]
 ds_read_b128 v[132:135], v13 offset:17408
 v_mfma_f32_16x16x32_bf16 v[52:55], v[148:151], a[172:175], v[52:55]
 v_mfma_f32_16x16x32_bf16 v[56:59], v[152:155], a[160:163], v[56:59]
 ds_read_b128 v[136:139], v13 offset:18432
 v_mfma_f32_16x16x32_bf16 v[56:59], v[156:159], a[168:171], v[56:59]
 buffer_load_dwordx4 v[168:171], v24, s[16:19], s85 offen offset:1024 sc1
 v_mfma_f32_16x16x32_bf16 v[60:63], v[152:155], a[164:167], v[60:63]
 ds_read_b128 v[140:143], v13 offset:27648
 v_mov_b32 v20, -1
 v_mfma_f32_16x16x32_bf16 v[60:63], v[156:159], a[172:175], v[60:63]
 v_mov_b32 v21, -1
 v_mfma_f32_16x16x32_bf16 v[80:83], v[96:99], a[160:163], v[80:83]
 ds_read_b128 v[144:147], v13 offset:19456
 v_mov_b32 v22, -1
 v_mfma_f32_16x16x32_bf16 v[80:83], v[100:103], a[168:171], v[80:83]
 buffer_load_dwordx4 v[172:175], v7, s[16:19], s85 offen offset:1024 sc1
 v_mov_b32 v23, -1
 v_mfma_f32_16x16x32_bf16 v[84:87], v[96:99], a[164:167], v[84:87]
 ds_read_b128 v[148:151], v13 offset:28672
 s_waitcnt lgkmcnt(4)
 v_mfma_f32_16x16x32_bf16 v[84:87], v[100:103], a[172:175], v[84:87]
 v_mfma_f32_16x16x32_bf16 v[88:91], v[104:107], a[160:163], v[88:91]
 ds_read_b128 v[152:155], v13 offset:20480
 v_mfma_f32_16x16x32_bf16 v[88:91], v[108:111], a[168:171], v[88:91]
 buffer_load_dwordx4 v[176:179], v24, s[16:19], s85 offen offset:2048 sc1
 v_mfma_f32_16x16x32_bf16 v[92:95], v[104:107], a[164:167], v[92:95]
 ds_read_b128 v[156:159], v13 offset:29696
 v_mfma_f32_16x16x32_bf16 v[92:95], v[108:111], a[172:175], v[92:95]
 v_mfma_f32_16x16x32_bf16 v[216:219], v[112:115], a[160:163], v[216:219]
 ds_read_b128 v[96:99], v13 offset:21504
 v_mfma_f32_16x16x32_bf16 v[216:219], v[116:119], a[168:171], v[216:219]
 buffer_load_dwordx4 v[180:183], v7, s[16:19], s85 offen offset:2048 sc1
 v_mfma_f32_16x16x32_bf16 v[220:223], v[112:115], a[164:167], v[220:223]
 ds_read_b128 v[100:103], v13 offset:30720
 v_mfma_f32_16x16x32_bf16 v[220:223], v[116:119], a[172:175], v[220:223]
 v_mfma_f32_16x16x32_bf16 v[224:227], v[120:123], a[160:163], v[224:227]
 ds_read_b128 v[104:107], v13 offset:22528
 v_mfma_f32_16x16x32_bf16 v[224:227], v[124:127], a[168:171], v[224:227]
 buffer_load_dwordx4 v[184:187], v24, s[16:19], s85 offen offset:3072 sc1
 v_mfma_f32_16x16x32_bf16 v[228:231], v[120:123], a[164:167], v[228:231]
 ds_read_b128 v[108:111], v13 offset:31744
 v_mfma_f32_16x16x32_bf16 v[228:231], v[124:127], a[172:175], v[228:231]
 v_mfma_f32_16x16x32_bf16 v[232:235], v[128:131], a[160:163], v[232:235]
 ds_read_b128 v[112:115], v13 offset:23552
 v_mfma_f32_16x16x32_bf16 v[232:235], v[132:135], a[168:171], v[232:235]
 buffer_load_dwordx4 v[188:191], v7, s[16:19], s85 offen offset:3072 sc1
 v_mfma_f32_16x16x32_bf16 v[236:239], v[128:131], a[164:167], v[236:239]
 ds_read_b128 v[116:119], v13 offset:32768
 s_waitcnt lgkmcnt(4)
 v_mfma_f32_16x16x32_bf16 v[236:239], v[132:135], a[172:175], v[236:239]
Lpg21:
 s_cbranch_vccnz Lj_Lfin
 v_mfma_f32_16x16x32_bf16 v[32:35], v[136:139], a[176:179], v[32:35]
 ds_read_b128 v[120:123], v13 offset:24576
 v_mfma_f32_16x16x32_bf16 v[32:35], v[140:143], a[184:187], v[32:35]
 buffer_store_dwordx4 v[20:23], v24, s[16:19], s77 offen offset:2048 sc1
 v_mfma_f32_16x16x32_bf16 v[36:39], v[136:139], a[180:183], v[36:39]
 ds_read_b128 v[124:127], v13 offset:33792
 v_mfma_f32_16x16x32_bf16 v[36:39], v[140:143], a[188:191], v[36:39]
 v_mfma_f32_16x16x32_bf16 v[40:43], v[144:147], a[176:179], v[40:43]
 ds_read_b128 v[128:131], v13 offset:25600
 v_mfma_f32_16x16x32_bf16 v[40:43], v[148:151], a[184:187], v[40:43]
 buffer_store_dwordx4 v[20:23], v24, s[16:19], s77 offen offset:3072 sc1
 v_mfma_f32_16x16x32_bf16 v[44:47], v[144:147], a[180:183], v[44:47]
 ds_read_b128 v[132:135], v13 offset:34816
 v_mfma_f32_16x16x32_bf16 v[44:47], v[148:151], a[188:191], v[44:47]
 v_mfma_f32_16x16x32_bf16 v[48:51], v[152:155], a[176:179], v[48:51]
 ds_read_b128 v[136:139], v13 offset:26624
 v_mfma_f32_16x16x32_bf16 v[48:51], v[156:159], a[184:187], v[48:51]
 buffer_store_dwordx4 v[20:23], v5, s[16:19], s77 offen sc1
 v_mfma_f32_16x16x32_bf16 v[52:55], v[152:155], a[180:183], v[52:55]
 ds_read_b128 v[140:143], v13 offset:35840
 s_mov_b32 s35, 0xffff0000
 v_mfma_f32_16x16x32_bf16 v[52:55], v[156:159], a[188:191], v[52:55]
 v_mfma_f32_16x16x32_bf16 v[56:59], v[96:99], a[176:179], v[56:59]
 s_mov_b64 s[12:13], s[4:5]
 v_mfma_f32_16x16x32_bf16 v[56:59], v[100:103], a[184:187], v[56:59]
 buffer_store_dwordx4 v[20:23], v5, s[16:19], s77 offen offset:1024 sc1
 v_mfma_f32_16x16x32_bf16 v[60:63], v[96:99], a[180:183], v[60:63]
 s_mov_b32 s14, 2359296
 v_mfma_f32_16x16x32_bf16 v[60:63], v[100:103], a[188:191], v[60:63]
 s_waitcnt lgkmcnt(2)
 v_mfma_f32_16x16x32_bf16 v[80:83], v[104:107], a[176:179], v[80:83]
 s_mov_b32 s15, 0x20000
 v_mfma_f32_16x16x32_bf16 v[80:83], v[108:111], a[184:187], v[80:83]
 buffer_store_dwordx4 v[20:23], v5, s[16:19], s77 offen offset:2048 sc1
 v_mfma_f32_16x16x32_bf16 v[84:87], v[104:107], a[180:183], v[84:87]
 v_mfma_f32_16x16x32_bf16 v[84:87], v[108:111], a[188:191], v[84:87]
 s_lshl_b32 s32, s24, 11
 v_mfma_f32_16x16x32_bf16 v[88:91], v[112:115], a[176:179], v[88:91]
 s_waitcnt vmcnt(22) lgkmcnt(0)
 s_barrier
 v_mfma_f32_16x16x32_bf16 v[88:91], v[116:119], a[184:187], v[88:91]
 ds_read_b128 v[144:147], v25 offset:0
 s_lshl_b32 s33, s24, 8
 v_mfma_f32_16x16x32_bf16 v[92:95], v[112:115], a[180:183], v[92:95]
 ds_read_b128 v[148:151], v25 offset:9216
 v_mfma_f32_16x16x32_bf16 v[92:95], v[116:119], a[188:191], v[92:95]
 ds_read_b128 v[152:155], v25 offset:1024
 s_add_u32 s33, s33, 8192
 v_mfma_f32_16x16x32_bf16 v[216:219], v[120:123], a[176:179], v[216:219]
 ds_read_b128 v[156:159], v25 offset:10240
 v_mfma_f32_16x16x32_bf16 v[216:219], v[124:127], a[184:187], v[216:219]
 ds_read_b128 v[96:99], v25 offset:2048
 s_lshl_b32 s36, s24, 3
 v_mfma_f32_16x16x32_bf16 v[220:223], v[120:123], a[180:183], v[220:223]
 ds_read_b128 v[100:103], v25 offset:11264
 v_mfma_f32_16x16x32_bf16 v[220:223], v[124:127], a[188:191], v[220:223]
 ds_read_b128 v[104:107], v25 offset:3072
 v_mfma_f32_16x16x32_bf16 v[224:227], v[128:131], a[176:179], v[224:227]
 ds_read_b128 v[108:111], v25 offset:12288
 s_lshl_b32 s37, s24, 6
 v_mfma_f32_16x16x32_bf16 v[224:227], v[132:135], a[184:187], v[224:227]
 ds_read_b128 v[112:115], v25 offset:4096
 v_mfma_f32_16x16x32_bf16 v[228:231], v[128:131], a[180:183], v[228:231]
 ds_read_b128 v[116:119], v25 offset:13312
 s_waitcnt lgkmcnt(8)
 v_mfma_f32_16x16x32_bf16 v[228:231], v[132:135], a[188:191], v[228:231]
 v_lshlrev_b32 v19, 4, v0
 v_mfma_f32_16x16x32_bf16 v[232:235], v[136:139], a[176:179], v[232:235]
 ds_read_b128 v[120:123], v25 offset:5120
 s_load_dwordx4 s[40:43], s[88:89], s61 offset:0
 v_mfma_f32_16x16x32_bf16 v[232:235], v[140:143], a[184:187], v[232:235]
 v_mov_b32 v29, 0
 v_mfma_f32_16x16x32_bf16 v[236:239], v[136:139], a[180:183], v[236:239]
 ds_read_b128 v[124:127], v25 offset:14336
 v_mov_b32 v30, 1
 v_mfma_f32_16x16x32_bf16 v[236:239], v[140:143], a[188:191], v[236:239]
 buffer_store_dwordx4 v[20:23], v5, s[16:19], s77 offen offset:3072 sc1
 v_mfma_f32_16x16x32_bf16 v[32:35], v[144:147], a[0:3], v[32:35]
 ds_read_b128 v[128:131], v25 offset:6144
 v_mfma_f32_16x16x32_bf16 v[32:35], v[148:151], a[8:11], v[32:35]
 v_min_u32 v31, 2, v0
 v_mfma_f32_16x16x32_bf16 v[36:39], v[144:147], a[4:7], v[36:39]
 ds_read_b128 v[132:135], v25 offset:15360
 s_waitcnt lgkmcnt(8)
 v_mfma_f32_16x16x32_bf16 v[36:39], v[148:151], a[12:15], v[36:39]
 v_add3_u32 v31, v31, 1, s49
 v_mfma_f32_16x16x32_bf16 v[40:43], v[152:155], a[0:3], v[40:43]
 ds_read_b128 v[136:139], v25 offset:7168
 v_mfma_f32_16x16x32_bf16 v[40:43], v[156:159], a[8:11], v[40:43]
 v_and_b32 v31, 3, v31
 v_mfma_f32_16x16x32_bf16 v[44:47], v[152:155], a[4:7], v[44:47]
 ds_read_b128 v[140:143], v25 offset:16384
 v_mfma_f32_16x16x32_bf16 v[44:47], v[156:159], a[12:15], v[44:47]
 v_lshlrev_b32 v31, 7, v31
 v_mfma_f32_16x16x32_bf16 v[48:51], v[96:99], a[0:3], v[48:51]
 ds_read_b128 v[144:147], v25 offset:8192
 v_mfma_f32_16x16x32_bf16 v[48:51], v[100:103], a[8:11], v[48:51]
 buffer_store_dwordx4 v[20:23], v6, s[16:19], s77 offen sc1
 v_mfma_f32_16x16x32_bf16 v[52:55], v[96:99], a[4:7], v[52:55]
 ds_read_b128 v[148:151], v25 offset:17408
 s_waitcnt lgkmcnt(8)
 v_mfma_f32_16x16x32_bf16 v[52:55], v[100:103], a[12:15], v[52:55]
 v_and_b32 v10, 15, v0
 v_mfma_f32_16x16x32_bf16 v[56:59], v[104:107], a[0:3], v[56:59]
 ds_read_b128 v[152:155], v25 offset:18432
 v_lshrrev_b32 v12, 4, v0
 v_mfma_f32_16x16x32_bf16 v[56:59], v[108:111], a[8:11], v[56:59]
 v_mfma_f32_16x16x32_bf16 v[60:63], v[104:107], a[4:7], v[60:63]
 ds_read_b128 v[156:159], v25 offset:27648
 v_mul_u32_u24 v11, 1152, v10
 v_mfma_f32_16x16x32_bf16 v[60:63], v[108:111], a[12:15], v[60:63]
 v_mfma_f32_16x16x32_bf16 v[80:83], v[112:115], a[0:3], v[80:83]
 ds_read_b128 v[96:99], v25 offset:19456
 v_lshl_add_u32 v11, v12, 3, v11
 v_mfma_f32_16x16x32_bf16 v[80:83], v[116:119], a[8:11], v[80:83]
 v_mfma_f32_16x16x32_bf16 v[84:87], v[112:115], a[4:7], v[84:87]
 ds_read_b128 v[100:103], v25 offset:28672
 s_waitcnt lgkmcnt(8)
 v_mfma_f32_16x16x32_bf16 v[84:87], v[116:119], a[12:15], v[84:87]
 v_add_u32 v11, s37, v11
 v_mfma_f32_16x16x32_bf16 v[88:91], v[120:123], a[0:3], v[88:91]
 ds_read_b128 v[104:107], v25 offset:20480
 v_mfma_f32_16x16x32_bf16 v[88:91], v[124:127], a[8:11], v[88:91]
 v_add_u32 v12, 18432, v11
 v_mfma_f32_16x16x32_bf16 v[92:95], v[120:123], a[4:7], v[92:95]
 ds_read_b128 v[108:111], v25 offset:29696
 v_mfma_f32_16x16x32_bf16 v[92:95], v[124:127], a[12:15], v[92:95]
 v_lshlrev_b32 v10, 2, v10
 v_mfma_f32_16x16x32_bf16 v[216:219], v[128:131], a[0:3], v[216:219]
 ds_read_b128 v[112:115], v25 offset:21504
 v_mfma_f32_16x16x32_bf16 v[216:219], v[132:135], a[8:11], v[216:219]
 v_and_b32 v16, 2, v0
 v_mfma_f32_16x16x32_bf16 v[220:223], v[128:131], a[4:7], v[220:223]
 ds_read_b128 v[116:119], v25 offset:30720
 s_waitcnt lgkmcnt(8)
 v_mfma_f32_16x16x32_bf16 v[220:223], v[132:135], a[12:15], v[220:223]
 v_mfma_f32_16x16x32_bf16 v[224:227], v[136:139], a[0:3], v[224:227]
 ds_read_b128 v[120:123], v25 offset:22528
 v_lshrrev_b32 v17, 2, v0
 v_mfma_f32_16x16x32_bf16 v[224:227], v[140:143], a[8:11], v[224:227]
 v_mfma_f32_16x16x32_bf16 v[228:231], v[136:139], a[4:7], v[228:231]
 ds_read_b128 v[124:127], v25 offset:31744
 v_lshl_add_u32 v17, v16, 3, v17
 v_mfma_f32_16x16x32_bf16 v[228:231], v[140:143], a[12:15], v[228:231]
 v_mfma_f32_16x16x32_bf16 v[232:235], v[144:147], a[0:3], v[232:235]
 ds_read_b128 v[128:131], v25 offset:23552
 v_and_b32 v15, 1, v0
 v_mfma_f32_16x16x32_bf16 v[232:235], v[148:151], a[8:11], v[232:235]
 v_mfma_f32_16x16x32_bf16 v[236:239], v[144:147], a[4:7], v[236:239]
 ds_read_b128 v[132:135], v25 offset:32768
 s_waitcnt lgkmcnt(8)
 v_mfma_f32_16x16x32_bf16 v[236:239], v[148:151], a[12:15], v[236:239]
 v_lshl_add_u32 v15, v15, 2, s36
 v_mfma_f32_16x16x32_bf16 v[32:35], v[152:155], a[16:19], v[32:35]
 ds_read_b128 v[136:139], v25 offset:24576
 v_mfma_f32_16x16x32_bf16 v[32:35], v[156:159], a[24:27], v[32:35]
 v_mul_u32_u24 v16, 1152, v17
 v_mfma_f32_16x16x32_bf16 v[36:39], v[152:155], a[20:23], v[36:39]
 ds_read_b128 v[140:143], v25 offset:33792
 v_mfma_f32_16x16x32_bf16 v[36:39], v[156:159], a[28:31], v[36:39]
 v_add_u32 v16, v16, v15
 v_mfma_f32_16x16x32_bf16 v[40:43], v[96:99], a[16:19], v[40:43]
 ds_read_b128 v[144:147], v25 offset:25600
 v_mfma_f32_16x16x32_bf16 v[40:43], v[100:103], a[24:27], v[40:43]
 v_lshlrev_b32 v17, 2, v17
 v_mfma_f32_16x16x32_bf16 v[44:47], v[96:99], a[20:23], v[44:47]
 ds_read_b128 v[148:151], v25 offset:34816
 s_waitcnt lgkmcnt(8)
 v_mfma_f32_16x16x32_bf16 v[44:47], v[100:103], a[28:31], v[44:47]
 v_add_u32 v14, s32, v19
 v_mfma_f32_16x16x32_bf16 v[48:51], v[104:107], a[16:19], v[48:51]
 ds_read_b128 v[152:155], v25 offset:26624
 v_mfma_f32_16x16x32_bf16 v[48:51], v[108:111], a[24:27], v[48:51]
 v_mfma_f32_16x16x32_bf16 v[52:55], v[104:107], a[20:23], v[52:55]
 ds_read_b128 v[156:159], v25 offset:35840
 v_lshl_add_u32 v15, v0, 2, s33
 v_mfma_f32_16x16x32_bf16 v[52:55], v[108:111], a[28:31], v[52:55]
 v_mfma_f32_16x16x32_bf16 v[56:59], v[112:115], a[16:19], v[56:59]
 v_mfma_f32_16x16x32_bf16 v[56:59], v[116:119], a[24:27], v[56:59]
 v_mfma_f32_16x16x32_bf16 v[60:63], v[112:115], a[20:23], v[60:63]
 v_mfma_f32_16x16x32_bf16 v[60:63], v[116:119], a[28:31], v[60:63]
 s_waitcnt lgkmcnt(6)
 v_mfma_f32_16x16x32_bf16 v[80:83], v[120:123], a[16:19], v[80:83]
 v_mfma_f32_16x16x32_bf16 v[80:83], v[124:127], a[24:27], v[80:83]
 v_mfma_f32_16x16x32_bf16 v[84:87], v[120:123], a[20:23], v[84:87]
 v_mfma_f32_16x16x32_bf16 v[84:87], v[124:127], a[28:31], v[84:87]
 v_mfma_f32_16x16x32_bf16 v[88:91], v[128:131], a[16:19], v[88:91]
 s_waitcnt vmcnt(7) lgkmcnt(0)
 s_waitcnt vmcnt(0)
 s_barrier
 v_mfma_f32_16x16x32_bf16 v[88:91], v[132:135], a[24:27], v[88:91]
 ds_read_b128 v[96:99], v8 offset:0
 s_mul_i32 s42, s42, 16843009
 v_mfma_f32_16x16x32_bf16 v[92:95], v[128:131], a[20:23], v[92:95]
 ds_read_b128 v[100:103], v8 offset:9216
 v_mfma_f32_16x16x32_bf16 v[92:95], v[132:135], a[28:31], v[92:95]
 ds_read_b128 v[104:107], v8 offset:18432
 s_and_b32 s40, s40, s41
 v_mfma_f32_16x16x32_bf16 v[216:219], v[136:139], a[16:19], v[216:219]
 ds_read_b128 v[108:111], v8 offset:27648
 s_and_b32 s40, s40, s42
 v_mfma_f32_16x16x32_bf16 v[216:219], v[140:143], a[24:27], v[216:219]
 ds_read_b128 v[112:115], v8 offset:1024
 s_and_b32 s40, s40, s43
 v_mfma_f32_16x16x32_bf16 v[220:223], v[136:139], a[20:23], v[220:223]
 ds_read_b128 v[116:119], v8 offset:10240
 v_mfma_f32_16x16x32_bf16 v[220:223], v[140:143], a[28:31], v[220:223]
 ds_read_b128 v[120:123], v8 offset:19456
 v_mfma_f32_16x16x32_bf16 v[224:227], v[144:147], a[16:19], v[224:227]
 ds_read_b128 v[124:127], v8 offset:28672
 v_mfma_f32_16x16x32_bf16 v[224:227], v[148:151], a[24:27], v[224:227]
 ds_read_b128 v[128:131], v8 offset:2048
 v_mfma_f32_16x16x32_bf16 v[228:231], v[144:147], a[20:23], v[228:231]
 ds_read_b128 v[132:135], v8 offset:11264
 s_waitcnt lgkmcnt(8)
 v_mfma_f32_16x16x32_bf16 v[228:231], v[148:151], a[28:31], v[228:231]
 s_cmp_eq_u32 s40, 16843009
 s_cbranch_scc0 Lsp_ha
Lrt_ha:
 v_mfma_f32_16x16x32_bf16 v[232:235], v[152:155], a[16:19], v[232:235]
 ds_read_b128 v[136:139], v8 offset:20480
 v_mfma_f32_16x16x32_bf16 v[232:235], v[156:159], a[24:27], v[232:235]
 buffer_load_dwordx4 v[200:203], v14, s[16:19], s72 offen sc1
 v_mfma_f32_16x16x32_bf16 v[236:239], v[152:155], a[20:23], v[236:239]
 ds_read_b128 v[140:143], v8 offset:29696
 v_mfma_f32_16x16x32_bf16 v[236:239], v[156:159], a[28:31], v[236:239]
 buffer_load_dwordx4 v[204:207], v14, s[16:19], s72 offen offset:1024 sc1
 v_mfma_f32_16x16x32_bf16 v[32:35], v[96:99], v[160:163], v[32:35]
 ds_read_b128 v[144:147], v8 offset:3072
 v_mfma_f32_16x16x32_bf16 v[32:35], v[100:103], v[168:171], v[32:35]
 buffer_load_dword v208, v15, s[16:19], s72 offen sc1
 v_mfma_f32_16x16x32_bf16 v[36:39], v[96:99], v[164:167], v[36:39]
 ds_read_b128 v[148:151], v8 offset:12288
 s_waitcnt lgkmcnt(4)
 v_mfma_f32_16x16x32_bf16 v[36:39], v[100:103], v[172:175], v[36:39]
 buffer_load_dword v212, v10, s[16:19], s73 offen sc1
 v_mfma_f32_16x16x32_bf16 v[32:35], v[104:107], v[176:179], v[32:35]
 ds_read_b128 v[152:155], v8 offset:21504
 v_mfma_f32_16x16x32_bf16 v[32:35], v[108:111], v[184:187], v[32:35]
 buffer_load_dword v213, v10, s[16:19], s73 offen offset:64 sc1
 v_mfma_f32_16x16x32_bf16 v[36:39], v[104:107], v[180:183], v[36:39]
 ds_read_b128 v[156:159], v8 offset:30720
 v_mfma_f32_16x16x32_bf16 v[36:39], v[108:111], v[188:191], v[36:39]
 buffer_load_dword v214, v17, s[16:19], s73 offen sc1
 v_mfma_f32_16x16x32_bf16 v[40:43], v[112:115], v[160:163], v[40:43]
 ds_read_b128 v[96:99], v8 offset:4096
 v_mfma_f32_16x16x32_bf16 v[40:43], v[116:119], v[168:171], v[40:43]
 v_mfma_f32_16x16x32_bf16 v[44:47], v[112:115], v[164:167], v[44:47]
 ds_read_b128 v[100:103], v8 offset:13312
 v_mfma_f32_16x16x32_bf16 v[44:47], v[116:119], v[172:175], v[44:47]
 v_mfma_f32_16x16x32_bf16 v[40:43], v[120:123], v[176:179], v[40:43]
 ds_read_b128 v[104:107], v8 offset:22528
 v_mfma_f32_16x16x32_bf16 v[40:43], v[124:127], v[184:187], v[40:43]
 v_cvt_pk_bf16_f32 v32, v32, v33
 v_mfma_f32_16x16x32_bf16 v[44:47], v[120:123], v[180:183], v[44:47]
 ds_read_b128 v[108:111], v8 offset:31744
 v_cvt_pk_bf16_f32 v33, v34, v35
 v_mfma_f32_16x16x32_bf16 v[44:47], v[124:127], v[188:191], v[44:47]
 v_cvt_pk_bf16_f32 v34, v36, v37
 v_cvt_pk_bf16_f32 v35, v38, v39
 v_mfma_f32_16x16x32_bf16 v[48:51], v[128:131], v[160:163], v[48:51]
 ds_read_b128 v[112:115], v8 offset:5120
 v_mfma_f32_16x16x32_bf16 v[48:51], v[132:135], v[168:171], v[48:51]
 buffer_store_dwordx4 v[32:35], v19, s[16:19], s77 offen sc1
 v_mfma_f32_16x16x32_bf16 v[52:55], v[128:131], v[164:167], v[52:55]
 ds_read_b128 v[116:119], v8 offset:14336
 s_waitcnt lgkmcnt(4)
 v_mfma_f32_16x16x32_bf16 v[52:55], v[132:135], v[172:175], v[52:55]
 v_mfma_f32_16x16x32_bf16 v[48:51], v[136:139], v[176:179], v[48:51]
 ds_read_b128 v[120:123], v8 offset:23552
 v_mfma_f32_16x16x32_bf16 v[48:51], v[140:143], v[184:187], v[48:51]
 v_cvt_pk_bf16_f32 v40, v40, v41
 v_mfma_f32_16x16x32_bf16 v[52:55], v[136:139], v[180:183], v[52:55]
 ds_read_b128 v[124:127], v8 offset:32768
 v_cvt_pk_bf16_f32 v41, v42, v43
 v_mfma_f32_16x16x32_bf16 v[52:55], v[140:143], v[188:191], v[52:55]
 v_cvt_pk_bf16_f32 v42, v44, v45
 v_cvt_pk_bf16_f32 v43, v46, v47
 v_mfma_f32_16x16x32_bf16 v[56:59], v[144:147], v[160:163], v[56:59]
 ds_read_b128 v[128:131], v8 offset:6144
 v_mfma_f32_16x16x32_bf16 v[56:59], v[148:151], v[168:171], v[56:59]
 buffer_store_dwordx4 v[40:43], v19, s[16:19], s77 offen offset:1024 sc1
 v_mfma_f32_16x16x32_bf16 v[60:63], v[144:147], v[164:167], v[60:63]
 ds_read_b128 v[132:135], v8 offset:15360
 v_mfma_f32_16x16x32_bf16 v[60:63], v[148:151], v[172:175], v[60:63]
 v_mfma_f32_16x16x32_bf16 v[56:59], v[152:155], v[176:179], v[56:59]
 ds_read_b128 v[136:139], v8 offset:24576
 v_mfma_f32_16x16x32_bf16 v[56:59], v[156:159], v[184:187], v[56:59]
 v_cvt_pk_bf16_f32 v48, v48, v49
 v_mfma_f32_16x16x32_bf16 v[60:63], v[152:155], v[180:183], v[60:63]
 ds_read_b128 v[140:143], v8 offset:33792
 v_cvt_pk_bf16_f32 v49, v50, v51
 v_mfma_f32_16x16x32_bf16 v[60:63], v[156:159], v[188:191], v[60:63]
 v_cvt_pk_bf16_f32 v50, v52, v53
 v_cvt_pk_bf16_f32 v51, v54, v55
 v_mfma_f32_16x16x32_bf16 v[80:83], v[96:99], v[160:163], v[80:83]
 ds_read_b128 v[144:147], v8 offset:7168
 v_mfma_f32_16x16x32_bf16 v[80:83], v[100:103], v[168:171], v[80:83]
 buffer_store_dwordx4 v[48:51], v19, s[16:19], s77 offen offset:2048 sc1
 v_mfma_f32_16x16x32_bf16 v[84:87], v[96:99], v[164:167], v[84:87]
 ds_read_b128 v[148:151], v8 offset:16384
 s_waitcnt lgkmcnt(4)
 v_mfma_f32_16x16x32_bf16 v[84:87], v[100:103], v[172:175], v[84:87]
 v_mfma_f32_16x16x32_bf16 v[80:83], v[104:107], v[176:179], v[80:83]
 ds_read_b128 v[152:155], v8 offset:25600
 v_mfma_f32_16x16x32_bf16 v[80:83], v[108:111], v[184:187], v[80:83]
 v_cvt_pk_bf16_f32 v56, v56, v57
 v_mfma_f32_16x16x32_bf16 v[84:87], v[104:107], v[180:183], v[84:87]
 ds_read_b128 v[156:159], v8 offset:34816
 v_cvt_pk_bf16_f32 v57, v58, v59
 v_mfma_f32_16x16x32_bf16 v[84:87], v[108:111], v[188:191], v[84:87]
 v_cvt_pk_bf16_f32 v58, v60, v61
 v_cvt_pk_bf16_f32 v59, v62, v63
 v_mfma_f32_16x16x32_bf16 v[88:91], v[112:115], v[160:163], v[88:91]
 ds_read_b128 v[96:99], v8 offset:8192
 v_mfma_f32_16x16x32_bf16 v[88:91], v[116:119], v[168:171], v[88:91]
 buffer_store_dwordx4 v[56:59], v19, s[16:19], s77 offen offset:3072 sc1
 v_mfma_f32_16x16x32_bf16 v[92:95], v[112:115], v[164:167], v[92:95]
 ds_read_b128 v[100:103], v8 offset:17408
 v_mfma_f32_16x16x32_bf16 v[92:95], v[116:119], v[172:175], v[92:95]
 v_mfma_f32_16x16x32_bf16 v[88:91], v[120:123], v[176:179], v[88:91]
 ds_read_b128 v[104:107], v8 offset:26624
 v_mfma_f32_16x16x32_bf16 v[88:91], v[124:127], v[184:187], v[88:91]
 v_cvt_pk_bf16_f32 v80, v80, v81
 v_mfma_f32_16x16x32_bf16 v[92:95], v[120:123], v[180:183], v[92:95]
 ds_read_b128 v[108:111], v8 offset:35840
 v_cvt_pk_bf16_f32 v81, v82, v83
 v_mfma_f32_16x16x32_bf16 v[92:95], v[124:127], v[188:191], v[92:95]
 v_cvt_pk_bf16_f32 v82, v84, v85
 v_cvt_pk_bf16_f32 v83, v86, v87
 v_mfma_f32_16x16x32_bf16 v[216:219], v[128:131], v[160:163], v[216:219]
 buffer_store_dwordx4 v[80:83], v5, s[16:19], s77 offen sc1
 v_mfma_f32_16x16x32_bf16 v[216:219], v[132:135], v[168:171], v[216:219]
 s_waitcnt vmcnt(3)
 v_mfma_f32_16x16x32_bf16 v[220:223], v[128:131], v[164:167], v[220:223]
 buffer_store_dword v30, v29, s[16:19], s74 offen sc1
 v_mfma_f32_16x16x32_bf16 v[220:223], v[132:135], v[172:175], v[220:223]
 s_waitcnt lgkmcnt(2)
 v_mfma_f32_16x16x32_bf16 v[216:219], v[136:139], v[176:179], v[216:219]
 v_mfma_f32_16x16x32_bf16 v[216:219], v[140:143], v[184:187], v[216:219]
 v_cvt_pk_bf16_f32 v88, v88, v89
 v_mfma_f32_16x16x32_bf16 v[220:223], v[136:139], v[180:183], v[220:223]
 v_cvt_pk_bf16_f32 v89, v90, v91
 v_mfma_f32_16x16x32_bf16 v[220:223], v[140:143], v[188:191], v[220:223]
 v_cvt_pk_bf16_f32 v90, v92, v93
 v_cvt_pk_bf16_f32 v91, v94, v95
 v_mfma_f32_16x16x32_bf16 v[224:227], v[144:147], v[160:163], v[224:227]
 buffer_store_dwordx4 v[88:91], v5, s[16:19], s77 offen offset:1024 sc1
 v_mfma_f32_16x16x32_bf16 v[224:227], v[148:151], v[168:171], v[224:227]
 buffer_load_dword v20, v31, s[16:19], s75 offen sc1
 v_mfma_f32_16x16x32_bf16 v[228:231], v[144:147], v[164:167], v[228:231]
 v_mfma_f32_16x16x32_bf16 v[228:231], v[148:151], v[172:175], v[228:231]
 v_mfma_f32_16x16x32_bf16 v[224:227], v[152:155], v[176:179], v[224:227]
 v_mfma_f32_16x16x32_bf16 v[224:227], v[156:159], v[184:187], v[224:227]
 v_cvt_pk_bf16_f32 v216, v216, v217
 v_mfma_f32_16x16x32_bf16 v[228:231], v[152:155], v[180:183], v[228:231]
 v_cvt_pk_bf16_f32 v217, v218, v219
 v_mfma_f32_16x16x32_bf16 v[228:231], v[156:159], v[188:191], v[228:231]
 v_cvt_pk_bf16_f32 v218, v220, v221
 v_cvt_pk_bf16_f32 v219, v222, v223
 v_mfma_f32_16x16x32_bf16 v[232:235], v[96:99], v[160:163], v[232:235]
 buffer_store_dwordx4 v[216:219], v5, s[16:19], s77 offen offset:2048 sc1
 v_mfma_f32_16x16x32_bf16 v[232:235], v[100:103], v[168:171], v[232:235]
 v_mfma_f32_16x16x32_bf16 v[236:239], v[96:99], v[164:167], v[236:239]
 v_mfma_f32_16x16x32_bf16 v[236:239], v[100:103], v[172:175], v[236:239]
 s_waitcnt lgkmcnt(0)
 v_mfma_f32_16x16x32_bf16 v[232:235], v[104:107], v[176:179], v[232:235]
 v_mfma_f32_16x16x32_bf16 v[232:235], v[108:111], v[184:187], v[232:235]
 v_cvt_pk_bf16_f32 v224, v224, v225
 v_mfma_f32_16x16x32_bf16 v[236:239], v[104:107], v[180:183], v[236:239]
 v_cvt_pk_bf16_f32 v225, v226, v227
 v_mfma_f32_16x16x32_bf16 v[236:239], v[108:111], v[188:191], v[236:239]
 v_cvt_pk_bf16_f32 v226, v228, v229
 v_cvt_pk_bf16_f32 v227, v230, v231
 buffer_store_dwordx4 v[224:227], v5, s[16:19], s77 offen offset:3072 sc1
 s_nop 0
 v_cvt_pk_bf16_f32 v232, v232, v233
 v_cvt_pk_bf16_f32 v233, v234, v235
 s_nop 1
 v_cvt_pk_bf16_f32 v234, v236, v237
 v_cvt_pk_bf16_f32 v235, v238, v239
 buffer_store_dwordx4 v[232:235], v6, s[16:19], s77 offen sc1
 s_waitcnt vmcnt(3)
 v_cmp_eq_u32 vcc, 0, v20
 s_nop 1
 s_and_b32 s43, vcc_lo, -1
 s_cbranch_scc1 Lnl_h
 buffer_load_dwordx4 v[96:99], v14, s[16:19], s78 offen sc1
 buffer_load_dwordx4 v[100:103], v14, s[16:19], s79 offen sc1
 buffer_load_dwordx4 v[104:107], v14, s[16:19], s0 offen sc1
 buffer_load_dwordx4 v[108:111], v14, s[16:19], s78 offen offset:1024 sc1
 buffer_load_dwordx4 v[112:115], v14, s[16:19], s79 offen offset:1024 sc1
 buffer_load_dwordx4 v[116:119], v14, s[16:19], s0 offen offset:1024 sc1
 buffer_load_dword v120, v15, s[16:19], s78 offen sc1
 buffer_load_dword v121, v15, s[16:19], s79 offen sc1
 buffer_load_dword v122, v15, s[16:19], s0 offen sc1
Lnl_h:
 s_cmp_lg_u32 s24, s49
 s_cbranch_scc1 Lfin
 ds_write_b128 v19, v[32:35] offset:0
 ds_write_b128 v19, v[40:43] offset:1024
 ds_write_b128 v19, v[48:51] offset:2048
 ds_write_b128 v19, v[56:59] offset:3072
 ds_write_b128 v19, v[80:83] offset:4096
 ds_write_b128 v19, v[88:91] offset:5120
 ds_write_b128 v19, v[216:219] offset:6144
 ds_write_b128 v19, v[224:227] offset:7168
 ds_write_b128 v19, v[232:235] offset:8192
 s_branch Lfin
.p2align 12
Lj_Lfin:
 s_setpc_b64 s[22:23]
Lfin:
 v_sub_f32 v152, 1.0, v212
 v_mov_b32 v160, v212
 v_sub_f32 v154, 1.0, v213
 v_mov_b32 v162, v213
 v_sub_f32 v156, 1.0, v214
 v_mov_b32 v164, v214
 v_lshlrev_b32 v134, 16, v200
 v_and_b32 v135, s35, v200
 v_lshlrev_b32 v136, 16, v201
 v_and_b32 v137, s35, v201
 v_lshlrev_b32 v138, 16, v202
 v_and_b32 v139, s35, v202
 v_lshlrev_b32 v140, 16, v203
 v_and_b32 v141, s35, v203
 v_lshlrev_b32 v142, 16, v204
 v_and_b32 v143, s35, v204
 v_lshlrev_b32 v144, 16, v205
 v_and_b32 v145, s35, v205
 v_lshlrev_b32 v146, 16, v206
 v_and_b32 v147, s35, v206
 v_lshlrev_b32 v148, 16, v207
 v_and_b32 v149, s35, v207
 v_lshlrev_b32 v150, 16, v208
 v_and_b32 v151, s35, v208
 s_waitcnt lgkmcnt(0)
 s_barrier
 ds_read_b128 v[124:127], v14
 ds_read_b128 v[128:131], v14 offset:1024
 ds_read_b32 v132, v15
 s_mov_b32 s40, 0x40000
 s_mov_b32 s44, 0x2000
 v_pk_mul_f32 v[134:135], v[134:135], v[160:161] op_sel_hi:[1,0]
 v_pk_mul_f32 v[136:137], v[136:137], v[160:161] op_sel_hi:[1,0]
 v_pk_mul_f32 v[138:139], v[138:139], v[162:163] op_sel_hi:[1,0]
 v_pk_mul_f32 v[140:141], v[140:141], v[162:163] op_sel_hi:[1,0]
 v_pk_mul_f32 v[142:143], v[142:143], v[160:161] op_sel_hi:[1,0]
 v_pk_mul_f32 v[144:145], v[144:145], v[160:161] op_sel_hi:[1,0]
 v_pk_mul_f32 v[146:147], v[146:147], v[162:163] op_sel_hi:[1,0]
 v_pk_mul_f32 v[148:149], v[148:149], v[162:163] op_sel_hi:[1,0]
 v_pk_mul_f32 v[150:151], v[150:151], v[164:165] op_sel_hi:[1,0]
 s_waitcnt lgkmcnt(2)
 v_lshlrev_b32 v168, 16, v124
 v_and_b32 v169, s35, v124
 v_lshlrev_b32 v170, 16, v125
 v_and_b32 v171, s35, v125
 v_lshlrev_b32 v172, 16, v126
 v_and_b32 v173, s35, v126
 v_lshlrev_b32 v174, 16, v127
 v_and_b32 v175, s35, v127
 s_waitcnt lgkmcnt(1)
 v_lshlrev_b32 v176, 16, v128
 v_and_b32 v177, s35, v128
 v_lshlrev_b32 v178, 16, v129
 v_and_b32 v179, s35, v129
 v_lshlrev_b32 v180, 16, v130
 v_and_b32 v181, s35, v130
 v_lshlrev_b32 v182, 16, v131
 v_and_b32 v183, s35, v131
 s_waitcnt lgkmcnt(0)
 v_lshlrev_b32 v184, 16, v132
 v_and_b32 v185, s35, v132
 v_pk_fma_f32 v[134:135], v[168:169], v[152:153], v[134:135] op_sel_hi:[1,0,1]
 v_pk_fma_f32 v[136:137], v[170:171], v[152:153], v[136:137] op_sel_hi:[1,0,1]
 v_pk_fma_f32 v[138:139], v[172:173], v[154:155], v[138:139] op_sel_hi:[1,0,1]
 v_pk_fma_f32 v[140:141], v[174:175], v[154:155], v[140:141] op_sel_hi:[1,0,1]
 v_pk_fma_f32 v[142:143], v[176:177], v[152:153], v[142:143] op_sel_hi:[1,0,1]
 v_pk_fma_f32 v[144:145], v[178:179], v[152:153], v[144:145] op_sel_hi:[1,0,1]
 v_pk_fma_f32 v[146:147], v[180:181], v[154:155], v[146:147] op_sel_hi:[1,0,1]
 v_pk_fma_f32 v[148:149], v[182:183], v[154:155], v[148:149] op_sel_hi:[1,0,1]
 v_pk_fma_f32 v[150:151], v[184:185], v[156:157], v[150:151] op_sel_hi:[1,0,1]
 s_cmp_eq_u32 s43, 0
 s_cbranch_scc1 L2_chk
L2_poll:
 buffer_load_dword v20, v31, s[16:19], s75 offen sc1
 s_sub_u32 s40, s40, 1
 s_cselect_b32 s42, 0, -1
 s_waitcnt vmcnt(0)
 v_cmp_eq_u32 vcc, 0, v20
 s_nop 1
 s_and_b32 s41, s42, vcc_lo
 s_cbranch_scc1 L2_poll
L2_ld:
 buffer_load_dwordx4 v[96:99], v14, s[16:19], s78 offen sc1
 buffer_load_dwordx4 v[100:103], v14, s[16:19], s79 offen sc1
 buffer_load_dwordx4 v[104:107], v14, s[16:19], s0 offen sc1
 buffer_load_dwordx4 v[108:111], v14, s[16:19], s78 offen offset:1024 sc1
 buffer_load_dwordx4 v[112:115], v14, s[16:19], s79 offen offset:1024 sc1
 buffer_load_dwordx4 v[116:119], v14, s[16:19], s0 offen offset:1024 sc1
 buffer_load_dword v120, v15, s[16:19], s78 offen sc1
 buffer_load_dword v121, v15, s[16:19], s79 offen sc1
 buffer_load_dword v122, v15, s[16:19], s0 offen sc1
L2_chk:
 s_sub_u32 s44, s44, 1
 s_cselect_b64 s[42:43], 0, -1
 s_waitcnt vmcnt(6)
 v_max3_u32 v22, v96, v97, v98
 v_max3_u32 v23, v99, v100, v101
 v_max3_u32 v24, v102, v103, v104
 v_max3_u32 v25, v105, v106, v107
 s_waitcnt vmcnt(3)
 v_max3_u32 v26, v108, v109, v110
 v_max3_u32 v27, v111, v112, v113
 v_max3_u32 v28, v114, v115, v116
 v_max3_u32 v29, v117, v118, v119
 v_max3_u32 v22, v22, v23, v24
 v_max3_u32 v25, v25, v26, v27
 s_waitcnt vmcnt(0)
 v_max3_u32 v21, v120, v121, v122
 v_max3_u32 v22, v22, v25, v28
 v_max3_u32 v21, v21, v22, v29
 v_cmp_eq_u32 vcc, -1, v21
 s_nop 1
 s_and_b64 s[40:41], s[42:43], vcc
 s_cbranch_scc1 L2_ld
 v_lshlrev_b32 v32, 16, v96
 v_and_b32 v33, s35, v96
 v_lshlrev_b32 v34, 16, v97
 v_and_b32 v35, s35, v97
 v_lshlrev_b32 v36, 16, v98
 v_and_b32 v37, s35, v98
 v_lshlrev_b32 v38, 16, v99
 v_and_b32 v39, s35, v99
 v_pk_fma_f32 v[134:135], v[32:33], v[152:153], v[134:135] op_sel_hi:[1,0,1]
 v_pk_fma_f32 v[136:137], v[34:35], v[152:153], v[136:137] op_sel_hi:[1,0,1]
 v_pk_fma_f32 v[138:139], v[36:37], v[154:155], v[138:139] op_sel_hi:[1,0,1]
 v_pk_fma_f32 v[140:141], v[38:39], v[154:155], v[140:141] op_sel_hi:[1,0,1]
 v_lshlrev_b32 v32, 16, v100
 v_and_b32 v33, s35, v100
 v_lshlrev_b32 v34, 16, v101
 v_and_b32 v35, s35, v101
 v_lshlrev_b32 v36, 16, v102
 v_and_b32 v37, s35, v102
 v_lshlrev_b32 v38, 16, v103
 v_and_b32 v39, s35, v103
 v_pk_fma_f32 v[134:135], v[32:33], v[152:153], v[134:135] op_sel_hi:[1,0,1]
 v_pk_fma_f32 v[136:137], v[34:35], v[152:153], v[136:137] op_sel_hi:[1,0,1]
 v_pk_fma_f32 v[138:139], v[36:37], v[154:155], v[138:139] op_sel_hi:[1,0,1]
 v_pk_fma_f32 v[140:141], v[38:39], v[154:155], v[140:141] op_sel_hi:[1,0,1]
 v_lshlrev_b32 v32, 16, v104
 v_and_b32 v33, s35, v104
 v_lshlrev_b32 v34, 16, v105
 v_and_b32 v35, s35, v105
 v_lshlrev_b32 v36, 16, v106
 v_and_b32 v37, s35, v106
 v_lshlrev_b32 v38, 16, v107
 v_and_b32 v39, s35, v107
 v_pk_fma_f32 v[134:135], v[32:33], v[152:153], v[134:135] op_sel_hi:[1,0,1]
 v_pk_fma_f32 v[136:137], v[34:35], v[152:153], v[136:137] op_sel_hi:[1,0,1]
 v_pk_fma_f32 v[138:139], v[36:37], v[154:155], v[138:139] op_sel_hi:[1,0,1]
 v_pk_fma_f32 v[140:141], v[38:39], v[154:155], v[140:141] op_sel_hi:[1,0,1]
 v_cvt_pk_bf16_f32 v40, v134, v135
 v_cvt_pk_bf16_f32 v41, v136, v137
 v_cvt_pk_bf16_f32 v42, v138, v139
 v_cvt_pk_bf16_f32 v43, v140, v141
 buffer_store_dwordx2 v[40:41], v11, s[12:15], s76 offen offset:0
 buffer_store_dwordx2 v[42:43], v12, s[12:15], s76 offen offset:0
 v_lshlrev_b32 v32, 16, v108
 v_and_b32 v33, s35, v108
 v_lshlrev_b32 v34, 16, v109
 v_and_b32 v35, s35, v109
 v_lshlrev_b32 v36, 16, v110
 v_and_b32 v37, s35, v110
 v_lshlrev_b32 v38, 16, v111
 v_and_b32 v39, s35, v111
 v_pk_fma_f32 v[142:143], v[32:33], v[152:153], v[142:143] op_sel_hi:[1,0,1]
 v_pk_fma_f32 v[144:145], v[34:35], v[152:153], v[144:145] op_sel_hi:[1,0,1]
 v_pk_fma_f32 v[146:147], v[36:37], v[154:155], v[146:147] op_sel_hi:[1,0,1]
 v_pk_fma_f32 v[148:149], v[38:39], v[154:155], v[148:149] op_sel_hi:[1,0,1]
 v_lshlrev_b32 v32, 16, v112
 v_and_b32 v33, s35, v112
 v_lshlrev_b32 v34, 16, v113
 v_and_b32 v35, s35, v113
 v_lshlrev_b32 v36, 16, v114
 v_and_b32 v37, s35, v114
 v_lshlrev_b32 v38, 16, v115
 v_and_b32 v39, s35, v115
 v_pk_fma_f32 v[142:143], v[32:33], v[152:153], v[142:143] op_sel_hi:[1,0,1]
 v_pk_fma_f32 v[144:145], v[34:35], v[152:153], v[144:145] op_sel_hi:[1,0,1]
 v_pk_fma_f32 v[146:147], v[36:37], v[154:155], v[146:147] op_sel_hi:[1,0,1]
 v_pk_fma_f32 v[148:149], v[38:39], v[154:155], v[148:149] op_sel_hi:[1,0,1]
 v_lshlrev_b32 v32, 16, v116
 v_and_b32 v33, s35, v116
 v_lshlrev_b32 v34, 16, v117
 v_and_b32 v35, s35, v117
 v_lshlrev_b32 v36, 16, v118
 v_and_b32 v37, s35, v118
 v_lshlrev_b32 v38, 16, v119
 v_and_b32 v39, s35, v119
 v_pk_fma_f32 v[142:143], v[32:33], v[152:153], v[142:143] op_sel_hi:[1,0,1]
 v_pk_fma_f32 v[144:145], v[34:35], v[152:153], v[144:145] op_sel_hi:[1,0,1]
 v_pk_fma_f32 v[146:147], v[36:37], v[154:155], v[146:147] op_sel_hi:[1,0,1]
 v_pk_fma_f32 v[148:149], v[38:39], v[154:155], v[148:149] op_sel_hi:[1,0,1]
 v_cvt_pk_bf16_f32 v44, v142, v143
 v_cvt_pk_bf16_f32 v45, v144, v145
 v_cvt_pk_bf16_f32 v46, v146, v147
 v_cvt_pk_bf16_f32 v47, v148, v149
 buffer_store_dwordx2 v[44:45], v11, s[12:15], s76 offen offset:32
 buffer_store_dwordx2 v[46:47], v12, s[12:15], s76 offen offset:32
 v_lshlrev_b32 v32, 16, v120
 v_and_b32 v33, s35, v120
 v_pk_fma_f32 v[150:151], v[32:33], v[156:157], v[150:151] op_sel_hi:[1,0,1]
 v_lshlrev_b32 v32, 16, v121
 v_and_b32 v33, s35, v121
 v_pk_fma_f32 v[150:151], v[32:33], v[156:157], v[150:151] op_sel_hi:[1,0,1]
 v_lshlrev_b32 v32, 16, v122
 v_and_b32 v33, s35, v122
 v_pk_fma_f32 v[150:151], v[32:33], v[156:157], v[150:151] op_sel_hi:[1,0,1]
 v_cvt_pk_bf16_f32 v48, v150, v151
 buffer_store_dword v48, v16, s[12:15], s76 offen offset:256
 s_endpgm
L1_gate:
 s_sub_u32 s14, s14, 36
 v_lshrrev_b32 v1, 3, v0
 v_and_b32 v2, 7, v0
 v_lshlrev_b32 v3, 4, v2
 v_mul_u32_u24 v4, 1152, v1
 v_add_u32 v4, v4, v3
 v_lshlrev_b32 v5, 2, v1
 s_lshl_b32 s14, s14, 2
 s_add_u32 s14, s14, s24
 s_mul_i32 s25, s14, 147456
 s_lshl_b32 s26, s14, 9
 s_add_u32 s26, s26, 40894464
 s_mov_b32 s54, 0xbfb8aa3b
 s_waitcnt lgkmcnt(0)
 s_mov_b32 s8, s64
 s_mov_b32 s9, s65
 s_mov_b32 s10, 2359296
 s_mov_b32 s11, 0x20000
 s_mov_b32 s12, s86
 s_mov_b32 s13, s87
 s_mov_b32 s14, 1152
 s_mov_b32 s15, 0x20000
 s_mov_b32 s16, s88
 s_mov_b32 s17, s89
 s_mov_b32 s18, 268435456
 s_mov_b32 s19, 0x20000
 v_lshlrev_b32 v6, 4, v0
 v_mov_b32 v8, 0
 v_mov_b32 v9, 0
 v_mov_b32 v10, 0
 v_mov_b32 v11, 0
 s_sub_u32 s28, s2, 252
 s_lshl_b32 s28, s28, 2
 s_add_u32 s27, s28, s24
 s_mul_i32 s27, s27, 12288
 s_add_u32 s27, s27, 40960000
 buffer_store_dwordx4 v[8:11], v6, s[16:19], s27 offen sc1
 buffer_store_dwordx4 v[8:11], v6, s[16:19], s27 offen offset:1024 sc1
 buffer_store_dwordx4 v[8:11], v6, s[16:19], s27 offen offset:2048 sc1
 buffer_store_dwordx4 v[8:11], v6, s[16:19], s27 offen offset:3072 sc1
 s_add_u32 s27, s27, 4096
 buffer_store_dwordx4 v[8:11], v6, s[16:19], s27 offen sc1
 buffer_store_dwordx4 v[8:11], v6, s[16:19], s27 offen offset:1024 sc1
 buffer_store_dwordx4 v[8:11], v6, s[16:19], s27 offen offset:2048 sc1
 buffer_store_dwordx4 v[8:11], v6, s[16:19], s27 offen offset:3072 sc1
 s_add_u32 s27, s27, 4096
 buffer_store_dwordx4 v[8:11], v6, s[16:19], s27 offen sc1
 buffer_store_dwordx4 v[8:11], v6, s[16:19], s27 offen offset:1024 sc1
 buffer_store_dwordx4 v[8:11], v6, s[16:19], s27 offen offset:2048 sc1
 buffer_store_dwordx4 v[8:11], v6, s[16:19], s27 offen offset:3072 sc1
 s_add_u32 s27, s27, 4096
 s_mov_b32 s20, s6
 s_mov_b32 s21, s7
 s_mov_b32 s22, 256
 s_mov_b32 s23, 0x20000
 s_lshr_b32 s28, s28, 2
 s_cmp_eq_u32 s24, 0
 s_cselect_b32 s28, s28, 1073741824
 v_mov_b32 v7, 1
 s_waitcnt vmcnt(0)
 s_barrier
 buffer_store_byte v7, v8, s[20:23], s28 offen sc1
 buffer_load_dwordx4 v[24:27], v3, s[12:15], 0 offen offset:0
 buffer_load_dwordx4 v[28:31], v3, s[12:15], 0 offen offset:128
 buffer_load_dwordx4 v[32:35], v3, s[12:15], 0 offen offset:256
 buffer_load_dwordx4 v[36:39], v3, s[12:15], 0 offen offset:384
 buffer_load_dwordx4 v[40:43], v3, s[12:15], 0 offen offset:512
 buffer_load_dwordx4 v[44:47], v3, s[12:15], 0 offen offset:640
 buffer_load_dwordx4 v[48:51], v3, s[12:15], 0 offen offset:768
 buffer_load_dwordx4 v[52:55], v3, s[12:15], 0 offen offset:896
 buffer_load_dwordx4 v[56:59], v3, s[12:15], 0 offen offset:1024
 buffer_load_dwordx4 v[64:67], v4, s[8:11], s25 offen offset:0
 buffer_load_dwordx4 v[68:71], v4, s[8:11], s25 offen offset:128
 buffer_load_dwordx4 v[72:75], v4, s[8:11], s25 offen offset:256
 buffer_load_dwordx4 v[76:79], v4, s[8:11], s25 offen offset:384
 buffer_load_dwordx4 v[80:83], v4, s[8:11], s25 offen offset:512
 buffer_load_dwordx4 v[84:87], v4, s[8:11], s25 offen offset:640
 buffer_load_dwordx4 v[88:91], v4, s[8:11], s25 offen offset:768
 buffer_load_dwordx4 v[92:95], v4, s[8:11], s25 offen offset:896
 buffer_load_dwordx4 v[96:99], v4, s[8:11], s25 offen offset:1024
 s_add_u32 s25, s25, 9216
 buffer_load_dwordx4 v[100:103], v4, s[8:11], s25 offen offset:0
 buffer_load_dwordx4 v[104:107], v4, s[8:11], s25 offen offset:128
 buffer_load_dwordx4 v[108:111], v4, s[8:11], s25 offen offset:256
 buffer_load_dwordx4 v[112:115], v4, s[8:11], s25 offen offset:384
 buffer_load_dwordx4 v[116:119], v4, s[8:11], s25 offen offset:512
 buffer_load_dwordx4 v[120:123], v4, s[8:11], s25 offen offset:640
 buffer_load_dwordx4 v[124:127], v4, s[8:11], s25 offen offset:768
 buffer_load_dwordx4 v[128:131], v4, s[8:11], s25 offen offset:896
 buffer_load_dwordx4 v[132:135], v4, s[8:11], s25 offen offset:1024
 s_add_u32 s25, s25, 9216
 buffer_load_dwordx4 v[136:139], v4, s[8:11], s25 offen offset:0
 buffer_load_dwordx4 v[140:143], v4, s[8:11], s25 offen offset:128
 buffer_load_dwordx4 v[144:147], v4, s[8:11], s25 offen offset:256
 buffer_load_dwordx4 v[148:151], v4, s[8:11], s25 offen offset:384
 buffer_load_dwordx4 v[152:155], v4, s[8:11], s25 offen offset:512
 buffer_load_dwordx4 v[156:159], v4, s[8:11], s25 offen offset:640
 buffer_load_dwordx4 v[160:163], v4, s[8:11], s25 offen offset:768
 buffer_load_dwordx4 v[164:167], v4, s[8:11], s25 offen offset:896
 buffer_load_dwordx4 v[168:171], v4, s[8:11], s25 offen offset:1024
 s_add_u32 s25, s25, 9216
 buffer_load_dwordx4 v[172:175], v4, s[8:11], s25 offen offset:0
 buffer_load_dwordx4 v[176:179], v4, s[8:11], s25 offen offset:128
 buffer_load_dwordx4 v[180:183], v4, s[8:11], s25 offen offset:256
 buffer_load_dwordx4 v[184:187], v4, s[8:11], s25 offen offset:384
 buffer_load_dwordx4 v[188:191], v4, s[8:11], s25 offen offset:512
 buffer_load_dwordx4 v[192:195], v4, s[8:11], s25 offen offset:640
 buffer_load_dwordx4 v[196:199], v4, s[8:11], s25 offen offset:768
 buffer_load_dwordx4 v[200:203], v4, s[8:11], s25 offen offset:896
 buffer_load_dwordx4 v[204:207], v4, s[8:11], s25 offen offset:1024
 s_add_u32 s25, s25, 9216
 s_waitcnt vmcnt(27)
 v_dot2_f32_bf16 v8, v64, v24, 0
 v_dot2_f32_bf16 v8, v65, v25, v8
 v_dot2_f32_bf16 v8, v66, v26, v8
 v_dot2_f32_bf16 v8, v67, v27, v8
 v_dot2_f32_bf16 v8, v68, v28, v8
 v_dot2_f32_bf16 v8, v69, v29, v8
 v_dot2_f32_bf16 v8, v70, v30, v8
 v_dot2_f32_bf16 v8, v71, v31, v8
 v_dot2_f32_bf16 v8, v72, v32, v8
 v_dot2_f32_bf16 v8, v73, v33, v8
 v_dot2_f32_bf16 v8, v74, v34, v8
 v_dot2_f32_bf16 v8, v75, v35, v8
 v_dot2_f32_bf16 v8, v76, v36, v8
 v_dot2_f32_bf16 v8, v77, v37, v8
 v_dot2_f32_bf16 v8, v78, v38, v8
 v_dot2_f32_bf16 v8, v79, v39, v8
 v_dot2_f32_bf16 v8, v80, v40, v8
 v_dot2_f32_bf16 v8, v81, v41, v8
 v_dot2_f32_bf16 v8, v82, v42, v8
 v_dot2_f32_bf16 v8, v83, v43, v8
 v_dot2_f32_bf16 v8, v84, v44, v8
 v_dot2_f32_bf16 v8, v85, v45, v8
 v_dot2_f32_bf16 v8, v86, v46, v8
 v_dot2_f32_bf16 v8, v87, v47, v8
 v_dot2_f32_bf16 v8, v88, v48, v8
 v_dot2_f32_bf16 v8, v89, v49, v8
 v_dot2_f32_bf16 v8, v90, v50, v8
 v_dot2_f32_bf16 v8, v91, v51, v8
 v_dot2_f32_bf16 v8, v92, v52, v8
 v_dot2_f32_bf16 v8, v93, v53, v8
 v_dot2_f32_bf16 v8, v94, v54, v8
 v_dot2_f32_bf16 v8, v95, v55, v8
 v_dot2_f32_bf16 v8, v96, v56, v8
 v_dot2_f32_bf16 v8, v97, v57, v8
 v_dot2_f32_bf16 v8, v98, v58, v8
 v_dot2_f32_bf16 v8, v99, v59, v8
 buffer_load_dwordx4 v[64:67], v4, s[8:11], s25 offen offset:0
 buffer_load_dwordx4 v[68:71], v4, s[8:11], s25 offen offset:128
 buffer_load_dwordx4 v[72:75], v4, s[8:11], s25 offen offset:256
 buffer_load_dwordx4 v[76:79], v4, s[8:11], s25 offen offset:384
 buffer_load_dwordx4 v[80:83], v4, s[8:11], s25 offen offset:512
 buffer_load_dwordx4 v[84:87], v4, s[8:11], s25 offen offset:640
 buffer_load_dwordx4 v[88:91], v4, s[8:11], s25 offen offset:768
 buffer_load_dwordx4 v[92:95], v4, s[8:11], s25 offen offset:896
 buffer_load_dwordx4 v[96:99], v4, s[8:11], s25 offen offset:1024
 s_add_u32 s25, s25, 9216
 s_waitcnt vmcnt(27)
 v_dot2_f32_bf16 v9, v100, v24, 0
 v_dot2_f32_bf16 v9, v101, v25, v9
 v_dot2_f32_bf16 v9, v102, v26, v9
 v_dot2_f32_bf16 v9, v103, v27, v9
 v_dot2_f32_bf16 v9, v104, v28, v9
 v_dot2_f32_bf16 v9, v105, v29, v9
 v_dot2_f32_bf16 v9, v106, v30, v9
 v_dot2_f32_bf16 v9, v107, v31, v9
 v_dot2_f32_bf16 v9, v108, v32, v9
 v_dot2_f32_bf16 v9, v109, v33, v9
 v_dot2_f32_bf16 v9, v110, v34, v9
 v_dot2_f32_bf16 v9, v111, v35, v9
 v_dot2_f32_bf16 v9, v112, v36, v9
 v_dot2_f32_bf16 v9, v113, v37, v9
 v_dot2_f32_bf16 v9, v114, v38, v9
 v_dot2_f32_bf16 v9, v115, v39, v9
 v_dot2_f32_bf16 v9, v116, v40, v9
 v_dot2_f32_bf16 v9, v117, v41, v9
 v_dot2_f32_bf16 v9, v118, v42, v9
 v_dot2_f32_bf16 v9, v119, v43, v9
 v_dot2_f32_bf16 v9, v120, v44, v9
 v_dot2_f32_bf16 v9, v121, v45, v9
 v_dot2_f32_bf16 v9, v122, v46, v9
 v_dot2_f32_bf16 v9, v123, v47, v9
 v_dot2_f32_bf16 v9, v124, v48, v9
 v_dot2_f32_bf16 v9, v125, v49, v9
 v_dot2_f32_bf16 v9, v126, v50, v9
 v_dot2_f32_bf16 v9, v127, v51, v9
 v_dot2_f32_bf16 v9, v128, v52, v9
 v_dot2_f32_bf16 v9, v129, v53, v9
 v_dot2_f32_bf16 v9, v130, v54, v9
 v_dot2_f32_bf16 v9, v131, v55, v9
 v_dot2_f32_bf16 v9, v132, v56, v9
 v_dot2_f32_bf16 v9, v133, v57, v9
 v_dot2_f32_bf16 v9, v134, v58, v9
 v_dot2_f32_bf16 v9, v135, v59, v9
 buffer_load_dwordx4 v[100:103], v4, s[8:11], s25 offen offset:0
 buffer_load_dwordx4 v[104:107], v4, s[8:11], s25 offen offset:128
 buffer_load_dwordx4 v[108:111], v4, s[8:11], s25 offen offset:256
 buffer_load_dwordx4 v[112:115], v4, s[8:11], s25 offen offset:384
 buffer_load_dwordx4 v[116:119], v4, s[8:11], s25 offen offset:512
 buffer_load_dwordx4 v[120:123], v4, s[8:11], s25 offen offset:640
 buffer_load_dwordx4 v[124:127], v4, s[8:11], s25 offen offset:768
 buffer_load_dwordx4 v[128:131], v4, s[8:11], s25 offen offset:896
 buffer_load_dwordx4 v[132:135], v4, s[8:11], s25 offen offset:1024
 s_add_u32 s25, s25, 9216
 s_waitcnt vmcnt(27)
 v_dot2_f32_bf16 v10, v136, v24, 0
 v_dot2_f32_bf16 v10, v137, v25, v10
 v_dot2_f32_bf16 v10, v138, v26, v10
 v_dot2_f32_bf16 v10, v139, v27, v10
 v_dot2_f32_bf16 v10, v140, v28, v10
 v_dot2_f32_bf16 v10, v141, v29, v10
 v_dot2_f32_bf16 v10, v142, v30, v10
 v_dot2_f32_bf16 v10, v143, v31, v10
 v_dot2_f32_bf16 v10, v144, v32, v10
 v_dot2_f32_bf16 v10, v145, v33, v10
 v_dot2_f32_bf16 v10, v146, v34, v10
 v_dot2_f32_bf16 v10, v147, v35, v10
 v_dot2_f32_bf16 v10, v148, v36, v10
 v_dot2_f32_bf16 v10, v149, v37, v10
 v_dot2_f32_bf16 v10, v150, v38, v10
 v_dot2_f32_bf16 v10, v151, v39, v10
 v_dot2_f32_bf16 v10, v152, v40, v10
 v_dot2_f32_bf16 v10, v153, v41, v10
 v_dot2_f32_bf16 v10, v154, v42, v10
 v_dot2_f32_bf16 v10, v155, v43, v10
 v_dot2_f32_bf16 v10, v156, v44, v10
 v_dot2_f32_bf16 v10, v157, v45, v10
 v_dot2_f32_bf16 v10, v158, v46, v10
 v_dot2_f32_bf16 v10, v159, v47, v10
 v_dot2_f32_bf16 v10, v160, v48, v10
 v_dot2_f32_bf16 v10, v161, v49, v10
 v_dot2_f32_bf16 v10, v162, v50, v10
 v_dot2_f32_bf16 v10, v163, v51, v10
 v_dot2_f32_bf16 v10, v164, v52, v10
 v_dot2_f32_bf16 v10, v165, v53, v10
 v_dot2_f32_bf16 v10, v166, v54, v10
 v_dot2_f32_bf16 v10, v167, v55, v10
 v_dot2_f32_bf16 v10, v168, v56, v10
 v_dot2_f32_bf16 v10, v169, v57, v10
 v_dot2_f32_bf16 v10, v170, v58, v10
 v_dot2_f32_bf16 v10, v171, v59, v10
 buffer_load_dwordx4 v[136:139], v4, s[8:11], s25 offen offset:0
 buffer_load_dwordx4 v[140:143], v4, s[8:11], s25 offen offset:128
 buffer_load_dwordx4 v[144:147], v4, s[8:11], s25 offen offset:256
 buffer_load_dwordx4 v[148:151], v4, s[8:11], s25 offen offset:384
 buffer_load_dwordx4 v[152:155], v4, s[8:11], s25 offen offset:512
 buffer_load_dwordx4 v[156:159], v4, s[8:11], s25 offen offset:640
 buffer_load_dwordx4 v[160:163], v4, s[8:11], s25 offen offset:768
 buffer_load_dwordx4 v[164:167], v4, s[8:11], s25 offen offset:896
 buffer_load_dwordx4 v[168:171], v4, s[8:11], s25 offen offset:1024
 s_add_u32 s25, s25, 9216
 s_waitcnt vmcnt(27)
 v_dot2_f32_bf16 v11, v172, v24, 0
 v_dot2_f32_bf16 v11, v173, v25, v11
 v_dot2_f32_bf16 v11, v174, v26, v11
 v_dot2_f32_bf16 v11, v175, v27, v11
 v_dot2_f32_bf16 v11, v176, v28, v11
 v_dot2_f32_bf16 v11, v177, v29, v11
 v_dot2_f32_bf16 v11, v178, v30, v11
 v_dot2_f32_bf16 v11, v179, v31, v11
 v_dot2_f32_bf16 v11, v180, v32, v11
 v_dot2_f32_bf16 v11, v181, v33, v11
 v_dot2_f32_bf16 v11, v182, v34, v11
 v_dot2_f32_bf16 v11, v183, v35, v11
 v_dot2_f32_bf16 v11, v184, v36, v11
 v_dot2_f32_bf16 v11, v185, v37, v11
 v_dot2_f32_bf16 v11, v186, v38, v11
 v_dot2_f32_bf16 v11, v187, v39, v11
 v_dot2_f32_bf16 v11, v188, v40, v11
 v_dot2_f32_bf16 v11, v189, v41, v11
 v_dot2_f32_bf16 v11, v190, v42, v11
 v_dot2_f32_bf16 v11, v191, v43, v11
 v_dot2_f32_bf16 v11, v192, v44, v11
 v_dot2_f32_bf16 v11, v193, v45, v11
 v_dot2_f32_bf16 v11, v194, v46, v11
 v_dot2_f32_bf16 v11, v195, v47, v11
 v_dot2_f32_bf16 v11, v196, v48, v11
 v_dot2_f32_bf16 v11, v197, v49, v11
 v_dot2_f32_bf16 v11, v198, v50, v11
 v_dot2_f32_bf16 v11, v199, v51, v11
 v_dot2_f32_bf16 v11, v200, v52, v11
 v_dot2_f32_bf16 v11, v201, v53, v11
 v_dot2_f32_bf16 v11, v202, v54, v11
 v_dot2_f32_bf16 v11, v203, v55, v11
 v_dot2_f32_bf16 v11, v204, v56, v11
 v_dot2_f32_bf16 v11, v205, v57, v11
 v_dot2_f32_bf16 v11, v206, v58, v11
 v_dot2_f32_bf16 v11, v207, v59, v11
 buffer_load_dwordx4 v[172:175], v4, s[8:11], s25 offen offset:0
 buffer_load_dwordx4 v[176:179], v4, s[8:11], s25 offen offset:128
 buffer_load_dwordx4 v[180:183], v4, s[8:11], s25 offen offset:256
 buffer_load_dwordx4 v[184:187], v4, s[8:11], s25 offen offset:384
 buffer_load_dwordx4 v[188:191], v4, s[8:11], s25 offen offset:512
 buffer_load_dwordx4 v[192:195], v4, s[8:11], s25 offen offset:640
 buffer_load_dwordx4 v[196:199], v4, s[8:11], s25 offen offset:768
 buffer_load_dwordx4 v[200:203], v4, s[8:11], s25 offen offset:896
 buffer_load_dwordx4 v[204:207], v4, s[8:11], s25 offen offset:1024
 s_add_u32 s25, s25, 9216
 s_waitcnt vmcnt(27)
 v_dot2_f32_bf16 v12, v64, v24, 0
 v_dot2_f32_bf16 v12, v65, v25, v12
 v_dot2_f32_bf16 v12, v66, v26, v12
 v_dot2_f32_bf16 v12, v67, v27, v12
 v_dot2_f32_bf16 v12, v68, v28, v12
 v_dot2_f32_bf16 v12, v69, v29, v12
 v_dot2_f32_bf16 v12, v70, v30, v12
 v_dot2_f32_bf16 v12, v71, v31, v12
 v_dot2_f32_bf16 v12, v72, v32, v12
 v_dot2_f32_bf16 v12, v73, v33, v12
 v_dot2_f32_bf16 v12, v74, v34, v12
 v_dot2_f32_bf16 v12, v75, v35, v12
 v_dot2_f32_bf16 v12, v76, v36, v12
 v_dot2_f32_bf16 v12, v77, v37, v12
 v_dot2_f32_bf16 v12, v78, v38, v12
 v_dot2_f32_bf16 v12, v79, v39, v12
 v_dot2_f32_bf16 v12, v80, v40, v12
 v_dot2_f32_bf16 v12, v81, v41, v12
 v_dot2_f32_bf16 v12, v82, v42, v12
 v_dot2_f32_bf16 v12, v83, v43, v12
 v_dot2_f32_bf16 v12, v84, v44, v12
 v_dot2_f32_bf16 v12, v85, v45, v12
 v_dot2_f32_bf16 v12, v86, v46, v12
 v_dot2_f32_bf16 v12, v87, v47, v12
 v_dot2_f32_bf16 v12, v88, v48, v12
 v_dot2_f32_bf16 v12, v89, v49, v12
 v_dot2_f32_bf16 v12, v90, v50, v12
 v_dot2_f32_bf16 v12, v91, v51, v12
 v_dot2_f32_bf16 v12, v92, v52, v12
 v_dot2_f32_bf16 v12, v93, v53, v12
 v_dot2_f32_bf16 v12, v94, v54, v12
 v_dot2_f32_bf16 v12, v95, v55, v12
 v_dot2_f32_bf16 v12, v96, v56, v12
 v_dot2_f32_bf16 v12, v97, v57, v12
 v_dot2_f32_bf16 v12, v98, v58, v12
 v_dot2_f32_bf16 v12, v99, v59, v12
 buffer_load_dwordx4 v[64:67], v4, s[8:11], s25 offen offset:0
 buffer_load_dwordx4 v[68:71], v4, s[8:11], s25 offen offset:128
 buffer_load_dwordx4 v[72:75], v4, s[8:11], s25 offen offset:256
 buffer_load_dwordx4 v[76:79], v4, s[8:11], s25 offen offset:384
 buffer_load_dwordx4 v[80:83], v4, s[8:11], s25 offen offset:512
 buffer_load_dwordx4 v[84:87], v4, s[8:11], s25 offen offset:640
 buffer_load_dwordx4 v[88:91], v4, s[8:11], s25 offen offset:768
 buffer_load_dwordx4 v[92:95], v4, s[8:11], s25 offen offset:896
 buffer_load_dwordx4 v[96:99], v4, s[8:11], s25 offen offset:1024
 s_add_u32 s25, s25, 9216
 s_waitcnt vmcnt(27)
 v_dot2_f32_bf16 v13, v100, v24, 0
 v_dot2_f32_bf16 v13, v101, v25, v13
 v_dot2_f32_bf16 v13, v102, v26, v13
 v_dot2_f32_bf16 v13, v103, v27, v13
 v_dot2_f32_bf16 v13, v104, v28, v13
 v_dot2_f32_bf16 v13, v105, v29, v13
 v_dot2_f32_bf16 v13, v106, v30, v13
 v_dot2_f32_bf16 v13, v107, v31, v13
 v_dot2_f32_bf16 v13, v108, v32, v13
 v_dot2_f32_bf16 v13, v109, v33, v13
 v_dot2_f32_bf16 v13, v110, v34, v13
 v_dot2_f32_bf16 v13, v111, v35, v13
 v_dot2_f32_bf16 v13, v112, v36, v13
 v_dot2_f32_bf16 v13, v113, v37, v13
 v_dot2_f32_bf16 v13, v114, v38, v13
 v_dot2_f32_bf16 v13, v115, v39, v13
 v_dot2_f32_bf16 v13, v116, v40, v13
 v_dot2_f32_bf16 v13, v117, v41, v13
 v_dot2_f32_bf16 v13, v118, v42, v13
 v_dot2_f32_bf16 v13, v119, v43, v13
 v_dot2_f32_bf16 v13, v120, v44, v13
 v_dot2_f32_bf16 v13, v121, v45, v13
 v_dot2_f32_bf16 v13, v122, v46, v13
 v_dot2_f32_bf16 v13, v123, v47, v13
 v_dot2_f32_bf16 v13, v124, v48, v13
 v_dot2_f32_bf16 v13, v125, v49, v13
 v_dot2_f32_bf16 v13, v126, v50, v13
 v_dot2_f32_bf16 v13, v127, v51, v13
 v_dot2_f32_bf16 v13, v128, v52, v13
 v_dot2_f32_bf16 v13, v129, v53, v13
 v_dot2_f32_bf16 v13, v130, v54, v13
 v_dot2_f32_bf16 v13, v131, v55, v13
 v_dot2_f32_bf16 v13, v132, v56, v13
 v_dot2_f32_bf16 v13, v133, v57, v13
 v_dot2_f32_bf16 v13, v134, v58, v13
 v_dot2_f32_bf16 v13, v135, v59, v13
 buffer_load_dwordx4 v[100:103], v4, s[8:11], s25 offen offset:0
 buffer_load_dwordx4 v[104:107], v4, s[8:11], s25 offen offset:128
 buffer_load_dwordx4 v[108:111], v4, s[8:11], s25 offen offset:256
 buffer_load_dwordx4 v[112:115], v4, s[8:11], s25 offen offset:384
 buffer_load_dwordx4 v[116:119], v4, s[8:11], s25 offen offset:512
 buffer_load_dwordx4 v[120:123], v4, s[8:11], s25 offen offset:640
 buffer_load_dwordx4 v[124:127], v4, s[8:11], s25 offen offset:768
 buffer_load_dwordx4 v[128:131], v4, s[8:11], s25 offen offset:896
 buffer_load_dwordx4 v[132:135], v4, s[8:11], s25 offen offset:1024
 s_add_u32 s25, s25, 9216
 s_waitcnt vmcnt(27)
 v_dot2_f32_bf16 v14, v136, v24, 0
 v_dot2_f32_bf16 v14, v137, v25, v14
 v_dot2_f32_bf16 v14, v138, v26, v14
 v_dot2_f32_bf16 v14, v139, v27, v14
 v_dot2_f32_bf16 v14, v140, v28, v14
 v_dot2_f32_bf16 v14, v141, v29, v14
 v_dot2_f32_bf16 v14, v142, v30, v14
 v_dot2_f32_bf16 v14, v143, v31, v14
 v_dot2_f32_bf16 v14, v144, v32, v14
 v_dot2_f32_bf16 v14, v145, v33, v14
 v_dot2_f32_bf16 v14, v146, v34, v14
 v_dot2_f32_bf16 v14, v147, v35, v14
 v_dot2_f32_bf16 v14, v148, v36, v14
 v_dot2_f32_bf16 v14, v149, v37, v14
 v_dot2_f32_bf16 v14, v150, v38, v14
 v_dot2_f32_bf16 v14, v151, v39, v14
 v_dot2_f32_bf16 v14, v152, v40, v14
 v_dot2_f32_bf16 v14, v153, v41, v14
 v_dot2_f32_bf16 v14, v154, v42, v14
 v_dot2_f32_bf16 v14, v155, v43, v14
 v_dot2_f32_bf16 v14, v156, v44, v14
 v_dot2_f32_bf16 v14, v157, v45, v14
 v_dot2_f32_bf16 v14, v158, v46, v14
 v_dot2_f32_bf16 v14, v159, v47, v14
 v_dot2_f32_bf16 v14, v160, v48, v14
 v_dot2_f32_bf16 v14, v161, v49, v14
 v_dot2_f32_bf16 v14, v162, v50, v14
 v_dot2_f32_bf16 v14, v163, v51, v14
 v_dot2_f32_bf16 v14, v164, v52, v14
 v_dot2_f32_bf16 v14, v165, v53, v14
 v_dot2_f32_bf16 v14, v166, v54, v14
 v_dot2_f32_bf16 v14, v167, v55, v14
 v_dot2_f32_bf16 v14, v168, v56, v14
 v_dot2_f32_bf16 v14, v169, v57, v14
 v_dot2_f32_bf16 v14, v170, v58, v14
 v_dot2_f32_bf16 v14, v171, v59, v14
 buffer_load_dwordx4 v[136:139], v4, s[8:11], s25 offen offset:0
 buffer_load_dwordx4 v[140:143], v4, s[8:11], s25 offen offset:128
 buffer_load_dwordx4 v[144:147], v4, s[8:11], s25 offen offset:256
 buffer_load_dwordx4 v[148:151], v4, s[8:11], s25 offen offset:384
 buffer_load_dwordx4 v[152:155], v4, s[8:11], s25 offen offset:512
 buffer_load_dwordx4 v[156:159], v4, s[8:11], s25 offen offset:640
 buffer_load_dwordx4 v[160:163], v4, s[8:11], s25 offen offset:768
 buffer_load_dwordx4 v[164:167], v4, s[8:11], s25 offen offset:896
 buffer_load_dwordx4 v[168:171], v4, s[8:11], s25 offen offset:1024
 s_add_u32 s25, s25, 9216
 s_waitcnt vmcnt(27)
 v_dot2_f32_bf16 v15, v172, v24, 0
 v_dot2_f32_bf16 v15, v173, v25, v15
 v_dot2_f32_bf16 v15, v174, v26, v15
 v_dot2_f32_bf16 v15, v175, v27, v15
 v_dot2_f32_bf16 v15, v176, v28, v15
 v_dot2_f32_bf16 v15, v177, v29, v15
 v_dot2_f32_bf16 v15, v178, v30, v15
 v_dot2_f32_bf16 v15, v179, v31, v15
 v_dot2_f32_bf16 v15, v180, v32, v15
 v_dot2_f32_bf16 v15, v181, v33, v15
 v_dot2_f32_bf16 v15, v182, v34, v15
 v_dot2_f32_bf16 v15, v183, v35, v15
 v_dot2_f32_bf16 v15, v184, v36, v15
 v_dot2_f32_bf16 v15, v185, v37, v15
 v_dot2_f32_bf16 v15, v186, v38, v15
 v_dot2_f32_bf16 v15, v187, v39, v15
 v_dot2_f32_bf16 v15, v188, v40, v15
 v_dot2_f32_bf16 v15, v189, v41, v15
 v_dot2_f32_bf16 v15, v190, v42, v15
 v_dot2_f32_bf16 v15, v191, v43, v15
 v_dot2_f32_bf16 v15, v192, v44, v15
 v_dot2_f32_bf16 v15, v193, v45, v15
 v_dot2_f32_bf16 v15, v194, v46, v15
 v_dot2_f32_bf16 v15, v195, v47, v15
 v_dot2_f32_bf16 v15, v196, v48, v15
 v_dot2_f32_bf16 v15, v197, v49, v15
 v_dot2_f32_bf16 v15, v198, v50, v15
 v_dot2_f32_bf16 v15, v199, v51, v15
 v_dot2_f32_bf16 v15, v200, v52, v15
 v_dot2_f32_bf16 v15, v201, v53, v15
 v_dot2_f32_bf16 v15, v202, v54, v15
 v_dot2_f32_bf16 v15, v203, v55, v15
 v_dot2_f32_bf16 v15, v204, v56, v15
 v_dot2_f32_bf16 v15, v205, v57, v15
 v_dot2_f32_bf16 v15, v206, v58, v15
 v_dot2_f32_bf16 v15, v207, v59, v15
 buffer_load_dwordx4 v[172:175], v4, s[8:11], s25 offen offset:0
 buffer_load_dwordx4 v[176:179], v4, s[8:11], s25 offen offset:128
 buffer_load_dwordx4 v[180:183], v4, s[8:11], s25 offen offset:256
 buffer_load_dwordx4 v[184:187], v4, s[8:11], s25 offen offset:384
 buffer_load_dwordx4 v[188:191], v4, s[8:11], s25 offen offset:512
 buffer_load_dwordx4 v[192:195], v4, s[8:11], s25 offen offset:640
 buffer_load_dwordx4 v[196:199], v4, s[8:11], s25 offen offset:768
 buffer_load_dwordx4 v[200:203], v4, s[8:11], s25 offen offset:896
 buffer_load_dwordx4 v[204:207], v4, s[8:11], s25 offen offset:1024
 s_add_u32 s25, s25, 9216
 s_waitcnt vmcnt(27)
 v_dot2_f32_bf16 v16, v64, v24, 0
 v_dot2_f32_bf16 v16, v65, v25, v16
 v_dot2_f32_bf16 v16, v66, v26, v16
 v_dot2_f32_bf16 v16, v67, v27, v16
 v_dot2_f32_bf16 v16, v68, v28, v16
 v_dot2_f32_bf16 v16, v69, v29, v16
 v_dot2_f32_bf16 v16, v70, v30, v16
 v_dot2_f32_bf16 v16, v71, v31, v16
 v_dot2_f32_bf16 v16, v72, v32, v16
 v_dot2_f32_bf16 v16, v73, v33, v16
 v_dot2_f32_bf16 v16, v74, v34, v16
 v_dot2_f32_bf16 v16, v75, v35, v16
 v_dot2_f32_bf16 v16, v76, v36, v16
 v_dot2_f32_bf16 v16, v77, v37, v16
 v_dot2_f32_bf16 v16, v78, v38, v16
 v_dot2_f32_bf16 v16, v79, v39, v16
 v_dot2_f32_bf16 v16, v80, v40, v16
 v_dot2_f32_bf16 v16, v81, v41, v16
 v_dot2_f32_bf16 v16, v82, v42, v16
 v_dot2_f32_bf16 v16, v83, v43, v16
 v_dot2_f32_bf16 v16, v84, v44, v16
 v_dot2_f32_bf16 v16, v85, v45, v16
 v_dot2_f32_bf16 v16, v86, v46, v16
 v_dot2_f32_bf16 v16, v87, v47, v16
 v_dot2_f32_bf16 v16, v88, v48, v16
 v_dot2_f32_bf16 v16, v89, v49, v16
 v_dot2_f32_bf16 v16, v90, v50, v16
 v_dot2_f32_bf16 v16, v91, v51, v16
 v_dot2_f32_bf16 v16, v92, v52, v16
 v_dot2_f32_bf16 v16, v93, v53, v16
 v_dot2_f32_bf16 v16, v94, v54, v16
 v_dot2_f32_bf16 v16, v95, v55, v16
 v_dot2_f32_bf16 v16, v96, v56, v16
 v_dot2_f32_bf16 v16, v97, v57, v16
 v_dot2_f32_bf16 v16, v98, v58, v16
 v_dot2_f32_bf16 v16, v99, v59, v16
 buffer_load_dwordx4 v[64:67], v4, s[8:11], s25 offen offset:0
 buffer_load_dwordx4 v[68:71], v4, s[8:11], s25 offen offset:128
 buffer_load_dwordx4 v[72:75], v4, s[8:11], s25 offen offset:256
 buffer_load_dwordx4 v[76:79], v4, s[8:11], s25 offen offset:384
 buffer_load_dwordx4 v[80:83], v4, s[8:11], s25 offen offset:512
 buffer_load_dwordx4 v[84:87], v4, s[8:11], s25 offen offset:640
 buffer_load_dwordx4 v[88:91], v4, s[8:11], s25 offen offset:768
 buffer_load_dwordx4 v[92:95], v4, s[8:11], s25 offen offset:896
 buffer_load_dwordx4 v[96:99], v4, s[8:11], s25 offen offset:1024
 s_add_u32 s25, s25, 9216
 s_waitcnt vmcnt(27)
 v_dot2_f32_bf16 v17, v100, v24, 0
 v_dot2_f32_bf16 v17, v101, v25, v17
 v_dot2_f32_bf16 v17, v102, v26, v17
 v_dot2_f32_bf16 v17, v103, v27, v17
 v_dot2_f32_bf16 v17, v104, v28, v17
 v_dot2_f32_bf16 v17, v105, v29, v17
 v_dot2_f32_bf16 v17, v106, v30, v17
 v_dot2_f32_bf16 v17, v107, v31, v17
 v_dot2_f32_bf16 v17, v108, v32, v17
 v_dot2_f32_bf16 v17, v109, v33, v17
 v_dot2_f32_bf16 v17, v110, v34, v17
 v_dot2_f32_bf16 v17, v111, v35, v17
 v_dot2_f32_bf16 v17, v112, v36, v17
 v_dot2_f32_bf16 v17, v113, v37, v17
 v_dot2_f32_bf16 v17, v114, v38, v17
 v_dot2_f32_bf16 v17, v115, v39, v17
 v_dot2_f32_bf16 v17, v116, v40, v17
 v_dot2_f32_bf16 v17, v117, v41, v17
 v_dot2_f32_bf16 v17, v118, v42, v17
 v_dot2_f32_bf16 v17, v119, v43, v17
 v_dot2_f32_bf16 v17, v120, v44, v17
 v_dot2_f32_bf16 v17, v121, v45, v17
 v_dot2_f32_bf16 v17, v122, v46, v17
 v_dot2_f32_bf16 v17, v123, v47, v17
 v_dot2_f32_bf16 v17, v124, v48, v17
 v_dot2_f32_bf16 v17, v125, v49, v17
 v_dot2_f32_bf16 v17, v126, v50, v17
 v_dot2_f32_bf16 v17, v127, v51, v17
 v_dot2_f32_bf16 v17, v128, v52, v17
 v_dot2_f32_bf16 v17, v129, v53, v17
 v_dot2_f32_bf16 v17, v130, v54, v17
 v_dot2_f32_bf16 v17, v131, v55, v17
 v_dot2_f32_bf16 v17, v132, v56, v17
 v_dot2_f32_bf16 v17, v133, v57, v17
 v_dot2_f32_bf16 v17, v134, v58, v17
 v_dot2_f32_bf16 v17, v135, v59, v17
 buffer_load_dwordx4 v[100:103], v4, s[8:11], s25 offen offset:0
 buffer_load_dwordx4 v[104:107], v4, s[8:11], s25 offen offset:128
 buffer_load_dwordx4 v[108:111], v4, s[8:11], s25 offen offset:256
 buffer_load_dwordx4 v[112:115], v4, s[8:11], s25 offen offset:384
 buffer_load_dwordx4 v[116:119], v4, s[8:11], s25 offen offset:512
 buffer_load_dwordx4 v[120:123], v4, s[8:11], s25 offen offset:640
 buffer_load_dwordx4 v[124:127], v4, s[8:11], s25 offen offset:768
 buffer_load_dwordx4 v[128:131], v4, s[8:11], s25 offen offset:896
 buffer_load_dwordx4 v[132:135], v4, s[8:11], s25 offen offset:1024
 s_add_u32 s25, s25, 9216
 s_waitcnt vmcnt(27)
 v_dot2_f32_bf16 v18, v136, v24, 0
 v_dot2_f32_bf16 v18, v137, v25, v18
 v_dot2_f32_bf16 v18, v138, v26, v18
 v_dot2_f32_bf16 v18, v139, v27, v18
 v_dot2_f32_bf16 v18, v140, v28, v18
 v_dot2_f32_bf16 v18, v141, v29, v18
 v_dot2_f32_bf16 v18, v142, v30, v18
 v_dot2_f32_bf16 v18, v143, v31, v18
 v_dot2_f32_bf16 v18, v144, v32, v18
 v_dot2_f32_bf16 v18, v145, v33, v18
 v_dot2_f32_bf16 v18, v146, v34, v18
 v_dot2_f32_bf16 v18, v147, v35, v18
 v_dot2_f32_bf16 v18, v148, v36, v18
 v_dot2_f32_bf16 v18, v149, v37, v18
 v_dot2_f32_bf16 v18, v150, v38, v18
 v_dot2_f32_bf16 v18, v151, v39, v18
 v_dot2_f32_bf16 v18, v152, v40, v18
 v_dot2_f32_bf16 v18, v153, v41, v18
 v_dot2_f32_bf16 v18, v154, v42, v18
 v_dot2_f32_bf16 v18, v155, v43, v18
 v_dot2_f32_bf16 v18, v156, v44, v18
 v_dot2_f32_bf16 v18, v157, v45, v18
 v_dot2_f32_bf16 v18, v158, v46, v18
 v_dot2_f32_bf16 v18, v159, v47, v18
 v_dot2_f32_bf16 v18, v160, v48, v18
 v_dot2_f32_bf16 v18, v161, v49, v18
 v_dot2_f32_bf16 v18, v162, v50, v18
 v_dot2_f32_bf16 v18, v163, v51, v18
 v_dot2_f32_bf16 v18, v164, v52, v18
 v_dot2_f32_bf16 v18, v165, v53, v18
 v_dot2_f32_bf16 v18, v166, v54, v18
 v_dot2_f32_bf16 v18, v167, v55, v18
 v_dot2_f32_bf16 v18, v168, v56, v18
 v_dot2_f32_bf16 v18, v169, v57, v18
 v_dot2_f32_bf16 v18, v170, v58, v18
 v_dot2_f32_bf16 v18, v171, v59, v18
 buffer_load_dwordx4 v[136:139], v4, s[8:11], s25 offen offset:0
 buffer_load_dwordx4 v[140:143], v4, s[8:11], s25 offen offset:128
 buffer_load_dwordx4 v[144:147], v4, s[8:11], s25 offen offset:256
 buffer_load_dwordx4 v[148:151], v4, s[8:11], s25 offen offset:384
 buffer_load_dwordx4 v[152:155], v4, s[8:11], s25 offen offset:512
 buffer_load_dwordx4 v[156:159], v4, s[8:11], s25 offen offset:640
 buffer_load_dwordx4 v[160:163], v4, s[8:11], s25 offen offset:768
 buffer_load_dwordx4 v[164:167], v4, s[8:11], s25 offen offset:896
 buffer_load_dwordx4 v[168:171], v4, s[8:11], s25 offen offset:1024
 s_add_u32 s25, s25, 9216
 s_waitcnt vmcnt(27)
 v_dot2_f32_bf16 v19, v172, v24, 0
 v_dot2_f32_bf16 v19, v173, v25, v19
 v_dot2_f32_bf16 v19, v174, v26, v19
 v_dot2_f32_bf16 v19, v175, v27, v19
 v_dot2_f32_bf16 v19, v176, v28, v19
 v_dot2_f32_bf16 v19, v177, v29, v19
 v_dot2_f32_bf16 v19, v178, v30, v19
 v_dot2_f32_bf16 v19, v179, v31, v19
 v_dot2_f32_bf16 v19, v180, v32, v19
 v_dot2_f32_bf16 v19, v181, v33, v19
 v_dot2_f32_bf16 v19, v182, v34, v19
 v_dot2_f32_bf16 v19, v183, v35, v19
 v_dot2_f32_bf16 v19, v184, v36, v19
 v_dot2_f32_bf16 v19, v185, v37, v19
 v_dot2_f32_bf16 v19, v186, v38, v19
 v_dot2_f32_bf16 v19, v187, v39, v19
 v_dot2_f32_bf16 v19, v188, v40, v19
 v_dot2_f32_bf16 v19, v189, v41, v19
 v_dot2_f32_bf16 v19, v190, v42, v19
 v_dot2_f32_bf16 v19, v191, v43, v19
 v_dot2_f32_bf16 v19, v192, v44, v19
 v_dot2_f32_bf16 v19, v193, v45, v19
 v_dot2_f32_bf16 v19, v194, v46, v19
 v_dot2_f32_bf16 v19, v195, v47, v19
 v_dot2_f32_bf16 v19, v196, v48, v19
 v_dot2_f32_bf16 v19, v197, v49, v19
 v_dot2_f32_bf16 v19, v198, v50, v19
 v_dot2_f32_bf16 v19, v199, v51, v19
 v_dot2_f32_bf16 v19, v200, v52, v19
 v_dot2_f32_bf16 v19, v201, v53, v19
 v_dot2_f32_bf16 v19, v202, v54, v19
 v_dot2_f32_bf16 v19, v203, v55, v19
 v_dot2_f32_bf16 v19, v204, v56, v19
 v_dot2_f32_bf16 v19, v205, v57, v19
 v_dot2_f32_bf16 v19, v206, v58, v19
 v_dot2_f32_bf16 v19, v207, v59, v19
 buffer_load_dwordx4 v[172:175], v4, s[8:11], s25 offen offset:0
 buffer_load_dwordx4 v[176:179], v4, s[8:11], s25 offen offset:128
 buffer_load_dwordx4 v[180:183], v4, s[8:11], s25 offen offset:256
 buffer_load_dwordx4 v[184:187], v4, s[8:11], s25 offen offset:384
 buffer_load_dwordx4 v[188:191], v4, s[8:11], s25 offen offset:512
 buffer_load_dwordx4 v[192:195], v4, s[8:11], s25 offen offset:640
 buffer_load_dwordx4 v[196:199], v4, s[8:11], s25 offen offset:768
 buffer_load_dwordx4 v[200:203], v4, s[8:11], s25 offen offset:896
 buffer_load_dwordx4 v[204:207], v4, s[8:11], s25 offen offset:1024
 s_add_u32 s25, s25, 9216
 s_waitcnt vmcnt(27)
 v_dot2_f32_bf16 v20, v64, v24, 0
 v_dot2_f32_bf16 v20, v65, v25, v20
 v_dot2_f32_bf16 v20, v66, v26, v20
 v_dot2_f32_bf16 v20, v67, v27, v20
 v_dot2_f32_bf16 v20, v68, v28, v20
 v_dot2_f32_bf16 v20, v69, v29, v20
 v_dot2_f32_bf16 v20, v70, v30, v20
 v_dot2_f32_bf16 v20, v71, v31, v20
 v_dot2_f32_bf16 v20, v72, v32, v20
 v_dot2_f32_bf16 v20, v73, v33, v20
 v_dot2_f32_bf16 v20, v74, v34, v20
 v_dot2_f32_bf16 v20, v75, v35, v20
 v_dot2_f32_bf16 v20, v76, v36, v20
 v_dot2_f32_bf16 v20, v77, v37, v20
 v_dot2_f32_bf16 v20, v78, v38, v20
 v_dot2_f32_bf16 v20, v79, v39, v20
 v_dot2_f32_bf16 v20, v80, v40, v20
 v_dot2_f32_bf16 v20, v81, v41, v20
 v_dot2_f32_bf16 v20, v82, v42, v20
 v_dot2_f32_bf16 v20, v83, v43, v20
 v_dot2_f32_bf16 v20, v84, v44, v20
 v_dot2_f32_bf16 v20, v85, v45, v20
 v_dot2_f32_bf16 v20, v86, v46, v20
 v_dot2_f32_bf16 v20, v87, v47, v20
 v_dot2_f32_bf16 v20, v88, v48, v20
 v_dot2_f32_bf16 v20, v89, v49, v20
 v_dot2_f32_bf16 v20, v90, v50, v20
 v_dot2_f32_bf16 v20, v91, v51, v20
 v_dot2_f32_bf16 v20, v92, v52, v20
 v_dot2_f32_bf16 v20, v93, v53, v20
 v_dot2_f32_bf16 v20, v94, v54, v20
 v_dot2_f32_bf16 v20, v95, v55, v20
 v_dot2_f32_bf16 v20, v96, v56, v20
 v_dot2_f32_bf16 v20, v97, v57, v20
 v_dot2_f32_bf16 v20, v98, v58, v20
 v_dot2_f32_bf16 v20, v99, v59, v20
 s_waitcnt vmcnt(18)
 v_dot2_f32_bf16 v21, v100, v24, 0
 v_dot2_f32_bf16 v21, v101, v25, v21
 v_dot2_f32_bf16 v21, v102, v26, v21
 v_dot2_f32_bf16 v21, v103, v27, v21
 v_dot2_f32_bf16 v21, v104, v28, v21
 v_dot2_f32_bf16 v21, v105, v29, v21
 v_dot2_f32_bf16 v21, v106, v30, v21
 v_dot2_f32_bf16 v21, v107, v31, v21
 v_dot2_f32_bf16 v21, v108, v32, v21
 v_dot2_f32_bf16 v21, v109, v33, v21
 v_dot2_f32_bf16 v21, v110, v34, v21
 v_dot2_f32_bf16 v21, v111, v35, v21
 v_dot2_f32_bf16 v21, v112, v36, v21
 v_dot2_f32_bf16 v21, v113, v37, v21
 v_dot2_f32_bf16 v21, v114, v38, v21
 v_dot2_f32_bf16 v21, v115, v39, v21
 v_dot2_f32_bf16 v21, v116, v40, v21
 v_dot2_f32_bf16 v21, v117, v41, v21
 v_dot2_f32_bf16 v21, v118, v42, v21
 v_dot2_f32_bf16 v21, v119, v43, v21
 v_dot2_f32_bf16 v21, v120, v44, v21
 v_dot2_f32_bf16 v21, v121, v45, v21
 v_dot2_f32_bf16 v21, v122, v46, v21
 v_dot2_f32_bf16 v21, v123, v47, v21
 v_dot2_f32_bf16 v21, v124, v48, v21
 v_dot2_f32_bf16 v21, v125, v49, v21
 v_dot2_f32_bf16 v21, v126, v50, v21
 v_dot2_f32_bf16 v21, v127, v51, v21
 v_dot2_f32_bf16 v21, v128, v52, v21
 v_dot2_f32_bf16 v21, v129, v53, v21
 v_dot2_f32_bf16 v21, v130, v54, v21
 v_dot2_f32_bf16 v21, v131, v55, v21
 v_dot2_f32_bf16 v21, v132, v56, v21
 v_dot2_f32_bf16 v21, v133, v57, v21
 v_dot2_f32_bf16 v21, v134, v58, v21
 v_dot2_f32_bf16 v21, v135, v59, v21
 s_waitcnt vmcnt(9)
 v_dot2_f32_bf16 v22, v136, v24, 0
 v_dot2_f32_bf16 v22, v137, v25, v22
 v_dot2_f32_bf16 v22, v138, v26, v22
 v_dot2_f32_bf16 v22, v139, v27, v22
 v_dot2_f32_bf16 v22, v140, v28, v22
 v_dot2_f32_bf16 v22, v141, v29, v22
 v_dot2_f32_bf16 v22, v142, v30, v22
 v_dot2_f32_bf16 v22, v143, v31, v22
 v_dot2_f32_bf16 v22, v144, v32, v22
 v_dot2_f32_bf16 v22, v145, v33, v22
 v_dot2_f32_bf16 v22, v146, v34, v22
 v_dot2_f32_bf16 v22, v147, v35, v22
 v_dot2_f32_bf16 v22, v148, v36, v22
 v_dot2_f32_bf16 v22, v149, v37, v22
 v_dot2_f32_bf16 v22, v150, v38, v22
 v_dot2_f32_bf16 v22, v151, v39, v22
 v_dot2_f32_bf16 v22, v152, v40, v22
 v_dot2_f32_bf16 v22, v153, v41, v22
 v_dot2_f32_bf16 v22, v154, v42, v22
 v_dot2_f32_bf16 v22, v155, v43, v22
 v_dot2_f32_bf16 v22, v156, v44, v22
 v_dot2_f32_bf16 v22, v157, v45, v22
 v_dot2_f32_bf16 v22, v158, v46, v22
 v_dot2_f32_bf16 v22, v159, v47, v22
 v_dot2_f32_bf16 v22, v160, v48, v22
 v_dot2_f32_bf16 v22, v161, v49, v22
 v_dot2_f32_bf16 v22, v162, v50, v22
 v_dot2_f32_bf16 v22, v163, v51, v22
 v_dot2_f32_bf16 v22, v164, v52, v22
 v_dot2_f32_bf16 v22, v165, v53, v22
 v_dot2_f32_bf16 v22, v166, v54, v22
 v_dot2_f32_bf16 v22, v167, v55, v22
 v_dot2_f32_bf16 v22, v168, v56, v22
 v_dot2_f32_bf16 v22, v169, v57, v22
 v_dot2_f32_bf16 v22, v170, v58, v22
 v_dot2_f32_bf16 v22, v171, v59, v22
 s_waitcnt vmcnt(0)
 v_dot2_f32_bf16 v23, v172, v24, 0
 v_dot2_f32_bf16 v23, v173, v25, v23
 v_dot2_f32_bf16 v23, v174, v26, v23
 v_dot2_f32_bf16 v23, v175, v27, v23
 v_dot2_f32_bf16 v23, v176, v28, v23
 v_dot2_f32_bf16 v23, v177, v29, v23
 v_dot2_f32_bf16 v23, v178, v30, v23
 v_dot2_f32_bf16 v23, v179, v31, v23
 v_dot2_f32_bf16 v23, v180, v32, v23
 v_dot2_f32_bf16 v23, v181, v33, v23
 v_dot2_f32_bf16 v23, v182, v34, v23
 v_dot2_f32_bf16 v23, v183, v35, v23
 v_dot2_f32_bf16 v23, v184, v36, v23
 v_dot2_f32_bf16 v23, v185, v37, v23
 v_dot2_f32_bf16 v23, v186, v38, v23
 v_dot2_f32_bf16 v23, v187, v39, v23
 v_dot2_f32_bf16 v23, v188, v40, v23
 v_dot2_f32_bf16 v23, v189, v41, v23
 v_dot2_f32_bf16 v23, v190, v42, v23
 v_dot2_f32_bf16 v23, v191, v43, v23
 v_dot2_f32_bf16 v23, v192, v44, v23
 v_dot2_f32_bf16 v23, v193, v45, v23
 v_dot2_f32_bf16 v23, v194, v46, v23
 v_dot2_f32_bf16 v23, v195, v47, v23
 v_dot2_f32_bf16 v23, v196, v48, v23
 v_dot2_f32_bf16 v23, v197, v49, v23
 v_dot2_f32_bf16 v23, v198, v50, v23
 v_dot2_f32_bf16 v23, v199, v51, v23
 v_dot2_f32_bf16 v23, v200, v52, v23
 v_dot2_f32_bf16 v23, v201, v53, v23
 v_dot2_f32_bf16 v23, v202, v54, v23
 v_dot2_f32_bf16 v23, v203, v55, v23
 v_dot2_f32_bf16 v23, v204, v56, v23
 v_dot2_f32_bf16 v23, v205, v57, v23
 v_dot2_f32_bf16 v23, v206, v58, v23
 v_dot2_f32_bf16 v23, v207, v59, v23
 v_add_f32 v8, v8, v8 quad_perm:[1,0,3,2] row_mask:0xf bank_mask:0xf
 v_add_f32 v9, v9, v9 quad_perm:[1,0,3,2] row_mask:0xf bank_mask:0xf
 v_add_f32 v10, v10, v10 quad_perm:[1,0,3,2] row_mask:0xf bank_mask:0xf
 v_add_f32 v11, v11, v11 quad_perm:[1,0,3,2] row_mask:0xf bank_mask:0xf
 v_add_f32 v12, v12, v12 quad_perm:[1,0,3,2] row_mask:0xf bank_mask:0xf
 v_add_f32 v13, v13, v13 quad_perm:[1,0,3,2] row_mask:0xf bank_mask:0xf
 v_add_f32 v14, v14, v14 quad_perm:[1,0,3,2] row_mask:0xf bank_mask:0xf
 v_add_f32 v15, v15, v15 quad_perm:[1,0,3,2] row_mask:0xf bank_mask:0xf
 v_add_f32 v16, v16, v16 quad_perm:[1,0,3,2] row_mask:0xf bank_mask:0xf
 v_add_f32 v17, v17, v17 quad_perm:[1,0,3,2] row_mask:0xf bank_mask:0xf
 v_add_f32 v18, v18, v18 quad_perm:[1,0,3,2] row_mask:0xf bank_mask:0xf
 v_add_f32 v19, v19, v19 quad_perm:[1,0,3,2] row_mask:0xf bank_mask:0xf
 v_add_f32 v20, v20, v20 quad_perm:[1,0,3,2] row_mask:0xf bank_mask:0xf
 v_add_f32 v21, v21, v21 quad_perm:[1,0,3,2] row_mask:0xf bank_mask:0xf
 v_add_f32 v22, v22, v22 quad_perm:[1,0,3,2] row_mask:0xf bank_mask:0xf
 v_add_f32 v23, v23, v23 quad_perm:[1,0,3,2] row_mask:0xf bank_mask:0xf
 v_add_f32 v8, v8, v8 quad_perm:[2,3,0,1] row_mask:0xf bank_mask:0xf
 v_add_f32 v9, v9, v9 quad_perm:[2,3,0,1] row_mask:0xf bank_mask:0xf
 v_add_f32 v10, v10, v10 quad_perm:[2,3,0,1] row_mask:0xf bank_mask:0xf
 v_add_f32 v11, v11, v11 quad_perm:[2,3,0,1] row_mask:0xf bank_mask:0xf
 v_add_f32 v12, v12, v12 quad_perm:[2,3,0,1] row_mask:0xf bank_mask:0xf
 v_add_f32 v13, v13, v13 quad_perm:[2,3,0,1] row_mask:0xf bank_mask:0xf
 v_add_f32 v14, v14, v14 quad_perm:[2,3,0,1] row_mask:0xf bank_mask:0xf
 v_add_f32 v15, v15, v15 quad_perm:[2,3,0,1] row_mask:0xf bank_mask:0xf
 v_add_f32 v16, v16, v16 quad_perm:[2,3,0,1] row_mask:0xf bank_mask:0xf
 v_add_f32 v17, v17, v17 quad_perm:[2,3,0,1] row_mask:0xf bank_mask:0xf
 v_add_f32 v18, v18, v18 quad_perm:[2,3,0,1] row_mask:0xf bank_mask:0xf
 v_add_f32 v19, v19, v19 quad_perm:[2,3,0,1] row_mask:0xf bank_mask:0xf
 v_add_f32 v20, v20, v20 quad_perm:[2,3,0,1] row_mask:0xf bank_mask:0xf
 v_add_f32 v21, v21, v21 quad_perm:[2,3,0,1] row_mask:0xf bank_mask:0xf
 v_add_f32 v22, v22, v22 quad_perm:[2,3,0,1] row_mask:0xf bank_mask:0xf
 v_add_f32 v23, v23, v23 quad_perm:[2,3,0,1] row_mask:0xf bank_mask:0xf
 v_add_f32 v8, v8, v8 row_half_mirror row_mask:0xf bank_mask:0xf
 v_add_f32 v9, v9, v9 row_half_mirror row_mask:0xf bank_mask:0xf
 v_add_f32 v10, v10, v10 row_half_mirror row_mask:0xf bank_mask:0xf
 v_add_f32 v11, v11, v11 row_half_mirror row_mask:0xf bank_mask:0xf
 v_add_f32 v12, v12, v12 row_half_mirror row_mask:0xf bank_mask:0xf
 v_add_f32 v13, v13, v13 row_half_mirror row_mask:0xf bank_mask:0xf
 v_add_f32 v14, v14, v14 row_half_mirror row_mask:0xf bank_mask:0xf
 v_add_f32 v15, v15, v15 row_half_mirror row_mask:0xf bank_mask:0xf
 v_add_f32 v16, v16, v16 row_half_mirror row_mask:0xf bank_mask:0xf
 v_add_f32 v17, v17, v17 row_half_mirror row_mask:0xf bank_mask:0xf
 v_add_f32 v18, v18, v18 row_half_mirror row_mask:0xf bank_mask:0xf
 v_add_f32 v19, v19, v19 row_half_mirror row_mask:0xf bank_mask:0xf
 v_add_f32 v20, v20, v20 row_half_mirror row_mask:0xf bank_mask:0xf
 v_add_f32 v21, v21, v21 row_half_mirror row_mask:0xf bank_mask:0xf
 v_add_f32 v22, v22, v22 row_half_mirror row_mask:0xf bank_mask:0xf
 v_add_f32 v23, v23, v23 row_half_mirror row_mask:0xf bank_mask:0xf
 v_mul_f32 v8, s54, v8
 v_mul_f32 v9, s54, v9
 v_mul_f32 v10, s54, v10
 v_mul_f32 v11, s54, v11
 v_mul_f32 v12, s54, v12
 v_mul_f32 v13, s54, v13
 v_mul_f32 v14, s54, v14
 v_mul_f32 v15, s54, v15
 v_mul_f32 v16, s54, v16
 v_mul_f32 v17, s54, v17
 v_mul_f32 v18, s54, v18
 v_mul_f32 v19, s54, v19
 v_mul_f32 v20, s54, v20
 v_mul_f32 v21, s54, v21
 v_mul_f32 v22, s54, v22
 v_mul_f32 v23, s54, v23
 v_exp_f32 v8, v8
 v_exp_f32 v9, v9
 v_exp_f32 v10, v10
 v_exp_f32 v11, v11
 v_exp_f32 v12, v12
 v_exp_f32 v13, v13
 v_exp_f32 v14, v14
 v_exp_f32 v15, v15
 v_exp_f32 v16, v16
 v_exp_f32 v17, v17
 v_exp_f32 v18, v18
 v_exp_f32 v19, v19
 v_exp_f32 v20, v20
 v_exp_f32 v21, v21
 v_exp_f32 v22, v22
 v_exp_f32 v23, v23
 v_add_f32 v8, 1.0, v8
 v_add_f32 v9, 1.0, v9
 v_add_f32 v10, 1.0, v10
 v_add_f32 v11, 1.0, v11
 v_add_f32 v12, 1.0, v12
 v_add_f32 v13, 1.0, v13
 v_add_f32 v14, 1.0, v14
 v_add_f32 v15, 1.0, v15
 v_add_f32 v16, 1.0, v16
 v_add_f32 v17, 1.0, v17
 v_add_f32 v18, 1.0, v18
 v_add_f32 v19, 1.0, v19
 v_add_f32 v20, 1.0, v20
 v_add_f32 v21, 1.0, v21
 v_add_f32 v22, 1.0, v22
 v_add_f32 v23, 1.0, v23
 v_rcp_f32 v8, v8
 v_rcp_f32 v9, v9
 v_rcp_f32 v10, v10
 v_rcp_f32 v11, v11
 v_rcp_f32 v12, v12
 v_rcp_f32 v13, v13
 v_rcp_f32 v14, v14
 v_rcp_f32 v15, v15
 v_rcp_f32 v16, v16
 v_rcp_f32 v17, v17
 v_rcp_f32 v18, v18
 v_rcp_f32 v19, v19
 v_rcp_f32 v20, v20
 v_rcp_f32 v21, v21
 v_rcp_f32 v22, v22
 v_rcp_f32 v23, v23
 buffer_store_dword v8, v5, s[16:19], s26 offen sc1
 buffer_store_dword v9, v5, s[16:19], s26 offen offset:32 sc1
 buffer_store_dword v10, v5, s[16:19], s26 offen offset:64 sc1
 buffer_store_dword v11, v5, s[16:19], s26 offen offset:96 sc1
 buffer_store_dword v12, v5, s[16:19], s26 offen offset:128 sc1
 buffer_store_dword v13, v5, s[16:19], s26 offen offset:160 sc1
 buffer_store_dword v14, v5, s[16:19], s26 offen offset:192 sc1
 buffer_store_dword v15, v5, s[16:19], s26 offen offset:224 sc1
 buffer_store_dword v16, v5, s[16:19], s26 offen offset:256 sc1
 buffer_store_dword v17, v5, s[16:19], s26 offen offset:288 sc1
 buffer_store_dword v18, v5, s[16:19], s26 offen offset:320 sc1
 buffer_store_dword v19, v5, s[16:19], s26 offen offset:352 sc1
 buffer_store_dword v20, v5, s[16:19], s26 offen offset:384 sc1
 buffer_store_dword v21, v5, s[16:19], s26 offen offset:416 sc1
 buffer_store_dword v22, v5, s[16:19], s26 offen offset:448 sc1
 buffer_store_dword v23, v5, s[16:19], s26 offen offset:480 sc1
 s_sub_u32 s59, s2, 252
 s_lshl_b32 s59, s59, 7
 s_add_u32 s59, s59, s24
 s_add_u32 s59, s59, 40960012
 s_waitcnt vmcnt(0)
 s_and_b32 s3, s2, 7
 s_lshr_b32 s49, s3, 1
 s_and_b32 s3, s3, 1
 s_lshl_b32 s3, s3, 3
 s_lshr_b32 s80, s2, 5
 s_add_u32 s80, s80, s3
 s_lshr_b32 s3, s2, 3
 s_and_b32 s60, s3, 3
 s_lshl_b32 s61, s80, 2
 s_add_u32 s61, s61, s60
 s_sub_u32 s81, s80, 11
 s_lshl_b32 s81, s81, 1
 s_mul_i32 s28, s24, 11
 s_add_u32 s28, s28, s80
 s_lshr_b32 s3, s24, 1
 s_mul_i32 s3, s3, 10
 s_and_b32 s82, s24, 1
 s_add_u32 s3, s3, s82
 s_add_u32 s3, s3, s81
 s_add_u32 s3, s3, 44
 s_cmp_lt_u32 s80, 11
 s_cselect_b32 s28, s28, s3
 s_mul_i32 s39, s49, 11
 s_add_u32 s39, s39, s80
 s_lshr_b32 s3, s49, 1
 s_mul_i32 s3, s3, 10
 s_and_b32 s82, s49, 1
 s_add_u32 s3, s3, s82
 s_add_u32 s3, s3, s81
 s_add_u32 s3, s3, 44
 s_cmp_lt_u32 s80, 11
 s_cselect_b32 s39, s39, s3
 s_lshr_b32 s3, s24, 1
 s_add_u32 s3, s3, 4
 s_cmp_lt_u32 s80, 11
 s_cselect_b32 s29, s24, s3
 s_cselect_b32 s81, s80, s81
 s_cselect_b32 s82, 8, 6
 s_cmp_ge_u32 s81, 4
 s_cselect_b32 s62, 1, 0
 s_cselect_b32 s63, 0, 2
 s_cselect_b32 s83, 2, 1
 s_cmp_ge_u32 s81, s82
 s_cselect_b32 s62, 2, s62
 s_cselect_b32 s63, 1, s63
 s_cselect_b32 s83, 0, s83
 s_mul_i32 s56, s24, 9216
 s_mul_i32 s55, s24, 49152
 s_add_u32 s55, s55, 36864
 s_min_u32 s55, s55, 144384
 s_mul_i32 s3, s49, 36
 s_add_u32 s86, s3, s24
 s_mul_i32 s86, s86, 36864
 s_mul_i32 s81, s60, 9216
 s_add_u32 s86, s86, s81
 s_add_u32 s86, s86, 20971520
 s_mul_i32 s87, s28, 294912
 s_lshl_b32 s3, s3, 10
 s_add_u32 s87, s87, s3
 s_add_u32 s87, s87, 1048576
 s_lshl_b32 s80, s61, 11
 s_add_u32 s80, s80, 41025536
 s_lshl_b32 s74, s24, 9
 s_add_u32 s74, s74, s80
 s_lshl_b32 s3, s49, 7
 s_add_u32 s74, s74, s3
 s_lshl_b32 s75, s49, 9
 s_add_u32 s75, s75, s80
 s_mul_i32 s81, s60, 9216
 s_lshl_b32 s77, s49, 6
 s_add_u32 s77, s77, s28
 s_mul_i32 s77, s77, 36864
 s_add_u32 s77, s77, s81
 s_add_u32 s77, s77, 30408704
 s_cmp_eq_u32 s24, s49
 s_cselect_b32 s77, 1073741824, s77
 s_cselect_b32 s74, 1073741824, s74
 s_mul_i32 s80, s39, 36864
 s_mul_i32 s76, s60, 288
 s_add_u32 s76, s76, s80
 s_add_u32 s80, s80, s81
 s_add_u32 s72, s80, 27262976
 s_add_u32 s80, s80, 30408704
 s_lshl_b32 s73, s39, 7
 s_add_u32 s73, s73, 40894464
 s_lshl_b32 s61, s60, 2
 s_lshr_b32 s3, s39, 4
 s_add_u32 s61, s61, s3
 s_lshl_b32 s61, s61, 7
 s_lshl_b32 s60, s49, 2
 s_add_u32 s60, s60, s24
 s_lshl_b32 s60, s60, 8
 s_mul_i32 s81, s49, 18
 s_add_u32 s81, s81, s29
 s_add_u32 s3, s49, 1
 s_and_b32 s3, s3, 3
 s_mul_i32 s3, s3, 2359296
 s_add_u32 s78, s80, s3
 s_mul_i32 s3, s62, 6
 s_add_u32 s3, s3, s81
 s_lshl_b32 s28, s3, 8
 s_add_u32 s3, s49, 2
 s_and_b32 s3, s3, 3
 s_mul_i32 s3, s3, 2359296
 s_add_u32 s79, s80, s3
 s_mul_i32 s3, s63, 6
 s_add_u32 s3, s3, s81
 s_lshl_b32 s29, s3, 8
 s_add_u32 s3, s49, 3
 s_and_b32 s3, s3, 3
 s_mul_i32 s3, s3, 2359296
 s_add_u32 s0, s80, s3
 s_mul_i32 s3, s83, 6
 s_add_u32 s3, s3, s81
 s_lshl_b32 s39, s3, 8
 s_add_u32 s88, s88, 40960000
 s_addc_u32 s89, s89, 0
 v_lshlrev_b32 v24, 4, v0
 v_add_u32 v5, 4096, v24
 v_add_u32 v6, 8192, v24
 v_add_u32 v7, 147456, v24
 v_add_u32 v8, 126976, v24
 v_add_u32 v9, 90112, v24
 v_add_u32 v13, 53248, v24
 v_add_u32 v25, 0, v24
 v_mov_b32 v1, 0
 v_mov_b32 v2, 1
 v_and_b32 v1, 3, v0
 v_lshlrev_b32 v1, 9, v1
 v_and_b32 v10, 15, v0
 v_min_u32 v11, 8, v10
 v_min_u32 v10, 2, v10
 v_add_u32 v11, s60, v11
 v_add_u32 v12, s28, v10
 v_add_u32 v10, s29, v10
 v_add_u32 v11, 4224, v11
 v_add_u32 v12, 8320, v12
 v_add_u32 v10, 26752, v10
 s_movk_i32 s30, 4096
 s_mov_b32 s31, 147456
 v_cmp_gt_u32 vcc, 16, v0
 s_nop 1
 v_cndmask_b32 v12, v12, v11, vcc
 v_lshlrev_b32 v19, 3, v0
 v_mov_b32 v23, v19
 v_mov_b32 v26, 0
 s_mov_b32 s54, 0
 s_mov_b32 s26, 1073741824
 s_branch Lsp_xi
Lrt_xi:
 buffer_store_byte v2, v1, s[16:19], s59 offen sc1
 s_mov_b32 s3, 0x100000
Lsl_hx:
 s_sleep 24
 global_load_ubyte v4, v12, s[88:89] sc1
 s_waitcnt vmcnt(0)
 s_sub_u32 s3, s3, 1
 s_cbranch_scc1 Lrt_hx
 v_cmp_eq_u32 vcc, 0, v4
 s_nop 4
 s_cbranch_vccnz Lsl_hx
Lrt_hx:
 s_mul_i32 s84, s62, 442368
 s_add_u32 s84, s84, s86
 s_add_u32 m0, s56, 126976
 s_nop 0
 buffer_load_dwordx4 v24, s[16:19], s84 offen sc1 lds
 buffer_load_dwordx4 v24, s[16:19], s84 offen offset:1024 sc1 lds
 buffer_load_dwordx4 v24, s[16:19], s84 offen offset:2048 sc1 lds
 buffer_load_dwordx4 v24, s[16:19], s84 offen offset:3072 sc1 lds
 s_add_u32 m0, m0, s30
 s_nop 0
 buffer_load_dwordx4 v5, s[16:19], s84 offen sc1 lds
 buffer_load_dwordx4 v5, s[16:19], s84 offen offset:1024 sc1 lds
 buffer_load_dwordx4 v5, s[16:19], s84 offen offset:2048 sc1 lds
 buffer_load_dwordx4 v5, s[16:19], s84 offen offset:3072 sc1 lds
 s_add_u32 m0, m0, s30
 s_nop 0
 buffer_load_dwordx4 v6, s[16:19], s84 offen sc1 lds
 s_mul_i32 s85, s62, 12288
 s_add_u32 s85, s85, s87
 buffer_load_dwordx4 v[160:163], v24, s[16:19], s85 offen sc1
 buffer_load_dwordx4 v[164:167], v7, s[16:19], s85 offen sc1
 buffer_load_dwordx4 v[168:171], v24, s[16:19], s85 offen offset:1024 sc1
 buffer_load_dwordx4 v[172:175], v7, s[16:19], s85 offen offset:1024 sc1
 buffer_load_dwordx4 v[176:179], v24, s[16:19], s85 offen offset:2048 sc1
 buffer_load_dwordx4 v[180:183], v7, s[16:19], s85 offen offset:2048 sc1
 buffer_load_dwordx4 v[184:187], v24, s[16:19], s85 offen offset:3072 sc1
 buffer_load_dwordx4 v[188:191], v7, s[16:19], s85 offen offset:3072 sc1
 s_add_u32 s84, s84, s31
 s_add_u32 m0, s56, 90112
 s_nop 0
 buffer_load_dwordx4 v24, s[16:19], s84 offen sc1 lds
 buffer_load_dwordx4 v24, s[16:19], s84 offen offset:1024 sc1 lds
 buffer_load_dwordx4 v24, s[16:19], s84 offen offset:2048 sc1 lds
 buffer_load_dwordx4 v24, s[16:19], s84 offen offset:3072 sc1 lds
 s_add_u32 m0, m0, s30
 s_nop 0
 buffer_load_dwordx4 v5, s[16:19], s84 offen sc1 lds
 buffer_load_dwordx4 v5, s[16:19], s84 offen offset:1024 sc1 lds
 buffer_load_dwordx4 v5, s[16:19], s84 offen offset:2048 sc1 lds
 buffer_load_dwordx4 v5, s[16:19], s84 offen offset:3072 sc1 lds
 s_add_u32 m0, m0, s30
 s_nop 0
 buffer_load_dwordx4 v6, s[16:19], s84 offen sc1 lds
 s_add_u32 s85, s85, s30
 buffer_load_dwordx4 a[128:131], v24, s[16:19], s85 offen sc1
 buffer_load_dwordx4 a[132:135], v7, s[16:19], s85 offen sc1
 buffer_load_dwordx4 a[136:139], v24, s[16:19], s85 offen offset:1024 sc1
 buffer_load_dwordx4 a[140:143], v7, s[16:19], s85 offen offset:1024 sc1
 buffer_load_dwordx4 a[144:147], v24, s[16:19], s85 offen offset:2048 sc1
 buffer_load_dwordx4 a[148:151], v7, s[16:19], s85 offen offset:2048 sc1
 buffer_load_dwordx4 a[152:155], v24, s[16:19], s85 offen offset:3072 sc1
 buffer_load_dwordx4 a[156:159], v7, s[16:19], s85 offen offset:3072 sc1
 s_add_u32 s85, s85, s30
 buffer_load_dwordx4 a[160:163], v24, s[16:19], s85 offen sc1
 buffer_load_dwordx4 a[164:167], v7, s[16:19], s85 offen sc1
 buffer_load_dwordx4 a[168:171], v24, s[16:19], s85 offen offset:1024 sc1
 buffer_load_dwordx4 a[172:175], v7, s[16:19], s85 offen offset:1024 sc1
 buffer_load_dwordx4 a[176:179], v24, s[16:19], s85 offen offset:2048 sc1
 buffer_load_dwordx4 a[180:183], v7, s[16:19], s85 offen offset:2048 sc1
 buffer_load_dwordx4 a[184:187], v24, s[16:19], s85 offen offset:3072 sc1
 buffer_load_dwordx4 a[188:191], v7, s[16:19], s85 offen offset:3072 sc1
Lgwarm:
 s_mov_b64 vcc, -1
 s_cmp_lg_u32 s24, 0
 s_cbranch_scc1 Lhg0
 s_call_b64 s[22:23], Lpg20
 s_branch Lhge
Lhg0:
 s_cmp_lg_u32 s24, 1
 s_cbranch_scc1 Lhg1
 s_call_b64 s[22:23], Lpg21
 s_branch Lhge
Lhg1:
 s_cmp_lg_u32 s24, 2
 s_cbranch_scc1 Lhg2
 s_call_b64 s[22:23], Lpg18
 s_branch Lhge
Lhg2:
 s_call_b64 s[22:23], Lpg19
Lhge:
 s_mov_b32 s3, 0x100000
Lsl_hy:
 s_sleep 8
 global_load_ubyte v4, v10, s[88:89] sc1
 s_waitcnt vmcnt(0)
 s_sub_u32 s3, s3, 1
 s_cbranch_scc1 Lrt_hy
 v_cmp_eq_u32 vcc, 0, v4
 s_nop 4
 s_cbranch_vccnz Lsl_hy
Lrt_hy:
 s_mov_b64 vcc, 0
 s_mov_b32 s64, 0x10101
 s_branch Lhelp2
Lsp_g11i:
 s_mov_b32 s3, 0x100000
 v_min_u32 v3, 3, v0
 v_add_u32 v3, 0, v3
 v_add_u32 v3, 0, v3
Lsl0_g11i:
 global_load_ubyte v4, v3, s[6:7] sc1
 s_sub_u32 s3, s3, 1
 s_cbranch_scc1 Lsx_g11i
 s_waitcnt vmcnt(0)
 v_cmp_eq_u32 vcc, 0, v4
 s_nop 4
 s_cbranch_vccz Lsn0_g11i
 s_sleep 4
 s_branch Lsl0_g11i
Lsn0_g11i:
Lsx_g11i:
 s_waitcnt vmcnt(0)
 s_mov_b64 vcc, 0
 s_branch Lrt_g11i
Lsp_g11w:
 s_mov_b32 s3, 0x100000
 v_min_u32 v3, 8, v0
 v_add_u32 v3, s60, v3
 v_add_u32 v3, 4096, v3
Lsl0_g11w:
 global_load_ubyte v4, v3, s[88:89] sc1
 s_sub_u32 s3, s3, 1
 s_cbranch_scc1 Lsx_g11w
 s_waitcnt vmcnt(0)
 v_cmp_eq_u32 vcc, 0, v4
 s_nop 4
 s_cbranch_vccz Lsn0_g11w
 s_sleep 4
 s_branch Lsl0_g11w
Lsn0_g11w:
Lsx_g11w:
 s_waitcnt vmcnt(0)
 s_mov_b64 vcc, 0
 s_branch Lrt_g11w
Lsp_g11p0:
 s_mov_b32 s3, 0x100000
 v_min_u32 v3, 2, v0
 v_add_u32 v3, s28, v3
 v_add_u32 v3, 8192, v3
Lsl0_g11p0:
 global_load_ubyte v4, v3, s[88:89] sc1
 s_sub_u32 s3, s3, 1
 s_cbranch_scc1 Lsx_g11p0
 s_waitcnt vmcnt(0)
 v_cmp_eq_u32 vcc, 0, v4
 s_nop 4
 s_cbranch_vccz Lsn0_g11p0
 s_sleep 4
 s_branch Lsl0_g11p0
Lsn0_g11p0:
Lsx_g11p0:
 s_waitcnt vmcnt(0)
 s_mov_b64 vcc, 0
 s_branch Lrt_g11p0
Lsp_g11p1:
 s_mov_b32 s3, 0x100000
 v_min_u32 v3, 2, v0
 v_add_u32 v3, s29, v3
 v_add_u32 v3, 26624, v3
Lsl0_g11p1:
 global_load_ubyte v4, v3, s[88:89] sc1
 s_sub_u32 s3, s3, 1
 s_cbranch_scc1 Lsx_g11p1
 s_waitcnt vmcnt(0)
 v_cmp_eq_u32 vcc, 0, v4
 s_nop 4
 s_cbranch_vccz Lsn0_g11p1
 s_sleep 4
 s_branch Lsl0_g11p1
Lsn0_g11p1:
Lsx_g11p1:
 s_waitcnt vmcnt(0)
 s_mov_b64 vcc, 0
 s_branch Lrt_g11p1
Lsp_g11p2:
 s_mov_b32 s3, 0x100000
 v_min_u32 v3, 2, v0
 v_add_u32 v3, s39, v3
 v_add_u32 v3, 45056, v3
Lsl0_g11p2:
 global_load_ubyte v4, v3, s[88:89] sc1
 s_sub_u32 s3, s3, 1
 s_cbranch_scc1 Lsx_g11p2
 s_waitcnt vmcnt(0)
 v_cmp_eq_u32 vcc, 0, v4
 s_nop 4
 s_cbranch_vccz Lsn0_g11p2
 s_sleep 4
 s_branch Lsl0_g11p2
Lsn0_g11p2:
Lsx_g11p2:
 s_waitcnt vmcnt(0)
 s_mov_b64 vcc, 0
 s_branch Lrt_g11p2
Lsp_g11a:
 s_mov_b32 s3, 0x100000
 v_min_u32 v3, 8, v0
 v_add_u32 v3, s61, v3
 v_add_u32 v3, 0, v3
Lsl0_g11a:
 global_load_ubyte v4, v3, s[88:89] sc1
 s_sub_u32 s3, s3, 1
 s_cbranch_scc1 Lsx_g11a
 s_waitcnt vmcnt(0)
 v_cmp_eq_u32 vcc, 0, v4
 s_nop 4
 s_cbranch_vccz Lsn0_g11a
 s_sleep 4
 s_branch Lsl0_g11a
Lsn0_g11a:
 v_min_u32 v3, 3, v0
 v_add_u32 v3, s61, v3
 v_add_u32 v3, 12, v3
Lsl1_g11a:
 global_load_ubyte v4, v3, s[88:89] sc1
 s_sub_u32 s3, s3, 1
 s_cbranch_scc1 Lsx_g11a
 s_waitcnt vmcnt(0)
 v_cmp_eq_u32 vcc, 0, v4
 s_nop 4
 s_cbranch_vccz Lsn1_g11a
 s_sleep 4
 s_branch Lsl1_g11a
Lsn1_g11a:
Lsx_g11a:
 s_waitcnt vmcnt(0)
 s_mov_b64 vcc, 0
 s_branch Lrt_g11a
Lsp_g10i:
 s_mov_b32 s3, 0x100000
 v_min_u32 v3, 3, v0
 v_add_u32 v3, 0, v3
 v_add_u32 v3, 0, v3
Lsl0_g10i:
 global_load_ubyte v4, v3, s[6:7] sc1
 s_sub_u32 s3, s3, 1
 s_cbranch_scc1 Lsx_g10i
 s_waitcnt vmcnt(0)
 v_cmp_eq_u32 vcc, 0, v4
 s_nop 4
 s_cbranch_vccz Lsn0_g10i
 s_sleep 4
 s_branch Lsl0_g10i
Lsn0_g10i:
Lsx_g10i:
 s_waitcnt vmcnt(0)
 s_mov_b64 vcc, 0
 s_branch Lrt_g10i
Lsp_g10w:
 s_mov_b32 s3, 0x100000
 v_min_u32 v3, 8, v0
 v_add_u32 v3, s60, v3
 v_add_u32 v3, 4224, v3
Lsl0_g10w:
 global_load_ubyte v4, v3, s[88:89] sc1
 s_sub_u32 s3, s3, 1
 s_cbranch_scc1 Lsx_g10w
 s_waitcnt vmcnt(0)
 v_cmp_eq_u32 vcc, 0, v4
 s_nop 4
 s_cbranch_vccz Lsn0_g10w
 s_sleep 4
 s_branch Lsl0_g10w
Lsn0_g10w:
Lsx_g10w:
 s_waitcnt vmcnt(0)
 s_mov_b64 vcc, 0
 s_branch Lrt_g10w
Lsp_g10p0:
 s_mov_b32 s3, 0x100000
 v_min_u32 v3, 2, v0
 v_add_u32 v3, s28, v3
 v_add_u32 v3, 8320, v3
Lsl0_g10p0:
 global_load_ubyte v4, v3, s[88:89] sc1
 s_sub_u32 s3, s3, 1
 s_cbranch_scc1 Lsx_g10p0
 s_waitcnt vmcnt(0)
 v_cmp_eq_u32 vcc, 0, v4
 s_nop 4
 s_cbranch_vccz Lsn0_g10p0
 s_sleep 4
 s_branch Lsl0_g10p0
Lsn0_g10p0:
Lsx_g10p0:
 s_waitcnt vmcnt(0)
 s_mov_b64 vcc, 0
 s_branch Lrt_g10p0
Lsp_g10p1:
 s_mov_b32 s3, 0x100000
 v_min_u32 v3, 2, v0
 v_add_u32 v3, s29, v3
 v_add_u32 v3, 26752, v3
Lsl0_g10p1:
 global_load_ubyte v4, v3, s[88:89] sc1
 s_sub_u32 s3, s3, 1
 s_cbranch_scc1 Lsx_g10p1
 s_waitcnt vmcnt(0)
 v_cmp_eq_u32 vcc, 0, v4
 s_nop 4
 s_cbranch_vccz Lsn0_g10p1
 s_sleep 4
 s_branch Lsl0_g10p1
Lsn0_g10p1:
Lsx_g10p1:
 s_waitcnt vmcnt(0)
 s_mov_b64 vcc, 0
 s_branch Lrt_g10p1
Lsp_g10p2:
 s_mov_b32 s3, 0x100000
 v_min_u32 v3, 2, v0
 v_add_u32 v3, s39, v3
 v_add_u32 v3, 45184, v3
Lsl0_g10p2:
 global_load_ubyte v4, v3, s[88:89] sc1
 s_sub_u32 s3, s3, 1
 s_cbranch_scc1 Lsx_g10p2
 s_waitcnt vmcnt(0)
 v_cmp_eq_u32 vcc, 0, v4
 s_nop 4
 s_cbranch_vccz Lsn0_g10p2
 s_sleep 4
 s_branch Lsl0_g10p2
Lsn0_g10p2:
Lsx_g10p2:
 s_waitcnt vmcnt(0)
 s_mov_b64 vcc, 0
 s_branch Lrt_g10p2
Lsp_g10a:
 s_mov_b32 s3, 0x100000
 v_min_u32 v3, 8, v0
 v_add_u32 v3, s61, v3
 v_add_u32 v3, 0, v3
Lsl0_g10a:
 global_load_ubyte v4, v3, s[88:89] sc1
 s_sub_u32 s3, s3, 1
 s_cbranch_scc1 Lsx_g10a
 s_waitcnt vmcnt(0)
 v_cmp_eq_u32 vcc, 0, v4
 s_nop 4
 s_cbranch_vccz Lsn0_g10a
 s_sleep 4
 s_branch Lsl0_g10a
Lsn0_g10a:
 v_min_u32 v3, 3, v0
 v_add_u32 v3, s61, v3
 v_add_u32 v3, 12, v3
Lsl1_g10a:
 global_load_ubyte v4, v3, s[88:89] sc1
 s_sub_u32 s3, s3, 1
 s_cbranch_scc1 Lsx_g10a
 s_waitcnt vmcnt(0)
 v_cmp_eq_u32 vcc, 0, v4
 s_nop 4
 s_cbranch_vccz Lsn1_g10a
 s_sleep 4
 s_branch Lsl1_g10a
Lsn1_g10a:
Lsx_g10a:
 s_waitcnt vmcnt(0)
 s_mov_b64 vcc, 0
 s_branch Lrt_g10a
Lsp_hi:
 s_mov_b32 s3, 0x100000
 v_min_u32 v3, 3, v0
 v_add_u32 v3, 0, v3
 v_add_u32 v3, 0, v3
Lsl0_hi:
 global_load_ubyte v4, v3, s[6:7] sc1
 s_sub_u32 s3, s3, 1
 s_cbranch_scc1 Lsx_hi
 s_waitcnt vmcnt(0)
 v_cmp_eq_u32 vcc, 0, v4
 s_nop 4
 s_cbranch_vccz Lsn0_hi
 s_sleep 4
 s_branch Lsl0_hi
Lsn0_hi:
Lsx_hi:
 s_waitcnt vmcnt(0)
 s_mov_b64 vcc, 0
 s_branch Lrt_hi
Lsp_hw:
 s_mov_b32 s3, 0x100000
 v_min_u32 v3, 8, v0
 v_add_u32 v3, s60, v3
 v_add_u32 v3, 4224, v3
Lsl0_hw:
 global_load_ubyte v4, v3, s[88:89] sc1
 s_sub_u32 s3, s3, 1
 s_cbranch_scc1 Lsx_hw
 s_waitcnt vmcnt(0)
 v_cmp_eq_u32 vcc, 0, v4
 s_nop 4
 s_cbranch_vccz Lsn0_hw
 s_sleep 4
 s_branch Lsl0_hw
Lsn0_hw:
Lsx_hw:
 s_waitcnt vmcnt(0)
 s_mov_b64 vcc, 0
 s_branch Lrt_hw
Lsp_hp0:
 s_mov_b32 s3, 0x100000
 v_min_u32 v3, 2, v0
 v_add_u32 v3, s28, v3
 v_add_u32 v3, 8320, v3
Lsl0_hp0:
 global_load_ubyte v4, v3, s[88:89] sc1
 s_sub_u32 s3, s3, 1
 s_cbranch_scc1 Lsx_hp0
 s_waitcnt vmcnt(0)
 v_cmp_eq_u32 vcc, 0, v4
 s_nop 4
 s_cbranch_vccz Lsn0_hp0
 s_sleep 4
 s_branch Lsl0_hp0
Lsn0_hp0:
Lsx_hp0:
 s_waitcnt vmcnt(0)
 s_mov_b64 vcc, 0
 s_branch Lrt_hp0
Lsp_hp1:
 s_mov_b32 s3, 0x100000
 v_min_u32 v3, 2, v0
 v_add_u32 v3, s29, v3
 v_add_u32 v3, 26752, v3
Lsl0_hp1:
 global_load_ubyte v4, v3, s[88:89] sc1
 s_sub_u32 s3, s3, 1
 s_cbranch_scc1 Lsx_hp1
 s_waitcnt vmcnt(0)
 v_cmp_eq_u32 vcc, 0, v4
 s_nop 4
 s_cbranch_vccz Lsn0_hp1
 s_sleep 4
 s_branch Lsl0_hp1
Lsn0_hp1:
Lsx_hp1:
 s_waitcnt vmcnt(0)
 s_mov_b64 vcc, 0
 s_branch Lrt_hp1
Lsp_hp2:
 s_mov_b32 s3, 0x100000
 v_min_u32 v3, 2, v0
 v_add_u32 v3, s39, v3
 v_add_u32 v3, 45184, v3
Lsl0_hp2:
 global_load_ubyte v4, v3, s[88:89] sc1
 s_sub_u32 s3, s3, 1
 s_cbranch_scc1 Lsx_hp2
 s_waitcnt vmcnt(0)
 v_cmp_eq_u32 vcc, 0, v4
 s_nop 4
 s_cbranch_vccz Lsn0_hp2
 s_sleep 4
 s_branch Lsl0_hp2
Lsn0_hp2:
Lsx_hp2:
 s_waitcnt vmcnt(0)
 s_mov_b64 vcc, 0
 s_branch Lrt_hp2
Lsp_ha:
 s_mov_b32 s3, 0x100000
 v_min_u32 v3, 8, v0
 v_add_u32 v3, s61, v3
 v_add_u32 v3, 0, v3
Lsl0_ha:
 global_load_ubyte v4, v3, s[88:89] sc1
 s_sub_u32 s3, s3, 1
 s_cbranch_scc1 Lsx_ha
 s_waitcnt vmcnt(0)
 v_cmp_eq_u32 vcc, 0, v4
 s_nop 4
 s_cbranch_vccz Lsn0_ha
 s_sleep 4
 s_branch Lsl0_ha
Lsn0_ha:
 v_min_u32 v3, 3, v0
 v_add_u32 v3, s61, v3
 v_add_u32 v3, 12, v3
Lsl1_ha:
 global_load_ubyte v4, v3, s[88:89] sc1
 s_sub_u32 s3, s3, 1
 s_cbranch_scc1 Lsx_ha
 s_waitcnt vmcnt(0)
 v_cmp_eq_u32 vcc, 0, v4
 s_nop 4
 s_cbranch_vccz Lsn1_ha
 s_sleep 4
 s_branch Lsl1_ha
Lsn1_ha:
Lsx_ha:
 s_waitcnt vmcnt(0)
 s_mov_b64 vcc, 0
 s_branch Lrt_ha
Lsp_xi:
 s_mov_b32 s3, 0x100000
 v_min_u32 v3, 3, v0
 v_add_u32 v3, 0, v3
 v_add_u32 v3, 0, v3
Lsl0_xi:
 global_load_ubyte v4, v3, s[6:7] sc1
 s_sub_u32 s3, s3, 1
 s_cbranch_scc1 Lsx_xi
 s_waitcnt vmcnt(0)
 v_cmp_eq_u32 vcc, 0, v4
 s_nop 4
 s_cbranch_vccz Lsn0_xi
 s_sleep 4
 s_branch Lsl0_xi
Lsn0_xi:
Lsx_xi:
 s_waitcnt vmcnt(0)
 s_mov_b64 vcc, 0
 s_branch Lrt_xi
L1_end:
 s_endpgm
L_text_end:
.p2align 7
.type L_table,@object
L_table:
.long 1536,0,3072,0,0,40960000,0,1536,20999168,2818048,27511808,40895232,1073741824,41080832,222048,1073741824,1,0,2,33016832,35376128,37735424,0,0
.long 1792,256,3328,0,9216,40960128,256,1536,21036032,6062080,27511808,40895232,41081344,41080832,222048,31063040,1,0,2,33016832,35376128,37735424,0,0
.long 2048,512,3584,0,18432,40960256,512,1536,21072896,9306112,27511808,40895232,41081856,41080832,222048,31468544,1,0,2,33016832,35376128,37735424,0,0
.long 2304,768,3840,0,27648,40960384,768,1536,21109760,12550144,27511808,40895232,41082368,41080832,222048,31874048,1,0,2,33016832,35376128,37735424,0,0
.long 4096,2560,1024,0,0,40960004,0,1920,20999168,15794176,29133824,40900864,1073741824,41146368,1844064,1073741824,2,1,0,34638848,36998144,39357440,0,0
.long 4096,2560,1024,0,9216,40960132,256,1920,21036032,16089088,29133824,40900864,41146880,41146368,1844064,32316416,2,1,0,34638848,36998144,39357440,0,0
.long 4352,2816,1280,0,18432,40960260,512,1920,21072896,18743296,29133824,40900864,41147392,41146368,1844064,32648192,2,1,0,34638848,36998144,39357440,0,0
.long 4352,2816,1280,0,27648,40960388,768,1920,21109760,19038208,29133824,40900864,41147904,41146368,1844064,32685056,2,1,0,34638848,36998144,39357440,0,0
.long 6144,4608,7680,1,0,40960008,1024,1664,22326272,2854912,27917312,40896640,41080960,41081344,627552,33016832,1,0,2,35781632,38140928,31063040,0,0
.long 6400,4864,7936,1,9216,40960136,1280,1664,22363136,6098944,27917312,40896640,1073741824,41081344,627552,1073741824,1,0,2,35781632,38140928,31063040,0,0
.long 6656,5120,8192,1,18432,40960264,1536,1664,22400000,9342976,27917312,40896640,41081984,41081344,627552,33827840,1,0,2,35781632,38140928,31063040,0,0
.long 6912,5376,8448,1,27648,40960392,1792,1664,22436864,12587008,27917312,40896640,41082496,41081344,627552,34233344,1,0,2,35781632,38140928,31063040,0,0
.long 8704,7168,5632,1,0,40960515,1024,1920,22326272,15831040,29170688,40900992,41146496,41146880,1880928,34638848,2,1,0,37035008,39394304,32316416,0,0
.long 8704,7168,5632,1,9216,40960643,1280,1920,22363136,16125952,29170688,40900992,1073741824,41146880,1880928,1073741824,2,1,0,37035008,39394304,32316416,0,0
.long 8960,7424,5888,1,18432,40960771,1536,1920,22400000,18780160,29170688,40900992,41147520,41146880,1880928,35007488,2,1,0,37035008,39394304,32316416,0,0
.long 8960,7424,5888,1,27648,40960899,1792,1920,22436864,19075072,29170688,40900992,41148032,41146880,1880928,35044352,2,1,0,37035008,39394304,32316416,0,0
.long 10752,9216,12288,2,0,40960519,2048,1664,23653376,2891776,28322816,40898048,41081088,41081856,1033056,35376128,1,0,2,38546432,31468544,33827840,0,0
.long 11008,9472,12544,2,9216,40960647,2304,1664,23690240,6135808,28322816,40898048,41081600,41081856,1033056,35781632,1,0,2,38546432,31468544,33827840,0,0
.long 11264,9728,12800,2,18432,40960775,2560,1664,23727104,9379840,28322816,40898048,1073741824,41081856,1033056,1073741824,1,0,2,38546432,31468544,33827840,0,0
.long 11520,9984,13056,2,27648,40960903,2816,1664,23763968,12623872,28322816,40898048,41082624,41081856,1033056,36592640,1,0,2,38546432,31468544,33827840,0,0
.long 13312,11776,10240,2,0,40961026,2048,1920,23653376,15867904,29502464,40902144,41146624,41147392,2212704,36998144,2,1,0,39726080,32648192,35007488,0,0
.long 13312,11776,10240,2,9216,40961154,2304,1920,23690240,16162816,29502464,40902144,41147136,41147392,2212704,37035008,2,1,0,39726080,32648192,35007488,0,0
.long 13568,12032,10496,2,18432,40961282,2560,1920,23727104,18817024,29502464,40902144,1073741824,41147392,2212704,1073741824,2,1,0,39726080,32648192,35007488,0,0
.long 13568,12032,10496,2,27648,40961410,2816,1920,23763968,19111936,29502464,40902144,41148160,41147392,2212704,37403648,2,1,0,39726080,32648192,35007488,0,0
.long 15360,13824,16896,3,0,40961030,3072,1792,24980480,2928640,28728320,40899456,41081216,41082368,1438560,37735424,1,0,2,31874048,34233344,36592640,0,0
.long 15616,14080,17152,3,9216,40961158,3328,1792,25017344,6172672,28728320,40899456,41081728,41082368,1438560,38140928,1,0,2,31874048,34233344,36592640,0,0
.long 15872,14336,17408,3,18432,40961286,3584,1792,25054208,9416704,28728320,40899456,41082240,41082368,1438560,38546432,1,0,2,31874048,34233344,36592640,0,0
.long 16128,14592,17664,3,27648,40961414,3840,1792,25091072,12660736,28728320,40899456,1073741824,41082368,1438560,1073741824,1,0,2,31874048,34233344,36592640,0,0
.long 17920,16384,14848,3,0,40961537,3072,1920,24980480,15904768,29539328,40902272,41146752,41147904,2249568,39357440,2,1,0,32685056,35044352,37403648,0,0
.long 17920,16384,14848,3,9216,40961665,3328,1920,25017344,16199680,29539328,40902272,41147264,41147904,2249568,39394304,2,1,0,32685056,35044352,37403648,0,0
.long 18176,16640,15104,3,18432,40961793,3584,1920,25054208,18853888,29539328,40902272,41147776,41147904,2249568,39726080,2,1,0,32685056,35044352,37403648,0,0
.long 18176,16640,15104,3,27648,40961921,3840,1920,25091072,19148800,29539328,40902272,1073741824,41147904,2249568,1073741824,2,1,0,32685056,35044352,37403648,0,0
.long 1536,0,3072,0,0,40960001,0,0,20971520,3112960,27521024,40895360,1073741824,41082880,258048,1073741824,1,0,2,33026048,35385344,37744640,0,0
.long 1792,256,3328,0,9216,40960129,256,0,21008384,6356992,27521024,40895360,41083392,41082880,258048,31072256,1,0,2,33026048,35385344,37744640,0,0
.long 2048,512,3584,0,18432,40960257,512,0,21045248,9601024,27521024,40895360,41083904,41082880,258048,31477760,1,0,2,33026048,35385344,37744640,0,0
.long 2304,768,3840,0,27648,40960385,768,0,21082112,12845056,27521024,40895360,41084416,41082880,258048,31883264,1,0,2,33026048,35385344,37744640,0,0
.long 4096,2560,1024,0,0,40960005,0,384,20971520,16384000,29179904,40901120,1073741824,41148416,1916928,1073741824,2,1,0,34684928,37044224,39403520,0,0
.long 4096,2560,1024,0,9216,40960133,256,384,21008384,16678912,29179904,40901120,41148928,41148416,1916928,32362496,2,1,0,34684928,37044224,39403520,0,0
.long 4352,2816,1280,0,18432,40960261,512,384,21045248,19333120,29179904,40901120,41149440,41148416,1916928,32694272,2,1,0,34684928,37044224,39403520,0,0
.long 4352,2816,1280,0,27648,40960389,768,384,21082112,19628032,29179904,40901120,41149952,41148416,1916928,32731136,2,1,0,34684928,37044224,39403520,0,0
.long 6144,4608,7680,1,0,40960512,1024,128,22298624,3149824,27926528,40896768,41083008,41083392,663552,33026048,1,0,2,35790848,38150144,31072256,0,0
.long 6400,4864,7936,1,9216,40960640,1280,128,22335488,6393856,27926528,40896768,1073741824,41083392,663552,1073741824,1,0,2,35790848,38150144,31072256,0,0
.long 6656,5120,8192,1,18432,40960768,1536,128,22372352,9637888,27926528,40896768,41084032,41083392,663552,33837056,1,0,2,35790848,38150144,31072256,0,0
.long 6912,5376,8448,1,27648,40960896,1792,128,22409216,12881920,27926528,40896768,41084544,41083392,663552,34242560,1,0,2,35790848,38150144,31072256,0,0
.long 8704,7168,5632,1,0,40960516,1024,384,22298624,16420864,29216768,40901248,41148544,41148928,1953792,34684928,2,1,0,37081088,39440384,32362496,0,0
.long 8704,7168,5632,1,9216,40960644,1280,384,22335488,16715776,29216768,40901248,1073741824,41148928,1953792,1073741824,2,1,0,37081088,39440384,32362496,0,0
.long 8960,7424,5888,1,18432,40960772,1536,384,22372352,19369984,29216768,40901248,41149568,41148928,1953792,35053568,2,1,0,37081088,39440384,32362496,0,0
.long 8960,7424,5888,1,27648,40960900,1792,384,22409216,19664896,29216768,40901248,41150080,41148928,1953792,35090432,2,1,0,37081088,39440384,32362496,0,0
.long 10752,9216,12288,2,0,40960520,2048,128,23625728,3186688,28332032,40898176,41083136,41083904,1069056,35385344,1,0,2,38555648,31477760,33837056,0,0
.long 11008,9472,12544,2,9216,40960648,2304,128,23662592,6430720,28332032,40898176,41083648,41083904,1069056,35790848,1,0,2,38555648,31477760,33837056,0,0
.long 11264,9728,12800,2,18432,40960776,2560,128,23699456,9674752,28332032,40898176,1073741824,41083904,1069056,1073741824,1,0,2,38555648,31477760,33837056,0,0
.long 11520,9984,13056,2,27648,40960904,2816,128,23736320,12918784,28332032,40898176,41084672,41083904,1069056,36601856,1,0,2,38555648,31477760,33837056,0,0
.long 13312,11776,10240,2,0,40961027,2048,384,23625728,16457728,29548544,40902400,41148672,41149440,2285568,37044224,2,1,0,39772160,32694272,35053568,0,0
.long 13312,11776,10240,2,9216,40961155,2304,384,23662592,16752640,29548544,40902400,41149184,41149440,2285568,37081088,2,1,0,39772160,32694272,35053568,0,0
.long 13568,12032,10496,2,18432,40961283,2560,384,23699456,19406848,29548544,40902400,1073741824,41149440,2285568,1073741824,2,1,0,39772160,32694272,35053568,0,0
.long 13568,12032,10496,2,27648,40961411,2816,384,23736320,19701760,29548544,40902400,41150208,41149440,2285568,37449728,2,1,0,39772160,32694272,35053568,0,0
.long 15360,13824,16896,3,0,40961031,3072,256,24952832,3223552,28737536,40899584,41083264,41084416,1474560,37744640,1,0,2,31883264,34242560,36601856,0,0
.long 15616,14080,17152,3,9216,40961159,3328,256,24989696,6467584,28737536,40899584,41083776,41084416,1474560,38150144,1,0,2,31883264,34242560,36601856,0,0
.long 15872,14336,17408,3,18432,40961287,3584,256,25026560,9711616,28737536,40899584,41084288,41084416,1474560,38555648,1,0,2,31883264,34242560,36601856,0,0
.long 16128,14592,17664,3,27648,40961415,3840,256,25063424,12955648,28737536,40899584,1073741824,41084416,1474560,1073741824,1,0,2,31883264,34242560,36601856,0,0
.long 17920,16384,14848,3,0,40961538,3072,384,24952832,16494592,29585408,40902528,41148800,41149952,2322432,39403520,2,1,0,32731136,35090432,37449728,0,0
.long 17920,16384,14848,3,9216,40961666,3328,384,24989696,16789504,29585408,40902528,41149312,41149952,2322432,39440384,2,1,0,32731136,35090432,37449728,0,0
.long 18176,16640,15104,3,18432,40961794,3584,384,25026560,19443712,29585408,40902528,41149824,41149952,2322432,39772160,2,1,0,32731136,35090432,37449728,0,0
.long 18176,16640,15104,3,27648,40961922,3840,384,25063424,19738624,29585408,40902528,1073741824,41149952,2322432,1073741824,2,1,0,32731136,35090432,37449728,0,0
.long 1536,0,3072,0,0,40960002,0,512,20980736,3112960,27530240,40895360,1073741824,41084928,258336,1073741824,1,0,2,33035264,35394560,37753856,0,0
.long 1792,256,3328,0,9216,40960130,256,512,21017600,6356992,27530240,40895360,41085440,41084928,258336,31081472,1,0,2,33035264,35394560,37753856,0,0
.long 2048,512,3584,0,18432,40960258,512,512,21054464,9601024,27530240,40895360,41085952,41084928,258336,31486976,1,0,2,33035264,35394560,37753856,0,0
.long 2304,768,3840,0,27648,40960386,768,512,21091328,12845056,27530240,40895360,41086464,41084928,258336,31892480,1,0,2,33035264,35394560,37753856,0,0
.long 4096,2560,1024,0,0,40960006,0,896,20980736,16384000,29189120,40901120,1073741824,41150464,1917216,1073741824,2,1,0,34694144,37053440,39412736,0,0
.long 4096,2560,1024,0,9216,40960134,256,896,21017600,16678912,29189120,40901120,41150976,41150464,1917216,32371712,2,1,0,34694144,37053440,39412736,0,0
.long 4352,2816,1280,0,18432,40960262,512,896,21054464,19333120,29189120,40901120,41151488,41150464,1917216,32703488,2,1,0,34694144,37053440,39412736,0,0
.long 4352,2816,1280,0,27648,40960390,768,896,21091328,19628032,29189120,40901120,41152000,41150464,1917216,32740352,2,1,0,34694144,37053440,39412736,0,0
.long 6144,4608,7680,1,0,40960513,1024,640,22307840,3149824,27935744,40896768,41085056,41085440,663840,33035264,1,0,2,35800064,38159360,31081472,0,0
.long 6400,4864,7936,1,9216,40960641,1280,640,22344704,6393856,27935744,40896768,1073741824,41085440,663840,1073741824,1,0,2,35800064,38159360,31081472,0,0
.long 6656,5120,8192,1,18432,40960769,1536,640,22381568,9637888,27935744,40896768,41086080,41085440,663840,33846272,1,0,2,35800064,38159360,31081472,0,0
.long 6912,5376,8448,1,27648,40960897,1792,640,22418432,12881920,27935744,40896768,41086592,41085440,663840,34251776,1,0,2,35800064,38159360,31081472,0,0
.long 8704,7168,5632,1,0,40960517,1024,896,22307840,16420864,29225984,40901248,41150592,41150976,1954080,34694144,2,1,0,37090304,39449600,32371712,0,0
.long 8704,7168,5632,1,9216,40960645,1280,896,22344704,16715776,29225984,40901248,1073741824,41150976,1954080,1073741824,2,1,0,37090304,39449600,32371712,0,0
.long 8960,7424,5888,1,18432,40960773,1536,896,22381568,19369984,29225984,40901248,41151616,41150976,1954080,35062784,2,1,0,37090304,39449600,32371712,0,0
.long 8960,7424,5888,1,27648,40960901,1792,896,22418432,19664896,29225984,40901248,41152128,41150976,1954080,35099648,2,1,0,37090304,39449600,32371712,0,0
.long 10752,9216,12288,2,0,40961024,2048,640,23634944,3186688,28341248,40898176,41085184,41085952,1069344,35394560,1,0,2,38564864,31486976,33846272,0,0
.long 11008,9472,12544,2,9216,40961152,2304,640,23671808,6430720,28341248,40898176,41085696,41085952,1069344,35800064,1,0,2,38564864,31486976,33846272,0,0
.long 11264,9728,12800,2,18432,40961280,2560,640,23708672,9674752,28341248,40898176,1073741824,41085952,1069344,1073741824,1,0,2,38564864,31486976,33846272,0,0
.long 11520,9984,13056,2,27648,40961408,2816,640,23745536,12918784,28341248,40898176,41086720,41085952,1069344,36611072,1,0,2,38564864,31486976,33846272,0,0
.long 13312,11776,10240,2,0,40961028,2048,896,23634944,16457728,29557760,40902400,41150720,41151488,2285856,37053440,2,1,0,39781376,32703488,35062784,0,0
.long 13312,11776,10240,2,9216,40961156,2304,896,23671808,16752640,29557760,40902400,41151232,41151488,2285856,37090304,2,1,0,39781376,32703488,35062784,0,0
.long 13568,12032,10496,2,18432,40961284,2560,896,23708672,19406848,29557760,40902400,1073741824,41151488,2285856,1073741824,2,1,0,39781376,32703488,35062784,0,0
.long 13568,12032,10496,2,27648,40961412,2816,896,23745536,19701760,29557760,40902400,41152256,41151488,2285856,37458944,2,1,0,39781376,32703488,35062784,0,0
.long 15360,13824,16896,3,0,40961032,3072,768,24962048,3223552,28746752,40899584,41085312,41086464,1474848,37753856,1,0,2,31892480,34251776,36611072,0,0
.long 15616,14080,17152,3,9216,40961160,3328,768,24998912,6467584,28746752,40899584,41085824,41086464,1474848,38159360,1,0,2,31892480,34251776,36611072,0,0
.long 15872,14336,17408,3,18432,40961288,3584,768,25035776,9711616,28746752,40899584,41086336,41086464,1474848,38564864,1,0,2,31892480,34251776,36611072,0,0
.long 16128,14592,17664,3,27648,40961416,3840,768,25072640,12955648,28746752,40899584,1073741824,41086464,1474848,1073741824,1,0,2,31892480,34251776,36611072,0,0
.long 17920,16384,14848,3,0,40961539,3072,896,24962048,16494592,29594624,40902528,41150848,41152000,2322720,39412736,2,1,0,32740352,35099648,37458944,0,0
.long 17920,16384,14848,3,9216,40961667,3328,896,24998912,16789504,29594624,40902528,41151360,41152000,2322720,39449600,2,1,0,32740352,35099648,37458944,0,0
.long 18176,16640,15104,3,18432,40961795,3584,896,25035776,19443712,29594624,40902528,41151872,41152000,2322720,39781376,2,1,0,32740352,35099648,37458944,0,0
.long 18176,16640,15104,3,27648,40961923,3840,896,25072640,19738624,29594624,40902528,1073741824,41152000,2322720,1073741824,2,1,0,32740352,35099648,37458944,0,0
.long 1536,0,3072,0,0,40960003,0,1024,20989952,3112960,27539456,40895360,1073741824,41086976,258624,1073741824,1,0,2,33044480,35403776,37763072,0,0
.long 1792,256,3328,0,9216,40960131,256,1024,21026816,6356992,27539456,40895360,41087488,41086976,258624,31090688,1,0,2,33044480,35403776,37763072,0,0
.long 2048,512,3584,0,18432,40960259,512,1024,21063680,9601024,27539456,40895360,41088000,41086976,258624,31496192,1,0,2,33044480,35403776,37763072,0,0
.long 2304,768,3840,0,27648,40960387,768,1024,21100544,12845056,27539456,40895360,41088512,41086976,258624,31901696,1,0,2,33044480,35403776,37763072,0,0
.long 4096,2560,1024,0,0,40960007,0,1408,20989952,16384000,29198336,40901120,1073741824,41152512,1917504,1073741824,2,1,0,34703360,37062656,39421952,0,0
.long 4096,2560,1024,0,9216,40960135,256,1408,21026816,16678912,29198336,40901120,41153024,41152512,1917504,32380928,2,1,0,34703360,37062656,39421952,0,0
.long 4352,2816,1280,0,18432,40960263,512,1408,21063680,19333120,29198336,40901120,41153536,41152512,1917504,32712704,2,1,0,34703360,37062656,39421952,0,0
.long 4352,2816,1280,0,27648,40960391,768,1408,21100544,19628032,29198336,40901120,41154048,41152512,1917504,32749568,2,1,0,34703360,37062656,39421952,0,0
.long 6144,4608,7680,1,0,40960514,1024,1152,22317056,3149824,27944960,40896768,41087104,41087488,664128,33044480,1,0,2,35809280,38168576,31090688,0,0
.long 6400,4864,7936,1,9216,40960642,1280,1152,22353920,6393856,27944960,40896768,1073741824,41087488,664128,1073741824,1,0,2,35809280,38168576,31090688,0,0
.long 6656,5120,8192,1,18432,40960770,1536,1152,22390784,9637888,27944960,40896768,41088128,41087488,664128,33855488,1,0,2,35809280,38168576,31090688,0,0
.long 6912,5376,8448,1,27648,40960898,1792,1152,22427648,12881920,27944960,40896768,41088640,41087488,664128,34260992,1,0,2,35809280,38168576,31090688,0,0
.long 8704,7168,5632,1,0,40960518,1024,1408,22317056,16420864,29235200,40901248,41152640,41153024,1954368,34703360,2,1,0,37099520,39458816,32380928,0,0
.long 8704,7168,5632,1,9216,40960646,1280,1408,22353920,16715776,29235200,40901248,1073741824,41153024,1954368,1073741824,2,1,0,37099520,39458816,32380928,0,0
.long 8960,7424,5888,1,18432,40960774,1536,1408,22390784,19369984,29235200,40901248,41153664,41153024,1954368,35072000,2,1,0,37099520,39458816,32380928,0,0
.long 8960,7424,5888,1,27648,40960902,1792,1408,22427648,19664896,29235200,40901248,41154176,41153024,1954368,35108864,2,1,0,37099520,39458816,32380928,0,0
.long 10752,9216,12288,2,0,40961025,2048,1152,23644160,3186688,28350464,40898176,41087232,41088000,1069632,35403776,1,0,2,38574080,31496192,33855488,0,0
.long 11008,9472,12544,2,9216,40961153,2304,1152,23681024,6430720,28350464,40898176,41087744,41088000,1069632,35809280,1,0,2,38574080,31496192,33855488,0,0
.long 11264,9728,12800,2,18432,40961281,2560,1152,23717888,9674752,28350464,40898176,1073741824,41088000,1069632,1073741824,1,0,2,38574080,31496192,33855488,0,0
.long 11520,9984,13056,2,27648,40961409,2816,1152,23754752,12918784,28350464,40898176,41088768,41088000,1069632,36620288,1,0,2,38574080,31496192,33855488,0,0
.long 13312,11776,10240,2,0,40961029,2048,1408,23644160,16457728,29566976,40902400,41152768,41153536,2286144,37062656,2,1,0,39790592,32712704,35072000,0,0
.long 13312,11776,10240,2,9216,40961157,2304,1408,23681024,16752640,29566976,40902400,41153280,41153536,2286144,37099520,2,1,0,39790592,32712704,35072000,0,0
.long 13568,12032,10496,2,18432,40961285,2560,1408,23717888,19406848,29566976,40902400,1073741824,41153536,2286144,1073741824,2,1,0,39790592,32712704,35072000,0,0
.long 13568,12032,10496,2,27648,40961413,2816,1408,23754752,19701760,29566976,40902400,41154304,41153536,2286144,37468160,2,1,0,39790592,32712704,35072000,0,0
.long 15360,13824,16896,3,0,40961536,3072,1280,24971264,3223552,28755968,40899584,41087360,41088512,1475136,37763072,1,0,2,31901696,34260992,36620288,0,0
.long 15616,14080,17152,3,9216,40961664,3328,1280,25008128,6467584,28755968,40899584,41087872,41088512,1475136,38168576,1,0,2,31901696,34260992,36620288,0,0
.long 15872,14336,17408,3,18432,40961792,3584,1280,25044992,9711616,28755968,40899584,41088384,41088512,1475136,38574080,1,0,2,31901696,34260992,36620288,0,0
.long 16128,14592,17664,3,27648,40961920,3840,1280,25081856,12955648,28755968,40899584,1073741824,41088512,1475136,1073741824,1,0,2,31901696,34260992,36620288,0,0
.long 17920,16384,14848,3,0,40961540,3072,1408,24971264,16494592,29603840,40902528,41152896,41154048,2323008,39421952,2,1,0,32749568,35108864,37468160,0,0
.long 17920,16384,14848,3,9216,40961668,3328,1408,25008128,16789504,29603840,40902528,41153408,41154048,2323008,39458816,2,1,0,32749568,35108864,37468160,0,0
.long 18176,16640,15104,3,18432,40961796,3584,1408,25044992,19443712,29603840,40902528,41153920,41154048,2323008,39790592,2,1,0,32749568,35108864,37468160,0,0
.long 18176,16640,15104,3,27648,40961924,3840,1408,25081856,19738624,29603840,40902528,1073741824,41154048,2323008,1073741824,2,1,0,32749568,35108864,37468160,0,0
.long 1536,0,3072,0,0,40961541,0,1536,20999168,3112960,27548672,40895360,1073741824,41089024,258912,1073741824,1,0,2,33053696,35412992,37772288,0,0
.long 1792,256,3328,0,9216,40961669,256,1536,21036032,6356992,27548672,40895360,41089536,41089024,258912,31099904,1,0,2,33053696,35412992,37772288,0,0
.long 2048,512,3584,0,18432,40961797,512,1536,21072896,9601024,27548672,40895360,41090048,41089024,258912,31505408,1,0,2,33053696,35412992,37772288,0,0
.long 2304,768,3840,0,27648,40961925,768,1536,21109760,12845056,27548672,40895360,41090560,41089024,258912,31910912,1,0,2,33053696,35412992,37772288,0,0
.long 4096,2560,1024,0,0,40961542,0,1920,20999168,16384000,29207552,40901120,1073741824,41154560,1917792,1073741824,2,1,0,34712576,37071872,39431168,0,0
.long 4096,2560,1024,0,9216,40961670,256,1920,21036032,16678912,29207552,40901120,41155072,41154560,1917792,32390144,2,1,0,34712576,37071872,39431168,0,0
.long 4352,2816,1280,0,18432,40961798,512,1920,21072896,19333120,29207552,40901120,41155584,41154560,1917792,32721920,2,1,0,34712576,37071872,39431168,0,0
.long 4352,2816,1280,0,27648,40961926,768,1920,21109760,19628032,29207552,40901120,41156096,41154560,1917792,32758784,2,1,0,34712576,37071872,39431168,0,0
.long 6144,4608,7680,1,0,40961543,1024,1664,22326272,3149824,27954176,40896768,41089152,41089536,664416,33053696,1,0,2,35818496,38177792,31099904,0,0
.long 6400,4864,7936,1,9216,40961671,1280,1664,22363136,6393856,27954176,40896768,1073741824,41089536,664416,1073741824,1,0,2,35818496,38177792,31099904,0,0
.long 6656,5120,8192,1,18432,40961799,1536,1664,22400000,9637888,27954176,40896768,41090176,41089536,664416,33864704,1,0,2,35818496,38177792,31099904,0,0
.long 6912,5376,8448,1,27648,40961927,1792,1664,22436864,12881920,27954176,40896768,41090688,41089536,664416,34270208,1,0,2,35818496,38177792,31099904,0,0
.long 8704,7168,5632,1,0,40961544,1024,1920,22326272,16420864,29244416,40901248,41154688,41155072,1954656,34712576,2,1,0,37108736,39468032,32390144,0,0
.long 8704,7168,5632,1,9216,40961672,1280,1920,22363136,16715776,29244416,40901248,1073741824,41155072,1954656,1073741824,2,1,0,37108736,39468032,32390144,0,0
.long 8960,7424,5888,1,18432,40961800,1536,1920,22400000,19369984,29244416,40901248,41155712,41155072,1954656,35081216,2,1,0,37108736,39468032,32390144,0,0
.long 8960,7424,5888,1,27648,40961928,1792,1920,22436864,19664896,29244416,40901248,41156224,41155072,1954656,35118080,2,1,0,37108736,39468032,32390144,0,0
.size L_table, 13824
.section .rodata,"a"
.p2align 6
.amdhsa_kernel gated_mix__ssm_conv_s4d__swiglu_ffn__prompt_kernel
  .amdhsa_next_free_vgpr 512
  .amdhsa_next_free_sgpr 102
  .amdhsa_accum_offset 256
  .amdhsa_group_segment_fixed_size 0
  .amdhsa_kernarg_size 120
  .amdhsa_user_sgpr_count 2
  .amdhsa_user_sgpr_kernarg_segment_ptr 1
  .amdhsa_system_sgpr_workgroup_id_x 1
  .amdhsa_float_denorm_mode_32 3
.end_amdhsa_kernel
```
